```python
import torch

def _softmax(x, axis=-1):
    return torch.softmax(x, dim=axis)
def _gelu(x):
    return torch.nn.functional.gelu(x, approximate="tanh")
def _silu(x):
    return torch.nn.functional.silu(x)
def _sigmoid(x):
    return torch.sigmoid(x)
def _layernorm(x, axis=-1, eps=1e-5):
    m = x.mean(dim=axis, keepdim=True)
    v = x.var(dim=axis, keepdim=True, unbiased=False)
    return (x - m) / torch.sqrt(v + eps)
def _scatter_add(tgt, idx, src, axis=0):
    return tgt.clone().index_add_(axis, idx, src)
def _segment_sum(src, seg, n):
    out = torch.zeros((n,) + src.shape[1:], dtype=src.dtype)
    return out.index_add_(0, seg, src)
def _pad(x, pw):
    flat = tuple(v for pair in reversed(pw) for v in pair)
    return torch.nn.functional.pad(x, flat)

kernel_name = 'standalone__gqa_softmax__near_ridge'

def setup_inputs():

    _w = (lambda a: (lambda t: t.to(torch.bfloat16) if t.is_floating_point() else t)(torch.as_tensor(a)))
    B, Hq, Hkv, Sq, Sk, D = 8, 32, 32, 768, 512, 192
    return {
        "q": _w((lambda *s: torch.randn(*s, dtype=torch.bfloat16) * 0.8)(B, Hq, Sq, D)),
        "k": _w((lambda *s: torch.randn(*s, dtype=torch.bfloat16) * 0.8)(B, Hkv, Sk, D)),
        "v": _w((lambda *s: torch.randn(*s, dtype=torch.bfloat16) * 0.05)(B, Hkv, Sk, D)),
    }

def reference(q, k, v):
    B, Hq, Sq, D = q.shape
    Hkv = k.shape[1]
    rep = Hq // Hkv
    k = (lambda x, n, axis: torch.repeat_interleave(x, n, dim=axis))(k, rep, axis=1)
    v = (lambda x, n, axis: torch.repeat_interleave(x, n, dim=axis))(v, rep, axis=1)
    scale = D ** -0.5
    scores = torch.einsum("bhqd,bhkd->bhqk", q, k) * scale
    p = _softmax(scores, axis=-1)
    return torch.einsum("bhqk,bhkd->bhqd", p, v)
```

```asm
; @launch grid=(256,1,1) block=(256,1,1) lds=159744
.amdgcn_target "amdgcn-amd-amdhsa--gfx950"
.text
.globl standalone__gqa_softmax__near_ridge_kernel
.p2align 8
.type standalone__gqa_softmax__near_ridge_kernel,@function
standalone__gqa_softmax__near_ridge_kernel:
    s_cmp_ge_u32 s2, 256
    s_cbranch_scc1 L_end
    s_load_dwordx4 s[4:7], s[0:1], 0
    s_load_dwordx4 s[8:11], s[0:1], 16
    s_getpc_b64 s[76:77]
L_pc:
    s_sub_u32 s76, s76, L_pc-standalone__gqa_softmax__near_ridge_kernel
    s_subb_u32 s77, s77, 0
    s_lshr_b32 s29, s2, 3
    s_mul_i32 s29, s29, 3072
    v_mul_u32_u24 v35, 12, v0
    v_add_u32 v35, s29, v35
    v_min_u32 v35, L_code_end-standalone__gqa_softmax__near_ridge_kernel-8, v35
    global_load_dwordx2 a[244:245], v35, s[76:77]
    v_lshrrev_b32 v39, 6, v0
    v_and_b32 v36, 63, v0
    v_readfirstlane_b32 s39, v39
    v_lshlrev_b32 v33, 4, v36
    s_and_b32 s28, s2, 7
    s_mul_i32 s28, s28, 96
    s_lshr_b32 s29, s2, 3
    s_add_u32 s28, s28, s29
    s_mov_b32 s38, 0x55555556
    s_mul_hi_u32 s30, s28, s38
    s_mul_i32 s30, s30, 196608
    s_mul_i32 s31, s28, 98304
    s_mov_b32 s47, 73728
    s_cmp_eq_u32 s39, 0
    s_cselect_b32 s47, 36864, s47
    s_cmp_eq_u32 s39, 2
    s_cselect_b32 s47, 86016, s47
    s_cmp_eq_u32 s39, 3
    s_cselect_b32 s47, 147456, s47
    s_mul_i32 s39, s39, 3072
    v_add_u32 v39, 0, v33
    v_lshrrev_b32 v34, 7, v39
    v_mul_u32_u24 v34, 171, v34
    v_lshrrev_b32 v11, 9, v34
    v_and_b32 v8, 6, v11
    v_lshlrev_b32 v8, 4, v8
    v_xor_b32 v8, v8, v33
    v_add_u32 v8, s39, v8
    v_add_u32 v39, 1024, v33
    v_lshrrev_b32 v34, 7, v39
    v_mul_u32_u24 v34, 171, v34
    v_lshrrev_b32 v12, 9, v34
    v_and_b32 v9, 6, v12
    v_lshlrev_b32 v9, 4, v9
    v_xor_b32 v9, v9, v33
    v_add_u32 v9, s39, v9
    v_add_u32 v39, 2048, v33
    v_lshrrev_b32 v34, 7, v39
    v_mul_u32_u24 v34, 171, v34
    v_lshrrev_b32 v13, 9, v34
    v_and_b32 v10, 6, v13
    v_lshlrev_b32 v10, 4, v10
    v_xor_b32 v10, v10, v33
    v_add_u32 v10, s39, v10
    s_lshl_b32 s46, s39, 2
    s_add_u32 s46, s46, 98304
    s_mul_i32 s29, s39, 7
    s_add_u32 s88, s46, 0
    s_add_u32 s80, s29, 0
    s_add_u32 s84, s29, 12288
    s_add_u32 s89, s46, 3072
    s_add_u32 s81, s29, 3072
    s_add_u32 s85, s29, 15360
    s_add_u32 s90, s46, 6144
    s_add_u32 s82, s29, 6144
    s_add_u32 s86, s29, 18432
    s_add_u32 s91, s46, 9216
    s_add_u32 s83, s29, 9216
    s_add_u32 s87, s29, 21504
    s_waitcnt lgkmcnt(0)
    s_mov_b32 m0, s39
    s_add_u32 s12, s6, s30
    s_addc_u32 s13, s7, 0
    s_mov_b32 s14, 196608
    s_mov_b32 s15, 0x00020000
    buffer_load_dwordx4 v8, s[12:15], 0 offen nt lds
    buffer_load_dwordx4 v9, s[12:15], 0 offen offset:1024 nt lds
    buffer_load_dwordx4 v10, s[12:15], 0 offen offset:2048 nt lds
    s_add_u32 s20, s4, s31
    s_addc_u32 s21, s5, 0
    s_mov_b32 s22, 98304
    s_mov_b32 s23, 0x00020000
    s_mov_b32 m0, s88
    s_nop 0
    buffer_load_dwordx4 v8, s[20:23], s80 offen nt lds
    buffer_load_dwordx4 v9, s[20:23], s80 offen offset:1024 nt lds
    buffer_load_dwordx4 v10, s[20:23], s80 offen offset:2048 nt lds
    s_mov_b32 m0, s89
    s_nop 0
    buffer_load_dwordx4 v8, s[20:23], s81 offen nt lds
    buffer_load_dwordx4 v9, s[20:23], s81 offen offset:1024 nt lds
    buffer_load_dwordx4 v10, s[20:23], s81 offen offset:2048 nt lds
    s_mov_b32 m0, s90
    s_nop 0
    buffer_load_dwordx4 v8, s[20:23], s82 offen nt lds
    buffer_load_dwordx4 v9, s[20:23], s82 offen offset:1024 nt lds
    buffer_load_dwordx4 v10, s[20:23], s82 offen offset:2048 nt lds
    s_mov_b32 m0, s91
    s_nop 0
    buffer_load_dwordx4 v8, s[20:23], s83 offen nt lds
    buffer_load_dwordx4 v9, s[20:23], s83 offen offset:1024 nt lds
    buffer_load_dwordx4 v10, s[20:23], s83 offen offset:2048 nt lds
    s_add_u32 s16, s8, s30
    s_addc_u32 s17, s9, 0
    s_mov_b32 s18, 196608
    s_mov_b32 s19, 0x00020000
    s_add_u32 s42, s39, 0
    s_add_u32 s48, s39, 49152
    s_add_u32 s43, s39, 12288
    s_add_u32 s49, s39, 61440
    s_add_u32 s44, s39, 24576
    s_add_u32 s50, s39, 73728
    s_add_u32 s45, s39, 36864
    s_add_u32 s51, s39, 86016
    s_mov_b32 s52, 12288
    s_mov_b32 s53, 24576
    s_mov_b32 s54, 36864
    s_mov_b32 s55, 49152
    s_mov_b32 s56, 61440
    s_mov_b32 s57, 73728
    s_mov_b32 s58, 86016
    s_mov_b32 s59, 98304
    s_mov_b32 s60, 110592
    s_mov_b32 s61, 122880
    s_mov_b32 s62, 135168
    s_mov_b32 s63, 147456
    s_mov_b32 s64, 159744
    s_mov_b32 s65, 172032
    s_mov_b32 s66, 184320
    s_mov_b32 m0, s43
    s_nop 0
    buffer_load_dwordx4 v8, s[12:15], s52 offen nt lds
    buffer_load_dwordx4 v9, s[12:15], s52 offen offset:1024 nt lds
    buffer_load_dwordx4 v10, s[12:15], s52 offen offset:2048 nt lds
    s_mov_b32 m0, s48
    s_nop 0
    buffer_load_dwordx4 v8, s[16:19], 0 offen nt lds
    buffer_load_dwordx4 v9, s[16:19], 0 offen offset:1024 nt lds
    buffer_load_dwordx4 v10, s[16:19], 0 offen offset:2048 nt lds
    s_add_u32 m0, s47, 0
    s_nop 0
    buffer_load_dwordx4 v8, s[20:23], s84 offen nt lds
    buffer_load_dwordx4 v9, s[20:23], s84 offen offset:1024 nt lds
    buffer_load_dwordx4 v10, s[20:23], s84 offen offset:2048 nt lds
    s_add_u32 m0, s47, 3072
    s_nop 0
    buffer_load_dwordx4 v8, s[20:23], s85 offen nt lds
    buffer_load_dwordx4 v9, s[20:23], s85 offen offset:1024 nt lds
    buffer_load_dwordx4 v10, s[20:23], s85 offen offset:2048 nt lds
    s_mov_b32 s24, s10
    s_mov_b32 s25, s11
    s_mov_b32 s26, 0
    s_mov_b32 s27, 0x00020000
    s_mov_b32 s96, s10
    s_mov_b32 s97, s11
    s_mov_b32 s98, 0
    s_mov_b32 s99, 0x00020000
    s_mov_b32 s34, 0
    s_mov_b32 s35, 0x3dd53b95
    s_mov_b32 s36, 0xbdd53b95
    s_mov_b32 s37, 0x45800000
    s_lshr_b32 s92, s2, 3
    s_and_b32 s92, s92, 15
    s_lshl_b32 s92, s92, 12
    s_mul_hi_u32 s29, s39, s38
    s_add_u32 s92, s92, s29
    s_add_u32 s92, s92, L_loop-standalone__gqa_softmax__near_ridge_kernel
    s_min_u32 s92, s92, L_code_end-standalone__gqa_softmax__near_ridge_kernel-1024
    s_add_u32 s74, s76, s92
    s_addc_u32 s75, s77, 0
    s_sub_u32 s74, s74, s46
    s_subb_u32 s75, s75, 0
    v_lshlrev_b32 v11, 4, v11
    v_xor_b32 v11, v11, v33
    v_add_u32 v11, s39, v11
    v_lshlrev_b32 v12, 4, v12
    v_xor_b32 v12, v12, v33
    v_add_u32 v12, s39, v12
    v_lshlrev_b32 v13, 4, v13
    v_xor_b32 v13, v13, v33
    v_add_u32 v13, s39, v13
    v_add_u32 v1, s46, v33
    v_and_b32 v37, 15, v36
    v_lshrrev_b32 v38, 4, v36
    v_mul_u32_u24 v39, 384, v37
    v_and_b32 v33, 6, v37
    v_xor_b32 v33, v33, v38
    v_lshl_add_u32 v2, v33, 4, v39
    v_xor_b32 v3, 64, v2
    v_add_u32 v14, s46, v2
    v_add_u32 v208, s47, v2
    v_add_u32 v15, s46, v3
    v_add_u32 v209, s47, v3
    v_lshrrev_b32 v33, 1, v38
    v_and_b32 v34, 7, v37
    v_xor_b32 v33, v33, v34
    v_lshl_add_u32 v32, v33, 4, v39
    v_and_b32 v33, 1, v38
    v_lshl_add_u32 v32, v33, 3, v32
    v_add_u32 v32, s46, v32
    v_lshrrev_b32 v33, 2, v36
    v_mul_u32_u24 v39, 384, v33
    v_and_b32 v33, 6, v33
    v_lshl_add_u32 v39, v33, 4, v39
    v_and_b32 v33, 3, v36
    v_lshl_add_u32 v39, v33, 3, v39
    v_add_u32 v4, 49152, v39
    v_xor_b32 v5, 32, v4
    v_xor_b32 v6, 64, v4
    v_xor_b32 v7, 96, v4
    s_mov_b32 s92, 0x3f803f80
    v_mov_b32 v39, s92
    v_cmp_eq_u32 vcc, 0, v37
    v_cmp_eq_u32 s[40:41], 2, v37
    s_nop 0
    s_or_b64 vcc, vcc, s[40:41]
    s_nop 1
    v_cndmask_b32 v33, 0, v39, vcc
    v_accvgpr_write_b32 a248, v33
    v_accvgpr_write_b32 a249, v33
    v_accvgpr_write_b32 a250, v33
    v_accvgpr_write_b32 a251, v33
    v_cmp_eq_u32 vcc, 1, v37
    v_cmp_eq_u32 s[40:41], 2, v37
    s_nop 0
    s_or_b64 vcc, vcc, s[40:41]
    s_nop 1
    v_cndmask_b32 v33, 0, v39, vcc
    v_accvgpr_write_b32 a252, v33
    v_accvgpr_write_b32 a253, v33
    v_accvgpr_write_b32 a254, v33
    v_accvgpr_write_b32 a255, v33
    s_mov_b64 exec, 0
    s_cmp_eq_u32 s39, 0
    s_cbranch_scc1 L_hop_0
    s_cmp_eq_u32 s39, 3072
    s_cbranch_scc1 L_hop_1
    s_cmp_eq_u32 s39, 6144
    s_cbranch_scc1 L_hop_2
    s_branch L_hop_3
L_hop_end:
    s_mov_b64 exec, -1
    s_nop 3
    s_branch L_main
.p2align 12
L_main:
    s_waitcnt vmcnt(12)
    s_barrier
    ds_read_b128 a[192:195], v2 offset:0
    ds_read_b128 a[196:199], v3 offset:0
    ds_read_b128 a[200:203], v2 offset:128
    ds_read_b128 a[204:207], v3 offset:128
    ds_read_b128 a[208:211], v2 offset:256
    ds_read_b128 a[212:215], v3 offset:256
    ds_read_b128 a[96:99], v14 offset:0
    ds_read_b128 a[120:123], v14 offset:6144
    ds_read_b128 a[100:103], v15 offset:0
    ds_read_b128 a[124:127], v15 offset:6144
    ds_read_b128 a[104:107], v14 offset:128
    ds_read_b128 a[128:131], v14 offset:6272
    ds_read_b128 a[108:111], v15 offset:128
    ds_read_b128 a[132:135], v15 offset:6272
    ds_read_b128 a[112:115], v14 offset:256
    ds_read_b128 a[136:139], v14 offset:6400
    ds_read_b128 a[116:119], v15 offset:256
    ds_read_b128 a[140:143], v15 offset:6400
    s_waitcnt lgkmcnt(8)
    v_mfma_f32_16x16x32_bf16 v[96:99], a[192:195], a[96:99], 0
    s_mov_b32 m0, s44
    v_mfma_f32_16x16x32_bf16 v[104:107], a[192:195], a[120:123], 0
    ds_read_b128 a[192:195], v2 offset:6144
    buffer_load_dwordx4 v8, s[12:15], s53 offen nt lds
    v_mfma_f32_16x16x32_bf16 v[96:99], a[196:199], a[100:103], v[96:99]
    s_waitcnt lgkmcnt(1)
    buffer_load_dwordx4 v9, s[12:15], s53 offen offset:1024 nt lds
    v_mfma_f32_16x16x32_bf16 v[104:107], a[196:199], a[124:127], v[104:107]
    ds_read_b128 a[196:199], v3 offset:6144
    buffer_load_dwordx4 v10, s[12:15], s53 offen offset:2048 nt lds
    v_mfma_f32_16x16x32_bf16 v[96:99], a[200:203], a[104:107], v[96:99]
    s_mov_b32 m0, s49
    v_mfma_f32_16x16x32_bf16 v[104:107], a[200:203], a[128:131], v[104:107]
    ds_read_b128 a[200:203], v2 offset:6272
    buffer_load_dwordx4 v8, s[16:19], s52 offen nt lds
    v_mfma_f32_16x16x32_bf16 v[96:99], a[204:207], a[108:111], v[96:99]
    buffer_load_dwordx4 v9, s[16:19], s52 offen offset:1024 nt lds
    v_mfma_f32_16x16x32_bf16 v[104:107], a[204:207], a[132:135], v[104:107]
    ds_read_b128 a[204:207], v3 offset:6272
    buffer_load_dwordx4 v10, s[16:19], s52 offen offset:2048 nt lds
    v_mfma_f32_16x16x32_bf16 v[96:99], a[208:211], a[112:115], v[96:99]
    v_mfma_f32_16x16x32_bf16 v[104:107], a[208:211], a[136:139], v[104:107]
    ds_read_b128 a[208:211], v2 offset:6400
    v_mfma_f32_16x16x32_bf16 v[96:99], a[212:215], a[116:119], v[96:99]
    v_mfma_f32_16x16x32_bf16 v[104:107], a[212:215], a[140:143], v[104:107]
    ds_read_b128 a[212:215], v3 offset:6400
    s_waitcnt lgkmcnt(3)
    v_mfma_f32_16x16x32_bf16 v[100:103], a[192:195], a[96:99], 0
    s_waitcnt vmcnt(12)
    s_barrier
    v_mfma_f32_16x16x32_bf16 v[108:111], a[192:195], a[120:123], 0
    ds_read_b128 a[192:195], v2 offset:12288
    v_mfma_f32_16x16x32_bf16 v[100:103], a[196:199], a[100:103], v[100:103]
    s_add_u32 m0, s47, 6144
    v_mfma_f32_16x16x32_bf16 v[108:111], a[196:199], a[124:127], v[108:111]
    ds_read_b128 a[196:199], v3 offset:12288
    buffer_load_dwordx4 v8, s[20:23], s86 offen nt lds
    v_mfma_f32_16x16x32_bf16 v[100:103], a[200:203], a[104:107], v[100:103]
    buffer_load_dwordx4 v9, s[20:23], s86 offen offset:1024 nt lds
    v_mfma_f32_16x16x32_bf16 v[108:111], a[200:203], a[128:131], v[108:111]
    ds_read_b128 a[200:203], v2 offset:12416
    s_waitcnt lgkmcnt(3)
    buffer_load_dwordx4 v10, s[20:23], s86 offen offset:2048 nt lds
    v_mfma_f32_16x16x32_bf16 v[100:103], a[204:207], a[108:111], v[100:103]
    s_add_u32 m0, s47, 9216
    v_mfma_f32_16x16x32_bf16 v[108:111], a[204:207], a[132:135], v[108:111]
    ds_read_b128 a[204:207], v3 offset:12416
    buffer_load_dwordx4 v8, s[20:23], s87 offen nt lds
    v_mfma_f32_16x16x32_bf16 v[100:103], a[208:211], a[112:115], v[100:103]
    buffer_load_dwordx4 v9, s[20:23], s87 offen offset:1024 nt lds
    v_mfma_f32_16x16x32_bf16 v[108:111], a[208:211], a[136:139], v[108:111]
    ds_read_b128 a[208:211], v2 offset:12544
    buffer_load_dwordx4 v10, s[20:23], s87 offen offset:2048 nt lds
    v_mfma_f32_16x16x32_bf16 v[100:103], a[212:215], a[116:119], v[100:103]
    v_mfma_f32_16x16x32_bf16 v[108:111], a[212:215], a[140:143], v[108:111]
    ds_read_b128 a[212:215], v3 offset:12544
    s_waitcnt lgkmcnt(3)
    v_mfma_f32_16x16x32_bf16 v[64:67], a[192:195], a[96:99], 0
    v_mfma_f32_16x16x32_bf16 v[72:75], a[192:195], a[120:123], 0
    ds_read_b128 a[192:195], v2 offset:18432
    v_mfma_f32_16x16x32_bf16 v[64:67], a[196:199], a[100:103], v[64:67]
    v_mfma_f32_16x16x32_bf16 v[72:75], a[196:199], a[124:127], v[72:75]
    ds_read_b128 a[196:199], v3 offset:18432
    v_max3_f32 v33, v96, v97, v98
    v_max3_f32 v34, v104, v105, v106
    v_max3_f32 v33, v33, v99, v100
    v_max3_f32 v34, v34, v107, v108
    v_max3_f32 v33, v33, v101, v102
    v_max3_f32 v34, v34, v109, v110
    v_mfma_f32_16x16x32_bf16 v[64:67], a[200:203], a[104:107], v[64:67]
    v_max_f32 v33, v33, v103
    v_max_f32 v34, v34, v111
    v_mfma_f32_16x16x32_bf16 v[72:75], a[200:203], a[128:131], v[72:75]
    ds_read_b128 a[200:203], v2 offset:18560
    s_waitcnt lgkmcnt(3)
    v_permlane32_swap_b32 v33, v34
    v_max_f32 v33, v33, v34
    v_mov_b32 v34, v33
    v_mfma_f32_16x16x32_bf16 v[64:67], a[204:207], a[108:111], v[64:67]
    v_mfma_f32_16x16x32_bf16 v[72:75], a[204:207], a[132:135], v[72:75]
    ds_read_b128 a[204:207], v3 offset:18560
    v_permlane16_swap_b32 v33, v34
    v_max_f32 v33, v33, v34
    v_mul_f32 v24, s36, v33
    v_mul_f32 v25, s36, v33
    v_mfma_f32_16x16x32_bf16 v[64:67], a[208:211], a[112:115], v[64:67]
    v_mfma_f32_16x16x32_bf16 v[72:75], a[208:211], a[136:139], v[72:75]
    ds_read_b128 a[208:211], v2 offset:18688
    v_permlane32_swap_b32 v24, v25
    v_fma_f32 v36, v96, s35, v24
    v_fma_f32 v37, v97, s35, v24
    v_exp_f32 v36, v36
    v_mfma_f32_16x16x32_bf16 v[64:67], a[212:215], a[116:119], v[64:67]
    v_exp_f32 v37, v37
    v_fma_f32 v38, v98, s35, v24
    v_fma_f32 v39, v99, s35, v24
    v_mfma_f32_16x16x32_bf16 v[72:75], a[212:215], a[140:143], v[72:75]
    ds_read_b128 a[212:215], v3 offset:18688
    s_waitcnt lgkmcnt(3)
    v_exp_f32 v38, v38
    v_cvt_pk_bf16_f32 v40, v36, v37
    v_mfma_f32_16x16x32_bf16 v[68:71], a[192:195], a[96:99], 0
    v_exp_f32 v39, v39
    v_fma_f32 v0, v100, s35, v24
    v_fma_f32 v36, v101, s35, v24
    v_cvt_pk_bf16_f32 v41, v38, v39
    v_mfma_f32_16x16x32_bf16 v[76:79], a[192:195], a[120:123], 0
    ds_read_b64_tr_b16 a[192:193], v4 offset:0
    ds_read_b64_tr_b16 a[194:195], v4 offset:6144
    v_exp_f32 v0, v0
    v_fma_f32 v37, v102, s35, v24
    v_mfma_f32_16x16x32_bf16 v[68:71], a[196:199], a[100:103], v[68:71]
    v_exp_f32 v36, v36
    v_fma_f32 v38, v103, s35, v24
    v_exp_f32 v37, v37
    v_mfma_f32_16x16x32_bf16 v[76:79], a[196:199], a[124:127], v[76:79]
    ds_read_b64_tr_b16 a[196:197], v5 offset:0
    ds_read_b64_tr_b16 a[198:199], v5 offset:6144
    v_cvt_pk_bf16_f32 v42, v0, v36
    v_fma_f32 v39, v104, s35, v25
    v_mfma_f32_16x16x32_bf16 v[68:71], a[200:203], a[104:107], v[68:71]
    s_waitcnt lgkmcnt(4)
    v_fma_f32 v0, v105, s35, v25
    v_exp_f32 v38, v38
    v_fma_f32 v36, v106, s35, v25
    v_mfma_f32_16x16x32_bf16 v[76:79], a[200:203], a[128:131], v[76:79]
    ds_read_b64_tr_b16 a[200:201], v6 offset:0
    ds_read_b64_tr_b16 a[202:203], v6 offset:6144
    v_exp_f32 v39, v39
    v_cvt_pk_bf16_f32 v43, v37, v38
    v_mfma_f32_16x16x32_bf16 v[68:71], a[204:207], a[108:111], v[68:71]
    v_exp_f32 v0, v0
    v_fma_f32 v37, v107, s35, v25
    v_exp_f32 v36, v36
    v_mfma_f32_16x16x32_bf16 v[76:79], a[204:207], a[132:135], v[76:79]
    ds_read_b64_tr_b16 a[204:205], v7 offset:0
    ds_read_b64_tr_b16 a[206:207], v7 offset:6144
    v_cvt_pk_bf16_f32 v44, v39, v0
    v_fma_f32 v38, v108, s35, v25
    v_mfma_f32_16x16x32_bf16 v[68:71], a[208:211], a[112:115], v[68:71]
    v_exp_f32 v37, v37
    v_fma_f32 v39, v109, s35, v25
    v_exp_f32 v38, v38
    v_mfma_f32_16x16x32_bf16 v[76:79], a[208:211], a[136:139], v[76:79]
    ds_read_b64_tr_b16 a[208:209], v4 offset:128
    ds_read_b64_tr_b16 a[210:211], v4 offset:6272
    v_cvt_pk_bf16_f32 v45, v36, v37
    v_fma_f32 v0, v110, s35, v25
    v_fma_f32 v36, v111, s35, v25
    v_mfma_f32_16x16x32_bf16 v[68:71], a[212:215], a[116:119], v[68:71]
    s_waitcnt lgkmcnt(4)
    v_exp_f32 v39, v39
    v_exp_f32 v0, v0
    v_cvt_pk_bf16_f32 v46, v38, v39
    v_exp_f32 v36, v36
    s_nop 0
    v_cvt_pk_bf16_f32 v47, v0, v36
    v_mfma_f32_16x16x32_bf16 v[76:79], a[212:215], a[140:143], v[76:79]
    ds_read_b64_tr_b16 a[212:213], v5 offset:128
    ds_read_b64_tr_b16 a[214:215], v5 offset:6272
    v_mfma_f32_16x16x32_bf16 v[28:31], a[248:251], v[40:43], 0
    v_mfma_f32_16x16x32_bf16 v[28:31], a[252:255], v[44:47], v[28:31]
    v_mfma_f32_16x16x32_bf16 v[112:115], a[192:195], v[40:43], 0
    v_mfma_f32_16x16x32_bf16 v[116:119], a[192:195], v[44:47], 0
    ds_read_b64_tr_b16 a[192:193], v6 offset:128
    ds_read_b64_tr_b16 a[194:195], v6 offset:6272
    v_fma_f32 v37, v64, s35, v24
    v_fma_f32 v38, v65, s35, v24
    v_exp_f32 v37, v37
    v_mfma_f32_16x16x32_bf16 v[120:123], a[196:199], v[40:43], 0
    v_exp_f32 v38, v38
    v_fma_f32 v39, v66, s35, v24
    v_fma_f32 v0, v67, s35, v24
    v_exp_f32 v39, v39
    v_mfma_f32_16x16x32_bf16 v[124:127], a[196:199], v[44:47], 0
    ds_read_b64_tr_b16 a[196:197], v7 offset:128
    ds_read_b64_tr_b16 a[198:199], v7 offset:6272
    v_cvt_pk_bf16_f32 v48, v37, v38
    v_fma_f32 v36, v68, s35, v24
    v_mfma_f32_16x16x32_bf16 v[128:131], a[200:203], v[40:43], 0
    s_waitcnt lgkmcnt(4)
    v_fma_f32 v37, v69, s35, v24
    v_exp_f32 v0, v0
    v_mfma_f32_16x16x32_bf16 v[132:135], a[200:203], v[44:47], 0
    ds_read_b64_tr_b16 a[200:201], v4 offset:256
    ds_read_b64_tr_b16 a[202:203], v4 offset:6400
    v_exp_f32 v36, v36
    v_cvt_pk_bf16_f32 v49, v39, v0
    v_mfma_f32_16x16x32_bf16 v[136:139], a[204:207], v[40:43], 0
    v_exp_f32 v37, v37
    v_mov_b32 v17, v28
    v_fma_f32 v38, v70, s35, v24
    v_fma_f32 v39, v71, s35, v24
    v_cvt_pk_bf16_f32 v50, v36, v37
    v_mfma_f32_16x16x32_bf16 v[140:143], a[204:207], v[44:47], 0
    ds_read_b64_tr_b16 a[204:205], v5 offset:256
    ds_read_b64_tr_b16 a[206:207], v5 offset:6400
    v_mov_b32 v19, v29
    v_exp_f32 v38, v38
    v_mfma_f32_16x16x32_bf16 v[144:147], a[208:211], v[40:43], 0
    v_exp_f32 v39, v39
    v_fma_f32 v0, v72, s35, v25
    v_fma_f32 v36, v73, s35, v25
    v_mfma_f32_16x16x32_bf16 v[148:151], a[208:211], v[44:47], 0
    ds_read_b64_tr_b16 a[208:209], v6 offset:256
    ds_read_b64_tr_b16 a[210:211], v6 offset:6400
    v_exp_f32 v0, v0
    v_cvt_pk_bf16_f32 v51, v38, v39
    v_mfma_f32_16x16x32_bf16 v[152:155], a[212:215], v[40:43], 0
    s_waitcnt lgkmcnt(4)
    v_fma_f32 v37, v74, s35, v25
    v_exp_f32 v36, v36
    v_fma_f32 v38, v75, s35, v25
    v_mfma_f32_16x16x32_bf16 v[156:159], a[212:215], v[44:47], 0
    ds_read_b64_tr_b16 a[212:213], v7 offset:256
    ds_read_b64_tr_b16 a[214:215], v7 offset:6400
    v_exp_f32 v37, v37
    v_cvt_pk_bf16_f32 v52, v0, v36
    v_mfma_f32_16x16x32_bf16 v[160:163], a[192:195], v[40:43], 0
    s_waitcnt vmcnt(6)
    s_barrier
    v_fma_f32 v39, v76, s35, v25
    v_fma_f32 v0, v77, s35, v25
    v_mfma_f32_16x16x32_bf16 v[164:167], a[192:195], v[44:47], 0
    ds_read_b128 a[192:195], v2 offset:24576
    v_fma_f32 v36, v78, s35, v25
    v_exp_f32 v38, v38
    v_mfma_f32_16x16x32_bf16 v[168:171], a[196:199], v[40:43], 0
    v_exp_f32 v39, v39
    v_cvt_pk_bf16_f32 v53, v37, v38
    v_exp_f32 v0, v0
    v_mfma_f32_16x16x32_bf16 v[172:175], a[196:199], v[44:47], 0
    ds_read_b128 a[196:199], v3 offset:24576
    v_fma_f32 v37, v79, s35, v25
    v_exp_f32 v36, v36
    v_cvt_pk_bf16_f32 v54, v39, v0
    v_mfma_f32_16x16x32_bf16 v[176:179], a[200:203], v[40:43], 0
    v_exp_f32 v37, v37
    s_nop 0
    v_cvt_pk_bf16_f32 v55, v36, v37
    v_mfma_f32_16x16x32_bf16 v[180:183], a[200:203], v[44:47], 0
    ds_read_b128 a[200:203], v2 offset:24704
    s_waitcnt lgkmcnt(3)
    v_mfma_f32_16x16x32_bf16 v[28:31], a[248:251], v[48:51], 0
    v_mfma_f32_16x16x32_bf16 v[28:31], a[252:255], v[52:55], v[28:31]
    v_mfma_f32_16x16x32_bf16 v[184:187], a[204:207], v[40:43], 0
    v_mfma_f32_16x16x32_bf16 v[188:191], a[204:207], v[44:47], 0
    ds_read_b128 a[204:207], v3 offset:24704
    v_mfma_f32_16x16x32_bf16 v[192:195], a[208:211], v[40:43], 0
    v_mfma_f32_16x16x32_bf16 v[196:199], a[208:211], v[44:47], 0
    ds_read_b128 a[208:211], v2 offset:24832
    s_nop 1
    v_cmp_nge_f32 vcc, s37, v30
    v_mfma_f32_16x16x32_bf16 v[200:203], a[212:215], v[40:43], 0
    v_mfma_f32_16x16x32_bf16 v[204:207], a[212:215], v[44:47], 0
    ds_read_b128 a[212:215], v3 offset:24832
    s_waitcnt lgkmcnt(3)
    s_cbranch_vccnz L_tr_P_A
L_ret_P_A:
    v_mfma_f32_16x16x32_bf16 v[64:67], a[192:195], a[96:99], 0
    v_add_f32 v17, v17, v28
    v_mfma_f32_16x16x32_bf16 v[72:75], a[192:195], a[120:123], 0
    ds_read_b128 a[192:195], v2 offset:30720
    v_add_f32 v19, v19, v29
    v_mfma_f32_16x16x32_bf16 v[64:67], a[196:199], a[100:103], v[64:67]
    v_mfma_f32_16x16x32_bf16 v[72:75], a[196:199], a[124:127], v[72:75]
    ds_read_b128 a[196:199], v3 offset:30720
    v_mfma_f32_16x16x32_bf16 v[64:67], a[200:203], a[104:107], v[64:67]
    v_mfma_f32_16x16x32_bf16 v[72:75], a[200:203], a[128:131], v[72:75]
    ds_read_b128 a[200:203], v2 offset:30848
    s_waitcnt lgkmcnt(3)
    v_mfma_f32_16x16x32_bf16 v[64:67], a[204:207], a[108:111], v[64:67]
    v_mfma_f32_16x16x32_bf16 v[72:75], a[204:207], a[132:135], v[72:75]
    ds_read_b128 a[204:207], v3 offset:30848
    v_mfma_f32_16x16x32_bf16 v[64:67], a[208:211], a[112:115], v[64:67]
    v_mfma_f32_16x16x32_bf16 v[72:75], a[208:211], a[136:139], v[72:75]
    ds_read_b128 a[208:211], v2 offset:30976
    v_mfma_f32_16x16x32_bf16 v[64:67], a[212:215], a[116:119], v[64:67]
    v_mfma_f32_16x16x32_bf16 v[72:75], a[212:215], a[140:143], v[72:75]
    ds_read_b128 a[212:215], v3 offset:30976
    s_waitcnt lgkmcnt(3)
    v_mfma_f32_16x16x32_bf16 v[68:71], a[192:195], a[96:99], 0
    v_mfma_f32_16x16x32_bf16 v[76:79], a[192:195], a[120:123], 0
    ds_read_b64_tr_b16 a[192:193], v4 offset:12288
    ds_read_b64_tr_b16 a[194:195], v4 offset:18432
    v_mfma_f32_16x16x32_bf16 v[68:71], a[196:199], a[100:103], v[68:71]
    v_mfma_f32_16x16x32_bf16 v[76:79], a[196:199], a[124:127], v[76:79]
    ds_read_b64_tr_b16 a[196:197], v5 offset:12288
    ds_read_b64_tr_b16 a[198:199], v5 offset:18432
    v_fma_f32 v38, v64, s35, v24
    v_fma_f32 v39, v65, s35, v24
    v_mfma_f32_16x16x32_bf16 v[68:71], a[200:203], a[104:107], v[68:71]
    s_waitcnt lgkmcnt(4)
    v_fma_f32 v0, v66, s35, v24
    v_exp_f32 v38, v38
    v_mfma_f32_16x16x32_bf16 v[76:79], a[200:203], a[128:131], v[76:79]
    ds_read_b64_tr_b16 a[200:201], v6 offset:12288
    ds_read_b64_tr_b16 a[202:203], v6 offset:18432
    v_exp_f32 v39, v39
    v_mfma_f32_16x16x32_bf16 v[68:71], a[204:207], a[108:111], v[68:71]
    v_exp_f32 v0, v0
    v_fma_f32 v36, v67, s35, v24
    v_cvt_pk_bf16_f32 v40, v38, v39
    v_mfma_f32_16x16x32_bf16 v[76:79], a[204:207], a[132:135], v[76:79]
    ds_read_b64_tr_b16 a[204:205], v7 offset:12288
    ds_read_b64_tr_b16 a[206:207], v7 offset:18432
    v_fma_f32 v37, v72, s35, v25
    v_mfma_f32_16x16x32_bf16 v[68:71], a[208:211], a[112:115], v[68:71]
    v_exp_f32 v36, v36
    v_fma_f32 v38, v73, s35, v25
    v_exp_f32 v37, v37
    v_mfma_f32_16x16x32_bf16 v[76:79], a[208:211], a[136:139], v[76:79]
    ds_read_b64_tr_b16 a[208:209], v4 offset:12416
    ds_read_b64_tr_b16 a[210:211], v4 offset:18560
    v_cvt_pk_bf16_f32 v41, v0, v36
    v_mfma_f32_16x16x32_bf16 v[68:71], a[212:215], a[116:119], v[68:71]
    s_waitcnt lgkmcnt(4)
    v_fma_f32 v39, v74, s35, v25
    v_exp_f32 v38, v38
    v_mfma_f32_16x16x32_bf16 v[76:79], a[212:215], a[140:143], v[76:79]
    ds_read_b64_tr_b16 a[212:213], v5 offset:12416
    ds_read_b64_tr_b16 a[214:215], v5 offset:18560
    v_fma_f32 v0, v75, s35, v25
    v_exp_f32 v39, v39
    v_mfma_f32_16x16x32_bf16 v[112:115], a[192:195], v[48:51], v[112:115]
    v_exp_f32 v0, v0
    v_mfma_f32_16x16x32_bf16 v[116:119], a[192:195], v[52:55], v[116:119]
    ds_read_b64_tr_b16 a[192:193], v6 offset:12416
    ds_read_b64_tr_b16 a[194:195], v6 offset:18560
    v_cvt_pk_bf16_f32 v44, v37, v38
    v_cvt_pk_bf16_f32 v45, v39, v0
    v_mfma_f32_16x16x32_bf16 v[120:123], a[196:199], v[48:51], v[120:123]
    v_fma_f32 v36, v68, s35, v24
    v_fma_f32 v37, v69, s35, v24
    v_mfma_f32_16x16x32_bf16 v[124:127], a[196:199], v[52:55], v[124:127]
    ds_read_b64_tr_b16 a[196:197], v7 offset:12416
    ds_read_b64_tr_b16 a[198:199], v7 offset:18560
    v_mfma_f32_16x16x32_bf16 v[128:131], a[200:203], v[48:51], v[128:131]
    s_waitcnt lgkmcnt(4)
    v_fma_f32 v38, v70, s35, v24
    v_mfma_f32_16x16x32_bf16 v[132:135], a[200:203], v[52:55], v[132:135]
    ds_read_b64_tr_b16 a[200:201], v4 offset:12544
    ds_read_b64_tr_b16 a[202:203], v4 offset:18688
    v_mfma_f32_16x16x32_bf16 v[136:139], a[204:207], v[48:51], v[136:139]
    v_exp_f32 v36, v36
    v_mfma_f32_16x16x32_bf16 v[140:143], a[204:207], v[52:55], v[140:143]
    ds_read_b64_tr_b16 a[204:205], v5 offset:12544
    ds_read_b64_tr_b16 a[206:207], v5 offset:18688
    v_mfma_f32_16x16x32_bf16 v[144:147], a[208:211], v[48:51], v[144:147]
    v_exp_f32 v37, v37
    v_mfma_f32_16x16x32_bf16 v[148:151], a[208:211], v[52:55], v[148:151]
    ds_read_b64_tr_b16 a[208:209], v6 offset:12544
    ds_read_b64_tr_b16 a[210:211], v6 offset:18688
    v_mfma_f32_16x16x32_bf16 v[152:155], a[212:215], v[48:51], v[152:155]
    s_waitcnt lgkmcnt(4)
    v_fma_f32 v39, v71, s35, v24
    v_cvt_pk_bf16_f32 v42, v36, v37
    v_mfma_f32_16x16x32_bf16 v[156:159], a[212:215], v[52:55], v[156:159]
    ds_read_b64_tr_b16 a[212:213], v7 offset:12544
    ds_read_b64_tr_b16 a[214:215], v7 offset:18688
    v_mfma_f32_16x16x32_bf16 v[160:163], a[192:195], v[48:51], v[160:163]
    v_exp_f32 v38, v38
    v_mfma_f32_16x16x32_bf16 v[164:167], a[192:195], v[52:55], v[164:167]
    ds_read_b128 a[192:195], v2 offset:0
    v_fma_f32 v0, v76, s35, v25
    v_fma_f32 v36, v77, s35, v25
    v_mfma_f32_16x16x32_bf16 v[168:171], a[196:199], v[48:51], v[168:171]
    v_exp_f32 v39, v39
    v_mfma_f32_16x16x32_bf16 v[172:175], a[196:199], v[52:55], v[172:175]
    ds_read_b128 a[196:199], v3 offset:0
    v_cvt_pk_bf16_f32 v43, v38, v39
    v_mfma_f32_16x16x32_bf16 v[176:179], a[200:203], v[48:51], v[176:179]
    v_exp_f32 v0, v0
    v_fma_f32 v37, v78, s35, v25
    v_mfma_f32_16x16x32_bf16 v[180:183], a[200:203], v[52:55], v[180:183]
    ds_read_b128 a[200:203], v2 offset:128
    s_waitcnt lgkmcnt(3)
    v_mfma_f32_16x16x32_bf16 v[184:187], a[204:207], v[48:51], v[184:187]
    v_exp_f32 v36, v36
    v_mfma_f32_16x16x32_bf16 v[188:191], a[204:207], v[52:55], v[188:191]
    ds_read_b128 a[204:207], v3 offset:128
    v_fma_f32 v38, v79, s35, v25
    v_mfma_f32_16x16x32_bf16 v[192:195], a[208:211], v[48:51], v[192:195]
    v_exp_f32 v37, v37
    v_cvt_pk_bf16_f32 v46, v0, v36
    v_mfma_f32_16x16x32_bf16 v[196:199], a[208:211], v[52:55], v[196:199]
    ds_read_b128 a[208:211], v2 offset:256
    v_exp_f32 v38, v38
    v_mfma_f32_16x16x32_bf16 v[200:203], a[212:215], v[48:51], v[200:203]
    v_cvt_pk_bf16_f32 v47, v37, v38
    v_mfma_f32_16x16x32_bf16 v[204:207], a[212:215], v[52:55], v[204:207]
    ds_read_b128 a[212:215], v3 offset:256
    s_waitcnt lgkmcnt(3)
    s_waitcnt vmcnt(0)
    ds_read_b128 a[144:147], v208 offset:0
    ds_read_b128 a[168:171], v208 offset:6144
    ds_read_b128 a[148:151], v209 offset:0
    ds_read_b128 a[172:175], v209 offset:6144
    ds_read_b128 a[152:155], v208 offset:128
    ds_read_b128 a[176:179], v208 offset:6272
    ds_read_b128 a[156:159], v209 offset:128
    ds_read_b128 a[180:183], v209 offset:6272
    ds_read_b128 a[160:163], v208 offset:256
    ds_read_b128 a[184:187], v208 offset:6400
    ds_read_b128 a[164:167], v209 offset:256
    ds_read_b128 a[188:191], v209 offset:6400
    s_waitcnt lgkmcnt(8)
    v_mfma_f32_16x16x32_bf16 v[80:83], a[192:195], a[144:147], 0
    v_mfma_f32_16x16x32_bf16 v[88:91], a[192:195], a[168:171], 0
    ds_read_b128 a[192:195], v2 offset:6144
    v_mfma_f32_16x16x32_bf16 v[80:83], a[196:199], a[148:151], v[80:83]
    s_waitcnt lgkmcnt(1)
    v_mfma_f32_16x16x32_bf16 v[88:91], a[196:199], a[172:175], v[88:91]
    ds_read_b128 a[196:199], v3 offset:6144
    v_mfma_f32_16x16x32_bf16 v[80:83], a[200:203], a[152:155], v[80:83]
    s_barrier
    v_mfma_f32_16x16x32_bf16 v[88:91], a[200:203], a[176:179], v[88:91]
    ds_read_b128 a[200:203], v2 offset:6272
    s_waitcnt lgkmcnt(15)
    v_mfma_f32_16x16x32_bf16 v[80:83], a[204:207], a[156:159], v[80:83]
    s_mov_b32 m0, s45
    v_mfma_f32_16x16x32_bf16 v[88:91], a[204:207], a[180:183], v[88:91]
    ds_read_b128 a[204:207], v3 offset:6272
    v_mfma_f32_16x16x32_bf16 v[80:83], a[208:211], a[160:163], v[80:83]
    buffer_load_dwordx4 v8, s[12:15], s54 offen nt lds
    v_mfma_f32_16x16x32_bf16 v[88:91], a[208:211], a[184:187], v[88:91]
    ds_read_b128 a[208:211], v2 offset:6400
    v_mfma_f32_16x16x32_bf16 v[80:83], a[212:215], a[164:167], v[80:83]
    buffer_load_dwordx4 v9, s[12:15], s54 offen offset:1024 nt lds
    v_mfma_f32_16x16x32_bf16 v[88:91], a[212:215], a[188:191], v[88:91]
    ds_read_b128 a[212:215], v3 offset:6400
    s_waitcnt lgkmcnt(3)
    v_mfma_f32_16x16x32_bf16 v[84:87], a[192:195], a[144:147], 0
    buffer_load_dwordx4 v10, s[12:15], s54 offen offset:2048 nt lds
    v_mfma_f32_16x16x32_bf16 v[92:95], a[192:195], a[168:171], 0
    ds_read_b128 a[192:195], v2 offset:12288
    v_mfma_f32_16x16x32_bf16 v[84:87], a[196:199], a[148:151], v[84:87]
    s_mov_b32 m0, s50
    v_mfma_f32_16x16x32_bf16 v[92:95], a[196:199], a[172:175], v[92:95]
    ds_read_b128 a[196:199], v3 offset:12288
    v_mfma_f32_16x16x32_bf16 v[84:87], a[200:203], a[152:155], v[84:87]
    buffer_load_dwordx4 v8, s[16:19], s53 offen nt lds
    v_mfma_f32_16x16x32_bf16 v[92:95], a[200:203], a[176:179], v[92:95]
    ds_read_b128 a[200:203], v2 offset:12416
    s_waitcnt lgkmcnt(3)
    v_mfma_f32_16x16x32_bf16 v[84:87], a[204:207], a[156:159], v[84:87]
    buffer_load_dwordx4 v9, s[16:19], s53 offen offset:1024 nt lds
    v_mfma_f32_16x16x32_bf16 v[92:95], a[204:207], a[180:183], v[92:95]
    ds_read_b128 a[204:207], v3 offset:12416
    v_mfma_f32_16x16x32_bf16 v[84:87], a[208:211], a[160:163], v[84:87]
    buffer_load_dwordx4 v10, s[16:19], s53 offen offset:2048 nt lds
    v_mfma_f32_16x16x32_bf16 v[92:95], a[208:211], a[184:187], v[92:95]
    ds_read_b128 a[208:211], v2 offset:12544
    v_mfma_f32_16x16x32_bf16 v[84:87], a[212:215], a[164:167], v[84:87]
    v_mfma_f32_16x16x32_bf16 v[92:95], a[212:215], a[188:191], v[92:95]
    ds_read_b128 a[212:215], v3 offset:12544
    s_waitcnt lgkmcnt(3)
    v_mfma_f32_16x16x32_bf16 v[96:99], a[192:195], a[144:147], 0
    s_barrier
    v_mfma_f32_16x16x32_bf16 v[104:107], a[192:195], a[168:171], 0
    ds_read_b128 a[192:195], v2 offset:18432
    v_mfma_f32_16x16x32_bf16 v[96:99], a[196:199], a[148:151], v[96:99]
    s_mov_b32 m0, s42
    v_mfma_f32_16x16x32_bf16 v[104:107], a[196:199], a[172:175], v[104:107]
    ds_read_b128 a[196:199], v3 offset:18432
    v_max3_f32 v33, v80, v81, v82
    v_max3_f32 v34, v88, v89, v90
    v_max3_f32 v33, v33, v83, v84
    v_max3_f32 v34, v34, v91, v92
    v_max3_f32 v33, v33, v85, v86
    v_max3_f32 v34, v34, v93, v94
    v_mfma_f32_16x16x32_bf16 v[96:99], a[200:203], a[152:155], v[96:99]
    buffer_load_dwordx4 v8, s[12:15], s55 offen nt lds
    v_max_f32 v33, v33, v87
    v_max_f32 v34, v34, v95
    v_mfma_f32_16x16x32_bf16 v[104:107], a[200:203], a[176:179], v[104:107]
    ds_read_b128 a[200:203], v2 offset:18560
    s_waitcnt lgkmcnt(3)
    v_permlane32_swap_b32 v33, v34
    v_max_f32 v33, v33, v34
    v_mov_b32 v34, v33
    v_mfma_f32_16x16x32_bf16 v[96:99], a[204:207], a[156:159], v[96:99]
    buffer_load_dwordx4 v9, s[12:15], s55 offen offset:1024 nt lds
    v_permlane16_swap_b32 v33, v34
    v_max_f32 v33, v33, v34
    v_mfma_f32_16x16x32_bf16 v[104:107], a[204:207], a[180:183], v[104:107]
    ds_read_b128 a[204:207], v3 offset:18560
    v_mul_f32 v26, s36, v33
    v_mul_f32 v27, s36, v33
    v_mfma_f32_16x16x32_bf16 v[96:99], a[208:211], a[160:163], v[96:99]
    buffer_load_dwordx4 v10, s[12:15], s55 offen offset:2048 nt lds
    v_permlane32_swap_b32 v26, v27
    v_fma_f32 v39, v80, s35, v26
    v_fma_f32 v0, v81, s35, v26
    v_fma_f32 v36, v82, s35, v26
    v_mfma_f32_16x16x32_bf16 v[104:107], a[208:211], a[184:187], v[104:107]
    ds_read_b128 a[208:211], v2 offset:18688
    v_fma_f32 v37, v83, s35, v26
    v_exp_f32 v39, v39
    v_fma_f32 v38, v84, s35, v26
    v_mfma_f32_16x16x32_bf16 v[96:99], a[212:215], a[164:167], v[96:99]
    s_mov_b32 m0, s51
    v_exp_f32 v0, v0
    v_exp_f32 v36, v36
    v_mfma_f32_16x16x32_bf16 v[104:107], a[212:215], a[188:191], v[104:107]
    ds_read_b128 a[212:215], v3 offset:18688
    s_waitcnt lgkmcnt(3)
    v_cvt_pk_bf16_f32 v56, v39, v0
    v_exp_f32 v37, v37
    v_mfma_f32_16x16x32_bf16 v[100:103], a[192:195], a[144:147], 0
    buffer_load_dwordx4 v8, s[16:19], s54 offen nt lds
    v_fma_f32 v39, v85, s35, v26
    v_exp_f32 v38, v38
    v_mfma_f32_16x16x32_bf16 v[108:111], a[192:195], a[168:171], 0
    ds_read_b128 a[192:195], v2 offset:24576
    v_cvt_pk_bf16_f32 v57, v36, v37
    v_fma_f32 v0, v86, s35, v26
    v_exp_f32 v39, v39
    v_mfma_f32_16x16x32_bf16 v[100:103], a[196:199], a[148:151], v[100:103]
    buffer_load_dwordx4 v9, s[16:19], s54 offen offset:1024 nt lds
    v_fma_f32 v36, v87, s35, v26
    v_exp_f32 v0, v0
    v_mfma_f32_16x16x32_bf16 v[108:111], a[196:199], a[172:175], v[108:111]
    ds_read_b128 a[196:199], v3 offset:24576
    v_cvt_pk_bf16_f32 v58, v38, v39
    v_fma_f32 v37, v88, s35, v27
    v_exp_f32 v36, v36
    v_mfma_f32_16x16x32_bf16 v[100:103], a[200:203], a[152:155], v[100:103]
    buffer_load_dwordx4 v10, s[16:19], s54 offen offset:2048 nt lds
    v_fma_f32 v38, v89, s35, v27
    v_exp_f32 v37, v37
    v_mfma_f32_16x16x32_bf16 v[108:111], a[200:203], a[176:179], v[108:111]
    ds_read_b128 a[200:203], v2 offset:24704
    s_waitcnt lgkmcnt(3)
    v_cvt_pk_bf16_f32 v59, v0, v36
    v_fma_f32 v39, v90, s35, v27
    v_exp_f32 v38, v38
    v_mfma_f32_16x16x32_bf16 v[100:103], a[204:207], a[156:159], v[100:103]
    v_exp_f32 v39, v39
    v_fma_f32 v0, v91, s35, v27
    v_cvt_pk_bf16_f32 v60, v37, v38
    v_mfma_f32_16x16x32_bf16 v[108:111], a[204:207], a[180:183], v[108:111]
    ds_read_b128 a[204:207], v3 offset:24704
    v_fma_f32 v36, v92, s35, v27
    v_exp_f32 v0, v0
    v_fma_f32 v37, v93, s35, v27
    v_cvt_pk_bf16_f32 v61, v39, v0
    v_mfma_f32_16x16x32_bf16 v[100:103], a[208:211], a[160:163], v[100:103]
    v_exp_f32 v36, v36
    v_fma_f32 v38, v94, s35, v27
    v_exp_f32 v37, v37
    v_mfma_f32_16x16x32_bf16 v[108:111], a[208:211], a[184:187], v[108:111]
    ds_read_b128 a[208:211], v2 offset:24832
    v_fma_f32 v39, v95, s35, v27
    v_exp_f32 v38, v38
    v_cvt_pk_bf16_f32 v62, v36, v37
    v_mfma_f32_16x16x32_bf16 v[100:103], a[212:215], a[164:167], v[100:103]
    v_exp_f32 v39, v39
    s_nop 0
    v_cvt_pk_bf16_f32 v63, v38, v39
    v_mfma_f32_16x16x32_bf16 v[108:111], a[212:215], a[188:191], v[108:111]
L_hop_0:
    s_cbranch_execz L_hop_4
    ds_read_b128 a[212:215], v3 offset:24832
    s_waitcnt lgkmcnt(3)
    v_mfma_f32_16x16x32_bf16 v[28:31], a[248:251], v[56:59], 0
    v_mfma_f32_16x16x32_bf16 v[28:31], a[252:255], v[60:63], v[28:31]
    v_mfma_f32_16x16x32_bf16 v[80:83], a[192:195], a[144:147], 0
    s_barrier
    v_mfma_f32_16x16x32_bf16 v[88:91], a[192:195], a[168:171], 0
    ds_read_b128 a[192:195], v2 offset:30720
    v_fma_f32 v0, v96, s35, v26
    v_fma_f32 v36, v97, s35, v26
    v_mfma_f32_16x16x32_bf16 v[80:83], a[196:199], a[148:151], v[80:83]
    s_mov_b32 m0, s43
    v_fma_f32 v37, v98, s35, v26
    v_exp_f32 v0, v0
    v_mfma_f32_16x16x32_bf16 v[88:91], a[196:199], a[172:175], v[88:91]
    ds_read_b128 a[196:199], v3 offset:30720
    v_fma_f32 v38, v99, s35, v26
    v_mfma_f32_16x16x32_bf16 v[80:83], a[200:203], a[152:155], v[80:83]
    buffer_load_dwordx4 v8, s[12:15], s56 offen nt lds
    v_fma_f32 v39, v100, s35, v26
    v_mfma_f32_16x16x32_bf16 v[88:91], a[200:203], a[176:179], v[88:91]
    ds_read_b128 a[200:203], v2 offset:30848
    s_waitcnt lgkmcnt(3)
    v_mfma_f32_16x16x32_bf16 v[80:83], a[204:207], a[156:159], v[80:83]
    buffer_load_dwordx4 v9, s[12:15], s56 offen offset:1024 nt lds
    v_mov_b32 v21, v28
    v_mfma_f32_16x16x32_bf16 v[88:91], a[204:207], a[180:183], v[88:91]
    ds_read_b128 a[204:207], v3 offset:30848
    v_mov_b32 v23, v29
    v_mfma_f32_16x16x32_bf16 v[80:83], a[208:211], a[160:163], v[80:83]
    buffer_load_dwordx4 v10, s[12:15], s56 offen offset:2048 nt lds
    v_exp_f32 v36, v36
    v_mfma_f32_16x16x32_bf16 v[88:91], a[208:211], a[184:187], v[88:91]
    ds_read_b128 a[208:211], v2 offset:30976
    v_cvt_pk_bf16_f32 v48, v0, v36
    v_mfma_f32_16x16x32_bf16 v[80:83], a[212:215], a[164:167], v[80:83]
    v_exp_f32 v37, v37
    v_exp_f32 v38, v38
    v_mfma_f32_16x16x32_bf16 v[88:91], a[212:215], a[188:191], v[88:91]
    ds_read_b128 a[212:215], v3 offset:30976
    s_waitcnt lgkmcnt(3)
    v_mfma_f32_16x16x32_bf16 v[84:87], a[192:195], a[144:147], 0
    v_exp_f32 v39, v39
    v_fma_f32 v0, v101, s35, v26
    v_mfma_f32_16x16x32_bf16 v[92:95], a[192:195], a[168:171], 0
    ds_read_b64_tr_b16 a[192:193], v4 offset:0
    ds_read_b64_tr_b16 a[194:195], v4 offset:6144
    v_mfma_f32_16x16x32_bf16 v[84:87], a[196:199], a[148:151], v[84:87]
    v_exp_f32 v0, v0
    v_cvt_pk_bf16_f32 v49, v37, v38
    v_mfma_f32_16x16x32_bf16 v[92:95], a[196:199], a[172:175], v[92:95]
    ds_read_b64_tr_b16 a[196:197], v5 offset:0
    ds_read_b64_tr_b16 a[198:199], v5 offset:6144
    v_fma_f32 v36, v102, s35, v26
    v_mfma_f32_16x16x32_bf16 v[84:87], a[200:203], a[152:155], v[84:87]
    s_waitcnt lgkmcnt(4)
    v_fma_f32 v37, v103, s35, v26
    v_cvt_pk_bf16_f32 v50, v39, v0
    v_mfma_f32_16x16x32_bf16 v[92:95], a[200:203], a[176:179], v[92:95]
    ds_read_b64_tr_b16 a[200:201], v6 offset:0
    ds_read_b64_tr_b16 a[202:203], v6 offset:6144
    v_mfma_f32_16x16x32_bf16 v[84:87], a[204:207], a[156:159], v[84:87]
    v_exp_f32 v36, v36
    v_fma_f32 v38, v104, s35, v27
    v_mfma_f32_16x16x32_bf16 v[92:95], a[204:207], a[180:183], v[92:95]
    ds_read_b64_tr_b16 a[204:205], v7 offset:0
    ds_read_b64_tr_b16 a[206:207], v7 offset:6144
    v_fma_f32 v39, v105, s35, v27
    v_mfma_f32_16x16x32_bf16 v[84:87], a[208:211], a[160:163], v[84:87]
    v_exp_f32 v37, v37
    v_fma_f32 v0, v106, s35, v27
    v_mfma_f32_16x16x32_bf16 v[92:95], a[208:211], a[184:187], v[92:95]
    ds_read_b64_tr_b16 a[208:209], v4 offset:128
    ds_read_b64_tr_b16 a[210:211], v4 offset:6272
    v_mfma_f32_16x16x32_bf16 v[84:87], a[212:215], a[164:167], v[84:87]
    s_waitcnt lgkmcnt(4)
    v_cvt_pk_bf16_f32 v51, v36, v37
    v_exp_f32 v38, v38
    v_mfma_f32_16x16x32_bf16 v[92:95], a[212:215], a[188:191], v[92:95]
    ds_read_b64_tr_b16 a[212:213], v5 offset:128
    ds_read_b64_tr_b16 a[214:215], v5 offset:6272
    v_mfma_f32_16x16x32_bf16 a[0:3], a[192:195], v[56:59], 0
    v_exp_f32 v39, v39
    v_mfma_f32_16x16x32_bf16 a[4:7], a[192:195], v[60:63], 0
    ds_read_b64_tr_b16 a[192:193], v6 offset:128
    ds_read_b64_tr_b16 a[194:195], v6 offset:6272
    v_fma_f32 v36, v107, s35, v27
    v_mfma_f32_16x16x32_bf16 a[8:11], a[196:199], v[56:59], 0
    v_exp_f32 v0, v0
    v_mfma_f32_16x16x32_bf16 a[12:15], a[196:199], v[60:63], 0
    ds_read_b64_tr_b16 a[196:197], v7 offset:128
    ds_read_b64_tr_b16 a[198:199], v7 offset:6272
    v_cvt_pk_bf16_f32 v52, v38, v39
    v_mfma_f32_16x16x32_bf16 a[16:19], a[200:203], v[56:59], 0
    s_waitcnt lgkmcnt(4)
    v_fma_f32 v37, v108, s35, v27
    v_fma_f32 v38, v109, s35, v27
    v_mfma_f32_16x16x32_bf16 a[20:23], a[200:203], v[60:63], 0
    ds_read_b64_tr_b16 a[200:201], v4 offset:256
    ds_read_b64_tr_b16 a[202:203], v4 offset:6400
    v_mfma_f32_16x16x32_bf16 a[24:27], a[204:207], v[56:59], 0
    v_exp_f32 v36, v36
    v_fma_f32 v39, v110, s35, v27
    v_mfma_f32_16x16x32_bf16 a[28:31], a[204:207], v[60:63], 0
    ds_read_b64_tr_b16 a[204:205], v5 offset:256
    ds_read_b64_tr_b16 a[206:207], v5 offset:6400
    v_mfma_f32_16x16x32_bf16 a[32:35], a[208:211], v[56:59], 0
    v_exp_f32 v37, v37
    v_cvt_pk_bf16_f32 v53, v0, v36
    v_mfma_f32_16x16x32_bf16 a[36:39], a[208:211], v[60:63], 0
    ds_read_b64_tr_b16 a[208:209], v6 offset:256
    ds_read_b64_tr_b16 a[210:211], v6 offset:6400
    v_mfma_f32_16x16x32_bf16 a[40:43], a[212:215], v[56:59], 0
    s_waitcnt lgkmcnt(4)
    v_fma_f32 v0, v111, s35, v27
    v_mfma_f32_16x16x32_bf16 a[44:47], a[212:215], v[60:63], 0
    ds_read_b64_tr_b16 a[212:213], v7 offset:256
    ds_read_b64_tr_b16 a[214:215], v7 offset:6400
    v_exp_f32 v38, v38
    v_mfma_f32_16x16x32_bf16 a[48:51], a[192:195], v[56:59], 0
    v_exp_f32 v39, v39
    v_mfma_f32_16x16x32_bf16 a[52:55], a[192:195], v[60:63], 0
    ds_read_b64_tr_b16 a[192:193], v4 offset:12288
    ds_read_b64_tr_b16 a[194:195], v4 offset:18432
    v_cvt_pk_bf16_f32 v54, v37, v38
    v_mfma_f32_16x16x32_bf16 a[56:59], a[196:199], v[56:59], 0
    v_exp_f32 v0, v0
    v_mfma_f32_16x16x32_bf16 a[60:63], a[196:199], v[60:63], 0
    ds_read_b64_tr_b16 a[196:197], v5 offset:12288
    ds_read_b64_tr_b16 a[198:199], v5 offset:18432
    v_cvt_pk_bf16_f32 v55, v39, v0
    v_mfma_f32_16x16x32_bf16 a[64:67], a[200:203], v[56:59], 0
    s_waitcnt lgkmcnt(4)
    v_mfma_f32_16x16x32_bf16 a[68:71], a[200:203], v[60:63], 0
    ds_read_b64_tr_b16 a[200:201], v6 offset:12288
    ds_read_b64_tr_b16 a[202:203], v6 offset:18432
    v_mfma_f32_16x16x32_bf16 v[28:31], a[248:251], v[48:51], 0
    v_mfma_f32_16x16x32_bf16 v[28:31], a[252:255], v[52:55], v[28:31]
    v_mfma_f32_16x16x32_bf16 a[72:75], a[204:207], v[56:59], 0
    v_mfma_f32_16x16x32_bf16 a[76:79], a[204:207], v[60:63], 0
    ds_read_b64_tr_b16 a[204:205], v7 offset:12288
    ds_read_b64_tr_b16 a[206:207], v7 offset:18432
    v_mfma_f32_16x16x32_bf16 a[80:83], a[208:211], v[56:59], 0
    v_mfma_f32_16x16x32_bf16 a[84:87], a[208:211], v[60:63], 0
    ds_read_b64_tr_b16 a[208:209], v4 offset:12416
    ds_read_b64_tr_b16 a[210:211], v4 offset:18560
    v_cmp_nge_f32 vcc, s37, v30
    v_mfma_f32_16x16x32_bf16 a[88:91], a[212:215], v[56:59], 0
    s_waitcnt lgkmcnt(4)
    v_mfma_f32_16x16x32_bf16 a[92:95], a[212:215], v[60:63], 0
    ds_read_b64_tr_b16 a[212:213], v5 offset:12416
    ds_read_b64_tr_b16 a[214:215], v5 offset:18560
    s_cbranch_vccnz L_tr_P_B
L_ret_P_B:
    v_mfma_f32_16x16x32_bf16 a[0:3], a[192:195], v[48:51], a[0:3]
    s_waitcnt vmcnt(12)
    s_barrier
    v_mfma_f32_16x16x32_bf16 a[4:7], a[192:195], v[52:55], a[4:7]
    ds_read_b64_tr_b16 a[192:193], v6 offset:12416
    ds_read_b64_tr_b16 a[194:195], v6 offset:18560
    v_mfma_f32_16x16x32_bf16 a[8:11], a[196:199], v[48:51], a[8:11]
    s_mov_b32 m0, s48
    v_add_f32 v21, v21, v28
    v_add_f32 v23, v23, v29
    v_mfma_f32_16x16x32_bf16 a[12:15], a[196:199], v[52:55], a[12:15]
    ds_read_b64_tr_b16 a[196:197], v7 offset:12416
    ds_read_b64_tr_b16 a[198:199], v7 offset:18560
    v_mfma_f32_16x16x32_bf16 a[16:19], a[200:203], v[48:51], a[16:19]
    s_waitcnt lgkmcnt(4)
    buffer_load_dwordx4 v8, s[16:19], s55 offen nt lds
    v_mfma_f32_16x16x32_bf16 a[20:23], a[200:203], v[52:55], a[20:23]
    ds_read_b64_tr_b16 a[200:201], v4 offset:12544
    ds_read_b64_tr_b16 a[202:203], v4 offset:18688
    v_mfma_f32_16x16x32_bf16 a[24:27], a[204:207], v[48:51], a[24:27]
    buffer_load_dwordx4 v9, s[16:19], s55 offen offset:1024 nt lds
    v_mfma_f32_16x16x32_bf16 a[28:31], a[204:207], v[52:55], a[28:31]
    ds_read_b64_tr_b16 a[204:205], v5 offset:12544
    ds_read_b64_tr_b16 a[206:207], v5 offset:18688
    v_mfma_f32_16x16x32_bf16 a[32:35], a[208:211], v[48:51], a[32:35]
    buffer_load_dwordx4 v10, s[16:19], s55 offen offset:2048 nt lds
    v_mfma_f32_16x16x32_bf16 a[36:39], a[208:211], v[52:55], a[36:39]
    ds_read_b64_tr_b16 a[208:209], v6 offset:12544
    ds_read_b64_tr_b16 a[210:211], v6 offset:18688
    v_mfma_f32_16x16x32_bf16 a[40:43], a[212:215], v[48:51], a[40:43]
    s_waitcnt lgkmcnt(4)
    s_mov_b32 s32, s31
    v_mfma_f32_16x16x32_bf16 a[44:47], a[212:215], v[52:55], a[44:47]
    ds_read_b64_tr_b16 a[212:213], v7 offset:12544
    ds_read_b64_tr_b16 a[214:215], v7 offset:18688
    v_mfma_f32_16x16x32_bf16 a[48:51], a[192:195], v[48:51], a[48:51]
    s_add_u32 s28, s28, 32
    s_mul_hi_u32 s30, s28, s38
    v_mfma_f32_16x16x32_bf16 a[52:55], a[192:195], v[52:55], a[52:55]
    ds_read_b128 a[192:195], v2 offset:36864
    v_mfma_f32_16x16x32_bf16 a[56:59], a[196:199], v[48:51], a[56:59]
    s_mul_i32 s30, s30, 196608
    s_mul_i32 s31, s28, 98304
    v_mfma_f32_16x16x32_bf16 a[60:63], a[196:199], v[52:55], a[60:63]
    ds_read_b128 a[196:199], v3 offset:36864
    v_mfma_f32_16x16x32_bf16 a[64:67], a[200:203], v[48:51], a[64:67]
    s_cmp_lt_u32 s34, 2
    v_mfma_f32_16x16x32_bf16 a[68:71], a[200:203], v[52:55], a[68:71]
    ds_read_b128 a[200:203], v2 offset:36992
    s_waitcnt lgkmcnt(3)
    v_mfma_f32_16x16x32_bf16 a[72:75], a[204:207], v[48:51], a[72:75]
    s_cselect_b32 s33, 196608, 0
    v_mfma_f32_16x16x32_bf16 a[76:79], a[204:207], v[52:55], a[76:79]
    ds_read_b128 a[204:207], v3 offset:36992
    s_cselect_b32 s22, 98304, 0
    v_mfma_f32_16x16x32_bf16 a[80:83], a[208:211], v[48:51], a[80:83]
    s_add_u32 s20, s4, s31
    v_mfma_f32_16x16x32_bf16 a[84:87], a[208:211], v[52:55], a[84:87]
    ds_read_b128 a[208:211], v2 offset:37120
    s_addc_u32 s21, s5, 0
    v_mfma_f32_16x16x32_bf16 a[88:91], a[212:215], v[48:51], a[88:91]
    v_mfma_f32_16x16x32_bf16 a[92:95], a[212:215], v[52:55], a[92:95]
    ds_read_b128 a[212:215], v3 offset:37120
    v_mfma_f32_16x16x32_bf16 v[28:31], a[248:251], v[40:43], 0
    s_waitcnt vmcnt(9)
    s_barrier
    v_mfma_f32_16x16x32_bf16 v[28:31], a[252:255], v[44:47], v[28:31]
    s_waitcnt lgkmcnt(3)
    v_mfma_f32_16x16x32_bf16 v[96:99], a[192:195], a[144:147], 0
    v_fma_f32 v36, v80, s35, v26
    v_fma_f32 v37, v81, s35, v26
    v_mfma_f32_16x16x32_bf16 v[96:99], a[196:199], a[148:151], v[96:99]
    v_exp_f32 v36, v36
    v_mfma_f32_16x16x32_bf16 v[96:99], a[200:203], a[152:155], v[96:99]
    s_mov_b32 m0, s44
    v_cmp_nge_f32 vcc, s37, v30
    v_mfma_f32_16x16x32_bf16 v[104:107], a[192:195], a[168:171], 0
    v_exp_f32 v37, v37
    v_mfma_f32_16x16x32_bf16 v[104:107], a[196:199], a[172:175], v[104:107]
    buffer_load_dwordx4 v8, s[12:15], s57 offen nt lds
    v_mfma_f32_16x16x32_bf16 v[104:107], a[200:203], a[176:179], v[104:107]
    v_fma_f32 v38, v82, s35, v26
    s_cbranch_vccnz L_tr_T2f_A
L_ret_T2f_A:
    v_mfma_f32_16x16x32_bf16 v[64:67], a[192:195], a[96:99], 0
    v_add_f32 v17, v17, v28
    v_add_f32 v19, v19, v29
    v_mfma_f32_16x16x32_bf16 v[64:67], a[196:199], a[100:103], v[64:67]
    v_exp_f32 v38, v38
    v_mfma_f32_16x16x32_bf16 v[64:67], a[200:203], a[104:107], v[64:67]
    buffer_load_dwordx4 v9, s[12:15], s57 offen offset:1024 nt lds
    v_mfma_f32_16x16x32_bf16 v[72:75], a[192:195], a[120:123], 0
    ds_read_b128 a[192:195], v2 offset:43008
    v_fma_f32 v39, v83, s35, v26
    v_mfma_f32_16x16x32_bf16 v[72:75], a[196:199], a[124:127], v[72:75]
    v_exp_f32 v39, v39
    v_mfma_f32_16x16x32_bf16 v[72:75], a[200:203], a[128:131], v[72:75]
    ds_read_b128 a[196:199], v3 offset:43008
    s_waitcnt lgkmcnt(2)
    v_mfma_f32_16x16x32_bf16 v[64:67], a[204:207], a[108:111], v[64:67]
    buffer_load_dwordx4 v10, s[12:15], s57 offen offset:2048 nt lds
    v_mfma_f32_16x16x32_bf16 v[64:67], a[208:211], a[112:115], v[64:67]
    ds_read_b128 a[200:203], v2 offset:43136
    v_cvt_pk_bf16_f32 v56, v36, v37
    v_mfma_f32_16x16x32_bf16 v[64:67], a[212:215], a[116:119], v[64:67]
    v_fma_f32 v0, v84, s35, v26
    v_fma_f32 v36, v85, s35, v26
    v_mfma_f32_16x16x32_bf16 v[72:75], a[204:207], a[132:135], v[72:75]
    v_exp_f32 v0, v0
    v_mfma_f32_16x16x32_bf16 v[72:75], a[208:211], a[136:139], v[72:75]
    v_exp_f32 v36, v36
    v_mfma_f32_16x16x32_bf16 v[72:75], a[212:215], a[140:143], v[72:75]
    v_cvt_pk_bf16_f32 v57, v38, v39
    v_fma_f32 v37, v86, s35, v26
    v_mfma_f32_16x16x32_bf16 v[96:99], a[204:207], a[156:159], v[96:99]
    v_exp_f32 v37, v37
    v_mfma_f32_16x16x32_bf16 v[96:99], a[208:211], a[160:163], v[96:99]
    v_fma_f32 v38, v87, s35, v26
    v_cvt_pk_bf16_f32 v58, v0, v36
    v_mfma_f32_16x16x32_bf16 v[96:99], a[212:215], a[164:167], v[96:99]
    v_exp_f32 v38, v38
    v_mfma_f32_16x16x32_bf16 v[104:107], a[204:207], a[180:183], v[104:107]
    ds_read_b128 a[204:207], v3 offset:43136
    v_fma_f32 v39, v88, s35, v27
    v_mfma_f32_16x16x32_bf16 v[104:107], a[208:211], a[184:187], v[104:107]
    v_exp_f32 v39, v39
    v_mfma_f32_16x16x32_bf16 v[104:107], a[212:215], a[188:191], v[104:107]
    ds_read_b128 a[208:211], v2 offset:43264
    s_waitcnt lgkmcnt(2)
    v_mfma_f32_16x16x32_bf16 v[68:71], a[192:195], a[96:99], 0
    v_fma_f32 v0, v89, s35, v27
    v_mfma_f32_16x16x32_bf16 v[68:71], a[196:199], a[100:103], v[68:71]
    ds_read_b128 a[212:215], v3 offset:43264
    v_cvt_pk_bf16_f32 v59, v37, v38
    v_mfma_f32_16x16x32_bf16 v[68:71], a[200:203], a[104:107], v[68:71]
    v_exp_f32 v0, v0
    v_mfma_f32_16x16x32_bf16 v[76:79], a[192:195], a[120:123], 0
    v_fma_f32 v36, v90, s35, v27
    v_mfma_f32_16x16x32_bf16 v[76:79], a[196:199], a[124:127], v[76:79]
    v_exp_f32 v36, v36
    v_mfma_f32_16x16x32_bf16 v[76:79], a[200:203], a[128:131], v[76:79]
    v_fma_f32 v37, v91, s35, v27
    v_mfma_f32_16x16x32_bf16 v[100:103], a[192:195], a[144:147], 0
    v_exp_f32 v37, v37
    v_mfma_f32_16x16x32_bf16 v[100:103], a[196:199], a[148:151], v[100:103]
    v_cvt_pk_bf16_f32 v60, v39, v0
    v_fma_f32 v38, v92, s35, v27
    v_mfma_f32_16x16x32_bf16 v[100:103], a[200:203], a[152:155], v[100:103]
    s_waitcnt lgkmcnt(0)
    v_fma_f32 v39, v93, s35, v27
    v_mfma_f32_16x16x32_bf16 v[108:111], a[192:195], a[168:171], 0
    ds_read_b64_tr_b16 a[192:193], v4 offset:24576
    ds_read_b64_tr_b16 a[194:195], v4 offset:30720
    v_mfma_f32_16x16x32_bf16 v[108:111], a[196:199], a[172:175], v[108:111]
    v_exp_f32 v38, v38
    v_mfma_f32_16x16x32_bf16 v[108:111], a[200:203], a[176:179], v[108:111]
    ds_read_b64_tr_b16 a[196:197], v5 offset:24576
    ds_read_b64_tr_b16 a[198:199], v5 offset:30720
    v_mfma_f32_16x16x32_bf16 v[68:71], a[204:207], a[108:111], v[68:71]
    v_exp_f32 v39, v39
    v_mfma_f32_16x16x32_bf16 v[68:71], a[208:211], a[112:115], v[68:71]
    ds_read_b64_tr_b16 a[200:201], v6 offset:24576
    ds_read_b64_tr_b16 a[202:203], v6 offset:30720
    v_mfma_f32_16x16x32_bf16 v[68:71], a[212:215], a[116:119], v[68:71]
    v_cvt_pk_bf16_f32 v61, v36, v37
    v_mfma_f32_16x16x32_bf16 v[76:79], a[204:207], a[132:135], v[76:79]
    v_fma_f32 v0, v94, s35, v27
    v_mfma_f32_16x16x32_bf16 v[76:79], a[208:211], a[136:139], v[76:79]
    v_exp_f32 v0, v0
    v_mfma_f32_16x16x32_bf16 v[76:79], a[212:215], a[140:143], v[76:79]
    v_fma_f32 v36, v95, s35, v27
    v_cvt_pk_bf16_f32 v62, v38, v39
    v_mfma_f32_16x16x32_bf16 v[100:103], a[204:207], a[156:159], v[100:103]
    v_exp_f32 v36, v36
    v_mfma_f32_16x16x32_bf16 v[100:103], a[208:211], a[160:163], v[100:103]
    v_cvt_pk_bf16_f32 v63, v0, v36
    v_mfma_f32_16x16x32_bf16 v[100:103], a[212:215], a[164:167], v[100:103]
    v_fma_f32 v37, v64, s35, v24
    v_mfma_f32_16x16x32_bf16 v[108:111], a[204:207], a[180:183], v[108:111]
    ds_read_b64_tr_b16 a[204:205], v7 offset:24576
    ds_read_b64_tr_b16 a[206:207], v7 offset:30720
    v_mfma_f32_16x16x32_bf16 v[108:111], a[208:211], a[184:187], v[108:111]
    s_mov_b32 m0, s49
    v_fma_f32 v38, v65, s35, v24
    v_mfma_f32_16x16x32_bf16 v[108:111], a[212:215], a[188:191], v[108:111]
    ds_read_b64_tr_b16 a[208:209], v4 offset:24704
    ds_read_b64_tr_b16 a[210:211], v4 offset:30848
    v_mfma_f32_16x16x32_bf16 v[28:31], a[248:251], v[56:59], 0
    buffer_load_dwordx4 v8, s[16:19], s56 offen nt lds
    v_mfma_f32_16x16x32_bf16 v[28:31], a[252:255], v[60:63], v[28:31]
    ds_read_b64_tr_b16 a[212:213], v5 offset:24704
    ds_read_b64_tr_b16 a[214:215], v5 offset:30848
    s_waitcnt lgkmcnt(6)
    v_mfma_f32_16x16x32_bf16 v[112:115], a[192:195], v[40:43], v[112:115]
    v_exp_f32 v37, v37
    v_mfma_f32_16x16x32_bf16 v[116:119], a[192:195], v[44:47], v[116:119]
    v_exp_f32 v38, v38
    v_mfma_f32_16x16x32_bf16 v[120:123], a[196:199], v[40:43], v[120:123]
    v_cmp_nge_f32 vcc, s37, v30
    v_mfma_f32_16x16x32_bf16 v[124:127], a[196:199], v[44:47], v[124:127]
    v_fma_f32 v39, v66, s35, v24
    v_fma_f32 v0, v67, s35, v24
    v_mfma_f32_16x16x32_bf16 v[128:131], a[200:203], v[40:43], v[128:131]
    v_exp_f32 v39, v39
    v_mfma_f32_16x16x32_bf16 v[132:135], a[200:203], v[44:47], v[132:135]
    v_cvt_pk_bf16_f32 v48, v37, v38
    s_cbranch_vccnz L_tr_T2f_B
L_ret_T2f_B:
    v_mfma_f32_16x16x32_bf16 a[0:3], a[192:195], v[56:59], a[0:3]
    v_add_f32 v21, v21, v28
    v_add_f32 v23, v23, v29
    v_mfma_f32_16x16x32_bf16 a[4:7], a[192:195], v[60:63], a[4:7]
    ds_read_b64_tr_b16 a[192:193], v6 offset:24704
    ds_read_b64_tr_b16 a[194:195], v6 offset:30848
    v_mfma_f32_16x16x32_bf16 a[8:11], a[196:199], v[56:59], a[8:11]
    buffer_load_dwordx4 v9, s[16:19], s56 offen offset:1024 nt lds
    v_mfma_f32_16x16x32_bf16 a[12:15], a[196:199], v[60:63], a[12:15]
    ds_read_b64_tr_b16 a[196:197], v7 offset:24704
    ds_read_b64_tr_b16 a[198:199], v7 offset:30848
    v_mfma_f32_16x16x32_bf16 a[16:19], a[200:203], v[56:59], a[16:19]
    s_waitcnt lgkmcnt(4)
    v_fma_f32 v36, v72, s35, v25
    v_mfma_f32_16x16x32_bf16 a[20:23], a[200:203], v[60:63], a[20:23]
    ds_read_b64_tr_b16 a[200:201], v4 offset:24832
    ds_read_b64_tr_b16 a[202:203], v4 offset:30976
    v_mfma_f32_16x16x32_bf16 v[136:139], a[204:207], v[40:43], v[136:139]
    v_exp_f32 v0, v0
    v_mfma_f32_16x16x32_bf16 v[140:143], a[204:207], v[44:47], v[140:143]
    v_exp_f32 v36, v36
    v_mfma_f32_16x16x32_bf16 a[24:27], a[204:207], v[56:59], a[24:27]
    v_fma_f32 v37, v73, s35, v25
    v_cvt_pk_bf16_f32 v49, v39, v0
    v_mfma_f32_16x16x32_bf16 a[28:31], a[204:207], v[60:63], a[28:31]
    ds_read_b64_tr_b16 a[204:205], v5 offset:24832
    ds_read_b64_tr_b16 a[206:207], v5 offset:30976
    v_mfma_f32_16x16x32_bf16 v[144:147], a[208:211], v[40:43], v[144:147]
    buffer_load_dwordx4 v10, s[16:19], s56 offen offset:2048 nt lds
    v_mfma_f32_16x16x32_bf16 v[148:151], a[208:211], v[44:47], v[148:151]
    v_exp_f32 v37, v37
    v_mfma_f32_16x16x32_bf16 a[32:35], a[208:211], v[56:59], a[32:35]
    v_fma_f32 v38, v74, s35, v25
    v_mfma_f32_16x16x32_bf16 a[36:39], a[208:211], v[60:63], a[36:39]
    ds_read_b64_tr_b16 a[208:209], v6 offset:24832
    ds_read_b64_tr_b16 a[210:211], v6 offset:30976
    v_mfma_f32_16x16x32_bf16 v[152:155], a[212:215], v[40:43], v[152:155]
    v_exp_f32 v38, v38
    v_mfma_f32_16x16x32_bf16 v[156:159], a[212:215], v[44:47], v[156:159]
    v_fma_f32 v39, v75, s35, v25
    v_cvt_pk_bf16_f32 v52, v36, v37
    v_mfma_f32_16x16x32_bf16 a[40:43], a[212:215], v[56:59], a[40:43]
    s_waitcnt lgkmcnt(4)
    v_fma_f32 v0, v68, s35, v24
    v_mfma_f32_16x16x32_bf16 a[44:47], a[212:215], v[60:63], a[44:47]
    ds_read_b64_tr_b16 a[212:213], v7 offset:24832
    ds_read_b64_tr_b16 a[214:215], v7 offset:30976
    v_mfma_f32_16x16x32_bf16 v[160:163], a[192:195], v[40:43], v[160:163]
    v_exp_f32 v39, v39
    v_mfma_f32_16x16x32_bf16 v[164:167], a[192:195], v[44:47], v[164:167]
    v_exp_f32 v0, v0
    v_mfma_f32_16x16x32_bf16 a[48:51], a[192:195], v[56:59], a[48:51]
    v_fma_f32 v36, v69, s35, v24
    v_mfma_f32_16x16x32_bf16 a[52:55], a[192:195], v[60:63], a[52:55]
    ds_read_b128 a[192:195], v2 offset:0
    v_mfma_f32_16x16x32_bf16 v[168:171], a[196:199], v[40:43], v[168:171]
    v_exp_f32 v36, v36
    v_mfma_f32_16x16x32_bf16 v[172:175], a[196:199], v[44:47], v[172:175]
    v_cvt_pk_bf16_f32 v53, v38, v39
    v_fma_f32 v37, v70, s35, v24
    v_mfma_f32_16x16x32_bf16 a[56:59], a[196:199], v[56:59], a[56:59]
    v_exp_f32 v37, v37
    v_mfma_f32_16x16x32_bf16 a[60:63], a[196:199], v[60:63], a[60:63]
    ds_read_b128 a[196:199], v3 offset:0
    v_mfma_f32_16x16x32_bf16 v[176:179], a[200:203], v[40:43], v[176:179]
    v_fma_f32 v38, v71, s35, v24
    v_cvt_pk_bf16_f32 v50, v0, v36
    v_mfma_f32_16x16x32_bf16 v[180:183], a[200:203], v[44:47], v[180:183]
    v_exp_f32 v38, v38
    v_mfma_f32_16x16x32_bf16 a[64:67], a[200:203], v[56:59], a[64:67]
    v_fma_f32 v39, v76, s35, v25
    v_mfma_f32_16x16x32_bf16 a[68:71], a[200:203], v[60:63], a[68:71]
    ds_read_b128 a[200:203], v2 offset:128
    s_waitcnt lgkmcnt(3)
    v_mfma_f32_16x16x32_bf16 v[184:187], a[204:207], v[40:43], v[184:187]
    v_exp_f32 v39, v39
    v_mfma_f32_16x16x32_bf16 v[188:191], a[204:207], v[44:47], v[188:191]
    v_fma_f32 v0, v77, s35, v25
    v_mfma_f32_16x16x32_bf16 a[72:75], a[204:207], v[56:59], a[72:75]
    v_exp_f32 v0, v0
    v_mfma_f32_16x16x32_bf16 a[76:79], a[204:207], v[60:63], a[76:79]
    ds_read_b128 a[204:207], v3 offset:128
    v_cvt_pk_bf16_f32 v51, v37, v38
    v_mfma_f32_16x16x32_bf16 v[192:195], a[208:211], v[40:43], v[192:195]
    v_fma_f32 v36, v78, s35, v25
    v_fma_f32 v37, v79, s35, v25
    v_mfma_f32_16x16x32_bf16 v[196:199], a[208:211], v[44:47], v[196:199]
    v_exp_f32 v36, v36
    v_mfma_f32_16x16x32_bf16 a[80:83], a[208:211], v[56:59], a[80:83]
    v_exp_f32 v37, v37
    v_mfma_f32_16x16x32_bf16 a[84:87], a[208:211], v[60:63], a[84:87]
    ds_read_b128 a[208:211], v2 offset:256
    v_mfma_f32_16x16x32_bf16 v[200:203], a[212:215], v[40:43], v[200:203]
    v_cvt_pk_bf16_f32 v54, v39, v0
    v_mfma_f32_16x16x32_bf16 v[204:207], a[212:215], v[44:47], v[204:207]
    v_cvt_pk_bf16_f32 v55, v36, v37
    v_mfma_f32_16x16x32_bf16 a[88:91], a[212:215], v[56:59], a[88:91]
    v_mfma_f32_16x16x32_bf16 a[92:95], a[212:215], v[60:63], a[92:95]
    ds_read_b128 a[212:215], v3 offset:256
    v_mfma_f32_16x16x32_bf16 v[28:31], a[248:251], v[48:51], 0
    s_waitcnt vmcnt(9)
    s_barrier
    v_mfma_f32_16x16x32_bf16 v[28:31], a[252:255], v[52:55], v[28:31]
    s_waitcnt lgkmcnt(3)
    v_mfma_f32_16x16x32_bf16 v[80:83], a[192:195], a[144:147], 0
    v_fma_f32 v36, v96, s35, v26
    v_fma_f32 v37, v97, s35, v26
    v_mfma_f32_16x16x32_bf16 v[80:83], a[196:199], a[148:151], v[80:83]
    v_exp_f32 v36, v36
    v_mfma_f32_16x16x32_bf16 v[80:83], a[200:203], a[152:155], v[80:83]
    s_mov_b32 m0, s45
    v_cmp_nge_f32 vcc, s37, v30
    v_mfma_f32_16x16x32_bf16 v[88:91], a[192:195], a[168:171], 0
    v_exp_f32 v37, v37
    v_mfma_f32_16x16x32_bf16 v[88:91], a[196:199], a[172:175], v[88:91]
    buffer_load_dwordx4 v8, s[12:15], s58 offen nt lds
    v_mfma_f32_16x16x32_bf16 v[88:91], a[200:203], a[176:179], v[88:91]
    v_fma_f32 v38, v98, s35, v26
    s_cbranch_vccnz L_tr_T3f_A
L_ret_T3f_A:
    v_mfma_f32_16x16x32_bf16 v[64:67], a[192:195], a[96:99], 0
    v_add_f32 v17, v17, v28
    v_add_f32 v19, v19, v29
    v_mfma_f32_16x16x32_bf16 v[64:67], a[196:199], a[100:103], v[64:67]
    v_exp_f32 v38, v38
    v_mfma_f32_16x16x32_bf16 v[64:67], a[200:203], a[104:107], v[64:67]
    buffer_load_dwordx4 v9, s[12:15], s58 offen offset:1024 nt lds
    v_mfma_f32_16x16x32_bf16 v[72:75], a[192:195], a[120:123], 0
    ds_read_b128 a[192:195], v2 offset:6144
    v_fma_f32 v39, v99, s35, v26
    v_mfma_f32_16x16x32_bf16 v[72:75], a[196:199], a[124:127], v[72:75]
    v_exp_f32 v39, v39
    v_mfma_f32_16x16x32_bf16 v[72:75], a[200:203], a[128:131], v[72:75]
    ds_read_b128 a[196:199], v3 offset:6144
    s_waitcnt lgkmcnt(2)
    v_mfma_f32_16x16x32_bf16 v[64:67], a[204:207], a[108:111], v[64:67]
    buffer_load_dwordx4 v10, s[12:15], s58 offen offset:2048 nt lds
    v_mfma_f32_16x16x32_bf16 v[64:67], a[208:211], a[112:115], v[64:67]
    ds_read_b128 a[200:203], v2 offset:6272
    v_cvt_pk_bf16_f32 v56, v36, v37
    v_mfma_f32_16x16x32_bf16 v[64:67], a[212:215], a[116:119], v[64:67]
    v_fma_f32 v0, v100, s35, v26
    v_fma_f32 v36, v101, s35, v26
    v_mfma_f32_16x16x32_bf16 v[72:75], a[204:207], a[132:135], v[72:75]
    v_exp_f32 v0, v0
    v_mfma_f32_16x16x32_bf16 v[72:75], a[208:211], a[136:139], v[72:75]
    v_exp_f32 v36, v36
    v_mfma_f32_16x16x32_bf16 v[72:75], a[212:215], a[140:143], v[72:75]
    v_cvt_pk_bf16_f32 v57, v38, v39
    v_fma_f32 v37, v102, s35, v26
    v_mfma_f32_16x16x32_bf16 v[80:83], a[204:207], a[156:159], v[80:83]
    v_exp_f32 v37, v37
    v_mfma_f32_16x16x32_bf16 v[80:83], a[208:211], a[160:163], v[80:83]
    v_fma_f32 v38, v103, s35, v26
    v_cvt_pk_bf16_f32 v58, v0, v36
    v_mfma_f32_16x16x32_bf16 v[80:83], a[212:215], a[164:167], v[80:83]
    v_exp_f32 v38, v38
    v_mfma_f32_16x16x32_bf16 v[88:91], a[204:207], a[180:183], v[88:91]
    ds_read_b128 a[204:207], v3 offset:6272
    v_fma_f32 v39, v104, s35, v27
    v_mfma_f32_16x16x32_bf16 v[88:91], a[208:211], a[184:187], v[88:91]
    v_exp_f32 v39, v39
    v_mfma_f32_16x16x32_bf16 v[88:91], a[212:215], a[188:191], v[88:91]
    ds_read_b128 a[208:211], v2 offset:6400
    s_waitcnt lgkmcnt(2)
    v_mfma_f32_16x16x32_bf16 v[68:71], a[192:195], a[96:99], 0
    v_fma_f32 v0, v105, s35, v27
    v_mfma_f32_16x16x32_bf16 v[68:71], a[196:199], a[100:103], v[68:71]
    ds_read_b128 a[212:215], v3 offset:6400
    v_cvt_pk_bf16_f32 v59, v37, v38
    v_mfma_f32_16x16x32_bf16 v[68:71], a[200:203], a[104:107], v[68:71]
    v_exp_f32 v0, v0
    v_mfma_f32_16x16x32_bf16 v[76:79], a[192:195], a[120:123], 0
    v_fma_f32 v36, v106, s35, v27
    v_mfma_f32_16x16x32_bf16 v[76:79], a[196:199], a[124:127], v[76:79]
    v_exp_f32 v36, v36
    v_mfma_f32_16x16x32_bf16 v[76:79], a[200:203], a[128:131], v[76:79]
    v_fma_f32 v37, v107, s35, v27
    v_mfma_f32_16x16x32_bf16 v[84:87], a[192:195], a[144:147], 0
    v_exp_f32 v37, v37
    v_mfma_f32_16x16x32_bf16 v[84:87], a[196:199], a[148:151], v[84:87]
    v_cvt_pk_bf16_f32 v60, v39, v0
    v_fma_f32 v38, v108, s35, v27
    v_mfma_f32_16x16x32_bf16 v[84:87], a[200:203], a[152:155], v[84:87]
    s_waitcnt lgkmcnt(0)
    v_fma_f32 v39, v109, s35, v27
    v_mfma_f32_16x16x32_bf16 v[92:95], a[192:195], a[168:171], 0
    ds_read_b64_tr_b16 a[192:193], v4 offset:36864
    ds_read_b64_tr_b16 a[194:195], v4 offset:43008
    v_mfma_f32_16x16x32_bf16 v[92:95], a[196:199], a[172:175], v[92:95]
    v_exp_f32 v38, v38
    v_mfma_f32_16x16x32_bf16 v[92:95], a[200:203], a[176:179], v[92:95]
    ds_read_b64_tr_b16 a[196:197], v5 offset:36864
    ds_read_b64_tr_b16 a[198:199], v5 offset:43008
    v_mfma_f32_16x16x32_bf16 v[68:71], a[204:207], a[108:111], v[68:71]
    v_exp_f32 v39, v39
    v_mfma_f32_16x16x32_bf16 v[68:71], a[208:211], a[112:115], v[68:71]
    ds_read_b64_tr_b16 a[200:201], v6 offset:36864
    ds_read_b64_tr_b16 a[202:203], v6 offset:43008
    v_mfma_f32_16x16x32_bf16 v[68:71], a[212:215], a[116:119], v[68:71]
    v_cvt_pk_bf16_f32 v61, v36, v37
    v_mfma_f32_16x16x32_bf16 v[76:79], a[204:207], a[132:135], v[76:79]
    v_fma_f32 v0, v110, s35, v27
    v_mfma_f32_16x16x32_bf16 v[76:79], a[208:211], a[136:139], v[76:79]
    v_exp_f32 v0, v0
    v_mfma_f32_16x16x32_bf16 v[76:79], a[212:215], a[140:143], v[76:79]
    v_fma_f32 v36, v111, s35, v27
    v_cvt_pk_bf16_f32 v62, v38, v39
    v_mfma_f32_16x16x32_bf16 v[84:87], a[204:207], a[156:159], v[84:87]
    v_exp_f32 v36, v36
    v_mfma_f32_16x16x32_bf16 v[84:87], a[208:211], a[160:163], v[84:87]
    v_cvt_pk_bf16_f32 v63, v0, v36
    v_mfma_f32_16x16x32_bf16 v[84:87], a[212:215], a[164:167], v[84:87]
    v_fma_f32 v37, v64, s35, v24
    v_mfma_f32_16x16x32_bf16 v[92:95], a[204:207], a[180:183], v[92:95]
L_hop_1:
    s_cbranch_execz L_hop_5
    ds_read_b64_tr_b16 a[204:205], v7 offset:36864
    ds_read_b64_tr_b16 a[206:207], v7 offset:43008
    v_mfma_f32_16x16x32_bf16 v[92:95], a[208:211], a[184:187], v[92:95]
    s_mov_b32 m0, s50
    v_fma_f32 v38, v65, s35, v24
    v_mfma_f32_16x16x32_bf16 v[92:95], a[212:215], a[188:191], v[92:95]
    ds_read_b64_tr_b16 a[208:209], v4 offset:36992
    ds_read_b64_tr_b16 a[210:211], v4 offset:43136
    v_mfma_f32_16x16x32_bf16 v[28:31], a[248:251], v[56:59], 0
    buffer_load_dwordx4 v8, s[16:19], s57 offen nt lds
    v_mfma_f32_16x16x32_bf16 v[28:31], a[252:255], v[60:63], v[28:31]
    ds_read_b64_tr_b16 a[212:213], v5 offset:36992
    ds_read_b64_tr_b16 a[214:215], v5 offset:43136
    s_waitcnt lgkmcnt(6)
    v_mfma_f32_16x16x32_bf16 v[112:115], a[192:195], v[48:51], v[112:115]
    v_exp_f32 v37, v37
    v_mfma_f32_16x16x32_bf16 v[116:119], a[192:195], v[52:55], v[116:119]
    v_exp_f32 v38, v38
    v_mfma_f32_16x16x32_bf16 v[120:123], a[196:199], v[48:51], v[120:123]
    v_cmp_nge_f32 vcc, s37, v30
    v_mfma_f32_16x16x32_bf16 v[124:127], a[196:199], v[52:55], v[124:127]
    v_fma_f32 v39, v66, s35, v24
    v_fma_f32 v0, v67, s35, v24
    v_mfma_f32_16x16x32_bf16 v[128:131], a[200:203], v[48:51], v[128:131]
    v_exp_f32 v39, v39
    v_mfma_f32_16x16x32_bf16 v[132:135], a[200:203], v[52:55], v[132:135]
    v_cvt_pk_bf16_f32 v40, v37, v38
    s_cbranch_vccnz L_tr_T3f_B
L_ret_T3f_B:
    v_mfma_f32_16x16x32_bf16 a[0:3], a[192:195], v[56:59], a[0:3]
    v_add_f32 v21, v21, v28
    v_add_f32 v23, v23, v29
    v_mfma_f32_16x16x32_bf16 a[4:7], a[192:195], v[60:63], a[4:7]
    ds_read_b64_tr_b16 a[192:193], v6 offset:36992
    ds_read_b64_tr_b16 a[194:195], v6 offset:43136
    v_mfma_f32_16x16x32_bf16 a[8:11], a[196:199], v[56:59], a[8:11]
    buffer_load_dwordx4 v9, s[16:19], s57 offen offset:1024 nt lds
    v_mfma_f32_16x16x32_bf16 a[12:15], a[196:199], v[60:63], a[12:15]
    ds_read_b64_tr_b16 a[196:197], v7 offset:36992
    ds_read_b64_tr_b16 a[198:199], v7 offset:43136
    v_mfma_f32_16x16x32_bf16 a[16:19], a[200:203], v[56:59], a[16:19]
    s_waitcnt lgkmcnt(4)
    v_fma_f32 v36, v72, s35, v25
    v_mfma_f32_16x16x32_bf16 a[20:23], a[200:203], v[60:63], a[20:23]
    ds_read_b64_tr_b16 a[200:201], v4 offset:37120
    ds_read_b64_tr_b16 a[202:203], v4 offset:43264
    v_mfma_f32_16x16x32_bf16 v[136:139], a[204:207], v[48:51], v[136:139]
    v_exp_f32 v0, v0
    v_mfma_f32_16x16x32_bf16 v[140:143], a[204:207], v[52:55], v[140:143]
    v_exp_f32 v36, v36
    v_mfma_f32_16x16x32_bf16 a[24:27], a[204:207], v[56:59], a[24:27]
    v_fma_f32 v37, v73, s35, v25
    v_cvt_pk_bf16_f32 v41, v39, v0
    v_mfma_f32_16x16x32_bf16 a[28:31], a[204:207], v[60:63], a[28:31]
    ds_read_b64_tr_b16 a[204:205], v5 offset:37120
    ds_read_b64_tr_b16 a[206:207], v5 offset:43264
    v_mfma_f32_16x16x32_bf16 v[144:147], a[208:211], v[48:51], v[144:147]
    buffer_load_dwordx4 v10, s[16:19], s57 offen offset:2048 nt lds
    v_mfma_f32_16x16x32_bf16 v[148:151], a[208:211], v[52:55], v[148:151]
    v_exp_f32 v37, v37
    v_mfma_f32_16x16x32_bf16 a[32:35], a[208:211], v[56:59], a[32:35]
    v_fma_f32 v38, v74, s35, v25
    v_mfma_f32_16x16x32_bf16 a[36:39], a[208:211], v[60:63], a[36:39]
    ds_read_b64_tr_b16 a[208:209], v6 offset:37120
    ds_read_b64_tr_b16 a[210:211], v6 offset:43264
    v_mfma_f32_16x16x32_bf16 v[152:155], a[212:215], v[48:51], v[152:155]
    v_exp_f32 v38, v38
    v_mfma_f32_16x16x32_bf16 v[156:159], a[212:215], v[52:55], v[156:159]
    v_fma_f32 v39, v75, s35, v25
    v_cvt_pk_bf16_f32 v44, v36, v37
    v_mfma_f32_16x16x32_bf16 a[40:43], a[212:215], v[56:59], a[40:43]
    s_waitcnt lgkmcnt(4)
    v_fma_f32 v0, v68, s35, v24
    v_mfma_f32_16x16x32_bf16 a[44:47], a[212:215], v[60:63], a[44:47]
    ds_read_b64_tr_b16 a[212:213], v7 offset:37120
    ds_read_b64_tr_b16 a[214:215], v7 offset:43264
    v_mfma_f32_16x16x32_bf16 v[160:163], a[192:195], v[48:51], v[160:163]
    v_exp_f32 v39, v39
    v_mfma_f32_16x16x32_bf16 v[164:167], a[192:195], v[52:55], v[164:167]
    v_exp_f32 v0, v0
    v_mfma_f32_16x16x32_bf16 a[48:51], a[192:195], v[56:59], a[48:51]
    v_fma_f32 v36, v69, s35, v24
    v_mfma_f32_16x16x32_bf16 a[52:55], a[192:195], v[60:63], a[52:55]
    ds_read_b128 a[192:195], v2 offset:12288
    v_mfma_f32_16x16x32_bf16 v[168:171], a[196:199], v[48:51], v[168:171]
    v_exp_f32 v36, v36
    v_mfma_f32_16x16x32_bf16 v[172:175], a[196:199], v[52:55], v[172:175]
    v_cvt_pk_bf16_f32 v45, v38, v39
    v_fma_f32 v37, v70, s35, v24
    v_mfma_f32_16x16x32_bf16 a[56:59], a[196:199], v[56:59], a[56:59]
    v_exp_f32 v37, v37
    v_mfma_f32_16x16x32_bf16 a[60:63], a[196:199], v[60:63], a[60:63]
    ds_read_b128 a[196:199], v3 offset:12288
    v_mfma_f32_16x16x32_bf16 v[176:179], a[200:203], v[48:51], v[176:179]
    v_fma_f32 v38, v71, s35, v24
    v_cvt_pk_bf16_f32 v42, v0, v36
    v_mfma_f32_16x16x32_bf16 v[180:183], a[200:203], v[52:55], v[180:183]
    v_exp_f32 v38, v38
    v_mfma_f32_16x16x32_bf16 a[64:67], a[200:203], v[56:59], a[64:67]
    v_fma_f32 v39, v76, s35, v25
    v_mfma_f32_16x16x32_bf16 a[68:71], a[200:203], v[60:63], a[68:71]
    ds_read_b128 a[200:203], v2 offset:12416
    s_waitcnt lgkmcnt(3)
    v_mfma_f32_16x16x32_bf16 v[184:187], a[204:207], v[48:51], v[184:187]
    v_exp_f32 v39, v39
    v_mfma_f32_16x16x32_bf16 v[188:191], a[204:207], v[52:55], v[188:191]
    v_fma_f32 v0, v77, s35, v25
    v_mfma_f32_16x16x32_bf16 a[72:75], a[204:207], v[56:59], a[72:75]
    v_exp_f32 v0, v0
    v_mfma_f32_16x16x32_bf16 a[76:79], a[204:207], v[60:63], a[76:79]
    ds_read_b128 a[204:207], v3 offset:12416
    v_cvt_pk_bf16_f32 v43, v37, v38
    v_mfma_f32_16x16x32_bf16 v[192:195], a[208:211], v[48:51], v[192:195]
    v_fma_f32 v36, v78, s35, v25
    v_fma_f32 v37, v79, s35, v25
    v_mfma_f32_16x16x32_bf16 v[196:199], a[208:211], v[52:55], v[196:199]
    v_exp_f32 v36, v36
    v_mfma_f32_16x16x32_bf16 a[80:83], a[208:211], v[56:59], a[80:83]
    v_exp_f32 v37, v37
    v_mfma_f32_16x16x32_bf16 a[84:87], a[208:211], v[60:63], a[84:87]
    ds_read_b128 a[208:211], v2 offset:12544
    v_mfma_f32_16x16x32_bf16 v[200:203], a[212:215], v[48:51], v[200:203]
    v_cvt_pk_bf16_f32 v46, v39, v0
    v_mfma_f32_16x16x32_bf16 v[204:207], a[212:215], v[52:55], v[204:207]
    v_cvt_pk_bf16_f32 v47, v36, v37
    v_mfma_f32_16x16x32_bf16 a[88:91], a[212:215], v[56:59], a[88:91]
    v_mfma_f32_16x16x32_bf16 a[92:95], a[212:215], v[60:63], a[92:95]
    ds_read_b128 a[212:215], v3 offset:12544
    v_mfma_f32_16x16x32_bf16 v[28:31], a[248:251], v[40:43], 0
    s_waitcnt vmcnt(9)
    s_barrier
    v_mfma_f32_16x16x32_bf16 v[28:31], a[252:255], v[44:47], v[28:31]
    s_waitcnt lgkmcnt(3)
    v_mfma_f32_16x16x32_bf16 v[96:99], a[192:195], a[144:147], 0
    v_fma_f32 v36, v80, s35, v26
    v_fma_f32 v37, v81, s35, v26
    v_mfma_f32_16x16x32_bf16 v[96:99], a[196:199], a[148:151], v[96:99]
    v_exp_f32 v36, v36
    v_mfma_f32_16x16x32_bf16 v[96:99], a[200:203], a[152:155], v[96:99]
    s_mov_b32 m0, s42
    v_cmp_nge_f32 vcc, s37, v30
    v_mfma_f32_16x16x32_bf16 v[104:107], a[192:195], a[168:171], 0
    v_exp_f32 v37, v37
    v_mfma_f32_16x16x32_bf16 v[104:107], a[196:199], a[172:175], v[104:107]
    buffer_load_dwordx4 v8, s[12:15], s59 offen nt lds
    v_mfma_f32_16x16x32_bf16 v[104:107], a[200:203], a[176:179], v[104:107]
    v_fma_f32 v38, v82, s35, v26
    s_cbranch_vccnz L_tr_T4f_A
L_ret_T4f_A:
    v_mfma_f32_16x16x32_bf16 v[64:67], a[192:195], a[96:99], 0
    v_add_f32 v17, v17, v28
    v_add_f32 v19, v19, v29
    v_mfma_f32_16x16x32_bf16 v[64:67], a[196:199], a[100:103], v[64:67]
    v_exp_f32 v38, v38
    v_mfma_f32_16x16x32_bf16 v[64:67], a[200:203], a[104:107], v[64:67]
    buffer_load_dwordx4 v9, s[12:15], s59 offen offset:1024 nt lds
    v_mfma_f32_16x16x32_bf16 v[72:75], a[192:195], a[120:123], 0
    ds_read_b128 a[192:195], v2 offset:18432
    v_fma_f32 v39, v83, s35, v26
    v_mfma_f32_16x16x32_bf16 v[72:75], a[196:199], a[124:127], v[72:75]
    v_exp_f32 v39, v39
    v_mfma_f32_16x16x32_bf16 v[72:75], a[200:203], a[128:131], v[72:75]
    ds_read_b128 a[196:199], v3 offset:18432
    s_waitcnt lgkmcnt(2)
    v_mfma_f32_16x16x32_bf16 v[64:67], a[204:207], a[108:111], v[64:67]
    buffer_load_dwordx4 v10, s[12:15], s59 offen offset:2048 nt lds
    v_mfma_f32_16x16x32_bf16 v[64:67], a[208:211], a[112:115], v[64:67]
    ds_read_b128 a[200:203], v2 offset:18560
    v_cvt_pk_bf16_f32 v56, v36, v37
    v_mfma_f32_16x16x32_bf16 v[64:67], a[212:215], a[116:119], v[64:67]
    v_fma_f32 v0, v84, s35, v26
    v_fma_f32 v36, v85, s35, v26
    v_mfma_f32_16x16x32_bf16 v[72:75], a[204:207], a[132:135], v[72:75]
    v_exp_f32 v0, v0
    v_mfma_f32_16x16x32_bf16 v[72:75], a[208:211], a[136:139], v[72:75]
    v_exp_f32 v36, v36
    v_mfma_f32_16x16x32_bf16 v[72:75], a[212:215], a[140:143], v[72:75]
    v_cvt_pk_bf16_f32 v57, v38, v39
    v_fma_f32 v37, v86, s35, v26
    v_mfma_f32_16x16x32_bf16 v[96:99], a[204:207], a[156:159], v[96:99]
    v_exp_f32 v37, v37
    v_mfma_f32_16x16x32_bf16 v[96:99], a[208:211], a[160:163], v[96:99]
    v_fma_f32 v38, v87, s35, v26
    v_cvt_pk_bf16_f32 v58, v0, v36
    v_mfma_f32_16x16x32_bf16 v[96:99], a[212:215], a[164:167], v[96:99]
    v_exp_f32 v38, v38
    v_mfma_f32_16x16x32_bf16 v[104:107], a[204:207], a[180:183], v[104:107]
    ds_read_b128 a[204:207], v3 offset:18560
    v_fma_f32 v39, v88, s35, v27
    v_mfma_f32_16x16x32_bf16 v[104:107], a[208:211], a[184:187], v[104:107]
    v_exp_f32 v39, v39
    v_mfma_f32_16x16x32_bf16 v[104:107], a[212:215], a[188:191], v[104:107]
    ds_read_b128 a[208:211], v2 offset:18688
    s_waitcnt lgkmcnt(2)
    v_mfma_f32_16x16x32_bf16 v[68:71], a[192:195], a[96:99], 0
    v_fma_f32 v0, v89, s35, v27
    v_cvt_pk_bf16_f32 v59, v37, v38
    v_mfma_f32_16x16x32_bf16 v[68:71], a[196:199], a[100:103], v[68:71]
    ds_read_b128 a[212:215], v3 offset:18688
    v_fma_f32 v36, v90, s35, v27
    v_mfma_f32_16x16x32_bf16 v[68:71], a[200:203], a[104:107], v[68:71]
    v_exp_f32 v0, v0
    v_mfma_f32_16x16x32_bf16 v[76:79], a[192:195], a[120:123], 0
    v_exp_f32 v36, v36
    v_mfma_f32_16x16x32_bf16 v[76:79], a[196:199], a[124:127], v[76:79]
    v_fma_f32 v37, v91, s35, v27
    v_cvt_pk_bf16_f32 v60, v39, v0
    v_mfma_f32_16x16x32_bf16 v[76:79], a[200:203], a[128:131], v[76:79]
    v_exp_f32 v37, v37
    v_mfma_f32_16x16x32_bf16 v[100:103], a[192:195], a[144:147], 0
    v_fma_f32 v38, v92, s35, v27
    v_mfma_f32_16x16x32_bf16 v[100:103], a[196:199], a[148:151], v[100:103]
    v_exp_f32 v38, v38
    v_mfma_f32_16x16x32_bf16 v[100:103], a[200:203], a[152:155], v[100:103]
    s_waitcnt lgkmcnt(0)
    v_fma_f32 v39, v93, s35, v27
    v_mfma_f32_16x16x32_bf16 v[108:111], a[192:195], a[168:171], 0
    ds_read_b64_tr_b16 a[192:193], v4 offset:0
    ds_read_b64_tr_b16 a[194:195], v4 offset:6144
    v_mfma_f32_16x16x32_bf16 v[108:111], a[196:199], a[172:175], v[108:111]
    v_exp_f32 v39, v39
    v_mfma_f32_16x16x32_bf16 v[108:111], a[200:203], a[176:179], v[108:111]
    ds_read_b64_tr_b16 a[196:197], v5 offset:0
    ds_read_b64_tr_b16 a[198:199], v5 offset:6144
    v_mfma_f32_16x16x32_bf16 v[68:71], a[204:207], a[108:111], v[68:71]
    v_cvt_pk_bf16_f32 v61, v36, v37
    v_mfma_f32_16x16x32_bf16 v[68:71], a[208:211], a[112:115], v[68:71]
    ds_read_b64_tr_b16 a[200:201], v6 offset:0
    ds_read_b64_tr_b16 a[202:203], v6 offset:6144
    v_mfma_f32_16x16x32_bf16 v[68:71], a[212:215], a[116:119], v[68:71]
    v_fma_f32 v0, v94, s35, v27
    v_fma_f32 v36, v95, s35, v27
    v_mfma_f32_16x16x32_bf16 v[76:79], a[204:207], a[132:135], v[76:79]
    v_exp_f32 v0, v0
    v_mfma_f32_16x16x32_bf16 v[76:79], a[208:211], a[136:139], v[76:79]
    v_exp_f32 v36, v36
    v_mfma_f32_16x16x32_bf16 v[76:79], a[212:215], a[140:143], v[76:79]
    v_cvt_pk_bf16_f32 v62, v38, v39
    v_mfma_f32_16x16x32_bf16 v[100:103], a[204:207], a[156:159], v[100:103]
    v_cvt_pk_bf16_f32 v63, v0, v36
    v_fma_f32 v37, v64, s35, v24
    v_mfma_f32_16x16x32_bf16 v[100:103], a[208:211], a[160:163], v[100:103]
    v_exp_f32 v37, v37
    v_mfma_f32_16x16x32_bf16 v[100:103], a[212:215], a[164:167], v[100:103]
    v_fma_f32 v38, v65, s35, v24
    v_mfma_f32_16x16x32_bf16 v[108:111], a[204:207], a[180:183], v[108:111]
    ds_read_b64_tr_b16 a[204:205], v7 offset:0
    ds_read_b64_tr_b16 a[206:207], v7 offset:6144
    v_mfma_f32_16x16x32_bf16 v[108:111], a[208:211], a[184:187], v[108:111]
    s_mov_b32 m0, s51
    v_fma_f32 v39, v66, s35, v24
    v_mfma_f32_16x16x32_bf16 v[108:111], a[212:215], a[188:191], v[108:111]
    ds_read_b64_tr_b16 a[208:209], v4 offset:128
    ds_read_b64_tr_b16 a[210:211], v4 offset:6272
    v_mfma_f32_16x16x32_bf16 v[28:31], a[248:251], v[56:59], 0
    buffer_load_dwordx4 v8, s[16:19], s58 offen nt lds
    v_mfma_f32_16x16x32_bf16 v[28:31], a[252:255], v[60:63], v[28:31]
    ds_read_b64_tr_b16 a[212:213], v5 offset:128
    ds_read_b64_tr_b16 a[214:215], v5 offset:6272
    s_waitcnt lgkmcnt(6)
    v_mfma_f32_16x16x32_bf16 v[112:115], a[192:195], v[40:43], v[112:115]
    v_exp_f32 v38, v38
    v_mfma_f32_16x16x32_bf16 v[116:119], a[192:195], v[44:47], v[116:119]
    v_exp_f32 v39, v39
    v_mfma_f32_16x16x32_bf16 v[120:123], a[196:199], v[40:43], v[120:123]
    v_fma_f32 v0, v67, s35, v24
    v_cmp_nge_f32 vcc, s37, v30
    v_mfma_f32_16x16x32_bf16 v[124:127], a[196:199], v[44:47], v[124:127]
    v_exp_f32 v0, v0
    v_mfma_f32_16x16x32_bf16 v[128:131], a[200:203], v[40:43], v[128:131]
    v_cvt_pk_bf16_f32 v48, v37, v38
    v_mfma_f32_16x16x32_bf16 v[132:135], a[200:203], v[44:47], v[132:135]
    v_fma_f32 v36, v72, s35, v25
    s_cbranch_vccnz L_tr_T4f_B
L_ret_T4f_B:
    v_mfma_f32_16x16x32_bf16 a[0:3], a[192:195], v[56:59], a[0:3]
    v_add_f32 v21, v21, v28
    v_add_f32 v23, v23, v29
    v_mfma_f32_16x16x32_bf16 a[4:7], a[192:195], v[60:63], a[4:7]
    ds_read_b64_tr_b16 a[192:193], v6 offset:128
    ds_read_b64_tr_b16 a[194:195], v6 offset:6272
    v_mfma_f32_16x16x32_bf16 a[8:11], a[196:199], v[56:59], a[8:11]
    buffer_load_dwordx4 v9, s[16:19], s58 offen offset:1024 nt lds
    v_mfma_f32_16x16x32_bf16 a[12:15], a[196:199], v[60:63], a[12:15]
    ds_read_b64_tr_b16 a[196:197], v7 offset:128
    ds_read_b64_tr_b16 a[198:199], v7 offset:6272
    v_mfma_f32_16x16x32_bf16 a[16:19], a[200:203], v[56:59], a[16:19]
    s_waitcnt lgkmcnt(4)
    v_fma_f32 v37, v73, s35, v25
    v_mfma_f32_16x16x32_bf16 a[20:23], a[200:203], v[60:63], a[20:23]
    ds_read_b64_tr_b16 a[200:201], v4 offset:256
    ds_read_b64_tr_b16 a[202:203], v4 offset:6400
    v_mfma_f32_16x16x32_bf16 v[136:139], a[204:207], v[40:43], v[136:139]
    v_exp_f32 v36, v36
    v_mfma_f32_16x16x32_bf16 v[140:143], a[204:207], v[44:47], v[140:143]
    v_exp_f32 v37, v37
    v_mfma_f32_16x16x32_bf16 a[24:27], a[204:207], v[56:59], a[24:27]
    v_cvt_pk_bf16_f32 v49, v39, v0
    v_fma_f32 v38, v74, s35, v25
    v_mfma_f32_16x16x32_bf16 a[28:31], a[204:207], v[60:63], a[28:31]
    ds_read_b64_tr_b16 a[204:205], v5 offset:256
    ds_read_b64_tr_b16 a[206:207], v5 offset:6400
    v_mfma_f32_16x16x32_bf16 v[144:147], a[208:211], v[40:43], v[144:147]
    buffer_load_dwordx4 v10, s[16:19], s58 offen offset:2048 nt lds
    v_mfma_f32_16x16x32_bf16 v[148:151], a[208:211], v[44:47], v[148:151]
    v_exp_f32 v38, v38
    v_mfma_f32_16x16x32_bf16 a[32:35], a[208:211], v[56:59], a[32:35]
    v_fma_f32 v39, v75, s35, v25
    v_cvt_pk_bf16_f32 v52, v36, v37
    v_mfma_f32_16x16x32_bf16 a[36:39], a[208:211], v[60:63], a[36:39]
    ds_read_b64_tr_b16 a[208:209], v6 offset:256
    ds_read_b64_tr_b16 a[210:211], v6 offset:6400
    v_mfma_f32_16x16x32_bf16 v[152:155], a[212:215], v[40:43], v[152:155]
    v_exp_f32 v39, v39
    v_mfma_f32_16x16x32_bf16 v[156:159], a[212:215], v[44:47], v[156:159]
    s_mov_b32 m0, s88
    v_fma_f32 v0, v68, s35, v24
    v_mfma_f32_16x16x32_bf16 a[40:43], a[212:215], v[56:59], a[40:43]
    s_waitcnt lgkmcnt(4)
    v_fma_f32 v36, v69, s35, v24
    v_mfma_f32_16x16x32_bf16 a[44:47], a[212:215], v[60:63], a[44:47]
    ds_read_b64_tr_b16 a[212:213], v7 offset:256
    ds_read_b64_tr_b16 a[214:215], v7 offset:6400
    v_mfma_f32_16x16x32_bf16 v[160:163], a[192:195], v[40:43], v[160:163]
    buffer_load_dwordx4 v8, s[20:23], s80 offen nt lds
    v_mfma_f32_16x16x32_bf16 v[164:167], a[192:195], v[44:47], v[164:167]
    v_exp_f32 v0, v0
    v_mfma_f32_16x16x32_bf16 a[48:51], a[192:195], v[56:59], a[48:51]
    v_exp_f32 v36, v36
    v_mfma_f32_16x16x32_bf16 a[52:55], a[192:195], v[60:63], a[52:55]
    ds_read_b128 a[192:195], v2 offset:24576
    v_mfma_f32_16x16x32_bf16 v[168:171], a[196:199], v[40:43], v[168:171]
    v_cvt_pk_bf16_f32 v53, v38, v39
    v_fma_f32 v37, v70, s35, v24
    v_mfma_f32_16x16x32_bf16 v[172:175], a[196:199], v[44:47], v[172:175]
    v_exp_f32 v37, v37
    v_mfma_f32_16x16x32_bf16 a[56:59], a[196:199], v[56:59], a[56:59]
    v_fma_f32 v38, v71, s35, v24
    v_cvt_pk_bf16_f32 v50, v0, v36
    v_mfma_f32_16x16x32_bf16 a[60:63], a[196:199], v[60:63], a[60:63]
    ds_read_b128 a[196:199], v3 offset:24576
    v_mfma_f32_16x16x32_bf16 v[176:179], a[200:203], v[40:43], v[176:179]
    buffer_load_dwordx4 v9, s[20:23], s80 offen offset:1024 nt lds
    v_mfma_f32_16x16x32_bf16 v[180:183], a[200:203], v[44:47], v[180:183]
    v_exp_f32 v38, v38
    v_mfma_f32_16x16x32_bf16 a[64:67], a[200:203], v[56:59], a[64:67]
    v_fma_f32 v39, v76, s35, v25
    v_fma_f32 v0, v77, s35, v25
    v_mfma_f32_16x16x32_bf16 a[68:71], a[200:203], v[60:63], a[68:71]
    ds_read_b128 a[200:203], v2 offset:24704
    s_waitcnt lgkmcnt(3)
    v_mfma_f32_16x16x32_bf16 v[184:187], a[204:207], v[40:43], v[184:187]
    v_exp_f32 v39, v39
    v_mfma_f32_16x16x32_bf16 v[188:191], a[204:207], v[44:47], v[188:191]
    v_exp_f32 v0, v0
    v_mfma_f32_16x16x32_bf16 a[72:75], a[204:207], v[56:59], a[72:75]
    v_cvt_pk_bf16_f32 v51, v37, v38
    v_mfma_f32_16x16x32_bf16 a[76:79], a[204:207], v[60:63], a[76:79]
    ds_read_b128 a[204:207], v3 offset:24704
    v_fma_f32 v36, v78, s35, v25
    v_mfma_f32_16x16x32_bf16 v[192:195], a[208:211], v[40:43], v[192:195]
    buffer_load_dwordx4 v10, s[20:23], s80 offen offset:2048 nt lds
    v_mfma_f32_16x16x32_bf16 v[196:199], a[208:211], v[44:47], v[196:199]
    v_exp_f32 v36, v36
    v_mfma_f32_16x16x32_bf16 a[80:83], a[208:211], v[56:59], a[80:83]
    v_fma_f32 v37, v79, s35, v25
    v_cvt_pk_bf16_f32 v54, v39, v0
    v_mfma_f32_16x16x32_bf16 a[84:87], a[208:211], v[60:63], a[84:87]
    ds_read_b128 a[208:211], v2 offset:24832
    v_mfma_f32_16x16x32_bf16 v[200:203], a[212:215], v[40:43], v[200:203]
    v_exp_f32 v37, v37
    v_mfma_f32_16x16x32_bf16 v[204:207], a[212:215], v[44:47], v[204:207]
    v_cvt_pk_bf16_f32 v55, v36, v37
    v_mfma_f32_16x16x32_bf16 a[88:91], a[212:215], v[56:59], a[88:91]
    v_mfma_f32_16x16x32_bf16 a[92:95], a[212:215], v[60:63], a[92:95]
    ds_read_b128 a[212:215], v3 offset:24832
    v_mfma_f32_16x16x32_bf16 v[28:31], a[248:251], v[48:51], 0
    s_waitcnt vmcnt(12)
    s_barrier
    v_mfma_f32_16x16x32_bf16 v[28:31], a[252:255], v[52:55], v[28:31]
    s_waitcnt lgkmcnt(3)
    v_mfma_f32_16x16x32_bf16 v[80:83], a[192:195], a[144:147], 0
    v_fma_f32 v36, v96, s35, v26
    v_fma_f32 v37, v97, s35, v26
    v_mfma_f32_16x16x32_bf16 v[80:83], a[196:199], a[148:151], v[80:83]
    v_exp_f32 v36, v36
    v_mfma_f32_16x16x32_bf16 v[80:83], a[200:203], a[152:155], v[80:83]
    s_mov_b32 m0, s43
    v_cmp_nge_f32 vcc, s37, v30
    v_mfma_f32_16x16x32_bf16 v[88:91], a[192:195], a[168:171], 0
    v_exp_f32 v37, v37
    v_mfma_f32_16x16x32_bf16 v[88:91], a[196:199], a[172:175], v[88:91]
    buffer_load_dwordx4 v8, s[12:15], s60 offen nt lds
    v_mfma_f32_16x16x32_bf16 v[88:91], a[200:203], a[176:179], v[88:91]
    v_fma_f32 v38, v98, s35, v26
    s_cbranch_vccnz L_tr_T5f_A
L_ret_T5f_A:
    v_mfma_f32_16x16x32_bf16 v[64:67], a[192:195], a[96:99], 0
    v_add_f32 v17, v17, v28
    v_add_f32 v19, v19, v29
    v_mfma_f32_16x16x32_bf16 v[64:67], a[196:199], a[100:103], v[64:67]
    v_exp_f32 v38, v38
    v_mfma_f32_16x16x32_bf16 v[64:67], a[200:203], a[104:107], v[64:67]
    buffer_load_dwordx4 v9, s[12:15], s60 offen offset:1024 nt lds
    v_mfma_f32_16x16x32_bf16 v[72:75], a[192:195], a[120:123], 0
    ds_read_b128 a[192:195], v2 offset:30720
    v_fma_f32 v39, v99, s35, v26
    v_mfma_f32_16x16x32_bf16 v[72:75], a[196:199], a[124:127], v[72:75]
    v_exp_f32 v39, v39
    v_mfma_f32_16x16x32_bf16 v[72:75], a[200:203], a[128:131], v[72:75]
    ds_read_b128 a[196:199], v3 offset:30720
    s_waitcnt lgkmcnt(2)
    v_mfma_f32_16x16x32_bf16 v[64:67], a[204:207], a[108:111], v[64:67]
    buffer_load_dwordx4 v10, s[12:15], s60 offen offset:2048 nt lds
    v_mfma_f32_16x16x32_bf16 v[64:67], a[208:211], a[112:115], v[64:67]
    ds_read_b128 a[200:203], v2 offset:30848
    v_cvt_pk_bf16_f32 v56, v36, v37
    v_mfma_f32_16x16x32_bf16 v[64:67], a[212:215], a[116:119], v[64:67]
    v_fma_f32 v0, v100, s35, v26
    v_fma_f32 v36, v101, s35, v26
    v_mfma_f32_16x16x32_bf16 v[72:75], a[204:207], a[132:135], v[72:75]
    v_exp_f32 v0, v0
    v_mfma_f32_16x16x32_bf16 v[72:75], a[208:211], a[136:139], v[72:75]
    v_exp_f32 v36, v36
    v_mfma_f32_16x16x32_bf16 v[72:75], a[212:215], a[140:143], v[72:75]
    v_cvt_pk_bf16_f32 v57, v38, v39
    v_fma_f32 v37, v102, s35, v26
    v_mfma_f32_16x16x32_bf16 v[80:83], a[204:207], a[156:159], v[80:83]
    v_exp_f32 v37, v37
    v_mfma_f32_16x16x32_bf16 v[80:83], a[208:211], a[160:163], v[80:83]
    v_fma_f32 v38, v103, s35, v26
    v_cvt_pk_bf16_f32 v58, v0, v36
    v_mfma_f32_16x16x32_bf16 v[80:83], a[212:215], a[164:167], v[80:83]
    v_exp_f32 v38, v38
    v_mfma_f32_16x16x32_bf16 v[88:91], a[204:207], a[180:183], v[88:91]
    ds_read_b128 a[204:207], v3 offset:30848
    v_fma_f32 v39, v104, s35, v27
    v_mfma_f32_16x16x32_bf16 v[88:91], a[208:211], a[184:187], v[88:91]
    v_exp_f32 v39, v39
    v_mfma_f32_16x16x32_bf16 v[88:91], a[212:215], a[188:191], v[88:91]
    ds_read_b128 a[208:211], v2 offset:30976
    s_waitcnt lgkmcnt(2)
    v_mfma_f32_16x16x32_bf16 v[68:71], a[192:195], a[96:99], 0
    v_fma_f32 v0, v105, s35, v27
    v_cvt_pk_bf16_f32 v59, v37, v38
    v_mfma_f32_16x16x32_bf16 v[68:71], a[196:199], a[100:103], v[68:71]
    ds_read_b128 a[212:215], v3 offset:30976
    v_fma_f32 v36, v106, s35, v27
    v_mfma_f32_16x16x32_bf16 v[68:71], a[200:203], a[104:107], v[68:71]
    v_exp_f32 v0, v0
    v_mfma_f32_16x16x32_bf16 v[76:79], a[192:195], a[120:123], 0
    v_exp_f32 v36, v36
    v_mfma_f32_16x16x32_bf16 v[76:79], a[196:199], a[124:127], v[76:79]
    v_fma_f32 v37, v107, s35, v27
    v_cvt_pk_bf16_f32 v60, v39, v0
    v_mfma_f32_16x16x32_bf16 v[76:79], a[200:203], a[128:131], v[76:79]
    v_exp_f32 v37, v37
    v_mfma_f32_16x16x32_bf16 v[84:87], a[192:195], a[144:147], 0
    v_fma_f32 v38, v108, s35, v27
    v_mfma_f32_16x16x32_bf16 v[84:87], a[196:199], a[148:151], v[84:87]
    v_exp_f32 v38, v38
    v_mfma_f32_16x16x32_bf16 v[84:87], a[200:203], a[152:155], v[84:87]
    s_waitcnt lgkmcnt(0)
    v_fma_f32 v39, v109, s35, v27
    v_mfma_f32_16x16x32_bf16 v[92:95], a[192:195], a[168:171], 0
    ds_read_b64_tr_b16 a[192:193], v4 offset:12288
    ds_read_b64_tr_b16 a[194:195], v4 offset:18432
    v_mfma_f32_16x16x32_bf16 v[92:95], a[196:199], a[172:175], v[92:95]
    v_exp_f32 v39, v39
    v_mfma_f32_16x16x32_bf16 v[92:95], a[200:203], a[176:179], v[92:95]
    ds_read_b64_tr_b16 a[196:197], v5 offset:12288
    ds_read_b64_tr_b16 a[198:199], v5 offset:18432
    v_mfma_f32_16x16x32_bf16 v[68:71], a[204:207], a[108:111], v[68:71]
    v_cvt_pk_bf16_f32 v61, v36, v37
    v_mfma_f32_16x16x32_bf16 v[68:71], a[208:211], a[112:115], v[68:71]
    ds_read_b64_tr_b16 a[200:201], v6 offset:12288
    ds_read_b64_tr_b16 a[202:203], v6 offset:18432
    v_mfma_f32_16x16x32_bf16 v[68:71], a[212:215], a[116:119], v[68:71]
    v_fma_f32 v0, v110, s35, v27
    v_fma_f32 v36, v111, s35, v27
    v_mfma_f32_16x16x32_bf16 v[76:79], a[204:207], a[132:135], v[76:79]
    v_exp_f32 v0, v0
    v_mfma_f32_16x16x32_bf16 v[76:79], a[208:211], a[136:139], v[76:79]
    v_exp_f32 v36, v36
    v_mfma_f32_16x16x32_bf16 v[76:79], a[212:215], a[140:143], v[76:79]
    v_cvt_pk_bf16_f32 v62, v38, v39
    v_mfma_f32_16x16x32_bf16 v[84:87], a[204:207], a[156:159], v[84:87]
    v_cvt_pk_bf16_f32 v63, v0, v36
    v_fma_f32 v37, v64, s35, v24
    v_mfma_f32_16x16x32_bf16 v[84:87], a[208:211], a[160:163], v[84:87]
    v_exp_f32 v37, v37
    v_mfma_f32_16x16x32_bf16 v[84:87], a[212:215], a[164:167], v[84:87]
    v_fma_f32 v38, v65, s35, v24
    v_mfma_f32_16x16x32_bf16 v[92:95], a[204:207], a[180:183], v[92:95]
    ds_read_b64_tr_b16 a[204:205], v7 offset:12288
    ds_read_b64_tr_b16 a[206:207], v7 offset:18432
    v_mfma_f32_16x16x32_bf16 v[92:95], a[208:211], a[184:187], v[92:95]
    s_mov_b32 m0, s48
    v_fma_f32 v39, v66, s35, v24
    v_mfma_f32_16x16x32_bf16 v[92:95], a[212:215], a[188:191], v[92:95]
    ds_read_b64_tr_b16 a[208:209], v4 offset:12416
    ds_read_b64_tr_b16 a[210:211], v4 offset:18560
    v_mfma_f32_16x16x32_bf16 v[28:31], a[248:251], v[56:59], 0
    buffer_load_dwordx4 v8, s[16:19], s59 offen nt lds
    v_mfma_f32_16x16x32_bf16 v[28:31], a[252:255], v[60:63], v[28:31]
    ds_read_b64_tr_b16 a[212:213], v5 offset:12416
    ds_read_b64_tr_b16 a[214:215], v5 offset:18560
    s_waitcnt lgkmcnt(6)
    v_mfma_f32_16x16x32_bf16 v[112:115], a[192:195], v[48:51], v[112:115]
    v_exp_f32 v38, v38
    v_mfma_f32_16x16x32_bf16 v[116:119], a[192:195], v[52:55], v[116:119]
    v_exp_f32 v39, v39
    v_mfma_f32_16x16x32_bf16 v[120:123], a[196:199], v[48:51], v[120:123]
    v_fma_f32 v0, v67, s35, v24
    v_cmp_nge_f32 vcc, s37, v30
    v_mfma_f32_16x16x32_bf16 v[124:127], a[196:199], v[52:55], v[124:127]
    v_exp_f32 v0, v0
    v_mfma_f32_16x16x32_bf16 v[128:131], a[200:203], v[48:51], v[128:131]
    v_cvt_pk_bf16_f32 v40, v37, v38
    v_mfma_f32_16x16x32_bf16 v[132:135], a[200:203], v[52:55], v[132:135]
    v_fma_f32 v36, v72, s35, v25
    s_cbranch_vccnz L_tr_T5f_B
L_ret_T5f_B:
    v_mfma_f32_16x16x32_bf16 a[0:3], a[192:195], v[56:59], a[0:3]
    v_add_f32 v21, v21, v28
    v_add_f32 v23, v23, v29
    v_mfma_f32_16x16x32_bf16 a[4:7], a[192:195], v[60:63], a[4:7]
    ds_read_b64_tr_b16 a[192:193], v6 offset:12416
    ds_read_b64_tr_b16 a[194:195], v6 offset:18560
    v_mfma_f32_16x16x32_bf16 a[8:11], a[196:199], v[56:59], a[8:11]
    buffer_load_dwordx4 v9, s[16:19], s59 offen offset:1024 nt lds
    v_mfma_f32_16x16x32_bf16 a[12:15], a[196:199], v[60:63], a[12:15]
    ds_read_b64_tr_b16 a[196:197], v7 offset:12416
    ds_read_b64_tr_b16 a[198:199], v7 offset:18560
    v_mfma_f32_16x16x32_bf16 a[16:19], a[200:203], v[56:59], a[16:19]
    s_waitcnt lgkmcnt(4)
    v_fma_f32 v37, v73, s35, v25
    v_mfma_f32_16x16x32_bf16 a[20:23], a[200:203], v[60:63], a[20:23]
    ds_read_b64_tr_b16 a[200:201], v4 offset:12544
    ds_read_b64_tr_b16 a[202:203], v4 offset:18688
    v_mfma_f32_16x16x32_bf16 v[136:139], a[204:207], v[48:51], v[136:139]
    v_exp_f32 v36, v36
    v_mfma_f32_16x16x32_bf16 v[140:143], a[204:207], v[52:55], v[140:143]
    v_exp_f32 v37, v37
    v_mfma_f32_16x16x32_bf16 a[24:27], a[204:207], v[56:59], a[24:27]
    v_cvt_pk_bf16_f32 v41, v39, v0
    v_fma_f32 v38, v74, s35, v25
    v_mfma_f32_16x16x32_bf16 a[28:31], a[204:207], v[60:63], a[28:31]
    ds_read_b64_tr_b16 a[204:205], v5 offset:12544
    ds_read_b64_tr_b16 a[206:207], v5 offset:18688
    v_mfma_f32_16x16x32_bf16 v[144:147], a[208:211], v[48:51], v[144:147]
    buffer_load_dwordx4 v10, s[16:19], s59 offen offset:2048 nt lds
    v_mfma_f32_16x16x32_bf16 v[148:151], a[208:211], v[52:55], v[148:151]
    v_exp_f32 v38, v38
    v_mfma_f32_16x16x32_bf16 a[32:35], a[208:211], v[56:59], a[32:35]
    v_fma_f32 v39, v75, s35, v25
    v_cvt_pk_bf16_f32 v44, v36, v37
    v_mfma_f32_16x16x32_bf16 a[36:39], a[208:211], v[60:63], a[36:39]
    ds_read_b64_tr_b16 a[208:209], v6 offset:12544
    ds_read_b64_tr_b16 a[210:211], v6 offset:18688
    v_mfma_f32_16x16x32_bf16 v[152:155], a[212:215], v[48:51], v[152:155]
    v_exp_f32 v39, v39
    v_mfma_f32_16x16x32_bf16 v[156:159], a[212:215], v[52:55], v[156:159]
    s_mov_b32 m0, s89
    v_fma_f32 v0, v68, s35, v24
    v_mfma_f32_16x16x32_bf16 a[40:43], a[212:215], v[56:59], a[40:43]
    s_waitcnt lgkmcnt(4)
    v_fma_f32 v36, v69, s35, v24
    v_mfma_f32_16x16x32_bf16 a[44:47], a[212:215], v[60:63], a[44:47]
    ds_read_b64_tr_b16 a[212:213], v7 offset:12544
    ds_read_b64_tr_b16 a[214:215], v7 offset:18688
    v_mfma_f32_16x16x32_bf16 v[160:163], a[192:195], v[48:51], v[160:163]
    buffer_load_dwordx4 v8, s[20:23], s81 offen nt lds
    v_mfma_f32_16x16x32_bf16 v[164:167], a[192:195], v[52:55], v[164:167]
    v_exp_f32 v0, v0
    v_mfma_f32_16x16x32_bf16 a[48:51], a[192:195], v[56:59], a[48:51]
    v_exp_f32 v36, v36
    v_mfma_f32_16x16x32_bf16 a[52:55], a[192:195], v[60:63], a[52:55]
    ds_read_b128 a[192:195], v2 offset:36864
L_hop_2:
    s_cbranch_execz L_hop_6
    v_mfma_f32_16x16x32_bf16 v[168:171], a[196:199], v[48:51], v[168:171]
    v_cvt_pk_bf16_f32 v45, v38, v39
    v_fma_f32 v37, v70, s35, v24
    v_mfma_f32_16x16x32_bf16 v[172:175], a[196:199], v[52:55], v[172:175]
    v_exp_f32 v37, v37
    v_mfma_f32_16x16x32_bf16 a[56:59], a[196:199], v[56:59], a[56:59]
    v_fma_f32 v38, v71, s35, v24
    v_cvt_pk_bf16_f32 v42, v0, v36
    v_mfma_f32_16x16x32_bf16 a[60:63], a[196:199], v[60:63], a[60:63]
    ds_read_b128 a[196:199], v3 offset:36864
    v_mfma_f32_16x16x32_bf16 v[176:179], a[200:203], v[48:51], v[176:179]
    buffer_load_dwordx4 v9, s[20:23], s81 offen offset:1024 nt lds
    v_mfma_f32_16x16x32_bf16 v[180:183], a[200:203], v[52:55], v[180:183]
    v_exp_f32 v38, v38
    v_mfma_f32_16x16x32_bf16 a[64:67], a[200:203], v[56:59], a[64:67]
    v_fma_f32 v39, v76, s35, v25
    v_fma_f32 v0, v77, s35, v25
    v_mfma_f32_16x16x32_bf16 a[68:71], a[200:203], v[60:63], a[68:71]
    ds_read_b128 a[200:203], v2 offset:36992
    s_waitcnt lgkmcnt(3)
    v_mfma_f32_16x16x32_bf16 v[184:187], a[204:207], v[48:51], v[184:187]
    v_exp_f32 v39, v39
    v_mfma_f32_16x16x32_bf16 v[188:191], a[204:207], v[52:55], v[188:191]
    v_exp_f32 v0, v0
    v_mfma_f32_16x16x32_bf16 a[72:75], a[204:207], v[56:59], a[72:75]
    v_cvt_pk_bf16_f32 v43, v37, v38
    v_mfma_f32_16x16x32_bf16 a[76:79], a[204:207], v[60:63], a[76:79]
    ds_read_b128 a[204:207], v3 offset:36992
    v_fma_f32 v36, v78, s35, v25
    v_mfma_f32_16x16x32_bf16 v[192:195], a[208:211], v[48:51], v[192:195]
    buffer_load_dwordx4 v10, s[20:23], s81 offen offset:2048 nt lds
    v_mfma_f32_16x16x32_bf16 v[196:199], a[208:211], v[52:55], v[196:199]
    v_exp_f32 v36, v36
    v_mfma_f32_16x16x32_bf16 a[80:83], a[208:211], v[56:59], a[80:83]
    v_fma_f32 v37, v79, s35, v25
    v_cvt_pk_bf16_f32 v46, v39, v0
    v_mfma_f32_16x16x32_bf16 a[84:87], a[208:211], v[60:63], a[84:87]
    ds_read_b128 a[208:211], v2 offset:37120
    v_mfma_f32_16x16x32_bf16 v[200:203], a[212:215], v[48:51], v[200:203]
    v_exp_f32 v37, v37
    v_mfma_f32_16x16x32_bf16 v[204:207], a[212:215], v[52:55], v[204:207]
    v_cvt_pk_bf16_f32 v47, v36, v37
    v_mfma_f32_16x16x32_bf16 a[88:91], a[212:215], v[56:59], a[88:91]
    v_mfma_f32_16x16x32_bf16 a[92:95], a[212:215], v[60:63], a[92:95]
    ds_read_b128 a[212:215], v3 offset:37120
    v_mfma_f32_16x16x32_bf16 v[28:31], a[248:251], v[40:43], 0
    s_waitcnt vmcnt(15)
    s_barrier
    v_mfma_f32_16x16x32_bf16 v[28:31], a[252:255], v[44:47], v[28:31]
    s_waitcnt lgkmcnt(3)
    v_mfma_f32_16x16x32_bf16 v[96:99], a[192:195], a[144:147], 0
    v_fma_f32 v36, v80, s35, v26
    v_fma_f32 v37, v81, s35, v26
    v_mfma_f32_16x16x32_bf16 v[96:99], a[196:199], a[148:151], v[96:99]
    v_exp_f32 v36, v36
    v_mfma_f32_16x16x32_bf16 v[96:99], a[200:203], a[152:155], v[96:99]
    s_mov_b32 m0, s44
    v_cmp_nge_f32 vcc, s37, v30
    v_mfma_f32_16x16x32_bf16 v[104:107], a[192:195], a[168:171], 0
    v_exp_f32 v37, v37
    v_mfma_f32_16x16x32_bf16 v[104:107], a[196:199], a[172:175], v[104:107]
    buffer_load_dwordx4 v8, s[12:15], s61 offen nt lds
    v_mfma_f32_16x16x32_bf16 v[104:107], a[200:203], a[176:179], v[104:107]
    v_fma_f32 v38, v82, s35, v26
    s_cbranch_vccnz L_tr_T6f_A
L_ret_T6f_A:
    v_mfma_f32_16x16x32_bf16 v[64:67], a[192:195], a[96:99], 0
    v_add_f32 v17, v17, v28
    v_add_f32 v19, v19, v29
    v_mfma_f32_16x16x32_bf16 v[64:67], a[196:199], a[100:103], v[64:67]
    v_exp_f32 v38, v38
    v_mfma_f32_16x16x32_bf16 v[64:67], a[200:203], a[104:107], v[64:67]
    buffer_load_dwordx4 v9, s[12:15], s61 offen offset:1024 nt lds
    v_mfma_f32_16x16x32_bf16 v[72:75], a[192:195], a[120:123], 0
    ds_read_b128 a[192:195], v2 offset:43008
    v_fma_f32 v39, v83, s35, v26
    v_mfma_f32_16x16x32_bf16 v[72:75], a[196:199], a[124:127], v[72:75]
    v_exp_f32 v39, v39
    v_mfma_f32_16x16x32_bf16 v[72:75], a[200:203], a[128:131], v[72:75]
    ds_read_b128 a[196:199], v3 offset:43008
    s_waitcnt lgkmcnt(2)
    v_mfma_f32_16x16x32_bf16 v[64:67], a[204:207], a[108:111], v[64:67]
    buffer_load_dwordx4 v10, s[12:15], s61 offen offset:2048 nt lds
    v_mfma_f32_16x16x32_bf16 v[64:67], a[208:211], a[112:115], v[64:67]
    ds_read_b128 a[200:203], v2 offset:43136
    v_cvt_pk_bf16_f32 v56, v36, v37
    v_mfma_f32_16x16x32_bf16 v[64:67], a[212:215], a[116:119], v[64:67]
    v_fma_f32 v0, v84, s35, v26
    v_fma_f32 v36, v85, s35, v26
    v_mfma_f32_16x16x32_bf16 v[72:75], a[204:207], a[132:135], v[72:75]
    v_exp_f32 v0, v0
    v_mfma_f32_16x16x32_bf16 v[72:75], a[208:211], a[136:139], v[72:75]
    v_exp_f32 v36, v36
    v_mfma_f32_16x16x32_bf16 v[72:75], a[212:215], a[140:143], v[72:75]
    v_cvt_pk_bf16_f32 v57, v38, v39
    v_fma_f32 v37, v86, s35, v26
    v_mfma_f32_16x16x32_bf16 v[96:99], a[204:207], a[156:159], v[96:99]
    v_exp_f32 v37, v37
    v_mfma_f32_16x16x32_bf16 v[96:99], a[208:211], a[160:163], v[96:99]
    v_fma_f32 v38, v87, s35, v26
    v_cvt_pk_bf16_f32 v58, v0, v36
    v_mfma_f32_16x16x32_bf16 v[96:99], a[212:215], a[164:167], v[96:99]
    v_exp_f32 v38, v38
    v_mfma_f32_16x16x32_bf16 v[104:107], a[204:207], a[180:183], v[104:107]
    ds_read_b128 a[204:207], v3 offset:43136
    v_fma_f32 v39, v88, s35, v27
    v_mfma_f32_16x16x32_bf16 v[104:107], a[208:211], a[184:187], v[104:107]
    v_exp_f32 v39, v39
    v_mfma_f32_16x16x32_bf16 v[104:107], a[212:215], a[188:191], v[104:107]
    ds_read_b128 a[208:211], v2 offset:43264
    s_waitcnt lgkmcnt(2)
    v_mfma_f32_16x16x32_bf16 v[68:71], a[192:195], a[96:99], 0
    v_fma_f32 v0, v89, s35, v27
    v_cvt_pk_bf16_f32 v59, v37, v38
    v_mfma_f32_16x16x32_bf16 v[68:71], a[196:199], a[100:103], v[68:71]
    ds_read_b128 a[212:215], v3 offset:43264
    v_fma_f32 v36, v90, s35, v27
    v_mfma_f32_16x16x32_bf16 v[68:71], a[200:203], a[104:107], v[68:71]
    v_exp_f32 v0, v0
    v_mfma_f32_16x16x32_bf16 v[76:79], a[192:195], a[120:123], 0
    v_exp_f32 v36, v36
    v_mfma_f32_16x16x32_bf16 v[76:79], a[196:199], a[124:127], v[76:79]
    v_fma_f32 v37, v91, s35, v27
    v_cvt_pk_bf16_f32 v60, v39, v0
    v_mfma_f32_16x16x32_bf16 v[76:79], a[200:203], a[128:131], v[76:79]
    v_exp_f32 v37, v37
    v_mfma_f32_16x16x32_bf16 v[100:103], a[192:195], a[144:147], 0
    v_fma_f32 v38, v92, s35, v27
    v_fma_f32 v39, v93, s35, v27
    v_mfma_f32_16x16x32_bf16 v[100:103], a[196:199], a[148:151], v[100:103]
    v_exp_f32 v38, v38
    v_mfma_f32_16x16x32_bf16 v[100:103], a[200:203], a[152:155], v[100:103]
    s_waitcnt lgkmcnt(0)
    v_mfma_f32_16x16x32_bf16 v[108:111], a[192:195], a[168:171], 0
    ds_read_b64_tr_b16 a[192:193], v4 offset:24576
    ds_read_b64_tr_b16 a[194:195], v4 offset:30720
    v_mfma_f32_16x16x32_bf16 v[108:111], a[196:199], a[172:175], v[108:111]
    v_exp_f32 v39, v39
    v_mfma_f32_16x16x32_bf16 v[108:111], a[200:203], a[176:179], v[108:111]
    ds_read_b64_tr_b16 a[196:197], v5 offset:24576
    ds_read_b64_tr_b16 a[198:199], v5 offset:30720
    v_mfma_f32_16x16x32_bf16 v[68:71], a[204:207], a[108:111], v[68:71]
    v_cvt_pk_bf16_f32 v61, v36, v37
    v_fma_f32 v0, v94, s35, v27
    v_mfma_f32_16x16x32_bf16 v[68:71], a[208:211], a[112:115], v[68:71]
    ds_read_b64_tr_b16 a[200:201], v6 offset:24576
    ds_read_b64_tr_b16 a[202:203], v6 offset:30720
    v_mfma_f32_16x16x32_bf16 v[68:71], a[212:215], a[116:119], v[68:71]
    v_exp_f32 v0, v0
    v_mfma_f32_16x16x32_bf16 v[76:79], a[204:207], a[132:135], v[76:79]
    v_fma_f32 v36, v95, s35, v27
    v_cvt_pk_bf16_f32 v62, v38, v39
    v_mfma_f32_16x16x32_bf16 v[76:79], a[208:211], a[136:139], v[76:79]
    v_exp_f32 v36, v36
    v_mfma_f32_16x16x32_bf16 v[76:79], a[212:215], a[140:143], v[76:79]
    v_cvt_pk_bf16_f32 v63, v0, v36
    v_mfma_f32_16x16x32_bf16 v[100:103], a[204:207], a[156:159], v[100:103]
    v_fma_f32 v37, v64, s35, v24
    v_fma_f32 v38, v65, s35, v24
    v_mfma_f32_16x16x32_bf16 v[100:103], a[208:211], a[160:163], v[100:103]
    v_exp_f32 v37, v37
    v_mfma_f32_16x16x32_bf16 v[100:103], a[212:215], a[164:167], v[100:103]
    global_load_dwordx4 v[252:255], v1, s[74:75]
    v_mfma_f32_16x16x32_bf16 v[108:111], a[204:207], a[180:183], v[108:111]
    ds_read_b64_tr_b16 a[204:205], v7 offset:24576
    ds_read_b64_tr_b16 a[206:207], v7 offset:30720
    v_mfma_f32_16x16x32_bf16 v[108:111], a[208:211], a[184:187], v[108:111]
    s_mov_b32 m0, s49
    v_fma_f32 v39, v66, s35, v24
    v_mfma_f32_16x16x32_bf16 v[108:111], a[212:215], a[188:191], v[108:111]
    ds_read_b64_tr_b16 a[208:209], v4 offset:24704
    ds_read_b64_tr_b16 a[210:211], v4 offset:30848
    v_mfma_f32_16x16x32_bf16 v[28:31], a[248:251], v[56:59], 0
    buffer_load_dwordx4 v8, s[16:19], s60 offen nt lds
    v_mfma_f32_16x16x32_bf16 v[28:31], a[252:255], v[60:63], v[28:31]
    ds_read_b64_tr_b16 a[212:213], v5 offset:24704
    ds_read_b64_tr_b16 a[214:215], v5 offset:30848
    s_waitcnt lgkmcnt(6)
    v_mfma_f32_16x16x32_bf16 v[112:115], a[192:195], v[40:43], v[112:115]
    v_exp_f32 v38, v38
    v_mfma_f32_16x16x32_bf16 v[116:119], a[192:195], v[44:47], v[116:119]
    v_exp_f32 v39, v39
    v_mfma_f32_16x16x32_bf16 v[120:123], a[196:199], v[40:43], v[120:123]
    v_cmp_nge_f32 vcc, s37, v30
    v_mfma_f32_16x16x32_bf16 v[124:127], a[196:199], v[44:47], v[124:127]
    v_fma_f32 v0, v67, s35, v24
    v_cvt_pk_bf16_f32 v48, v37, v38
    v_mfma_f32_16x16x32_bf16 v[128:131], a[200:203], v[40:43], v[128:131]
    v_exp_f32 v0, v0
    v_mfma_f32_16x16x32_bf16 v[132:135], a[200:203], v[44:47], v[132:135]
    s_cbranch_vccnz L_tr_T6f_B
L_ret_T6f_B:
    v_mfma_f32_16x16x32_bf16 a[0:3], a[192:195], v[56:59], a[0:3]
    v_add_f32 v21, v21, v28
    v_add_f32 v23, v23, v29
    v_mfma_f32_16x16x32_bf16 a[4:7], a[192:195], v[60:63], a[4:7]
    ds_read_b64_tr_b16 a[192:193], v6 offset:24704
    ds_read_b64_tr_b16 a[194:195], v6 offset:30848
    v_mfma_f32_16x16x32_bf16 a[8:11], a[196:199], v[56:59], a[8:11]
    buffer_load_dwordx4 v9, s[16:19], s60 offen offset:1024 nt lds
    v_mfma_f32_16x16x32_bf16 a[12:15], a[196:199], v[60:63], a[12:15]
    ds_read_b64_tr_b16 a[196:197], v7 offset:24704
    ds_read_b64_tr_b16 a[198:199], v7 offset:30848
    v_mfma_f32_16x16x32_bf16 a[16:19], a[200:203], v[56:59], a[16:19]
    s_waitcnt lgkmcnt(4)
    v_fma_f32 v36, v72, s35, v25
    v_mfma_f32_16x16x32_bf16 a[20:23], a[200:203], v[60:63], a[20:23]
    ds_read_b64_tr_b16 a[200:201], v4 offset:24832
    ds_read_b64_tr_b16 a[202:203], v4 offset:30976
    v_mfma_f32_16x16x32_bf16 v[136:139], a[204:207], v[40:43], v[136:139]
    v_exp_f32 v36, v36
    v_mfma_f32_16x16x32_bf16 v[140:143], a[204:207], v[44:47], v[140:143]
    v_fma_f32 v37, v73, s35, v25
    v_cvt_pk_bf16_f32 v49, v39, v0
    v_mfma_f32_16x16x32_bf16 a[24:27], a[204:207], v[56:59], a[24:27]
    v_exp_f32 v37, v37
    v_mfma_f32_16x16x32_bf16 a[28:31], a[204:207], v[60:63], a[28:31]
    ds_read_b64_tr_b16 a[204:205], v5 offset:24832
    ds_read_b64_tr_b16 a[206:207], v5 offset:30976
    v_mfma_f32_16x16x32_bf16 v[144:147], a[208:211], v[40:43], v[144:147]
    buffer_load_dwordx4 v10, s[16:19], s60 offen offset:2048 nt lds
    v_mfma_f32_16x16x32_bf16 v[148:151], a[208:211], v[44:47], v[148:151]
    v_fma_f32 v38, v74, s35, v25
    v_fma_f32 v39, v75, s35, v25
    v_mfma_f32_16x16x32_bf16 a[32:35], a[208:211], v[56:59], a[32:35]
    v_exp_f32 v38, v38
    v_mfma_f32_16x16x32_bf16 a[36:39], a[208:211], v[60:63], a[36:39]
    ds_read_b64_tr_b16 a[208:209], v6 offset:24832
    ds_read_b64_tr_b16 a[210:211], v6 offset:30976
    v_mfma_f32_16x16x32_bf16 v[152:155], a[212:215], v[40:43], v[152:155]
    v_exp_f32 v39, v39
    v_mfma_f32_16x16x32_bf16 v[156:159], a[212:215], v[44:47], v[156:159]
    s_mov_b32 m0, s90
    v_cvt_pk_bf16_f32 v52, v36, v37
    v_mfma_f32_16x16x32_bf16 a[40:43], a[212:215], v[56:59], a[40:43]
    s_waitcnt lgkmcnt(4)
    v_fma_f32 v0, v68, s35, v24
    v_mfma_f32_16x16x32_bf16 a[44:47], a[212:215], v[60:63], a[44:47]
    ds_read_b64_tr_b16 a[212:213], v7 offset:24832
    ds_read_b64_tr_b16 a[214:215], v7 offset:30976
    v_mfma_f32_16x16x32_bf16 v[160:163], a[192:195], v[40:43], v[160:163]
    buffer_load_dwordx4 v8, s[20:23], s82 offen nt lds
    v_mfma_f32_16x16x32_bf16 v[164:167], a[192:195], v[44:47], v[164:167]
    v_exp_f32 v0, v0
    v_mfma_f32_16x16x32_bf16 a[48:51], a[192:195], v[56:59], a[48:51]
    v_fma_f32 v36, v69, s35, v24
    v_cvt_pk_bf16_f32 v53, v38, v39
    v_mfma_f32_16x16x32_bf16 a[52:55], a[192:195], v[60:63], a[52:55]
    ds_read_b128 a[192:195], v2 offset:0
    v_fma_f32 v37, v70, s35, v24
    v_mfma_f32_16x16x32_bf16 v[168:171], a[196:199], v[40:43], v[168:171]
    v_exp_f32 v36, v36
    v_mfma_f32_16x16x32_bf16 v[172:175], a[196:199], v[44:47], v[172:175]
    v_exp_f32 v37, v37
    v_mfma_f32_16x16x32_bf16 a[56:59], a[196:199], v[56:59], a[56:59]
    v_fma_f32 v38, v71, s35, v24
    v_mfma_f32_16x16x32_bf16 a[60:63], a[196:199], v[60:63], a[60:63]
    ds_read_b128 a[196:199], v3 offset:0
    v_cvt_pk_bf16_f32 v50, v0, v36
    v_mfma_f32_16x16x32_bf16 v[176:179], a[200:203], v[40:43], v[176:179]
    buffer_load_dwordx4 v9, s[20:23], s82 offen offset:1024 nt lds
    v_mfma_f32_16x16x32_bf16 v[180:183], a[200:203], v[44:47], v[180:183]
    v_exp_f32 v38, v38
    v_mfma_f32_16x16x32_bf16 a[64:67], a[200:203], v[56:59], a[64:67]
    v_fma_f32 v39, v76, s35, v25
    v_fma_f32 v0, v77, s35, v25
    v_mfma_f32_16x16x32_bf16 a[68:71], a[200:203], v[60:63], a[68:71]
    ds_read_b128 a[200:203], v2 offset:128
    s_waitcnt lgkmcnt(3)
    v_mfma_f32_16x16x32_bf16 v[184:187], a[204:207], v[40:43], v[184:187]
    v_exp_f32 v39, v39
    v_mfma_f32_16x16x32_bf16 v[188:191], a[204:207], v[44:47], v[188:191]
    v_exp_f32 v0, v0
    v_mfma_f32_16x16x32_bf16 a[72:75], a[204:207], v[56:59], a[72:75]
    v_cvt_pk_bf16_f32 v51, v37, v38
    v_mfma_f32_16x16x32_bf16 a[76:79], a[204:207], v[60:63], a[76:79]
    ds_read_b128 a[204:207], v3 offset:128
    v_fma_f32 v36, v78, s35, v25
    v_mfma_f32_16x16x32_bf16 v[192:195], a[208:211], v[40:43], v[192:195]
    buffer_load_dwordx4 v10, s[20:23], s82 offen offset:2048 nt lds
    v_mfma_f32_16x16x32_bf16 v[196:199], a[208:211], v[44:47], v[196:199]
    v_exp_f32 v36, v36
    v_mfma_f32_16x16x32_bf16 a[80:83], a[208:211], v[56:59], a[80:83]
    v_fma_f32 v37, v79, s35, v25
    v_cvt_pk_bf16_f32 v54, v39, v0
    v_mfma_f32_16x16x32_bf16 a[84:87], a[208:211], v[60:63], a[84:87]
    ds_read_b128 a[208:211], v2 offset:256
    v_mfma_f32_16x16x32_bf16 v[200:203], a[212:215], v[40:43], v[200:203]
    v_exp_f32 v37, v37
    v_mfma_f32_16x16x32_bf16 v[204:207], a[212:215], v[44:47], v[204:207]
    v_cvt_pk_bf16_f32 v55, v36, v37
    v_mfma_f32_16x16x32_bf16 a[88:91], a[212:215], v[56:59], a[88:91]
    v_mfma_f32_16x16x32_bf16 a[92:95], a[212:215], v[60:63], a[92:95]
    ds_read_b128 a[212:215], v3 offset:256
    v_mfma_f32_16x16x32_bf16 v[28:31], a[248:251], v[48:51], 0
    s_waitcnt vmcnt(16)
    s_barrier
    v_mfma_f32_16x16x32_bf16 v[28:31], a[252:255], v[52:55], v[28:31]
    s_waitcnt lgkmcnt(3)
    v_mfma_f32_16x16x32_bf16 v[80:83], a[192:195], a[144:147], 0
    v_fma_f32 v36, v96, s35, v26
    v_fma_f32 v37, v97, s35, v26
    v_mfma_f32_16x16x32_bf16 v[80:83], a[196:199], a[148:151], v[80:83]
    v_exp_f32 v36, v36
    v_mfma_f32_16x16x32_bf16 v[80:83], a[200:203], a[152:155], v[80:83]
    s_mov_b32 m0, s45
    v_cmp_nge_f32 vcc, s37, v30
    v_mfma_f32_16x16x32_bf16 v[88:91], a[192:195], a[168:171], 0
    v_exp_f32 v37, v37
    v_mfma_f32_16x16x32_bf16 v[88:91], a[196:199], a[172:175], v[88:91]
    buffer_load_dwordx4 v8, s[12:15], s62 offen nt lds
    v_mfma_f32_16x16x32_bf16 v[88:91], a[200:203], a[176:179], v[88:91]
    v_fma_f32 v38, v98, s35, v26
    s_cbranch_vccnz L_tr_T7f_A
L_ret_T7f_A:
    v_mfma_f32_16x16x32_bf16 v[64:67], a[192:195], a[96:99], 0
    v_exp_f32 v38, v38
    v_mfma_f32_16x16x32_bf16 v[64:67], a[196:199], a[100:103], v[64:67]
    v_add_f32 v17, v17, v28
    v_add_f32 v19, v19, v29
    v_mfma_f32_16x16x32_bf16 v[64:67], a[200:203], a[104:107], v[64:67]
    buffer_load_dwordx4 v9, s[12:15], s62 offen offset:1024 nt lds
    v_mfma_f32_16x16x32_bf16 v[72:75], a[192:195], a[120:123], 0
    ds_read_b128 a[192:195], v2 offset:6144
    v_fma_f32 v39, v99, s35, v26
    v_mfma_f32_16x16x32_bf16 v[72:75], a[196:199], a[124:127], v[72:75]
    v_exp_f32 v39, v39
    v_mfma_f32_16x16x32_bf16 v[72:75], a[200:203], a[128:131], v[72:75]
    ds_read_b128 a[196:199], v3 offset:6144
    s_waitcnt lgkmcnt(2)
    v_cvt_pk_bf16_f32 v56, v36, v37
    v_mfma_f32_16x16x32_bf16 v[64:67], a[204:207], a[108:111], v[64:67]
    buffer_load_dwordx4 v10, s[12:15], s62 offen offset:2048 nt lds
    v_mfma_f32_16x16x32_bf16 v[64:67], a[208:211], a[112:115], v[64:67]
    ds_read_b128 a[200:203], v2 offset:6272
    v_fma_f32 v0, v100, s35, v26
    v_mfma_f32_16x16x32_bf16 v[64:67], a[212:215], a[116:119], v[64:67]
    v_exp_f32 v0, v0
    v_mfma_f32_16x16x32_bf16 v[72:75], a[204:207], a[132:135], v[72:75]
    v_fma_f32 v36, v101, s35, v26
    v_cvt_pk_bf16_f32 v57, v38, v39
    v_mfma_f32_16x16x32_bf16 v[72:75], a[208:211], a[136:139], v[72:75]
    v_exp_f32 v36, v36
    v_mfma_f32_16x16x32_bf16 v[72:75], a[212:215], a[140:143], v[72:75]
    v_fma_f32 v37, v102, s35, v26
    v_fma_f32 v38, v103, s35, v26
    v_mfma_f32_16x16x32_bf16 v[80:83], a[204:207], a[156:159], v[80:83]
    s_mov_b32 m0, s91
    v_cvt_pk_bf16_f32 v58, v0, v36
    v_mfma_f32_16x16x32_bf16 v[80:83], a[208:211], a[160:163], v[80:83]
    v_exp_f32 v37, v37
    v_mfma_f32_16x16x32_bf16 v[80:83], a[212:215], a[164:167], v[80:83]
    buffer_load_dwordx4 v8, s[20:23], s83 offen nt lds
    v_mfma_f32_16x16x32_bf16 v[88:91], a[204:207], a[180:183], v[88:91]
    ds_read_b128 a[204:207], v3 offset:6272
    v_fma_f32 v39, v104, s35, v27
    v_mfma_f32_16x16x32_bf16 v[88:91], a[208:211], a[184:187], v[88:91]
    v_exp_f32 v38, v38
    v_mfma_f32_16x16x32_bf16 v[88:91], a[212:215], a[188:191], v[88:91]
    ds_read_b128 a[208:211], v2 offset:6400
    s_waitcnt lgkmcnt(2)
    v_mfma_f32_16x16x32_bf16 v[68:71], a[192:195], a[96:99], 0
    v_exp_f32 v39, v39
    v_mfma_f32_16x16x32_bf16 v[68:71], a[196:199], a[100:103], v[68:71]
    ds_read_b128 a[212:215], v3 offset:6400
    v_fma_f32 v0, v105, s35, v27
    v_mfma_f32_16x16x32_bf16 v[68:71], a[200:203], a[104:107], v[68:71]
    v_exp_f32 v0, v0
    v_mfma_f32_16x16x32_bf16 v[76:79], a[192:195], a[120:123], 0
    v_cvt_pk_bf16_f32 v59, v37, v38
    v_fma_f32 v36, v106, s35, v27
    v_mfma_f32_16x16x32_bf16 v[76:79], a[196:199], a[124:127], v[76:79]
    buffer_load_dwordx4 v9, s[20:23], s83 offen offset:1024 nt lds
    v_mfma_f32_16x16x32_bf16 v[76:79], a[200:203], a[128:131], v[76:79]
    v_exp_f32 v36, v36
    v_mfma_f32_16x16x32_bf16 v[84:87], a[192:195], a[144:147], 0
    v_fma_f32 v37, v107, s35, v27
    v_cvt_pk_bf16_f32 v60, v39, v0
    v_mfma_f32_16x16x32_bf16 v[84:87], a[196:199], a[148:151], v[84:87]
    v_exp_f32 v37, v37
    v_mfma_f32_16x16x32_bf16 v[84:87], a[200:203], a[152:155], v[84:87]
    s_waitcnt lgkmcnt(0)
    v_fma_f32 v38, v108, s35, v27
    v_mfma_f32_16x16x32_bf16 v[92:95], a[192:195], a[168:171], 0
    ds_read_b64_tr_b16 a[192:193], v4 offset:36864
    ds_read_b64_tr_b16 a[194:195], v4 offset:43008
    v_mfma_f32_16x16x32_bf16 v[92:95], a[196:199], a[172:175], v[92:95]
    v_exp_f32 v38, v38
    v_mfma_f32_16x16x32_bf16 v[92:95], a[200:203], a[176:179], v[92:95]
    ds_read_b64_tr_b16 a[196:197], v5 offset:36864
    ds_read_b64_tr_b16 a[198:199], v5 offset:43008
    v_mfma_f32_16x16x32_bf16 v[68:71], a[204:207], a[108:111], v[68:71]
    buffer_load_dwordx4 v10, s[20:23], s83 offen offset:2048 nt lds
    v_mfma_f32_16x16x32_bf16 v[68:71], a[208:211], a[112:115], v[68:71]
    ds_read_b64_tr_b16 a[200:201], v6 offset:36864
    ds_read_b64_tr_b16 a[202:203], v6 offset:43008
    v_mfma_f32_16x16x32_bf16 v[68:71], a[212:215], a[116:119], v[68:71]
    v_fma_f32 v39, v109, s35, v27
    v_cvt_pk_bf16_f32 v61, v36, v37
    v_mfma_f32_16x16x32_bf16 v[76:79], a[204:207], a[132:135], v[76:79]
    v_exp_f32 v39, v39
    v_mfma_f32_16x16x32_bf16 v[76:79], a[208:211], a[136:139], v[76:79]
    v_fma_f32 v0, v110, s35, v27
    v_fma_f32 v36, v111, s35, v27
    v_mfma_f32_16x16x32_bf16 v[76:79], a[212:215], a[140:143], v[76:79]
    v_exp_f32 v0, v0
    v_mfma_f32_16x16x32_bf16 v[84:87], a[204:207], a[156:159], v[84:87]
    v_exp_f32 v36, v36
    v_mfma_f32_16x16x32_bf16 v[84:87], a[208:211], a[160:163], v[84:87]
    v_cvt_pk_bf16_f32 v62, v38, v39
    v_cvt_pk_bf16_f32 v63, v0, v36
    v_mfma_f32_16x16x32_bf16 v[84:87], a[212:215], a[164:167], v[84:87]
    v_fma_f32 v37, v64, s35, v24
    v_fma_f32 v38, v65, s35, v24
    v_mfma_f32_16x16x32_bf16 v[92:95], a[204:207], a[180:183], v[92:95]
    ds_read_b64_tr_b16 a[204:205], v7 offset:36864
    ds_read_b64_tr_b16 a[206:207], v7 offset:43008
    v_mfma_f32_16x16x32_bf16 v[92:95], a[208:211], a[184:187], v[92:95]
    s_mov_b32 m0, s50
    v_fma_f32 v39, v66, s35, v24
    v_mfma_f32_16x16x32_bf16 v[92:95], a[212:215], a[188:191], v[92:95]
    ds_read_b64_tr_b16 a[208:209], v4 offset:36992
    ds_read_b64_tr_b16 a[210:211], v4 offset:43136
    v_mfma_f32_16x16x32_bf16 v[28:31], a[248:251], v[56:59], 0
    buffer_load_dwordx4 v8, s[16:19], s61 offen nt lds
    v_mfma_f32_16x16x32_bf16 v[28:31], a[252:255], v[60:63], v[28:31]
    ds_read_b64_tr_b16 a[212:213], v5 offset:36992
    ds_read_b64_tr_b16 a[214:215], v5 offset:43136
    s_waitcnt lgkmcnt(6)
    v_mfma_f32_16x16x32_bf16 v[112:115], a[192:195], v[48:51], v[112:115]
    v_mfma_f32_16x16x32_bf16 v[116:119], a[192:195], v[52:55], v[116:119]
    v_exp_f32 v37, v37
    v_mfma_f32_16x16x32_bf16 v[120:123], a[196:199], v[48:51], v[120:123]
    s_nop 0
    v_cmp_nge_f32 vcc, s37, v30
    v_mfma_f32_16x16x32_bf16 v[124:127], a[196:199], v[52:55], v[124:127]
    v_exp_f32 v38, v38
    v_mfma_f32_16x16x32_bf16 v[128:131], a[200:203], v[48:51], v[128:131]
    v_exp_f32 v39, v39
    v_mfma_f32_16x16x32_bf16 v[132:135], a[200:203], v[52:55], v[132:135]
    s_cbranch_vccnz L_tr_T7f_B
L_ret_T7f_B:
    v_mfma_f32_16x16x32_bf16 a[0:3], a[192:195], v[56:59], a[0:3]
    v_add_f32 v21, v21, v28
    v_add_f32 v23, v23, v29
    v_mfma_f32_16x16x32_bf16 a[4:7], a[192:195], v[60:63], a[4:7]
    ds_read_b64_tr_b16 a[192:193], v6 offset:36992
    ds_read_b64_tr_b16 a[194:195], v6 offset:43136
    v_mfma_f32_16x16x32_bf16 a[8:11], a[196:199], v[56:59], a[8:11]
    buffer_load_dwordx4 v9, s[16:19], s61 offen offset:1024 nt lds
    v_mfma_f32_16x16x32_bf16 a[12:15], a[196:199], v[60:63], a[12:15]
    ds_read_b64_tr_b16 a[196:197], v7 offset:36992
    ds_read_b64_tr_b16 a[198:199], v7 offset:43136
    v_mfma_f32_16x16x32_bf16 a[16:19], a[200:203], v[56:59], a[16:19]
    s_waitcnt lgkmcnt(4)
    v_fma_f32 v0, v67, s35, v24
    v_mfma_f32_16x16x32_bf16 a[20:23], a[200:203], v[60:63], a[20:23]
    ds_read_b64_tr_b16 a[200:201], v4 offset:37120
    ds_read_b64_tr_b16 a[202:203], v4 offset:43264
    v_mfma_f32_16x16x32_bf16 v[136:139], a[204:207], v[48:51], v[136:139]
    v_exp_f32 v0, v0
    v_mfma_f32_16x16x32_bf16 v[140:143], a[204:207], v[52:55], v[140:143]
    v_cvt_pk_bf16_f32 v40, v37, v38
    v_fma_f32 v36, v72, s35, v25
    v_mfma_f32_16x16x32_bf16 a[24:27], a[204:207], v[56:59], a[24:27]
    v_exp_f32 v36, v36
    v_mfma_f32_16x16x32_bf16 a[28:31], a[204:207], v[60:63], a[28:31]
    ds_read_b64_tr_b16 a[204:205], v5 offset:37120
    ds_read_b64_tr_b16 a[206:207], v5 offset:43264
    v_mfma_f32_16x16x32_bf16 v[144:147], a[208:211], v[48:51], v[144:147]
    buffer_load_dwordx4 v10, s[16:19], s61 offen offset:2048 nt lds
    v_mfma_f32_16x16x32_bf16 v[148:151], a[208:211], v[52:55], v[148:151]
    v_fma_f32 v37, v73, s35, v25
    v_cvt_pk_bf16_f32 v41, v39, v0
    v_mfma_f32_16x16x32_bf16 a[32:35], a[208:211], v[56:59], a[32:35]
    v_exp_f32 v37, v37
    v_mfma_f32_16x16x32_bf16 a[36:39], a[208:211], v[60:63], a[36:39]
    ds_read_b64_tr_b16 a[208:209], v6 offset:37120
    ds_read_b64_tr_b16 a[210:211], v6 offset:43264
    v_mfma_f32_16x16x32_bf16 v[152:155], a[212:215], v[48:51], v[152:155]
    v_fma_f32 v38, v74, s35, v25
    v_fma_f32 v39, v75, s35, v25
    v_mfma_f32_16x16x32_bf16 v[156:159], a[212:215], v[52:55], v[156:159]
    v_exp_f32 v38, v38
    v_mfma_f32_16x16x32_bf16 a[40:43], a[212:215], v[56:59], a[40:43]
    s_waitcnt lgkmcnt(4)
    v_cvt_pk_bf16_f32 v44, v36, v37
    v_mfma_f32_16x16x32_bf16 a[44:47], a[212:215], v[60:63], a[44:47]
    ds_read_b64_tr_b16 a[212:213], v7 offset:37120
    ds_read_b64_tr_b16 a[214:215], v7 offset:43264
    v_mfma_f32_16x16x32_bf16 v[160:163], a[192:195], v[48:51], v[160:163]
    v_exp_f32 v39, v39
    v_mfma_f32_16x16x32_bf16 v[164:167], a[192:195], v[52:55], v[164:167]
    v_fma_f32 v0, v68, s35, v24
    v_mfma_f32_16x16x32_bf16 a[48:51], a[192:195], v[56:59], a[48:51]
    v_exp_f32 v0, v0
    v_mfma_f32_16x16x32_bf16 a[52:55], a[192:195], v[60:63], a[52:55]
    ds_read_b128 a[192:195], v2 offset:12288
    v_fma_f32 v36, v69, s35, v24
    v_mfma_f32_16x16x32_bf16 v[168:171], a[196:199], v[48:51], v[168:171]
    v_exp_f32 v36, v36
    v_mfma_f32_16x16x32_bf16 v[172:175], a[196:199], v[52:55], v[172:175]
    v_cvt_pk_bf16_f32 v45, v38, v39
    v_mfma_f32_16x16x32_bf16 a[56:59], a[196:199], v[56:59], a[56:59]
    v_fma_f32 v37, v70, s35, v24
    v_fma_f32 v38, v71, s35, v24
    v_mfma_f32_16x16x32_bf16 a[60:63], a[196:199], v[60:63], a[60:63]
    ds_read_b128 a[196:199], v3 offset:12288
    v_cvt_pk_bf16_f32 v42, v0, v36
    v_mfma_f32_16x16x32_bf16 v[176:179], a[200:203], v[48:51], v[176:179]
    v_exp_f32 v37, v37
    v_mfma_f32_16x16x32_bf16 v[180:183], a[200:203], v[52:55], v[180:183]
    v_exp_f32 v38, v38
    v_mfma_f32_16x16x32_bf16 a[64:67], a[200:203], v[56:59], a[64:67]
    v_fma_f32 v39, v76, s35, v25
    v_mfma_f32_16x16x32_bf16 a[68:71], a[200:203], v[60:63], a[68:71]
    ds_read_b128 a[200:203], v2 offset:12416
    s_waitcnt lgkmcnt(3)
    v_mfma_f32_16x16x32_bf16 v[184:187], a[204:207], v[48:51], v[184:187]
    v_exp_f32 v39, v39
    v_mfma_f32_16x16x32_bf16 v[188:191], a[204:207], v[52:55], v[188:191]
    v_fma_f32 v0, v77, s35, v25
    v_mfma_f32_16x16x32_bf16 a[72:75], a[204:207], v[56:59], a[72:75]
    v_exp_f32 v0, v0
    v_mfma_f32_16x16x32_bf16 a[76:79], a[204:207], v[60:63], a[76:79]
    ds_read_b128 a[204:207], v3 offset:12416
    v_cvt_pk_bf16_f32 v43, v37, v38
    v_mfma_f32_16x16x32_bf16 v[192:195], a[208:211], v[48:51], v[192:195]
    v_fma_f32 v36, v78, s35, v25
    v_mfma_f32_16x16x32_bf16 v[196:199], a[208:211], v[52:55], v[196:199]
    v_exp_f32 v36, v36
    v_mfma_f32_16x16x32_bf16 a[80:83], a[208:211], v[56:59], a[80:83]
    v_fma_f32 v37, v79, s35, v25
    v_cvt_pk_bf16_f32 v46, v39, v0
    v_mfma_f32_16x16x32_bf16 a[84:87], a[208:211], v[60:63], a[84:87]
    ds_read_b128 a[208:211], v2 offset:12544
    v_mfma_f32_16x16x32_bf16 v[200:203], a[212:215], v[48:51], v[200:203]
    v_exp_f32 v37, v37
    v_mfma_f32_16x16x32_bf16 v[204:207], a[212:215], v[52:55], v[204:207]
    v_cvt_pk_bf16_f32 v47, v36, v37
    v_mfma_f32_16x16x32_bf16 a[88:91], a[212:215], v[56:59], a[88:91]
    v_mfma_f32_16x16x32_bf16 a[92:95], a[212:215], v[60:63], a[92:95]
    ds_read_b128 a[212:215], v3 offset:12544
    v_mfma_f32_16x16x32_bf16 v[28:31], a[248:251], v[40:43], 0
    s_waitcnt vmcnt(16)
    s_barrier
    v_mfma_f32_16x16x32_bf16 v[28:31], a[252:255], v[44:47], v[28:31]
    s_waitcnt lgkmcnt(3)
    v_mfma_f32_16x16x32_bf16 v[96:99], a[192:195], a[144:147], 0
    v_fma_f32 v36, v80, s35, v26
    v_fma_f32 v37, v81, s35, v26
    v_mfma_f32_16x16x32_bf16 v[96:99], a[196:199], a[148:151], v[96:99]
    v_exp_f32 v36, v36
    v_mfma_f32_16x16x32_bf16 v[96:99], a[200:203], a[152:155], v[96:99]
    s_mov_b32 m0, s42
    v_cmp_nge_f32 vcc, s37, v30
    v_mfma_f32_16x16x32_bf16 v[104:107], a[192:195], a[168:171], 0
    v_exp_f32 v37, v37
    v_mfma_f32_16x16x32_bf16 v[104:107], a[196:199], a[172:175], v[104:107]
    buffer_load_dwordx4 v8, s[12:15], s63 offen nt lds
    v_mfma_f32_16x16x32_bf16 v[104:107], a[200:203], a[176:179], v[104:107]
    v_fma_f32 v38, v82, s35, v26
    s_cbranch_vccnz L_tr_T8f_A
L_ret_T8f_A:
    v_mfma_f32_16x16x32_bf16 v[64:67], a[192:195], a[96:99], 0
    v_add_f32 v17, v17, v28
    v_add_f32 v19, v19, v29
    v_mfma_f32_16x16x32_bf16 v[64:67], a[196:199], a[100:103], v[64:67]
    v_exp_f32 v38, v38
    v_mfma_f32_16x16x32_bf16 v[64:67], a[200:203], a[104:107], v[64:67]
    buffer_load_dwordx4 v9, s[12:15], s63 offen offset:1024 nt lds
    v_mfma_f32_16x16x32_bf16 v[72:75], a[192:195], a[120:123], 0
    ds_read_b128 a[192:195], v2 offset:18432
    v_fma_f32 v39, v83, s35, v26
    v_mfma_f32_16x16x32_bf16 v[72:75], a[196:199], a[124:127], v[72:75]
    v_exp_f32 v39, v39
    v_mfma_f32_16x16x32_bf16 v[72:75], a[200:203], a[128:131], v[72:75]
    ds_read_b128 a[196:199], v3 offset:18432
    s_waitcnt lgkmcnt(2)
    v_mfma_f32_16x16x32_bf16 v[64:67], a[204:207], a[108:111], v[64:67]
L_hop_3:
    s_cbranch_execz L_hop_7
    buffer_load_dwordx4 v10, s[12:15], s63 offen offset:2048 nt lds
    v_mfma_f32_16x16x32_bf16 v[64:67], a[208:211], a[112:115], v[64:67]
    ds_read_b128 a[200:203], v2 offset:18560
    v_cvt_pk_bf16_f32 v56, v36, v37
    v_mfma_f32_16x16x32_bf16 v[64:67], a[212:215], a[116:119], v[64:67]
    v_fma_f32 v0, v84, s35, v26
    v_fma_f32 v36, v85, s35, v26
    v_mfma_f32_16x16x32_bf16 v[72:75], a[204:207], a[132:135], v[72:75]
    v_exp_f32 v0, v0
    v_mfma_f32_16x16x32_bf16 v[72:75], a[208:211], a[136:139], v[72:75]
    v_exp_f32 v36, v36
    v_mfma_f32_16x16x32_bf16 v[72:75], a[212:215], a[140:143], v[72:75]
    v_cvt_pk_bf16_f32 v57, v38, v39
    v_fma_f32 v37, v86, s35, v26
    v_mfma_f32_16x16x32_bf16 v[96:99], a[204:207], a[156:159], v[96:99]
    v_exp_f32 v37, v37
    v_mfma_f32_16x16x32_bf16 v[96:99], a[208:211], a[160:163], v[96:99]
    v_fma_f32 v38, v87, s35, v26
    v_cvt_pk_bf16_f32 v58, v0, v36
    v_mfma_f32_16x16x32_bf16 v[96:99], a[212:215], a[164:167], v[96:99]
    v_exp_f32 v38, v38
    v_mfma_f32_16x16x32_bf16 v[104:107], a[204:207], a[180:183], v[104:107]
    ds_read_b128 a[204:207], v3 offset:18560
    v_fma_f32 v39, v88, s35, v27
    v_mfma_f32_16x16x32_bf16 v[104:107], a[208:211], a[184:187], v[104:107]
    v_exp_f32 v39, v39
    v_mfma_f32_16x16x32_bf16 v[104:107], a[212:215], a[188:191], v[104:107]
    ds_read_b128 a[208:211], v2 offset:18688
    s_waitcnt lgkmcnt(2)
    v_mfma_f32_16x16x32_bf16 v[68:71], a[192:195], a[96:99], 0
    v_fma_f32 v0, v89, s35, v27
    v_mfma_f32_16x16x32_bf16 v[68:71], a[196:199], a[100:103], v[68:71]
    ds_read_b128 a[212:215], v3 offset:18688
    v_cvt_pk_bf16_f32 v59, v37, v38
    v_mfma_f32_16x16x32_bf16 v[68:71], a[200:203], a[104:107], v[68:71]
    v_exp_f32 v0, v0
    v_mfma_f32_16x16x32_bf16 v[76:79], a[192:195], a[120:123], 0
    v_fma_f32 v36, v90, s35, v27
    v_mfma_f32_16x16x32_bf16 v[76:79], a[196:199], a[124:127], v[76:79]
    v_exp_f32 v36, v36
    v_mfma_f32_16x16x32_bf16 v[76:79], a[200:203], a[128:131], v[76:79]
    v_fma_f32 v37, v91, s35, v27
    v_mfma_f32_16x16x32_bf16 v[100:103], a[192:195], a[144:147], 0
    v_exp_f32 v37, v37
    v_mfma_f32_16x16x32_bf16 v[100:103], a[196:199], a[148:151], v[100:103]
    v_cvt_pk_bf16_f32 v60, v39, v0
    v_fma_f32 v38, v92, s35, v27
    v_mfma_f32_16x16x32_bf16 v[100:103], a[200:203], a[152:155], v[100:103]
    s_waitcnt lgkmcnt(0)
    v_fma_f32 v39, v93, s35, v27
    v_mfma_f32_16x16x32_bf16 v[108:111], a[192:195], a[168:171], 0
    ds_read_b64_tr_b16 a[192:193], v4 offset:0
    ds_read_b64_tr_b16 a[194:195], v4 offset:6144
    v_mfma_f32_16x16x32_bf16 v[108:111], a[196:199], a[172:175], v[108:111]
    v_exp_f32 v38, v38
    v_mfma_f32_16x16x32_bf16 v[108:111], a[200:203], a[176:179], v[108:111]
    ds_read_b64_tr_b16 a[196:197], v5 offset:0
    ds_read_b64_tr_b16 a[198:199], v5 offset:6144
    v_mfma_f32_16x16x32_bf16 v[68:71], a[204:207], a[108:111], v[68:71]
    v_exp_f32 v39, v39
    v_mfma_f32_16x16x32_bf16 v[68:71], a[208:211], a[112:115], v[68:71]
    ds_read_b64_tr_b16 a[200:201], v6 offset:0
    ds_read_b64_tr_b16 a[202:203], v6 offset:6144
    v_mfma_f32_16x16x32_bf16 v[68:71], a[212:215], a[116:119], v[68:71]
    v_cvt_pk_bf16_f32 v61, v36, v37
    v_mfma_f32_16x16x32_bf16 v[76:79], a[204:207], a[132:135], v[76:79]
    v_fma_f32 v0, v94, s35, v27
    v_mfma_f32_16x16x32_bf16 v[76:79], a[208:211], a[136:139], v[76:79]
    v_exp_f32 v0, v0
    v_mfma_f32_16x16x32_bf16 v[76:79], a[212:215], a[140:143], v[76:79]
    v_fma_f32 v36, v95, s35, v27
    v_cvt_pk_bf16_f32 v62, v38, v39
    v_mfma_f32_16x16x32_bf16 v[100:103], a[204:207], a[156:159], v[100:103]
    v_exp_f32 v36, v36
    v_mfma_f32_16x16x32_bf16 v[100:103], a[208:211], a[160:163], v[100:103]
    v_cvt_pk_bf16_f32 v63, v0, v36
    v_mfma_f32_16x16x32_bf16 v[100:103], a[212:215], a[164:167], v[100:103]
    v_fma_f32 v37, v64, s35, v24
    v_mfma_f32_16x16x32_bf16 v[108:111], a[204:207], a[180:183], v[108:111]
    ds_read_b64_tr_b16 a[204:205], v7 offset:0
    ds_read_b64_tr_b16 a[206:207], v7 offset:6144
    v_mfma_f32_16x16x32_bf16 v[108:111], a[208:211], a[184:187], v[108:111]
    s_mov_b32 m0, s51
    v_fma_f32 v38, v65, s35, v24
    v_mfma_f32_16x16x32_bf16 v[108:111], a[212:215], a[188:191], v[108:111]
    ds_read_b64_tr_b16 a[208:209], v4 offset:128
    ds_read_b64_tr_b16 a[210:211], v4 offset:6272
    v_mfma_f32_16x16x32_bf16 v[28:31], a[248:251], v[56:59], 0
    buffer_load_dwordx4 v8, s[16:19], s62 offen nt lds
    v_mfma_f32_16x16x32_bf16 v[28:31], a[252:255], v[60:63], v[28:31]
    ds_read_b64_tr_b16 a[212:213], v5 offset:128
    ds_read_b64_tr_b16 a[214:215], v5 offset:6272
    s_waitcnt lgkmcnt(6)
    v_mfma_f32_16x16x32_bf16 v[112:115], a[192:195], v[40:43], v[112:115]
    v_exp_f32 v37, v37
    v_mfma_f32_16x16x32_bf16 v[116:119], a[192:195], v[44:47], v[116:119]
    v_exp_f32 v38, v38
    v_mfma_f32_16x16x32_bf16 v[120:123], a[196:199], v[40:43], v[120:123]
    v_cmp_nge_f32 vcc, s37, v30
    v_mfma_f32_16x16x32_bf16 v[124:127], a[196:199], v[44:47], v[124:127]
    v_fma_f32 v39, v66, s35, v24
    v_fma_f32 v0, v67, s35, v24
    v_mfma_f32_16x16x32_bf16 v[128:131], a[200:203], v[40:43], v[128:131]
    v_exp_f32 v39, v39
    v_mfma_f32_16x16x32_bf16 v[132:135], a[200:203], v[44:47], v[132:135]
    v_cvt_pk_bf16_f32 v48, v37, v38
    s_cbranch_vccnz L_tr_T8f_B
L_ret_T8f_B:
    v_mfma_f32_16x16x32_bf16 a[0:3], a[192:195], v[56:59], a[0:3]
    v_add_f32 v21, v21, v28
    v_add_f32 v23, v23, v29
    v_mfma_f32_16x16x32_bf16 a[4:7], a[192:195], v[60:63], a[4:7]
    ds_read_b64_tr_b16 a[192:193], v6 offset:128
    ds_read_b64_tr_b16 a[194:195], v6 offset:6272
    v_mfma_f32_16x16x32_bf16 a[8:11], a[196:199], v[56:59], a[8:11]
    buffer_load_dwordx4 v9, s[16:19], s62 offen offset:1024 nt lds
    v_mfma_f32_16x16x32_bf16 a[12:15], a[196:199], v[60:63], a[12:15]
    ds_read_b64_tr_b16 a[196:197], v7 offset:128
    ds_read_b64_tr_b16 a[198:199], v7 offset:6272
    v_mfma_f32_16x16x32_bf16 a[16:19], a[200:203], v[56:59], a[16:19]
    s_waitcnt lgkmcnt(4)
    v_fma_f32 v36, v72, s35, v25
    v_mfma_f32_16x16x32_bf16 a[20:23], a[200:203], v[60:63], a[20:23]
    ds_read_b64_tr_b16 a[200:201], v4 offset:256
    ds_read_b64_tr_b16 a[202:203], v4 offset:6400
    v_mfma_f32_16x16x32_bf16 v[136:139], a[204:207], v[40:43], v[136:139]
    v_exp_f32 v0, v0
    v_mfma_f32_16x16x32_bf16 v[140:143], a[204:207], v[44:47], v[140:143]
    v_exp_f32 v36, v36
    v_mfma_f32_16x16x32_bf16 a[24:27], a[204:207], v[56:59], a[24:27]
    v_fma_f32 v37, v73, s35, v25
    v_cvt_pk_bf16_f32 v49, v39, v0
    v_mfma_f32_16x16x32_bf16 a[28:31], a[204:207], v[60:63], a[28:31]
    ds_read_b64_tr_b16 a[204:205], v5 offset:256
    ds_read_b64_tr_b16 a[206:207], v5 offset:6400
    v_mfma_f32_16x16x32_bf16 v[144:147], a[208:211], v[40:43], v[144:147]
    buffer_load_dwordx4 v10, s[16:19], s62 offen offset:2048 nt lds
    v_mfma_f32_16x16x32_bf16 v[148:151], a[208:211], v[44:47], v[148:151]
    v_exp_f32 v37, v37
    v_mfma_f32_16x16x32_bf16 a[32:35], a[208:211], v[56:59], a[32:35]
    v_fma_f32 v38, v74, s35, v25
    v_mfma_f32_16x16x32_bf16 a[36:39], a[208:211], v[60:63], a[36:39]
    ds_read_b64_tr_b16 a[208:209], v6 offset:256
    ds_read_b64_tr_b16 a[210:211], v6 offset:6400
    v_mfma_f32_16x16x32_bf16 v[152:155], a[212:215], v[40:43], v[152:155]
    v_exp_f32 v38, v38
    v_mfma_f32_16x16x32_bf16 v[156:159], a[212:215], v[44:47], v[156:159]
    v_fma_f32 v39, v75, s35, v25
    v_cvt_pk_bf16_f32 v52, v36, v37
    v_mfma_f32_16x16x32_bf16 a[40:43], a[212:215], v[56:59], a[40:43]
    s_waitcnt lgkmcnt(4)
    v_fma_f32 v0, v68, s35, v24
    v_mfma_f32_16x16x32_bf16 a[44:47], a[212:215], v[60:63], a[44:47]
    ds_read_b64_tr_b16 a[212:213], v7 offset:256
    ds_read_b64_tr_b16 a[214:215], v7 offset:6400
    v_mfma_f32_16x16x32_bf16 v[160:163], a[192:195], v[40:43], v[160:163]
    v_exp_f32 v39, v39
    v_mfma_f32_16x16x32_bf16 v[164:167], a[192:195], v[44:47], v[164:167]
    v_exp_f32 v0, v0
    v_mfma_f32_16x16x32_bf16 a[48:51], a[192:195], v[56:59], a[48:51]
    v_fma_f32 v36, v69, s35, v24
    v_mfma_f32_16x16x32_bf16 a[52:55], a[192:195], v[60:63], a[52:55]
    ds_read_b128 a[192:195], v2 offset:24576
    v_mfma_f32_16x16x32_bf16 v[168:171], a[196:199], v[40:43], v[168:171]
    v_exp_f32 v36, v36
    v_mfma_f32_16x16x32_bf16 v[172:175], a[196:199], v[44:47], v[172:175]
    v_cvt_pk_bf16_f32 v53, v38, v39
    v_fma_f32 v37, v70, s35, v24
    v_mfma_f32_16x16x32_bf16 a[56:59], a[196:199], v[56:59], a[56:59]
    v_exp_f32 v37, v37
    v_mfma_f32_16x16x32_bf16 a[60:63], a[196:199], v[60:63], a[60:63]
    ds_read_b128 a[196:199], v3 offset:24576
    v_mfma_f32_16x16x32_bf16 v[176:179], a[200:203], v[40:43], v[176:179]
    v_fma_f32 v38, v71, s35, v24
    v_cvt_pk_bf16_f32 v50, v0, v36
    v_mfma_f32_16x16x32_bf16 v[180:183], a[200:203], v[44:47], v[180:183]
    v_exp_f32 v38, v38
    v_mfma_f32_16x16x32_bf16 a[64:67], a[200:203], v[56:59], a[64:67]
    v_fma_f32 v39, v76, s35, v25
    v_mfma_f32_16x16x32_bf16 a[68:71], a[200:203], v[60:63], a[68:71]
    ds_read_b128 a[200:203], v2 offset:24704
    s_waitcnt lgkmcnt(3)
    v_mfma_f32_16x16x32_bf16 v[184:187], a[204:207], v[40:43], v[184:187]
    v_exp_f32 v39, v39
    v_mfma_f32_16x16x32_bf16 v[188:191], a[204:207], v[44:47], v[188:191]
    v_fma_f32 v0, v77, s35, v25
    v_mfma_f32_16x16x32_bf16 a[72:75], a[204:207], v[56:59], a[72:75]
    v_exp_f32 v0, v0
    v_mfma_f32_16x16x32_bf16 a[76:79], a[204:207], v[60:63], a[76:79]
    ds_read_b128 a[204:207], v3 offset:24704
    v_cvt_pk_bf16_f32 v51, v37, v38
    v_mfma_f32_16x16x32_bf16 v[192:195], a[208:211], v[40:43], v[192:195]
    v_fma_f32 v36, v78, s35, v25
    v_fma_f32 v37, v79, s35, v25
    v_mfma_f32_16x16x32_bf16 v[196:199], a[208:211], v[44:47], v[196:199]
    v_exp_f32 v36, v36
    v_mfma_f32_16x16x32_bf16 a[80:83], a[208:211], v[56:59], a[80:83]
    v_exp_f32 v37, v37
    v_mfma_f32_16x16x32_bf16 a[84:87], a[208:211], v[60:63], a[84:87]
    ds_read_b128 a[208:211], v2 offset:24832
    v_mfma_f32_16x16x32_bf16 v[200:203], a[212:215], v[40:43], v[200:203]
    v_cvt_pk_bf16_f32 v54, v39, v0
    v_mfma_f32_16x16x32_bf16 v[204:207], a[212:215], v[44:47], v[204:207]
    v_cvt_pk_bf16_f32 v55, v36, v37
    v_mfma_f32_16x16x32_bf16 a[88:91], a[212:215], v[56:59], a[88:91]
    v_mfma_f32_16x16x32_bf16 a[92:95], a[212:215], v[60:63], a[92:95]
    ds_read_b128 a[212:215], v3 offset:24832
    v_mfma_f32_16x16x32_bf16 v[28:31], a[248:251], v[48:51], 0
    s_waitcnt vmcnt(12)
    s_barrier
    v_mfma_f32_16x16x32_bf16 v[28:31], a[252:255], v[52:55], v[28:31]
    s_waitcnt lgkmcnt(3)
    v_mfma_f32_16x16x32_bf16 v[80:83], a[192:195], a[144:147], 0
    s_waitcnt vmcnt(9)
    v_fma_f32 v36, v96, s35, v26
    v_mfma_f32_16x16x32_bf16 v[80:83], a[196:199], a[148:151], v[80:83]
    ds_read_b128 v[208:211], v14 offset:0
    v_fma_f32 v37, v97, s35, v26
    v_mfma_f32_16x16x32_bf16 v[80:83], a[200:203], a[152:155], v[80:83]
    s_mov_b32 m0, s43
    v_cmp_nge_f32 vcc, s37, v30
    v_mfma_f32_16x16x32_bf16 v[88:91], a[192:195], a[168:171], 0
    v_exp_f32 v36, v36
    v_mfma_f32_16x16x32_bf16 v[88:91], a[196:199], a[172:175], v[88:91]
    buffer_load_dwordx4 v8, s[12:15], s64 offen nt lds
    v_mfma_f32_16x16x32_bf16 v[88:91], a[200:203], a[176:179], v[88:91]
    ds_read_b128 v[212:215], v15 offset:0
    s_cbranch_vccnz L_tr_T9f_A
L_ret_T9f_A:
    v_mfma_f32_16x16x32_bf16 v[64:67], a[192:195], a[96:99], 0
    v_exp_f32 v37, v37
    v_mfma_f32_16x16x32_bf16 v[64:67], a[196:199], a[100:103], v[64:67]
    v_add_f32 v17, v17, v28
    v_add_f32 v19, v19, v29
    v_mfma_f32_16x16x32_bf16 v[64:67], a[200:203], a[104:107], v[64:67]
    buffer_load_dwordx4 v9, s[12:15], s64 offen offset:1024 nt lds
    v_mfma_f32_16x16x32_bf16 v[72:75], a[192:195], a[120:123], 0
    ds_read_b128 a[192:195], v2 offset:30720
    ds_read_b128 v[216:219], v14 offset:128
    v_mfma_f32_16x16x32_bf16 v[72:75], a[196:199], a[124:127], v[72:75]
    v_fma_f32 v38, v98, s35, v26
    v_fma_f32 v39, v99, s35, v26
    v_mfma_f32_16x16x32_bf16 v[72:75], a[200:203], a[128:131], v[72:75]
    ds_read_b128 a[196:199], v3 offset:30720
    s_waitcnt lgkmcnt(5)
    v_cvt_pk_bf16_f32 v56, v36, v37
    v_mfma_f32_16x16x32_bf16 v[64:67], a[204:207], a[108:111], v[64:67]
    buffer_load_dwordx4 v10, s[12:15], s64 offen offset:2048 nt lds
    v_mfma_f32_16x16x32_bf16 v[64:67], a[208:211], a[112:115], v[64:67]
    ds_read_b128 a[200:203], v2 offset:30848
    ds_read_b128 v[220:223], v15 offset:128
    v_mfma_f32_16x16x32_bf16 v[64:67], a[212:215], a[116:119], v[64:67]
    v_exp_f32 v38, v38
    v_mfma_f32_16x16x32_bf16 v[72:75], a[204:207], a[132:135], v[72:75]
    v_exp_f32 v39, v39
    v_mfma_f32_16x16x32_bf16 v[72:75], a[208:211], a[136:139], v[72:75]
    v_fma_f32 v0, v100, s35, v26
    v_fma_f32 v36, v101, s35, v26
    v_mfma_f32_16x16x32_bf16 v[72:75], a[212:215], a[140:143], v[72:75]
    ds_read_b128 v[224:227], v14 offset:256
    v_cvt_pk_bf16_f32 v57, v38, v39
    v_mfma_f32_16x16x32_bf16 v[80:83], a[204:207], a[156:159], v[80:83]
    v_exp_f32 v0, v0
    v_mfma_f32_16x16x32_bf16 v[80:83], a[208:211], a[160:163], v[80:83]
    v_exp_f32 v36, v36
    v_mfma_f32_16x16x32_bf16 v[80:83], a[212:215], a[164:167], v[80:83]
    v_fma_f32 v37, v102, s35, v26
    v_fma_f32 v38, v103, s35, v26
    v_mfma_f32_16x16x32_bf16 v[88:91], a[204:207], a[180:183], v[88:91]
    ds_read_b128 a[204:207], v3 offset:30848
    ds_read_b128 v[228:231], v15 offset:256
    v_mfma_f32_16x16x32_bf16 v[88:91], a[208:211], a[184:187], v[88:91]
    v_exp_f32 v37, v37
    v_mfma_f32_16x16x32_bf16 v[88:91], a[212:215], a[188:191], v[88:91]
    ds_read_b128 a[208:211], v2 offset:30976
    s_waitcnt lgkmcnt(5)
    v_mfma_f32_16x16x32_bf16 v[68:71], a[192:195], a[96:99], 0
    v_exp_f32 v38, v38
    v_mfma_f32_16x16x32_bf16 v[68:71], a[196:199], a[100:103], v[68:71]
    ds_read_b128 a[212:215], v3 offset:30976
    ds_read_b128 v[232:235], v14 offset:6144
    v_mfma_f32_16x16x32_bf16 v[68:71], a[200:203], a[104:107], v[68:71]
    v_cvt_pk_bf16_f32 v58, v0, v36
    v_fma_f32 v39, v104, s35, v27
    v_mfma_f32_16x16x32_bf16 v[76:79], a[192:195], a[120:123], 0
    v_exp_f32 v39, v39
    v_fma_f32 v0, v105, s35, v27
    v_mfma_f32_16x16x32_bf16 v[76:79], a[196:199], a[124:127], v[76:79]
    v_exp_f32 v0, v0
    v_mfma_f32_16x16x32_bf16 v[76:79], a[200:203], a[128:131], v[76:79]
    ds_read_b128 v[236:239], v15 offset:6144
    v_cvt_pk_bf16_f32 v59, v37, v38
    v_mfma_f32_16x16x32_bf16 v[84:87], a[192:195], a[144:147], 0
    v_fma_f32 v36, v106, s35, v27
    v_fma_f32 v37, v107, s35, v27
    v_mfma_f32_16x16x32_bf16 v[84:87], a[196:199], a[148:151], v[84:87]
    v_exp_f32 v36, v36
    v_mfma_f32_16x16x32_bf16 v[84:87], a[200:203], a[152:155], v[84:87]
    s_waitcnt lgkmcnt(2)
    v_cvt_pk_bf16_f32 v60, v39, v0
    v_mfma_f32_16x16x32_bf16 v[92:95], a[192:195], a[168:171], 0
    ds_read_b64_tr_b16 a[192:193], v4 offset:12288
    ds_read_b64_tr_b16 a[194:195], v4 offset:18432
    ds_read_b128 v[240:243], v14 offset:6272
    v_mfma_f32_16x16x32_bf16 v[92:95], a[196:199], a[172:175], v[92:95]
    v_exp_f32 v37, v37
    v_mfma_f32_16x16x32_bf16 v[92:95], a[200:203], a[176:179], v[92:95]
    ds_read_b64_tr_b16 a[196:197], v5 offset:12288
    ds_read_b64_tr_b16 a[198:199], v5 offset:18432
    v_mfma_f32_16x16x32_bf16 v[68:71], a[204:207], a[108:111], v[68:71]
    v_fma_f32 v38, v108, s35, v27
    v_fma_f32 v39, v109, s35, v27
    v_mfma_f32_16x16x32_bf16 v[68:71], a[208:211], a[112:115], v[68:71]
    ds_read_b64_tr_b16 a[200:201], v6 offset:12288
    ds_read_b64_tr_b16 a[202:203], v6 offset:18432
    ds_read_b128 v[244:247], v15 offset:6272
    v_mfma_f32_16x16x32_bf16 v[68:71], a[212:215], a[116:119], v[68:71]
    v_exp_f32 v38, v38
    v_mfma_f32_16x16x32_bf16 v[76:79], a[204:207], a[132:135], v[76:79]
    v_exp_f32 v39, v39
    v_mfma_f32_16x16x32_bf16 v[76:79], a[208:211], a[136:139], v[76:79]
    v_cvt_pk_bf16_f32 v61, v36, v37
    v_fma_f32 v0, v110, s35, v27
    v_mfma_f32_16x16x32_bf16 v[76:79], a[212:215], a[140:143], v[76:79]
    ds_read_b128 v[248:251], v14 offset:6400
    v_fma_f32 v36, v111, s35, v27
    v_mfma_f32_16x16x32_bf16 v[84:87], a[204:207], a[156:159], v[84:87]
    v_exp_f32 v0, v0
    v_mfma_f32_16x16x32_bf16 v[84:87], a[208:211], a[160:163], v[84:87]
    v_exp_f32 v36, v36
    v_mfma_f32_16x16x32_bf16 v[84:87], a[212:215], a[164:167], v[84:87]
    v_cvt_pk_bf16_f32 v62, v38, v39
    v_cvt_pk_bf16_f32 v63, v0, v36
    v_mfma_f32_16x16x32_bf16 v[92:95], a[204:207], a[180:183], v[92:95]
    ds_read_b64_tr_b16 a[204:205], v7 offset:12288
    ds_read_b64_tr_b16 a[206:207], v7 offset:18432
    ds_read_b128 v[252:255], v15 offset:6400
    v_mfma_f32_16x16x32_bf16 v[92:95], a[208:211], a[184:187], v[92:95]
    s_mov_b32 m0, s48
    v_fma_f32 v37, v64, s35, v24
    v_fma_f32 v38, v65, s35, v24
    v_mfma_f32_16x16x32_bf16 v[92:95], a[212:215], a[188:191], v[92:95]
    ds_read_b64_tr_b16 a[208:209], v4 offset:12416
    ds_read_b64_tr_b16 a[210:211], v4 offset:18560
    v_mfma_f32_16x16x32_bf16 v[28:31], a[248:251], v[56:59], 0
    buffer_load_dwordx4 v8, s[16:19], s63 offen nt lds
    v_mfma_f32_16x16x32_bf16 v[28:31], a[252:255], v[60:63], v[28:31]
    ds_read_b64_tr_b16 a[212:213], v5 offset:12416
    ds_read_b64_tr_b16 a[214:215], v5 offset:18560
    s_waitcnt lgkmcnt(9)
    v_mfma_f32_16x16x32_bf16 v[112:115], a[192:195], v[48:51], v[112:115]
    v_exp_f32 v37, v37
    v_mfma_f32_16x16x32_bf16 v[116:119], a[192:195], v[52:55], v[116:119]
    v_exp_f32 v38, v38
    v_mfma_f32_16x16x32_bf16 v[120:123], a[196:199], v[48:51], v[120:123]
    v_fma_f32 v39, v66, s35, v24
    v_cmp_nge_f32 vcc, s37, v30
    v_mfma_f32_16x16x32_bf16 v[124:127], a[196:199], v[52:55], v[124:127]
    v_exp_f32 v39, v39
    v_mfma_f32_16x16x32_bf16 v[128:131], a[200:203], v[48:51], v[128:131]
    v_fma_f32 v0, v67, s35, v24
    v_cvt_pk_bf16_f32 v40, v37, v38
    v_mfma_f32_16x16x32_bf16 v[132:135], a[200:203], v[52:55], v[132:135]
    s_cbranch_vccnz L_tr_T9f_B
L_ret_T9f_B:
    v_mfma_f32_16x16x32_bf16 a[0:3], a[192:195], v[56:59], a[0:3]
    v_add_f32 v21, v21, v28
    v_add_f32 v23, v23, v29
    v_mfma_f32_16x16x32_bf16 a[4:7], a[192:195], v[60:63], a[4:7]
    ds_read_b64_tr_b16 a[192:193], v6 offset:12416
    ds_read_b64_tr_b16 a[194:195], v6 offset:18560
    v_mfma_f32_16x16x32_bf16 a[8:11], a[196:199], v[56:59], a[8:11]
    buffer_load_dwordx4 v9, s[16:19], s63 offen offset:1024 nt lds
    v_mfma_f32_16x16x32_bf16 a[12:15], a[196:199], v[60:63], a[12:15]
    ds_read_b64_tr_b16 a[196:197], v7 offset:12416
    ds_read_b64_tr_b16 a[198:199], v7 offset:18560
    v_mfma_f32_16x16x32_bf16 a[16:19], a[200:203], v[56:59], a[16:19]
    s_waitcnt lgkmcnt(4)
    v_fma_f32 v36, v72, s35, v25
    v_mfma_f32_16x16x32_bf16 a[20:23], a[200:203], v[60:63], a[20:23]
    ds_read_b64_tr_b16 a[200:201], v4 offset:12544
    ds_read_b64_tr_b16 a[202:203], v4 offset:18688
    v_mfma_f32_16x16x32_bf16 v[136:139], a[204:207], v[48:51], v[136:139]
    v_exp_f32 v0, v0
    v_mfma_f32_16x16x32_bf16 v[140:143], a[204:207], v[52:55], v[140:143]
    v_exp_f32 v36, v36
    v_mfma_f32_16x16x32_bf16 a[24:27], a[204:207], v[56:59], a[24:27]
    v_fma_f32 v37, v73, s35, v25
    v_cvt_pk_bf16_f32 v41, v39, v0
    v_mfma_f32_16x16x32_bf16 a[28:31], a[204:207], v[60:63], a[28:31]
    ds_read_b64_tr_b16 a[204:205], v5 offset:12544
    ds_read_b64_tr_b16 a[206:207], v5 offset:18688
    v_mfma_f32_16x16x32_bf16 v[144:147], a[208:211], v[48:51], v[144:147]
    buffer_load_dwordx4 v10, s[16:19], s63 offen offset:2048 nt lds
    v_mfma_f32_16x16x32_bf16 v[148:151], a[208:211], v[52:55], v[148:151]
    v_exp_f32 v37, v37
    v_mfma_f32_16x16x32_bf16 a[32:35], a[208:211], v[56:59], a[32:35]
    v_fma_f32 v38, v74, s35, v25
    v_fma_f32 v39, v75, s35, v25
    v_mfma_f32_16x16x32_bf16 a[36:39], a[208:211], v[60:63], a[36:39]
    ds_read_b64_tr_b16 a[208:209], v6 offset:12544
    ds_read_b64_tr_b16 a[210:211], v6 offset:18688
    v_mfma_f32_16x16x32_bf16 v[152:155], a[212:215], v[48:51], v[152:155]
    v_exp_f32 v38, v38
    v_mfma_f32_16x16x32_bf16 v[156:159], a[212:215], v[52:55], v[156:159]
    s_mov_b32 m0, s88
    v_cvt_pk_bf16_f32 v44, v36, v37
    v_mfma_f32_16x16x32_bf16 a[40:43], a[212:215], v[56:59], a[40:43]
    s_waitcnt lgkmcnt(4)
    v_fma_f32 v0, v68, s35, v24
    v_mfma_f32_16x16x32_bf16 a[44:47], a[212:215], v[60:63], a[44:47]
    ds_read_b64_tr_b16 a[212:213], v7 offset:12544
    ds_read_b64_tr_b16 a[214:215], v7 offset:18688
    v_mfma_f32_16x16x32_bf16 v[160:163], a[192:195], v[48:51], v[160:163]
    buffer_load_dwordx4 v8, s[20:23], s84 offen nt lds
    v_mfma_f32_16x16x32_bf16 v[164:167], a[192:195], v[52:55], v[164:167]
    v_exp_f32 v39, v39
    v_mfma_f32_16x16x32_bf16 a[48:51], a[192:195], v[56:59], a[48:51]
    v_exp_f32 v0, v0
    v_mfma_f32_16x16x32_bf16 a[52:55], a[192:195], v[60:63], a[52:55]
    ds_read_b128 a[192:195], v2 offset:36864
    v_fma_f32 v36, v69, s35, v24
    v_mfma_f32_16x16x32_bf16 v[168:171], a[196:199], v[48:51], v[168:171]
    v_exp_f32 v36, v36
    v_mfma_f32_16x16x32_bf16 v[172:175], a[196:199], v[52:55], v[172:175]
    v_cvt_pk_bf16_f32 v45, v38, v39
    v_fma_f32 v37, v70, s35, v24
    v_mfma_f32_16x16x32_bf16 a[56:59], a[196:199], v[56:59], a[56:59]
    v_exp_f32 v37, v37
    v_mfma_f32_16x16x32_bf16 a[60:63], a[196:199], v[60:63], a[60:63]
    ds_read_b128 a[196:199], v3 offset:36864
    v_fma_f32 v38, v71, s35, v24
    v_mfma_f32_16x16x32_bf16 v[176:179], a[200:203], v[48:51], v[176:179]
    buffer_load_dwordx4 v9, s[20:23], s84 offen offset:1024 nt lds
    v_mfma_f32_16x16x32_bf16 v[180:183], a[200:203], v[52:55], v[180:183]
    v_exp_f32 v38, v38
    v_mfma_f32_16x16x32_bf16 a[64:67], a[200:203], v[56:59], a[64:67]
    v_cvt_pk_bf16_f32 v42, v0, v36
    v_fma_f32 v39, v76, s35, v25
    v_mfma_f32_16x16x32_bf16 a[68:71], a[200:203], v[60:63], a[68:71]
    ds_read_b128 a[200:203], v2 offset:36992
    s_waitcnt lgkmcnt(3)
    v_mfma_f32_16x16x32_bf16 v[184:187], a[204:207], v[48:51], v[184:187]
    v_exp_f32 v39, v39
    v_mfma_f32_16x16x32_bf16 v[188:191], a[204:207], v[52:55], v[188:191]
    v_fma_f32 v0, v77, s35, v25
    v_cvt_pk_bf16_f32 v43, v37, v38
    v_mfma_f32_16x16x32_bf16 a[72:75], a[204:207], v[56:59], a[72:75]
    v_exp_f32 v0, v0
    v_mfma_f32_16x16x32_bf16 a[76:79], a[204:207], v[60:63], a[76:79]
    ds_read_b128 a[204:207], v3 offset:36992
    v_fma_f32 v36, v78, s35, v25
    v_mfma_f32_16x16x32_bf16 v[192:195], a[208:211], v[48:51], v[192:195]
    buffer_load_dwordx4 v10, s[20:23], s84 offen offset:2048 nt lds
    v_mfma_f32_16x16x32_bf16 v[196:199], a[208:211], v[52:55], v[196:199]
    v_exp_f32 v36, v36
    v_mfma_f32_16x16x32_bf16 a[80:83], a[208:211], v[56:59], a[80:83]
    v_fma_f32 v37, v79, s35, v25
    v_mfma_f32_16x16x32_bf16 a[84:87], a[208:211], v[60:63], a[84:87]
    ds_read_b128 a[208:211], v2 offset:37120
    v_cvt_pk_bf16_f32 v46, v39, v0
    v_mfma_f32_16x16x32_bf16 v[200:203], a[212:215], v[48:51], v[200:203]
    v_exp_f32 v37, v37
    v_mfma_f32_16x16x32_bf16 v[204:207], a[212:215], v[52:55], v[204:207]
    v_cvt_pk_bf16_f32 v47, v36, v37
    v_mfma_f32_16x16x32_bf16 a[88:91], a[212:215], v[56:59], a[88:91]
    v_mfma_f32_16x16x32_bf16 a[92:95], a[212:215], v[60:63], a[92:95]
    ds_read_b128 a[212:215], v3 offset:37120
    v_mfma_f32_16x16x32_bf16 v[28:31], a[248:251], v[40:43], 0
    s_waitcnt vmcnt(12)
    s_barrier
    v_mfma_f32_16x16x32_bf16 v[28:31], a[252:255], v[44:47], v[28:31]
    s_waitcnt lgkmcnt(3)
    s_branch L_join
L_hop_4:
    s_cbranch_execz L_hop_8
L_loop:
    v_mfma_f32_16x16x32_bf16 v[80:83], a[192:195], a[144:147], 0
    v_fma_f32 v36, v96, s35, v26
    v_fma_f32 v37, v97, s35, v26
    v_mfma_f32_16x16x32_bf16 v[80:83], a[196:199], a[148:151], v[80:83]
    ds_read_b128 a[216:219], v1 offset:0
    v_fma_f32 v38, v98, s35, v26
    v_mfma_f32_16x16x32_bf16 v[80:83], a[200:203], a[152:155], v[80:83]
    s_mov_b32 m0, s43
    v_cmp_nge_f32 vcc, s37, v30
    v_mfma_f32_16x16x32_bf16 v[88:91], a[192:195], a[168:171], 0
    v_exp_f32 v36, v36
    v_mfma_f32_16x16x32_bf16 v[88:91], a[196:199], a[172:175], v[88:91]
    buffer_load_dwordx4 v8, s[12:15], s56 offen nt lds
    v_mfma_f32_16x16x32_bf16 v[88:91], a[200:203], a[176:179], v[88:91]
    v_fma_f32 v39, v99, s35, v26
    s_cbranch_vccnz L_tr_T1_A
L_ret_T1_A:
    v_mfma_f32_16x16x32_bf16 v[64:67], a[192:195], a[96:99], 0
    v_exp_f32 v37, v37
    v_mfma_f32_16x16x32_bf16 v[64:67], a[196:199], a[100:103], v[64:67]
    v_exp_f32 v38, v38
    v_mfma_f32_16x16x32_bf16 v[64:67], a[200:203], a[104:107], v[64:67]
    buffer_load_dwordx4 v9, s[12:15], s56 offen offset:1024 nt lds
    v_add_f32 v17, v17, v28
    v_add_f32 v19, v19, v29
    v_mfma_f32_16x16x32_bf16 v[72:75], a[192:195], a[120:123], 0
    ds_read_b128 a[192:195], v2 offset:30720
    v_cvt_pk_bf16_f32 v56, v36, v37
    v_mfma_f32_16x16x32_bf16 v[72:75], a[196:199], a[124:127], v[72:75]
    v_exp_f32 v39, v39
    v_mfma_f32_16x16x32_bf16 v[72:75], a[200:203], a[128:131], v[72:75]
    ds_read_b128 a[196:199], v3 offset:30720
    s_waitcnt lgkmcnt(3)
    v_mfma_f32_16x16x32_bf16 v[64:67], a[204:207], a[108:111], v[64:67]
    buffer_load_dwordx4 v10, s[12:15], s56 offen offset:2048 nt lds
    v_mfma_f32_16x16x32_bf16 v[64:67], a[208:211], a[112:115], v[64:67]
    ds_read_b128 a[200:203], v2 offset:30848
    v_fma_f32 v0, v100, s35, v26
    v_mfma_f32_16x16x32_bf16 v[64:67], a[212:215], a[116:119], v[64:67]
    v_exp_f32 v0, v0
    v_mfma_f32_16x16x32_bf16 v[72:75], a[204:207], a[132:135], v[72:75]
    v_fma_f32 v36, v101, s35, v26
    v_cvt_pk_bf16_f32 v57, v38, v39
    v_mfma_f32_16x16x32_bf16 v[72:75], a[208:211], a[136:139], v[72:75]
    v_exp_f32 v36, v36
    v_mfma_f32_16x16x32_bf16 v[72:75], a[212:215], a[140:143], v[72:75]
    ds_read_b128 a[220:223], v1 offset:1024
    v_fma_f32 v37, v102, s35, v26
    v_mfma_f32_16x16x32_bf16 v[80:83], a[204:207], a[156:159], v[80:83]
    v_exp_f32 v37, v37
    v_mfma_f32_16x16x32_bf16 v[80:83], a[208:211], a[160:163], v[80:83]
    v_fma_f32 v38, v103, s35, v26
    v_cvt_pk_bf16_f32 v58, v0, v36
    v_mfma_f32_16x16x32_bf16 v[80:83], a[212:215], a[164:167], v[80:83]
    v_exp_f32 v38, v38
    v_mfma_f32_16x16x32_bf16 v[88:91], a[204:207], a[180:183], v[88:91]
    ds_read_b128 a[204:207], v3 offset:30848
    v_fma_f32 v39, v104, s35, v27
    v_mfma_f32_16x16x32_bf16 v[88:91], a[208:211], a[184:187], v[88:91]
    v_exp_f32 v39, v39
    v_mfma_f32_16x16x32_bf16 v[88:91], a[212:215], a[188:191], v[88:91]
    ds_read_b128 a[208:211], v2 offset:30976
    s_waitcnt lgkmcnt(3)
    v_mfma_f32_16x16x32_bf16 v[68:71], a[192:195], a[96:99], 0
    v_fma_f32 v0, v105, s35, v27
    v_cvt_pk_bf16_f32 v59, v37, v38
    v_mfma_f32_16x16x32_bf16 v[68:71], a[196:199], a[100:103], v[68:71]
    ds_read_b128 a[212:215], v3 offset:30976
    ds_read_b128 a[224:227], v1 offset:2048
    v_mfma_f32_16x16x32_bf16 v[68:71], a[200:203], a[104:107], v[68:71]
    v_exp_f32 v0, v0
    v_mfma_f32_16x16x32_bf16 v[76:79], a[192:195], a[120:123], 0
    s_mov_b32 s32, s31
    v_fma_f32 v36, v106, s35, v27
    v_mfma_f32_16x16x32_bf16 v[76:79], a[196:199], a[124:127], v[76:79]
    v_exp_f32 v36, v36
    v_mfma_f32_16x16x32_bf16 v[76:79], a[200:203], a[128:131], v[76:79]
    v_fma_f32 v37, v107, s35, v27
    s_add_u32 s28, s28, 32
    v_mfma_f32_16x16x32_bf16 v[84:87], a[192:195], a[144:147], 0
    v_exp_f32 v37, v37
    v_mfma_f32_16x16x32_bf16 v[84:87], a[196:199], a[148:151], v[84:87]
    v_cvt_pk_bf16_f32 v60, v39, v0
    v_fma_f32 v38, v108, s35, v27
    v_mfma_f32_16x16x32_bf16 v[84:87], a[200:203], a[152:155], v[84:87]
    s_waitcnt lgkmcnt(1)
    v_fma_f32 v39, v109, s35, v27
    v_mfma_f32_16x16x32_bf16 v[92:95], a[192:195], a[168:171], 0
    ds_read_b64_tr_b16 a[192:193], v4 offset:12288
    ds_read_b64_tr_b16 a[194:195], v4 offset:18432
    ds_read_b128 a[228:231], v1 offset:3072
    v_mfma_f32_16x16x32_bf16 v[92:95], a[196:199], a[172:175], v[92:95]
    v_exp_f32 v38, v38
    v_mfma_f32_16x16x32_bf16 v[92:95], a[200:203], a[176:179], v[92:95]
    ds_read_b64_tr_b16 a[196:197], v5 offset:12288
    ds_read_b64_tr_b16 a[198:199], v5 offset:18432
    v_mfma_f32_16x16x32_bf16 v[68:71], a[204:207], a[108:111], v[68:71]
    v_exp_f32 v39, v39
    v_mfma_f32_16x16x32_bf16 v[68:71], a[208:211], a[112:115], v[68:71]
    ds_read_b64_tr_b16 a[200:201], v6 offset:12288
    ds_read_b64_tr_b16 a[202:203], v6 offset:18432
L_hop_5:
    s_cbranch_execz L_hop_9
    v_mfma_f32_16x16x32_bf16 v[68:71], a[212:215], a[116:119], v[68:71]
    s_mul_hi_u32 s30, s28, s38
    v_cvt_pk_bf16_f32 v61, v36, v37
    v_mfma_f32_16x16x32_bf16 v[76:79], a[204:207], a[132:135], v[76:79]
    v_fma_f32 v0, v110, s35, v27
    v_fma_f32 v36, v111, s35, v27
    v_mfma_f32_16x16x32_bf16 v[76:79], a[208:211], a[136:139], v[76:79]
    v_exp_f32 v0, v0
    v_mfma_f32_16x16x32_bf16 v[76:79], a[212:215], a[140:143], v[76:79]
    ds_read_b128 a[232:235], v1 offset:4096
    s_mul_i32 s30, s30, 196608
    v_mfma_f32_16x16x32_bf16 v[84:87], a[204:207], a[156:159], v[84:87]
    v_exp_f32 v36, v36
    v_mfma_f32_16x16x32_bf16 v[84:87], a[208:211], a[160:163], v[84:87]
    v_cvt_pk_bf16_f32 v62, v38, v39
    v_cvt_pk_bf16_f32 v63, v0, v36
    v_mfma_f32_16x16x32_bf16 v[84:87], a[212:215], a[164:167], v[84:87]
    v_fma_f32 v37, v64, s35, v24
    s_mul_i32 s31, s28, 98304
    v_fma_f32 v38, v65, s35, v24
    v_mfma_f32_16x16x32_bf16 v[92:95], a[204:207], a[180:183], v[92:95]
    ds_read_b64_tr_b16 a[204:205], v7 offset:12288
    ds_read_b64_tr_b16 a[206:207], v7 offset:18432
    ds_read_b128 a[236:239], v1 offset:5120
    v_mfma_f32_16x16x32_bf16 v[92:95], a[208:211], a[184:187], v[92:95]
    s_mov_b32 m0, s48
    v_fma_f32 v39, v66, s35, v24
    v_mfma_f32_16x16x32_bf16 v[92:95], a[212:215], a[188:191], v[92:95]
    ds_read_b64_tr_b16 a[208:209], v4 offset:12416
    ds_read_b64_tr_b16 a[210:211], v4 offset:18560
    v_mfma_f32_16x16x32_bf16 v[28:31], a[248:251], v[56:59], 0
    buffer_load_dwordx4 v8, s[16:19], s55 offen nt lds
    v_mfma_f32_16x16x32_bf16 v[28:31], a[252:255], v[60:63], v[28:31]
    ds_read_b64_tr_b16 a[212:213], v5 offset:12416
    ds_read_b64_tr_b16 a[214:215], v5 offset:18560
    s_waitcnt lgkmcnt(8)
    v_mfma_f32_16x16x32_bf16 v[112:115], a[192:195], v[48:51], v[112:115]
    v_exp_f32 v37, v37
    v_mfma_f32_16x16x32_bf16 v[116:119], a[192:195], v[52:55], v[116:119]
    v_exp_f32 v38, v38
    v_mfma_f32_16x16x32_bf16 v[120:123], a[196:199], v[48:51], v[120:123]
    v_fma_f32 v0, v67, s35, v24
    v_cmp_nge_f32 vcc, s37, v30
    v_mfma_f32_16x16x32_bf16 v[124:127], a[196:199], v[52:55], v[124:127]
    v_exp_f32 v39, v39
    v_mfma_f32_16x16x32_bf16 v[128:131], a[200:203], v[48:51], v[128:131]
    v_exp_f32 v0, v0
    v_mfma_f32_16x16x32_bf16 v[132:135], a[200:203], v[52:55], v[132:135]
    s_cmp_lt_u32 s34, 2
    s_cbranch_vccnz L_tr_T1_B
L_ret_T1_B:
    v_mfma_f32_16x16x32_bf16 a[0:3], a[192:195], v[56:59], a[0:3]
    v_add_f32 v21, v21, v28
    v_add_f32 v23, v23, v29
    v_mfma_f32_16x16x32_bf16 a[4:7], a[192:195], v[60:63], a[4:7]
    ds_read_b64_tr_b16 a[192:193], v6 offset:12416
    ds_read_b64_tr_b16 a[194:195], v6 offset:18560
    v_mfma_f32_16x16x32_bf16 a[8:11], a[196:199], v[56:59], a[8:11]
    buffer_load_dwordx4 v9, s[16:19], s55 offen offset:1024 nt lds
    v_mfma_f32_16x16x32_bf16 a[12:15], a[196:199], v[60:63], a[12:15]
    ds_read_b64_tr_b16 a[196:197], v7 offset:12416
    ds_read_b64_tr_b16 a[198:199], v7 offset:18560
    ds_read_b128 a[240:243], v1 offset:6144
    v_mfma_f32_16x16x32_bf16 a[16:19], a[200:203], v[56:59], a[16:19]
    s_waitcnt lgkmcnt(5)
    v_cvt_pk_bf16_f32 v40, v37, v38
    v_mfma_f32_16x16x32_bf16 a[20:23], a[200:203], v[60:63], a[20:23]
    ds_read_b64_tr_b16 a[200:201], v4 offset:12544
    ds_read_b64_tr_b16 a[202:203], v4 offset:18688
    v_mfma_f32_16x16x32_bf16 v[136:139], a[204:207], v[48:51], v[136:139]
    s_cselect_b32 s33, 196608, 0
    v_fma_f32 v36, v72, s35, v25
    v_mfma_f32_16x16x32_bf16 v[140:143], a[204:207], v[52:55], v[140:143]
    v_exp_f32 v36, v36
    v_fma_f32 v37, v73, s35, v25
    v_mfma_f32_16x16x32_bf16 a[24:27], a[204:207], v[56:59], a[24:27]
    v_exp_f32 v37, v37
    v_mfma_f32_16x16x32_bf16 a[28:31], a[204:207], v[60:63], a[28:31]
    ds_read_b64_tr_b16 a[204:205], v5 offset:12544
    ds_read_b64_tr_b16 a[206:207], v5 offset:18688
    v_mfma_f32_16x16x32_bf16 v[144:147], a[208:211], v[48:51], v[144:147]
    buffer_load_dwordx4 v10, s[16:19], s55 offen offset:2048 nt lds
    v_mfma_f32_16x16x32_bf16 v[148:151], a[208:211], v[52:55], v[148:151]
    ds_read_b128 a[244:247], v1 offset:7168
    v_cvt_pk_bf16_f32 v41, v39, v0
    v_mfma_f32_16x16x32_bf16 a[32:35], a[208:211], v[56:59], a[32:35]
    s_cselect_b32 s22, 98304, 0
    v_fma_f32 v38, v74, s35, v25
    v_mfma_f32_16x16x32_bf16 a[36:39], a[208:211], v[60:63], a[36:39]
    ds_read_b64_tr_b16 a[208:209], v6 offset:12544
    ds_read_b64_tr_b16 a[210:211], v6 offset:18688
    v_mfma_f32_16x16x32_bf16 v[152:155], a[212:215], v[48:51], v[152:155]
    v_exp_f32 v38, v38
    v_mfma_f32_16x16x32_bf16 v[156:159], a[212:215], v[52:55], v[156:159]
    v_fma_f32 v39, v75, s35, v25
    v_cvt_pk_bf16_f32 v44, v36, v37
    v_mfma_f32_16x16x32_bf16 a[40:43], a[212:215], v[56:59], a[40:43]
    s_waitcnt lgkmcnt(5)
    v_fma_f32 v0, v68, s35, v24
    v_mfma_f32_16x16x32_bf16 a[44:47], a[212:215], v[60:63], a[44:47]
    ds_read_b64_tr_b16 a[212:213], v7 offset:12544
    ds_read_b64_tr_b16 a[214:215], v7 offset:18688
    v_mfma_f32_16x16x32_bf16 v[160:163], a[192:195], v[48:51], v[160:163]
    buffer_store_dwordx4 a[216:219], v11, s[24:27], s80 offen sc1
    v_mfma_f32_16x16x32_bf16 v[164:167], a[192:195], v[52:55], v[164:167]
    v_exp_f32 v39, v39
    v_mfma_f32_16x16x32_bf16 a[48:51], a[192:195], v[56:59], a[48:51]
    v_exp_f32 v0, v0
    v_mfma_f32_16x16x32_bf16 a[52:55], a[192:195], v[60:63], a[52:55]
    ds_read_b128 a[192:195], v2 offset:36864
    s_add_u32 s20, s4, s31
    v_mfma_f32_16x16x32_bf16 v[168:171], a[196:199], v[48:51], v[168:171]
    v_fma_f32 v36, v69, s35, v24
    v_cvt_pk_bf16_f32 v45, v38, v39
    v_mfma_f32_16x16x32_bf16 v[172:175], a[196:199], v[52:55], v[172:175]
    v_exp_f32 v36, v36
    v_mfma_f32_16x16x32_bf16 a[56:59], a[196:199], v[56:59], a[56:59]
    s_addc_u32 s21, s5, 0
    v_fma_f32 v37, v70, s35, v24
    v_fma_f32 v38, v71, s35, v24
    v_mfma_f32_16x16x32_bf16 a[60:63], a[196:199], v[60:63], a[60:63]
    ds_read_b128 a[196:199], v3 offset:36864
    v_cvt_pk_bf16_f32 v42, v0, v36
    v_mfma_f32_16x16x32_bf16 v[176:179], a[200:203], v[48:51], v[176:179]
    buffer_store_dwordx4 a[220:223], v12, s[24:27], s80 offen offset:1024 sc1
    v_mfma_f32_16x16x32_bf16 v[180:183], a[200:203], v[52:55], v[180:183]
    v_exp_f32 v37, v37
    v_mfma_f32_16x16x32_bf16 a[64:67], a[200:203], v[56:59], a[64:67]
    v_exp_f32 v38, v38
    v_mfma_f32_16x16x32_bf16 a[68:71], a[200:203], v[60:63], a[68:71]
    ds_read_b128 a[200:203], v2 offset:36992
    s_waitcnt lgkmcnt(3)
    v_mfma_f32_16x16x32_bf16 v[184:187], a[204:207], v[48:51], v[184:187]
    v_fma_f32 v39, v76, s35, v25
    v_fma_f32 v0, v77, s35, v25
    v_mfma_f32_16x16x32_bf16 v[188:191], a[204:207], v[52:55], v[188:191]
    v_exp_f32 v39, v39
    v_mfma_f32_16x16x32_bf16 a[72:75], a[204:207], v[56:59], a[72:75]
    v_exp_f32 v0, v0
    v_mfma_f32_16x16x32_bf16 a[76:79], a[204:207], v[60:63], a[76:79]
    ds_read_b128 a[204:207], v3 offset:36992
    v_cvt_pk_bf16_f32 v43, v37, v38
    v_mfma_f32_16x16x32_bf16 v[192:195], a[208:211], v[48:51], v[192:195]
    buffer_store_dwordx4 a[224:227], v13, s[24:27], s80 offen offset:2048 sc1
    v_mfma_f32_16x16x32_bf16 v[196:199], a[208:211], v[52:55], v[196:199]
    v_fma_f32 v36, v78, s35, v25
    v_fma_f32 v37, v79, s35, v25
    v_mfma_f32_16x16x32_bf16 a[80:83], a[208:211], v[56:59], a[80:83]
    v_exp_f32 v36, v36
    v_mfma_f32_16x16x32_bf16 a[84:87], a[208:211], v[60:63], a[84:87]
    ds_read_b128 a[208:211], v2 offset:37120
    v_cvt_pk_bf16_f32 v46, v39, v0
    v_mfma_f32_16x16x32_bf16 v[200:203], a[212:215], v[48:51], v[200:203]
    v_exp_f32 v37, v37
    v_mfma_f32_16x16x32_bf16 v[204:207], a[212:215], v[52:55], v[204:207]
    v_cvt_pk_bf16_f32 v47, v36, v37
    v_mfma_f32_16x16x32_bf16 a[88:91], a[212:215], v[56:59], a[88:91]
    v_mfma_f32_16x16x32_bf16 a[92:95], a[212:215], v[60:63], a[92:95]
    ds_read_b128 a[212:215], v3 offset:37120
    v_mfma_f32_16x16x32_bf16 v[28:31], a[248:251], v[40:43], 0
    s_waitcnt vmcnt(12)
    s_barrier
    v_mfma_f32_16x16x32_bf16 v[28:31], a[252:255], v[44:47], v[28:31]
    s_waitcnt lgkmcnt(3)
    v_mfma_f32_16x16x32_bf16 v[96:99], a[192:195], a[144:147], 0
    v_fma_f32 v36, v80, s35, v26
    v_fma_f32 v37, v81, s35, v26
    v_mfma_f32_16x16x32_bf16 v[96:99], a[196:199], a[148:151], v[96:99]
    ds_read_b128 a[216:219], v1 offset:8192
    v_fma_f32 v38, v82, s35, v26
    v_mfma_f32_16x16x32_bf16 v[96:99], a[200:203], a[152:155], v[96:99]
    s_mov_b32 m0, s44
    v_fma_f32 v39, v83, s35, v26
    v_cmp_nge_f32 vcc, s37, v30
    v_mfma_f32_16x16x32_bf16 v[104:107], a[192:195], a[168:171], 0
    v_exp_f32 v36, v36
    v_mfma_f32_16x16x32_bf16 v[104:107], a[196:199], a[172:175], v[104:107]
    buffer_load_dwordx4 v8, s[12:15], s57 offen nt lds
    v_mfma_f32_16x16x32_bf16 v[104:107], a[200:203], a[176:179], v[104:107]
    v_fma_f32 v0, v84, s35, v26
    s_cbranch_vccnz L_tr_T2_A
L_ret_T2_A:
    v_mfma_f32_16x16x32_bf16 v[64:67], a[192:195], a[96:99], 0
    v_exp_f32 v37, v37
    v_add_f32 v17, v17, v28
    v_mfma_f32_16x16x32_bf16 v[64:67], a[196:199], a[100:103], v[64:67]
    v_exp_f32 v38, v38
    v_mfma_f32_16x16x32_bf16 v[64:67], a[200:203], a[104:107], v[64:67]
    buffer_load_dwordx4 v9, s[12:15], s57 offen offset:1024 nt lds
    v_add_f32 v19, v19, v29
    v_mfma_f32_16x16x32_bf16 v[72:75], a[192:195], a[120:123], 0
    ds_read_b128 a[192:195], v2 offset:43008
    ds_read_b128 a[220:223], v1 offset:9216
    v_mfma_f32_16x16x32_bf16 v[72:75], a[196:199], a[124:127], v[72:75]
    v_exp_f32 v39, v39
    v_mfma_f32_16x16x32_bf16 v[72:75], a[200:203], a[128:131], v[72:75]
    ds_read_b128 a[196:199], v3 offset:43008
    s_waitcnt lgkmcnt(4)
    v_cvt_pk_bf16_f32 v56, v36, v37
    v_mfma_f32_16x16x32_bf16 v[64:67], a[204:207], a[108:111], v[64:67]
    buffer_load_dwordx4 v10, s[12:15], s57 offen offset:2048 nt lds
    v_mfma_f32_16x16x32_bf16 v[64:67], a[208:211], a[112:115], v[64:67]
    ds_read_b128 a[200:203], v2 offset:43136
    v_fma_f32 v36, v85, s35, v26
    v_mfma_f32_16x16x32_bf16 v[64:67], a[212:215], a[116:119], v[64:67]
    v_exp_f32 v0, v0
    v_mfma_f32_16x16x32_bf16 v[72:75], a[204:207], a[132:135], v[72:75]
    v_exp_f32 v36, v36
    v_mfma_f32_16x16x32_bf16 v[72:75], a[208:211], a[136:139], v[72:75]
    v_cvt_pk_bf16_f32 v57, v38, v39
    v_fma_f32 v37, v86, s35, v26
    v_mfma_f32_16x16x32_bf16 v[72:75], a[212:215], a[140:143], v[72:75]
    ds_read_b128 a[224:227], v1 offset:10240
    v_fma_f32 v38, v87, s35, v26
    v_mfma_f32_16x16x32_bf16 v[96:99], a[204:207], a[156:159], v[96:99]
    v_exp_f32 v37, v37
    v_mfma_f32_16x16x32_bf16 v[96:99], a[208:211], a[160:163], v[96:99]
    v_exp_f32 v38, v38
    v_mfma_f32_16x16x32_bf16 v[96:99], a[212:215], a[164:167], v[96:99]
    buffer_store_dwordx4 a[228:231], v11, s[24:27], s81 offen sc1
    v_mfma_f32_16x16x32_bf16 v[104:107], a[204:207], a[180:183], v[104:107]
    ds_read_b128 a[204:207], v3 offset:43136
    v_cvt_pk_bf16_f32 v58, v0, v36
    v_mfma_f32_16x16x32_bf16 v[104:107], a[208:211], a[184:187], v[104:107]
    ds_read_b128 a[228:231], v1 offset:11264
    v_fma_f32 v39, v88, s35, v27
    v_mfma_f32_16x16x32_bf16 v[104:107], a[212:215], a[188:191], v[104:107]
    ds_read_b128 a[208:211], v2 offset:43264
    s_waitcnt lgkmcnt(4)
    v_mfma_f32_16x16x32_bf16 v[68:71], a[192:195], a[96:99], 0
    ds_write_b64 v32, v[208:209] offset:0
    v_fma_f32 v0, v89, s35, v27
    v_mfma_f32_16x16x32_bf16 v[68:71], a[196:199], a[100:103], v[68:71]
    ds_read_b128 a[212:215], v3 offset:43264
    v_cvt_pk_bf16_f32 v59, v37, v38
    v_mfma_f32_16x16x32_bf16 v[68:71], a[200:203], a[104:107], v[68:71]
    v_exp_f32 v39, v39
    v_mfma_f32_16x16x32_bf16 v[76:79], a[192:195], a[120:123], 0
    v_exp_f32 v0, v0
    v_mfma_f32_16x16x32_bf16 v[76:79], a[196:199], a[124:127], v[76:79]
    ds_write_b64 v32, v[210:211] offset:6144
    v_mfma_f32_16x16x32_bf16 v[76:79], a[200:203], a[128:131], v[76:79]
    v_fma_f32 v36, v90, s35, v27
    v_fma_f32 v37, v91, s35, v27
    v_mfma_f32_16x16x32_bf16 v[100:103], a[192:195], a[144:147], 0
    v_exp_f32 v36, v36
    v_mfma_f32_16x16x32_bf16 v[100:103], a[196:199], a[148:151], v[100:103]
    v_exp_f32 v37, v37
    v_mfma_f32_16x16x32_bf16 v[100:103], a[200:203], a[152:155], v[100:103]
    s_waitcnt lgkmcnt(1)
    v_cvt_pk_bf16_f32 v60, v39, v0
    v_mfma_f32_16x16x32_bf16 v[108:111], a[192:195], a[168:171], 0
    ds_read_b64_tr_b16 a[192:193], v4 offset:24576
    ds_read_b64_tr_b16 a[194:195], v4 offset:30720
    v_mfma_f32_16x16x32_bf16 v[108:111], a[196:199], a[172:175], v[108:111]
    ds_write_b64 v32, v[224:225] offset:128
    v_fma_f32 v38, v92, s35, v27
    v_mfma_f32_16x16x32_bf16 v[108:111], a[200:203], a[176:179], v[108:111]
    ds_read_b64_tr_b16 a[196:197], v5 offset:24576
    ds_read_b64_tr_b16 a[198:199], v5 offset:30720
    v_mfma_f32_16x16x32_bf16 v[68:71], a[204:207], a[108:111], v[68:71]
    v_exp_f32 v38, v38
    v_mfma_f32_16x16x32_bf16 v[68:71], a[208:211], a[112:115], v[68:71]
    ds_read_b64_tr_b16 a[200:201], v6 offset:24576
    ds_read_b64_tr_b16 a[202:203], v6 offset:30720
    v_fma_f32 v39, v93, s35, v27
    v_mfma_f32_16x16x32_bf16 v[68:71], a[212:215], a[116:119], v[68:71]
    v_exp_f32 v39, v39
    v_mfma_f32_16x16x32_bf16 v[76:79], a[204:207], a[132:135], v[76:79]
    v_cvt_pk_bf16_f32 v61, v36, v37
    v_fma_f32 v0, v94, s35, v27
    v_mfma_f32_16x16x32_bf16 v[76:79], a[208:211], a[136:139], v[76:79]
    ds_write_b64 v32, v[226:227] offset:6272
    v_mfma_f32_16x16x32_bf16 v[76:79], a[212:215], a[140:143], v[76:79]
    v_exp_f32 v0, v0
    v_mfma_f32_16x16x32_bf16 v[100:103], a[204:207], a[156:159], v[100:103]
    v_fma_f32 v36, v95, s35, v27
    v_cvt_pk_bf16_f32 v62, v38, v39
    v_mfma_f32_16x16x32_bf16 v[100:103], a[208:211], a[160:163], v[100:103]
    v_exp_f32 v36, v36
    v_mfma_f32_16x16x32_bf16 v[100:103], a[212:215], a[164:167], v[100:103]
    buffer_store_dwordx4 a[232:235], v12, s[24:27], s81 offen offset:1024 sc1
    v_mfma_f32_16x16x32_bf16 v[108:111], a[204:207], a[180:183], v[108:111]
    ds_read_b64_tr_b16 a[204:205], v7 offset:24576
    ds_read_b64_tr_b16 a[206:207], v7 offset:30720
    v_mfma_f32_16x16x32_bf16 v[108:111], a[208:211], a[184:187], v[108:111]
    s_mov_b32 m0, s49
    v_cvt_pk_bf16_f32 v63, v0, v36
    v_mfma_f32_16x16x32_bf16 v[108:111], a[212:215], a[188:191], v[108:111]
    ds_read_b64_tr_b16 a[208:209], v4 offset:24704
    ds_read_b64_tr_b16 a[210:211], v4 offset:30848
    v_mfma_f32_16x16x32_bf16 v[28:31], a[248:251], v[56:59], 0
    buffer_load_dwordx4 v8, s[16:19], s56 offen nt lds
    v_mfma_f32_16x16x32_bf16 v[28:31], a[252:255], v[60:63], v[28:31]
    ds_read_b64_tr_b16 a[212:213], v5 offset:24704
    ds_read_b64_tr_b16 a[214:215], v5 offset:30848
    s_waitcnt lgkmcnt(7)
    v_mfma_f32_16x16x32_bf16 v[112:115], a[192:195], v[40:43], v[112:115]
    ds_write_b64 v32, v[240:241] offset:256
    v_fma_f32 v37, v64, s35, v24
    v_mfma_f32_16x16x32_bf16 v[116:119], a[192:195], v[44:47], v[116:119]
    v_exp_f32 v37, v37
    v_mfma_f32_16x16x32_bf16 v[120:123], a[196:199], v[40:43], v[120:123]
    v_fma_f32 v38, v65, s35, v24
    v_fma_f32 v39, v66, s35, v24
    v_cmp_nge_f32 vcc, s37, v30
    v_mfma_f32_16x16x32_bf16 v[124:127], a[196:199], v[44:47], v[124:127]
    v_exp_f32 v38, v38
    v_mfma_f32_16x16x32_bf16 v[128:131], a[200:203], v[40:43], v[128:131]
    ds_write_b64 v32, v[242:243] offset:6400
    v_mfma_f32_16x16x32_bf16 v[132:135], a[200:203], v[44:47], v[132:135]
    v_fma_f32 v0, v67, s35, v24
    s_cbranch_vccnz L_tr_T2_B
L_ret_T2_B:
    v_mfma_f32_16x16x32_bf16 a[0:3], a[192:195], v[56:59], a[0:3]
    v_exp_f32 v39, v39
    v_mfma_f32_16x16x32_bf16 a[4:7], a[192:195], v[60:63], a[4:7]
    ds_read_b64_tr_b16 a[192:193], v6 offset:24704
    ds_read_b64_tr_b16 a[194:195], v6 offset:30848
    v_mfma_f32_16x16x32_bf16 a[8:11], a[196:199], v[56:59], a[8:11]
    buffer_load_dwordx4 v9, s[16:19], s56 offen offset:1024 nt lds
    v_add_f32 v21, v21, v28
    v_add_f32 v23, v23, v29
    v_mfma_f32_16x16x32_bf16 a[12:15], a[196:199], v[60:63], a[12:15]
    ds_read_b64_tr_b16 a[196:197], v7 offset:24704
    ds_read_b64_tr_b16 a[198:199], v7 offset:30848
    v_mfma_f32_16x16x32_bf16 a[16:19], a[200:203], v[56:59], a[16:19]
    s_waitcnt lgkmcnt(6)
    v_cvt_pk_bf16_f32 v48, v37, v38
    v_mfma_f32_16x16x32_bf16 a[20:23], a[200:203], v[60:63], a[20:23]
    ds_read_b64_tr_b16 a[200:201], v4 offset:24832
    ds_read_b64_tr_b16 a[202:203], v4 offset:30976
    v_mfma_f32_16x16x32_bf16 v[136:139], a[204:207], v[40:43], v[136:139]
    v_exp_f32 v0, v0
    v_mfma_f32_16x16x32_bf16 v[140:143], a[204:207], v[44:47], v[140:143]
    v_fma_f32 v36, v72, s35, v25
    v_fma_f32 v37, v73, s35, v25
    v_mfma_f32_16x16x32_bf16 a[24:27], a[204:207], v[56:59], a[24:27]
    v_exp_f32 v36, v36
    v_mfma_f32_16x16x32_bf16 a[28:31], a[204:207], v[60:63], a[28:31]
    ds_read_b64_tr_b16 a[204:205], v5 offset:24832
    ds_read_b64_tr_b16 a[206:207], v5 offset:30976
    v_xor_b32 v35, 32, v32
    v_mfma_f32_16x16x32_bf16 v[144:147], a[208:211], v[40:43], v[144:147]
    buffer_load_dwordx4 v10, s[16:19], s56 offen offset:2048 nt lds
    v_mfma_f32_16x16x32_bf16 v[148:151], a[208:211], v[44:47], v[148:151]
    ds_write_b64 v35, v[212:213] offset:0
    v_mfma_f32_16x16x32_bf16 a[32:35], a[208:211], v[56:59], a[32:35]
    v_exp_f32 v37, v37
    v_mfma_f32_16x16x32_bf16 a[36:39], a[208:211], v[60:63], a[36:39]
    ds_read_b64_tr_b16 a[208:209], v6 offset:24832
    ds_read_b64_tr_b16 a[210:211], v6 offset:30976
    v_mfma_f32_16x16x32_bf16 v[152:155], a[212:215], v[40:43], v[152:155]
    v_cvt_pk_bf16_f32 v49, v39, v0
    v_fma_f32 v38, v74, s35, v25
    v_mfma_f32_16x16x32_bf16 v[156:159], a[212:215], v[44:47], v[156:159]
    ds_write_b64 v35, v[214:215] offset:6144
    v_mfma_f32_16x16x32_bf16 a[40:43], a[212:215], v[56:59], a[40:43]
    s_waitcnt lgkmcnt(6)
    v_fma_f32 v39, v75, s35, v25
    v_mfma_f32_16x16x32_bf16 a[44:47], a[212:215], v[60:63], a[44:47]
    ds_read_b64_tr_b16 a[212:213], v7 offset:24832
    ds_read_b64_tr_b16 a[214:215], v7 offset:30976
    v_mfma_f32_16x16x32_bf16 v[160:163], a[192:195], v[40:43], v[160:163]
    buffer_store_dwordx4 a[236:239], v13, s[24:27], s81 offen offset:2048 sc1
    v_mfma_f32_16x16x32_bf16 v[164:167], a[192:195], v[44:47], v[164:167]
    v_exp_f32 v38, v38
    v_cvt_pk_bf16_f32 v52, v36, v37
    v_mfma_f32_16x16x32_bf16 a[48:51], a[192:195], v[56:59], a[48:51]
    v_exp_f32 v39, v39
    v_mfma_f32_16x16x32_bf16 a[52:55], a[192:195], v[60:63], a[52:55]
    ds_read_b128 a[192:195], v2 offset:0
    v_fma_f32 v0, v68, s35, v24
    v_mfma_f32_16x16x32_bf16 v[168:171], a[196:199], v[40:43], v[168:171]
    ds_write_b64 v35, v[228:229] offset:128
    v_mfma_f32_16x16x32_bf16 v[172:175], a[196:199], v[44:47], v[172:175]
    v_exp_f32 v0, v0
    v_mfma_f32_16x16x32_bf16 a[56:59], a[196:199], v[56:59], a[56:59]
    v_fma_f32 v36, v69, s35, v24
    v_cvt_pk_bf16_f32 v53, v38, v39
    v_mfma_f32_16x16x32_bf16 a[60:63], a[196:199], v[60:63], a[60:63]
    ds_read_b128 a[196:199], v3 offset:0
    v_fma_f32 v37, v70, s35, v24
    v_mfma_f32_16x16x32_bf16 v[176:179], a[200:203], v[40:43], v[176:179]
    ds_write_b64 v35, v[230:231] offset:6272
    v_mfma_f32_16x16x32_bf16 v[180:183], a[200:203], v[44:47], v[180:183]
    v_exp_f32 v36, v36
    v_mfma_f32_16x16x32_bf16 a[64:67], a[200:203], v[56:59], a[64:67]
    v_exp_f32 v37, v37
    v_mfma_f32_16x16x32_bf16 a[68:71], a[200:203], v[60:63], a[68:71]
    ds_read_b128 a[200:203], v2 offset:128
    s_waitcnt lgkmcnt(5)
    v_fma_f32 v38, v71, s35, v24
    v_mfma_f32_16x16x32_bf16 v[184:187], a[204:207], v[40:43], v[184:187]
    v_exp_f32 v38, v38
    v_mfma_f32_16x16x32_bf16 v[188:191], a[204:207], v[44:47], v[188:191]
    v_cvt_pk_bf16_f32 v50, v0, v36
    v_fma_f32 v39, v76, s35, v25
    v_mfma_f32_16x16x32_bf16 a[72:75], a[204:207], v[56:59], a[72:75]
    ds_write_b64 v35, v[244:245] offset:256
    v_mfma_f32_16x16x32_bf16 a[76:79], a[204:207], v[60:63], a[76:79]
    ds_read_b128 a[204:207], v3 offset:128
    v_fma_f32 v0, v77, s35, v25
    v_mfma_f32_16x16x32_bf16 v[192:195], a[208:211], v[40:43], v[192:195]
    v_exp_f32 v39, v39
    v_mfma_f32_16x16x32_bf16 v[196:199], a[208:211], v[44:47], v[196:199]
    v_exp_f32 v0, v0
    v_cvt_pk_bf16_f32 v51, v37, v38
    v_mfma_f32_16x16x32_bf16 a[80:83], a[208:211], v[56:59], a[80:83]
    ds_write_b64 v35, v[246:247] offset:6400
    v_mfma_f32_16x16x32_bf16 a[84:87], a[208:211], v[60:63], a[84:87]
    ds_read_b128 a[208:211], v2 offset:256
    v_fma_f32 v36, v78, s35, v25
    v_mfma_f32_16x16x32_bf16 v[200:203], a[212:215], v[40:43], v[200:203]
    v_exp_f32 v36, v36
    v_mfma_f32_16x16x32_bf16 v[204:207], a[212:215], v[44:47], v[204:207]
    v_fma_f32 v37, v79, s35, v25
    v_cvt_pk_bf16_f32 v54, v39, v0
    v_mfma_f32_16x16x32_bf16 a[88:91], a[212:215], v[56:59], a[88:91]
    v_exp_f32 v37, v37
    s_nop 0
    v_cvt_pk_bf16_f32 v55, v36, v37
    v_mfma_f32_16x16x32_bf16 a[92:95], a[212:215], v[60:63], a[92:95]
    ds_read_b128 a[212:215], v3 offset:256
    v_mfma_f32_16x16x32_bf16 v[28:31], a[248:251], v[48:51], 0
    s_waitcnt vmcnt(15)
    s_barrier
    v_mfma_f32_16x16x32_bf16 v[28:31], a[252:255], v[52:55], v[28:31]
    s_waitcnt lgkmcnt(5)
    v_mfma_f32_16x16x32_bf16 v[80:83], a[192:195], a[144:147], 0
    v_fma_f32 v36, v96, s35, v26
    v_fma_f32 v37, v97, s35, v26
    v_mfma_f32_16x16x32_bf16 v[80:83], a[196:199], a[148:151], v[80:83]
    v_exp_f32 v36, v36
    v_fma_f32 v38, v98, s35, v26
    v_mfma_f32_16x16x32_bf16 v[80:83], a[200:203], a[152:155], v[80:83]
    s_mov_b32 m0, s45
    v_cmp_nge_f32 vcc, s37, v30
    v_mfma_f32_16x16x32_bf16 v[88:91], a[192:195], a[168:171], 0
    v_exp_f32 v37, v37
    v_xor_b32 v35, 64, v32
    v_mfma_f32_16x16x32_bf16 v[88:91], a[196:199], a[172:175], v[88:91]
    buffer_load_dwordx4 v8, s[12:15], s58 offen nt lds
    v_mfma_f32_16x16x32_bf16 v[88:91], a[200:203], a[176:179], v[88:91]
    ds_write_b64 v35, v[216:217] offset:0
    s_cbranch_vccnz L_tr_T3_A
L_ret_T3_A:
    v_mfma_f32_16x16x32_bf16 v[64:67], a[192:195], a[96:99], 0
    ds_write_b64 v35, v[218:219] offset:6144
    v_mfma_f32_16x16x32_bf16 v[64:67], a[196:199], a[100:103], v[64:67]
    v_exp_f32 v38, v38
    v_mfma_f32_16x16x32_bf16 v[64:67], a[200:203], a[104:107], v[64:67]
    buffer_load_dwordx4 v9, s[12:15], s58 offen offset:1024 nt lds
    v_add_f32 v17, v17, v28
    v_add_f32 v19, v19, v29
    v_mfma_f32_16x16x32_bf16 v[72:75], a[192:195], a[120:123], 0
    ds_read_b128 a[192:195], v2 offset:6144
    v_fma_f32 v39, v99, s35, v26
    v_mfma_f32_16x16x32_bf16 v[72:75], a[196:199], a[124:127], v[72:75]
    v_exp_f32 v39, v39
    v_mfma_f32_16x16x32_bf16 v[72:75], a[200:203], a[128:131], v[72:75]
    ds_read_b128 a[196:199], v3 offset:6144
    s_waitcnt lgkmcnt(4)
    v_mfma_f32_16x16x32_bf16 v[64:67], a[204:207], a[108:111], v[64:67]
    buffer_load_dwordx4 v10, s[12:15], s58 offen offset:2048 nt lds
    v_mfma_f32_16x16x32_bf16 v[64:67], a[208:211], a[112:115], v[64:67]
    ds_read_b128 a[200:203], v2 offset:6272
    v_cvt_pk_bf16_f32 v56, v36, v37
    v_mfma_f32_16x16x32_bf16 v[64:67], a[212:215], a[116:119], v[64:67]
    ds_write_b64 v35, v[232:233] offset:128
    v_mfma_f32_16x16x32_bf16 v[72:75], a[204:207], a[132:135], v[72:75]
    v_fma_f32 v0, v100, s35, v26
    v_fma_f32 v36, v101, s35, v26
    v_mfma_f32_16x16x32_bf16 v[72:75], a[208:211], a[136:139], v[72:75]
    v_exp_f32 v0, v0
    v_mfma_f32_16x16x32_bf16 v[72:75], a[212:215], a[140:143], v[72:75]
    ds_write_b64 v35, v[234:235] offset:6272
    v_mfma_f32_16x16x32_bf16 v[80:83], a[204:207], a[156:159], v[80:83]
    v_exp_f32 v36, v36
    v_mfma_f32_16x16x32_bf16 v[80:83], a[208:211], a[160:163], v[80:83]
    v_cvt_pk_bf16_f32 v57, v38, v39
    v_fma_f32 v37, v102, s35, v26
    v_fma_f32 v38, v103, s35, v26
    v_mfma_f32_16x16x32_bf16 v[80:83], a[212:215], a[164:167], v[80:83]
    buffer_store_dwordx4 a[240:243], v11, s[24:27], s82 offen sc1
    v_mfma_f32_16x16x32_bf16 v[88:91], a[204:207], a[180:183], v[88:91]
    ds_read_b128 a[204:207], v3 offset:6272
    v_cvt_pk_bf16_f32 v58, v0, v36
    v_mfma_f32_16x16x32_bf16 v[88:91], a[208:211], a[184:187], v[88:91]
    ds_write_b64 v35, v[248:249] offset:256
    v_mfma_f32_16x16x32_bf16 v[88:91], a[212:215], a[188:191], v[88:91]
    ds_read_b128 a[208:211], v2 offset:6400
    s_waitcnt lgkmcnt(5)
    v_mfma_f32_16x16x32_bf16 v[68:71], a[192:195], a[96:99], 0
    v_exp_f32 v37, v37
    v_fma_f32 v39, v104, s35, v27
    v_mfma_f32_16x16x32_bf16 v[68:71], a[196:199], a[100:103], v[68:71]
    ds_read_b128 a[212:215], v3 offset:6400
    v_fma_f32 v0, v105, s35, v27
    v_mfma_f32_16x16x32_bf16 v[68:71], a[200:203], a[104:107], v[68:71]
    v_exp_f32 v38, v38
    v_fma_f32 v36, v106, s35, v27
    v_mfma_f32_16x16x32_bf16 v[76:79], a[192:195], a[120:123], 0
    ds_write_b64 v35, v[250:251] offset:6400
    v_mfma_f32_16x16x32_bf16 v[76:79], a[196:199], a[124:127], v[76:79]
    v_exp_f32 v39, v39
    v_mfma_f32_16x16x32_bf16 v[76:79], a[200:203], a[128:131], v[76:79]
    v_exp_f32 v0, v0
    v_mfma_f32_16x16x32_bf16 v[84:87], a[192:195], a[144:147], 0
    v_exp_f32 v36, v36
    v_cvt_pk_bf16_f32 v59, v37, v38
    v_mfma_f32_16x16x32_bf16 v[84:87], a[196:199], a[148:151], v[84:87]
    v_fma_f32 v37, v107, s35, v27
    v_cvt_pk_bf16_f32 v60, v39, v0
    v_mfma_f32_16x16x32_bf16 v[84:87], a[200:203], a[152:155], v[84:87]
    s_waitcnt lgkmcnt(1)
    v_fma_f32 v38, v108, s35, v27
    v_fma_f32 v39, v109, s35, v27
    v_mfma_f32_16x16x32_bf16 v[92:95], a[192:195], a[168:171], 0
    ds_read_b64_tr_b16 a[192:193], v4 offset:36864
    ds_read_b64_tr_b16 a[194:195], v4 offset:43008
    v_mfma_f32_16x16x32_bf16 v[92:95], a[196:199], a[172:175], v[92:95]
    v_exp_f32 v37, v37
    v_fma_f32 v0, v110, s35, v27
    v_mfma_f32_16x16x32_bf16 v[92:95], a[200:203], a[176:179], v[92:95]
    ds_read_b64_tr_b16 a[196:197], v5 offset:36864
    ds_read_b64_tr_b16 a[198:199], v5 offset:43008
    v_mfma_f32_16x16x32_bf16 v[68:71], a[204:207], a[108:111], v[68:71]
    v_exp_f32 v38, v38
    v_xor_b32 v35, 96, v32
    v_mfma_f32_16x16x32_bf16 v[68:71], a[208:211], a[112:115], v[68:71]
    ds_read_b64_tr_b16 a[200:201], v6 offset:36864
    ds_read_b64_tr_b16 a[202:203], v6 offset:43008
    v_mfma_f32_16x16x32_bf16 v[68:71], a[212:215], a[116:119], v[68:71]
    ds_write_b64 v35, v[220:221] offset:0
    v_mfma_f32_16x16x32_bf16 v[76:79], a[204:207], a[132:135], v[76:79]
    ds_write_b64 v35, v[222:223] offset:6144
    v_mfma_f32_16x16x32_bf16 v[76:79], a[208:211], a[136:139], v[76:79]
    v_exp_f32 v39, v39
    v_mfma_f32_16x16x32_bf16 v[76:79], a[212:215], a[140:143], v[76:79]
    v_exp_f32 v0, v0
    v_mfma_f32_16x16x32_bf16 v[84:87], a[204:207], a[156:159], v[84:87]
    ds_write_b64 v35, v[236:237] offset:128
    v_mfma_f32_16x16x32_bf16 v[84:87], a[208:211], a[160:163], v[84:87]
    v_cvt_pk_bf16_f32 v61, v36, v37
    v_fma_f32 v36, v111, s35, v27
    v_mfma_f32_16x16x32_bf16 v[84:87], a[212:215], a[164:167], v[84:87]
    buffer_store_dwordx4 a[244:247], v12, s[24:27], s82 offen offset:1024 sc1
    v_mfma_f32_16x16x32_bf16 v[92:95], a[204:207], a[180:183], v[92:95]
    ds_read_b64_tr_b16 a[204:205], v7 offset:36864
    ds_read_b64_tr_b16 a[206:207], v7 offset:43008
    v_cvt_pk_bf16_f32 v62, v38, v39
    v_mfma_f32_16x16x32_bf16 v[92:95], a[208:211], a[184:187], v[92:95]
    s_mov_b32 m0, s50
    v_exp_f32 v36, v36
    v_fma_f32 v37, v64, s35, v24
    v_cvt_pk_bf16_f32 v63, v0, v36
    v_mfma_f32_16x16x32_bf16 v[92:95], a[212:215], a[188:191], v[92:95]
    ds_read_b64_tr_b16 a[208:209], v4 offset:36992
    ds_read_b64_tr_b16 a[210:211], v4 offset:43136
    v_mfma_f32_16x16x32_bf16 v[28:31], a[248:251], v[56:59], 0
    buffer_load_dwordx4 v8, s[16:19], s57 offen nt lds
    v_mfma_f32_16x16x32_bf16 v[28:31], a[252:255], v[60:63], v[28:31]
    ds_read_b64_tr_b16 a[212:213], v5 offset:36992
    ds_read_b64_tr_b16 a[214:215], v5 offset:43136
    s_waitcnt lgkmcnt(9)
    v_mfma_f32_16x16x32_bf16 v[112:115], a[192:195], v[48:51], v[112:115]
    ds_write_b64 v35, v[238:239] offset:6272
    v_mfma_f32_16x16x32_bf16 v[116:119], a[192:195], v[52:55], v[116:119]
    v_exp_f32 v37, v37
    v_mfma_f32_16x16x32_bf16 v[120:123], a[196:199], v[48:51], v[120:123]
    v_fma_f32 v38, v65, s35, v24
    v_cmp_nge_f32 vcc, s37, v30
    v_mfma_f32_16x16x32_bf16 v[124:127], a[196:199], v[52:55], v[124:127]
L_hop_6:
    s_cbranch_execz L_hop_10
    v_exp_f32 v38, v38
    v_mfma_f32_16x16x32_bf16 v[128:131], a[200:203], v[48:51], v[128:131]
    v_fma_f32 v39, v66, s35, v24
    v_fma_f32 v0, v67, s35, v24
    v_mfma_f32_16x16x32_bf16 v[132:135], a[200:203], v[52:55], v[132:135]
    ds_write_b64 v35, v[252:253] offset:256
    s_cbranch_vccnz L_tr_T3_B
L_ret_T3_B:
    v_mfma_f32_16x16x32_bf16 a[0:3], a[192:195], v[56:59], a[0:3]
    v_exp_f32 v39, v39
    v_mfma_f32_16x16x32_bf16 a[4:7], a[192:195], v[60:63], a[4:7]
    ds_read_b64_tr_b16 a[192:193], v6 offset:36992
    ds_read_b64_tr_b16 a[194:195], v6 offset:43136
    v_mfma_f32_16x16x32_bf16 a[8:11], a[196:199], v[56:59], a[8:11]
    buffer_load_dwordx4 v9, s[16:19], s57 offen offset:1024 nt lds
    v_add_f32 v21, v21, v28
    v_add_f32 v23, v23, v29
    v_mfma_f32_16x16x32_bf16 a[12:15], a[196:199], v[60:63], a[12:15]
    ds_read_b64_tr_b16 a[196:197], v7 offset:36992
    ds_read_b64_tr_b16 a[198:199], v7 offset:43136
    v_mfma_f32_16x16x32_bf16 a[16:19], a[200:203], v[56:59], a[16:19]
    s_waitcnt lgkmcnt(6)
    v_cvt_pk_bf16_f32 v40, v37, v38
    v_mfma_f32_16x16x32_bf16 a[20:23], a[200:203], v[60:63], a[20:23]
    ds_read_b64_tr_b16 a[200:201], v4 offset:37120
    ds_read_b64_tr_b16 a[202:203], v4 offset:43264
    v_mfma_f32_16x16x32_bf16 v[136:139], a[204:207], v[48:51], v[136:139]
    v_exp_f32 v0, v0
    v_mfma_f32_16x16x32_bf16 v[140:143], a[204:207], v[52:55], v[140:143]
    v_fma_f32 v36, v72, s35, v25
    v_fma_f32 v37, v73, s35, v25
    v_mfma_f32_16x16x32_bf16 a[24:27], a[204:207], v[56:59], a[24:27]
    ds_write_b64 v35, v[254:255] offset:6400
    v_mfma_f32_16x16x32_bf16 a[28:31], a[204:207], v[60:63], a[28:31]
    ds_read_b64_tr_b16 a[204:205], v5 offset:37120
    ds_read_b64_tr_b16 a[206:207], v5 offset:43264
    v_mfma_f32_16x16x32_bf16 v[144:147], a[208:211], v[48:51], v[144:147]
    buffer_load_dwordx4 v10, s[16:19], s57 offen offset:2048 nt lds
    v_mfma_f32_16x16x32_bf16 v[148:151], a[208:211], v[52:55], v[148:151]
    v_exp_f32 v36, v36
    v_mfma_f32_16x16x32_bf16 a[32:35], a[208:211], v[56:59], a[32:35]
    v_exp_f32 v37, v37
    v_mfma_f32_16x16x32_bf16 a[36:39], a[208:211], v[60:63], a[36:39]
    ds_read_b64_tr_b16 a[208:209], v6 offset:37120
    ds_read_b64_tr_b16 a[210:211], v6 offset:43264
    v_mfma_f32_16x16x32_bf16 v[152:155], a[212:215], v[48:51], v[152:155]
    v_cvt_pk_bf16_f32 v41, v39, v0
    v_fma_f32 v38, v74, s35, v25
    v_mfma_f32_16x16x32_bf16 v[156:159], a[212:215], v[52:55], v[156:159]
    ds_read_b128 v[208:211], v1 offset:0
    v_fma_f32 v39, v75, s35, v25
    v_mfma_f32_16x16x32_bf16 a[40:43], a[212:215], v[56:59], a[40:43]
    s_waitcnt lgkmcnt(6)
    v_cvt_pk_bf16_f32 v44, v36, v37
    v_mfma_f32_16x16x32_bf16 a[44:47], a[212:215], v[60:63], a[44:47]
    ds_read_b64_tr_b16 a[212:213], v7 offset:37120
    ds_read_b64_tr_b16 a[214:215], v7 offset:43264
    v_mfma_f32_16x16x32_bf16 v[160:163], a[192:195], v[48:51], v[160:163]
    buffer_store_dwordx4 a[216:219], v13, s[24:27], s82 offen offset:2048 sc1
    v_mfma_f32_16x16x32_bf16 v[164:167], a[192:195], v[52:55], v[164:167]
    ds_read_b128 v[212:215], v1 offset:1024
    v_fma_f32 v0, v68, s35, v24
    v_mfma_f32_16x16x32_bf16 a[48:51], a[192:195], v[56:59], a[48:51]
    v_exp_f32 v38, v38
    v_mfma_f32_16x16x32_bf16 a[52:55], a[192:195], v[60:63], a[52:55]
    ds_read_b128 a[192:195], v2 offset:12288
    v_fma_f32 v36, v69, s35, v24
    v_mfma_f32_16x16x32_bf16 v[168:171], a[196:199], v[48:51], v[168:171]
    v_exp_f32 v39, v39
    v_mfma_f32_16x16x32_bf16 v[172:175], a[196:199], v[52:55], v[172:175]
    ds_read_b128 v[216:219], v1 offset:2048
    v_cvt_pk_bf16_f32 v45, v38, v39
    v_mfma_f32_16x16x32_bf16 a[56:59], a[196:199], v[56:59], a[56:59]
    v_exp_f32 v0, v0
    v_mfma_f32_16x16x32_bf16 a[60:63], a[196:199], v[60:63], a[60:63]
    ds_read_b128 a[196:199], v3 offset:12288
    v_fma_f32 v37, v70, s35, v24
    v_mfma_f32_16x16x32_bf16 v[176:179], a[200:203], v[48:51], v[176:179]
    v_exp_f32 v36, v36
    v_mfma_f32_16x16x32_bf16 v[180:183], a[200:203], v[52:55], v[180:183]
    ds_read_b128 v[220:223], v1 offset:3072
    v_fma_f32 v38, v71, s35, v24
    v_mfma_f32_16x16x32_bf16 a[64:67], a[200:203], v[56:59], a[64:67]
    v_exp_f32 v37, v37
    v_mfma_f32_16x16x32_bf16 a[68:71], a[200:203], v[60:63], a[68:71]
    ds_read_b128 a[200:203], v2 offset:12416
    s_waitcnt lgkmcnt(6)
    v_mfma_f32_16x16x32_bf16 v[184:187], a[204:207], v[48:51], v[184:187]
    v_exp_f32 v38, v38
    v_mfma_f32_16x16x32_bf16 v[188:191], a[204:207], v[52:55], v[188:191]
    ds_read_b128 a[232:235], v1 offset:4096
    v_cvt_pk_bf16_f32 v42, v0, v36
    v_mfma_f32_16x16x32_bf16 a[72:75], a[204:207], v[56:59], a[72:75]
    v_fma_f32 v39, v76, s35, v25
    v_fma_f32 v0, v77, s35, v25
    v_mfma_f32_16x16x32_bf16 a[76:79], a[204:207], v[60:63], a[76:79]
    ds_read_b128 a[204:207], v3 offset:12416
    v_cvt_pk_bf16_f32 v43, v37, v38
    v_mfma_f32_16x16x32_bf16 v[192:195], a[208:211], v[48:51], v[192:195]
    v_exp_f32 v39, v39
    v_mfma_f32_16x16x32_bf16 v[196:199], a[208:211], v[52:55], v[196:199]
    ds_read_b128 a[236:239], v1 offset:5120
    v_fma_f32 v36, v78, s35, v25
    v_mfma_f32_16x16x32_bf16 a[80:83], a[208:211], v[56:59], a[80:83]
    v_exp_f32 v0, v0
    v_mfma_f32_16x16x32_bf16 a[84:87], a[208:211], v[60:63], a[84:87]
    ds_read_b128 a[208:211], v2 offset:12544
    v_fma_f32 v37, v79, s35, v25
    v_mfma_f32_16x16x32_bf16 v[200:203], a[212:215], v[48:51], v[200:203]
    v_exp_f32 v36, v36
    v_cvt_pk_bf16_f32 v46, v39, v0
    v_mfma_f32_16x16x32_bf16 v[204:207], a[212:215], v[52:55], v[204:207]
    ds_read_b128 a[240:243], v1 offset:6144
    v_exp_f32 v37, v37
    v_mfma_f32_16x16x32_bf16 a[88:91], a[212:215], v[56:59], a[88:91]
    v_cvt_pk_bf16_f32 v47, v36, v37
    v_mfma_f32_16x16x32_bf16 a[92:95], a[212:215], v[60:63], a[92:95]
    ds_read_b128 a[212:215], v3 offset:12544
    v_mfma_f32_16x16x32_bf16 v[28:31], a[248:251], v[40:43], 0
    s_waitcnt vmcnt(15)
    s_barrier
    v_mfma_f32_16x16x32_bf16 v[28:31], a[252:255], v[44:47], v[28:31]
    s_waitcnt lgkmcnt(6)
    v_mfma_f32_16x16x32_bf16 v[96:99], a[192:195], a[144:147], 0
    v_fma_f32 v36, v80, s35, v26
    v_fma_f32 v37, v81, s35, v26
    v_mfma_f32_16x16x32_bf16 v[96:99], a[196:199], a[148:151], v[96:99]
    ds_read_b128 a[244:247], v1 offset:7168
    v_fma_f32 v38, v82, s35, v26
    v_mfma_f32_16x16x32_bf16 v[96:99], a[200:203], a[152:155], v[96:99]
    s_mov_b32 m0, s42
    v_cmp_nge_f32 vcc, s37, v30
    v_mfma_f32_16x16x32_bf16 v[104:107], a[192:195], a[168:171], 0
    v_exp_f32 v36, v36
    v_mfma_f32_16x16x32_bf16 v[104:107], a[196:199], a[172:175], v[104:107]
    buffer_load_dwordx4 v8, s[12:15], s59 offen nt lds
    v_mfma_f32_16x16x32_bf16 v[104:107], a[200:203], a[176:179], v[104:107]
    v_fma_f32 v39, v83, s35, v26
    s_cbranch_vccnz L_tr_T4_A
L_ret_T4_A:
    v_mfma_f32_16x16x32_bf16 v[64:67], a[192:195], a[96:99], 0
    v_exp_f32 v37, v37
    v_mfma_f32_16x16x32_bf16 v[64:67], a[196:199], a[100:103], v[64:67]
    v_exp_f32 v38, v38
    v_mfma_f32_16x16x32_bf16 v[64:67], a[200:203], a[104:107], v[64:67]
    buffer_load_dwordx4 v9, s[12:15], s59 offen offset:1024 nt lds
    v_add_f32 v17, v17, v28
    v_add_f32 v19, v19, v29
    v_mfma_f32_16x16x32_bf16 v[72:75], a[192:195], a[120:123], 0
    ds_read_b128 a[192:195], v2 offset:18432
    ds_read_b128 a[216:219], v1 offset:8192
    v_mfma_f32_16x16x32_bf16 v[72:75], a[196:199], a[124:127], v[72:75]
    v_exp_f32 v39, v39
    v_mfma_f32_16x16x32_bf16 v[72:75], a[200:203], a[128:131], v[72:75]
    ds_read_b128 a[196:199], v3 offset:18432
    s_waitcnt lgkmcnt(4)
    v_mfma_f32_16x16x32_bf16 v[64:67], a[204:207], a[108:111], v[64:67]
    buffer_load_dwordx4 v10, s[12:15], s59 offen offset:2048 nt lds
    v_mfma_f32_16x16x32_bf16 v[64:67], a[208:211], a[112:115], v[64:67]
    ds_read_b128 a[200:203], v2 offset:18560
    v_cvt_pk_bf16_f32 v56, v36, v37
    v_mfma_f32_16x16x32_bf16 v[64:67], a[212:215], a[116:119], v[64:67]
    v_fma_f32 v0, v84, s35, v26
    v_fma_f32 v36, v85, s35, v26
    v_mfma_f32_16x16x32_bf16 v[72:75], a[204:207], a[132:135], v[72:75]
    v_exp_f32 v0, v0
    v_mfma_f32_16x16x32_bf16 v[72:75], a[208:211], a[136:139], v[72:75]
    buffer_store_dwordx4 a[220:223], v11, s[24:27], s83 offen sc1
    v_mfma_f32_16x16x32_bf16 v[72:75], a[212:215], a[140:143], v[72:75]
    v_exp_f32 v36, v36
    v_mfma_f32_16x16x32_bf16 v[96:99], a[204:207], a[156:159], v[96:99]
    ds_read_b128 a[220:223], v1 offset:9216
    v_cvt_pk_bf16_f32 v57, v38, v39
    v_mfma_f32_16x16x32_bf16 v[96:99], a[208:211], a[160:163], v[96:99]
    v_fma_f32 v37, v86, s35, v26
    v_fma_f32 v38, v87, s35, v26
    v_mfma_f32_16x16x32_bf16 v[96:99], a[212:215], a[164:167], v[96:99]
    v_exp_f32 v37, v37
    v_mfma_f32_16x16x32_bf16 v[104:107], a[204:207], a[180:183], v[104:107]
    ds_read_b128 a[204:207], v3 offset:18560
    v_cvt_pk_bf16_f32 v58, v0, v36
    v_mfma_f32_16x16x32_bf16 v[104:107], a[208:211], a[184:187], v[104:107]
    v_exp_f32 v38, v38
    v_mfma_f32_16x16x32_bf16 v[104:107], a[212:215], a[188:191], v[104:107]
    ds_read_b128 a[208:211], v2 offset:18688
    s_waitcnt lgkmcnt(3)
    v_mfma_f32_16x16x32_bf16 v[68:71], a[192:195], a[96:99], 0
    buffer_store_dwordx4 a[224:227], v12, s[24:27], s83 offen offset:1024 sc1
    v_mfma_f32_16x16x32_bf16 v[68:71], a[196:199], a[100:103], v[68:71]
    ds_read_b128 a[212:215], v3 offset:18688
    v_fma_f32 v39, v88, s35, v27
    v_mfma_f32_16x16x32_bf16 v[68:71], a[200:203], a[104:107], v[68:71]
    ds_read_b128 a[224:227], v1 offset:10240
    v_fma_f32 v0, v89, s35, v27
    v_mfma_f32_16x16x32_bf16 v[76:79], a[192:195], a[120:123], 0
    v_exp_f32 v39, v39
    v_mfma_f32_16x16x32_bf16 v[76:79], a[196:199], a[124:127], v[76:79]
    v_exp_f32 v0, v0
    v_mfma_f32_16x16x32_bf16 v[76:79], a[200:203], a[128:131], v[76:79]
    v_cvt_pk_bf16_f32 v59, v37, v38
    v_fma_f32 v36, v90, s35, v27
    v_mfma_f32_16x16x32_bf16 v[100:103], a[192:195], a[144:147], 0
    v_exp_f32 v36, v36
    v_mfma_f32_16x16x32_bf16 v[100:103], a[196:199], a[148:151], v[100:103]
    v_fma_f32 v37, v91, s35, v27
    v_cvt_pk_bf16_f32 v60, v39, v0
    v_mfma_f32_16x16x32_bf16 v[100:103], a[200:203], a[152:155], v[100:103]
    s_waitcnt lgkmcnt(1)
    buffer_store_dwordx4 a[228:231], v13, s[24:27], s83 offen offset:2048 sc1
    v_mfma_f32_16x16x32_bf16 v[108:111], a[192:195], a[168:171], 0
    ds_read_b64_tr_b16 a[192:193], v4 offset:0
    ds_read_b64_tr_b16 a[194:195], v4 offset:6144
    v_mfma_f32_16x16x32_bf16 v[108:111], a[196:199], a[172:175], v[108:111]
    ds_read_b128 a[228:231], v1 offset:11264
    v_fma_f32 v38, v92, s35, v27
    v_mfma_f32_16x16x32_bf16 v[108:111], a[200:203], a[176:179], v[108:111]
    ds_read_b64_tr_b16 a[196:197], v5 offset:0
    ds_read_b64_tr_b16 a[198:199], v5 offset:6144
    v_mfma_f32_16x16x32_bf16 v[68:71], a[204:207], a[108:111], v[68:71]
    v_exp_f32 v37, v37
    v_mfma_f32_16x16x32_bf16 v[68:71], a[208:211], a[112:115], v[68:71]
    ds_read_b64_tr_b16 a[200:201], v6 offset:0
    ds_read_b64_tr_b16 a[202:203], v6 offset:6144
    v_mfma_f32_16x16x32_bf16 v[68:71], a[212:215], a[116:119], v[68:71]
    v_exp_f32 v38, v38
    v_mfma_f32_16x16x32_bf16 v[76:79], a[204:207], a[132:135], v[76:79]
    v_fma_f32 v39, v93, s35, v27
    v_cvt_pk_bf16_f32 v61, v36, v37
    v_mfma_f32_16x16x32_bf16 v[76:79], a[208:211], a[136:139], v[76:79]
    v_exp_f32 v39, v39
    v_mfma_f32_16x16x32_bf16 v[76:79], a[212:215], a[140:143], v[76:79]
    v_fma_f32 v0, v94, s35, v27
    v_fma_f32 v36, v95, s35, v27
    v_mfma_f32_16x16x32_bf16 v[100:103], a[204:207], a[156:159], v[100:103]
    v_exp_f32 v0, v0
    v_mfma_f32_16x16x32_bf16 v[100:103], a[208:211], a[160:163], v[100:103]
    v_exp_f32 v36, v36
    v_mfma_f32_16x16x32_bf16 v[100:103], a[212:215], a[164:167], v[100:103]
    v_cvt_pk_bf16_f32 v62, v38, v39
    v_cvt_pk_bf16_f32 v63, v0, v36
    v_mfma_f32_16x16x32_bf16 v[108:111], a[204:207], a[180:183], v[108:111]
    ds_read_b64_tr_b16 a[204:205], v7 offset:0
    ds_read_b64_tr_b16 a[206:207], v7 offset:6144
    v_mfma_f32_16x16x32_bf16 v[108:111], a[208:211], a[184:187], v[108:111]
    s_mov_b32 m0, s51
    v_fma_f32 v37, v64, s35, v24
    v_fma_f32 v38, v65, s35, v24
    v_mfma_f32_16x16x32_bf16 v[108:111], a[212:215], a[188:191], v[108:111]
    ds_read_b64_tr_b16 a[208:209], v4 offset:128
    ds_read_b64_tr_b16 a[210:211], v4 offset:6272
    v_mfma_f32_16x16x32_bf16 v[28:31], a[248:251], v[56:59], 0
    buffer_load_dwordx4 v8, s[16:19], s58 offen nt lds
    v_mfma_f32_16x16x32_bf16 v[28:31], a[252:255], v[60:63], v[28:31]
    ds_read_b64_tr_b16 a[212:213], v5 offset:128
    ds_read_b64_tr_b16 a[214:215], v5 offset:6272
    s_waitcnt lgkmcnt(6)
    v_mfma_f32_16x16x32_bf16 v[112:115], a[192:195], v[40:43], v[112:115]
    v_exp_f32 v37, v37
    v_mfma_f32_16x16x32_bf16 v[116:119], a[192:195], v[44:47], v[116:119]
    v_exp_f32 v38, v38
    v_mfma_f32_16x16x32_bf16 v[120:123], a[196:199], v[40:43], v[120:123]
    v_fma_f32 v39, v66, s35, v24
    v_cmp_nge_f32 vcc, s37, v30
    v_mfma_f32_16x16x32_bf16 v[124:127], a[196:199], v[44:47], v[124:127]
    v_exp_f32 v39, v39
    v_mfma_f32_16x16x32_bf16 v[128:131], a[200:203], v[40:43], v[128:131]
    v_fma_f32 v0, v67, s35, v24
    v_cvt_pk_bf16_f32 v48, v37, v38
    v_mfma_f32_16x16x32_bf16 v[132:135], a[200:203], v[44:47], v[132:135]
    s_cbranch_vccnz L_tr_T4_B
L_ret_T4_B:
    v_mfma_f32_16x16x32_bf16 a[0:3], a[192:195], v[56:59], a[0:3]
    v_add_f32 v21, v21, v28
    v_add_f32 v23, v23, v29
    v_mfma_f32_16x16x32_bf16 a[4:7], a[192:195], v[60:63], a[4:7]
    ds_read_b64_tr_b16 a[192:193], v6 offset:128
    ds_read_b64_tr_b16 a[194:195], v6 offset:6272
    v_mfma_f32_16x16x32_bf16 a[8:11], a[196:199], v[56:59], a[8:11]
    buffer_load_dwordx4 v9, s[16:19], s58 offen offset:1024 nt lds
    v_mfma_f32_16x16x32_bf16 a[12:15], a[196:199], v[60:63], a[12:15]
    ds_read_b64_tr_b16 a[196:197], v7 offset:128
    ds_read_b64_tr_b16 a[198:199], v7 offset:6272
    v_mfma_f32_16x16x32_bf16 a[16:19], a[200:203], v[56:59], a[16:19]
    s_waitcnt lgkmcnt(4)
    v_fma_f32 v36, v72, s35, v25
    v_mfma_f32_16x16x32_bf16 a[20:23], a[200:203], v[60:63], a[20:23]
    ds_read_b64_tr_b16 a[200:201], v4 offset:256
    ds_read_b64_tr_b16 a[202:203], v4 offset:6400
    v_mfma_f32_16x16x32_bf16 v[136:139], a[204:207], v[40:43], v[136:139]
    v_exp_f32 v0, v0
    v_mfma_f32_16x16x32_bf16 v[140:143], a[204:207], v[44:47], v[140:143]
    v_exp_f32 v36, v36
    v_mfma_f32_16x16x32_bf16 a[24:27], a[204:207], v[56:59], a[24:27]
    v_fma_f32 v37, v73, s35, v25
    v_cvt_pk_bf16_f32 v49, v39, v0
    v_mfma_f32_16x16x32_bf16 a[28:31], a[204:207], v[60:63], a[28:31]
    ds_read_b64_tr_b16 a[204:205], v5 offset:256
    ds_read_b64_tr_b16 a[206:207], v5 offset:6400
    v_mfma_f32_16x16x32_bf16 v[144:147], a[208:211], v[40:43], v[144:147]
    buffer_load_dwordx4 v10, s[16:19], s58 offen offset:2048 nt lds
    v_mfma_f32_16x16x32_bf16 v[148:151], a[208:211], v[44:47], v[148:151]
    v_exp_f32 v37, v37
    v_mfma_f32_16x16x32_bf16 a[32:35], a[208:211], v[56:59], a[32:35]
    v_fma_f32 v38, v74, s35, v25
    v_fma_f32 v39, v75, s35, v25
    v_mfma_f32_16x16x32_bf16 a[36:39], a[208:211], v[60:63], a[36:39]
    ds_read_b64_tr_b16 a[208:209], v6 offset:256
    ds_read_b64_tr_b16 a[210:211], v6 offset:6400
    v_mfma_f32_16x16x32_bf16 v[152:155], a[212:215], v[40:43], v[152:155]
    v_exp_f32 v38, v38
    v_mfma_f32_16x16x32_bf16 v[156:159], a[212:215], v[44:47], v[156:159]
    s_mov_b32 m0, s88
    v_cvt_pk_bf16_f32 v52, v36, v37
    v_mfma_f32_16x16x32_bf16 a[40:43], a[212:215], v[56:59], a[40:43]
    s_waitcnt lgkmcnt(4)
    v_fma_f32 v0, v68, s35, v24
    v_mfma_f32_16x16x32_bf16 a[44:47], a[212:215], v[60:63], a[44:47]
    ds_read_b64_tr_b16 a[212:213], v7 offset:256
    ds_read_b64_tr_b16 a[214:215], v7 offset:6400
    v_mfma_f32_16x16x32_bf16 v[160:163], a[192:195], v[40:43], v[160:163]
    buffer_load_dwordx4 v8, s[20:23], s80 offen nt lds
    v_mfma_f32_16x16x32_bf16 v[164:167], a[192:195], v[44:47], v[164:167]
    v_exp_f32 v39, v39
    v_mfma_f32_16x16x32_bf16 a[48:51], a[192:195], v[56:59], a[48:51]
    v_exp_f32 v0, v0
    v_mfma_f32_16x16x32_bf16 a[52:55], a[192:195], v[60:63], a[52:55]
    ds_read_b128 a[192:195], v2 offset:24576
    v_fma_f32 v36, v69, s35, v24
    v_mfma_f32_16x16x32_bf16 v[168:171], a[196:199], v[40:43], v[168:171]
    v_exp_f32 v36, v36
    v_mfma_f32_16x16x32_bf16 v[172:175], a[196:199], v[44:47], v[172:175]
    v_cvt_pk_bf16_f32 v53, v38, v39
    v_fma_f32 v37, v70, s35, v24
    v_mfma_f32_16x16x32_bf16 a[56:59], a[196:199], v[56:59], a[56:59]
    v_exp_f32 v37, v37
    v_mfma_f32_16x16x32_bf16 a[60:63], a[196:199], v[60:63], a[60:63]
    ds_read_b128 a[196:199], v3 offset:24576
    v_fma_f32 v38, v71, s35, v24
    v_mfma_f32_16x16x32_bf16 v[176:179], a[200:203], v[40:43], v[176:179]
    buffer_load_dwordx4 v9, s[20:23], s80 offen offset:1024 nt lds
    v_mfma_f32_16x16x32_bf16 v[180:183], a[200:203], v[44:47], v[180:183]
    v_exp_f32 v38, v38
    v_mfma_f32_16x16x32_bf16 a[64:67], a[200:203], v[56:59], a[64:67]
    v_cvt_pk_bf16_f32 v50, v0, v36
    v_fma_f32 v39, v76, s35, v25
    v_mfma_f32_16x16x32_bf16 a[68:71], a[200:203], v[60:63], a[68:71]
    ds_read_b128 a[200:203], v2 offset:24704
    s_waitcnt lgkmcnt(3)
    v_mfma_f32_16x16x32_bf16 v[184:187], a[204:207], v[40:43], v[184:187]
    v_exp_f32 v39, v39
    v_mfma_f32_16x16x32_bf16 v[188:191], a[204:207], v[44:47], v[188:191]
    v_fma_f32 v0, v77, s35, v25
    v_cvt_pk_bf16_f32 v51, v37, v38
    v_mfma_f32_16x16x32_bf16 a[72:75], a[204:207], v[56:59], a[72:75]
    v_exp_f32 v0, v0
    v_mfma_f32_16x16x32_bf16 a[76:79], a[204:207], v[60:63], a[76:79]
    ds_read_b128 a[204:207], v3 offset:24704
    v_fma_f32 v36, v78, s35, v25
    v_mfma_f32_16x16x32_bf16 v[192:195], a[208:211], v[40:43], v[192:195]
    buffer_load_dwordx4 v10, s[20:23], s80 offen offset:2048 nt lds
    v_mfma_f32_16x16x32_bf16 v[196:199], a[208:211], v[44:47], v[196:199]
    v_exp_f32 v36, v36
    v_mfma_f32_16x16x32_bf16 a[80:83], a[208:211], v[56:59], a[80:83]
    v_fma_f32 v37, v79, s35, v25
    v_mfma_f32_16x16x32_bf16 a[84:87], a[208:211], v[60:63], a[84:87]
    ds_read_b128 a[208:211], v2 offset:24832
    v_cvt_pk_bf16_f32 v54, v39, v0
    v_mfma_f32_16x16x32_bf16 v[200:203], a[212:215], v[40:43], v[200:203]
    v_exp_f32 v37, v37
    v_mfma_f32_16x16x32_bf16 v[204:207], a[212:215], v[44:47], v[204:207]
    v_cvt_pk_bf16_f32 v55, v36, v37
    v_mfma_f32_16x16x32_bf16 a[88:91], a[212:215], v[56:59], a[88:91]
    v_mfma_f32_16x16x32_bf16 a[92:95], a[212:215], v[60:63], a[92:95]
    ds_read_b128 a[212:215], v3 offset:24832
    v_mfma_f32_16x16x32_bf16 v[28:31], a[248:251], v[48:51], 0
    s_waitcnt vmcnt(18)
    s_barrier
    v_mfma_f32_16x16x32_bf16 v[28:31], a[252:255], v[52:55], v[28:31]
    s_waitcnt lgkmcnt(3)
    v_mfma_f32_16x16x32_bf16 v[80:83], a[192:195], a[144:147], 0
    v_fma_f32 v36, v96, s35, v26
    v_fma_f32 v37, v97, s35, v26
    v_mfma_f32_16x16x32_bf16 v[80:83], a[196:199], a[148:151], v[80:83]
    v_exp_f32 v36, v36
    v_mfma_f32_16x16x32_bf16 v[80:83], a[200:203], a[152:155], v[80:83]
    s_mov_b32 m0, s43
    v_cmp_nge_f32 vcc, s37, v30
    v_mfma_f32_16x16x32_bf16 v[88:91], a[192:195], a[168:171], 0
    v_exp_f32 v37, v37
    v_mfma_f32_16x16x32_bf16 v[88:91], a[196:199], a[172:175], v[88:91]
    buffer_load_dwordx4 v8, s[12:15], s60 offen nt lds
    v_mfma_f32_16x16x32_bf16 v[88:91], a[200:203], a[176:179], v[88:91]
    v_fma_f32 v38, v98, s35, v26
    s_cbranch_vccnz L_tr_T5_A
L_ret_T5_A:
    v_mfma_f32_16x16x32_bf16 v[64:67], a[192:195], a[96:99], 0
    v_exp_f32 v38, v38
    v_mfma_f32_16x16x32_bf16 v[64:67], a[196:199], a[100:103], v[64:67]
    v_add_f32 v17, v17, v28
    v_add_f32 v19, v19, v29
    v_mfma_f32_16x16x32_bf16 v[64:67], a[200:203], a[104:107], v[64:67]
    buffer_load_dwordx4 v9, s[12:15], s60 offen offset:1024 nt lds
    v_mfma_f32_16x16x32_bf16 v[72:75], a[192:195], a[120:123], 0
    ds_read_b128 a[192:195], v2 offset:30720
    v_fma_f32 v39, v99, s35, v26
    v_mfma_f32_16x16x32_bf16 v[72:75], a[196:199], a[124:127], v[72:75]
    v_exp_f32 v39, v39
    v_mfma_f32_16x16x32_bf16 v[72:75], a[200:203], a[128:131], v[72:75]
    ds_read_b128 a[196:199], v3 offset:30720
    s_waitcnt lgkmcnt(2)
    v_cvt_pk_bf16_f32 v56, v36, v37
    v_mfma_f32_16x16x32_bf16 v[64:67], a[204:207], a[108:111], v[64:67]
    buffer_load_dwordx4 v10, s[12:15], s60 offen offset:2048 nt lds
    v_mfma_f32_16x16x32_bf16 v[64:67], a[208:211], a[112:115], v[64:67]
    ds_read_b128 a[200:203], v2 offset:30848
    v_fma_f32 v0, v100, s35, v26
    v_mfma_f32_16x16x32_bf16 v[64:67], a[212:215], a[116:119], v[64:67]
    v_exp_f32 v0, v0
    v_mfma_f32_16x16x32_bf16 v[72:75], a[204:207], a[132:135], v[72:75]
    v_fma_f32 v36, v101, s35, v26
    v_cvt_pk_bf16_f32 v57, v38, v39
    v_mfma_f32_16x16x32_bf16 v[72:75], a[208:211], a[136:139], v[72:75]
    v_exp_f32 v36, v36
    v_mfma_f32_16x16x32_bf16 v[72:75], a[212:215], a[140:143], v[72:75]
    v_fma_f32 v37, v102, s35, v26
    v_fma_f32 v38, v103, s35, v26
    v_mfma_f32_16x16x32_bf16 v[80:83], a[204:207], a[156:159], v[80:83]
    v_exp_f32 v37, v37
    v_mfma_f32_16x16x32_bf16 v[80:83], a[208:211], a[160:163], v[80:83]
    v_exp_f32 v38, v38
    v_mfma_f32_16x16x32_bf16 v[80:83], a[212:215], a[164:167], v[80:83]
    buffer_store_dwordx4 a[232:235], v12, s[96:99], s85 offen offset:1024 sc1
    v_mfma_f32_16x16x32_bf16 v[88:91], a[204:207], a[180:183], v[88:91]
    ds_read_b128 a[204:207], v3 offset:30848
    v_cvt_pk_bf16_f32 v58, v0, v36
    v_mfma_f32_16x16x32_bf16 v[88:91], a[208:211], a[184:187], v[88:91]
    v_fma_f32 v39, v104, s35, v27
    v_fma_f32 v0, v105, s35, v27
    v_mfma_f32_16x16x32_bf16 v[88:91], a[212:215], a[188:191], v[88:91]
    ds_read_b128 a[208:211], v2 offset:30976
    s_waitcnt lgkmcnt(2)
    v_mfma_f32_16x16x32_bf16 v[68:71], a[192:195], a[96:99], 0
    v_exp_f32 v39, v39
    v_mfma_f32_16x16x32_bf16 v[68:71], a[196:199], a[100:103], v[68:71]
    ds_read_b128 a[212:215], v3 offset:30976
    v_cvt_pk_bf16_f32 v59, v37, v38
    v_mfma_f32_16x16x32_bf16 v[68:71], a[200:203], a[104:107], v[68:71]
    v_exp_f32 v0, v0
    v_mfma_f32_16x16x32_bf16 v[76:79], a[192:195], a[120:123], 0
    v_fma_f32 v36, v106, s35, v27
    v_fma_f32 v37, v107, s35, v27
    v_mfma_f32_16x16x32_bf16 v[76:79], a[196:199], a[124:127], v[76:79]
    v_exp_f32 v36, v36
    v_cvt_pk_bf16_f32 v60, v39, v0
    v_mfma_f32_16x16x32_bf16 v[76:79], a[200:203], a[128:131], v[76:79]
    v_exp_f32 v37, v37
    v_mfma_f32_16x16x32_bf16 v[84:87], a[192:195], a[144:147], 0
    v_fma_f32 v38, v108, s35, v27
    v_fma_f32 v39, v109, s35, v27
    v_mfma_f32_16x16x32_bf16 v[84:87], a[196:199], a[148:151], v[84:87]
    v_exp_f32 v38, v38
    v_mfma_f32_16x16x32_bf16 v[84:87], a[200:203], a[152:155], v[84:87]
    s_waitcnt lgkmcnt(0)
    buffer_store_dwordx4 a[236:239], v13, s[96:99], s85 offen offset:2048 sc1
    v_mfma_f32_16x16x32_bf16 v[92:95], a[192:195], a[168:171], 0
    ds_read_b64_tr_b16 a[192:193], v4 offset:12288
    ds_read_b64_tr_b16 a[194:195], v4 offset:18432
    v_mfma_f32_16x16x32_bf16 v[92:95], a[196:199], a[172:175], v[92:95]
    v_exp_f32 v39, v39
    v_mfma_f32_16x16x32_bf16 v[92:95], a[200:203], a[176:179], v[92:95]
    ds_read_b64_tr_b16 a[196:197], v5 offset:12288
    ds_read_b64_tr_b16 a[198:199], v5 offset:18432
    v_mfma_f32_16x16x32_bf16 v[68:71], a[204:207], a[108:111], v[68:71]
    v_cvt_pk_bf16_f32 v61, v36, v37
    v_fma_f32 v0, v110, s35, v27
    v_mfma_f32_16x16x32_bf16 v[68:71], a[208:211], a[112:115], v[68:71]
    ds_read_b64_tr_b16 a[200:201], v6 offset:12288
    ds_read_b64_tr_b16 a[202:203], v6 offset:18432
    v_mfma_f32_16x16x32_bf16 v[68:71], a[212:215], a[116:119], v[68:71]
    v_exp_f32 v0, v0
    v_mfma_f32_16x16x32_bf16 v[76:79], a[204:207], a[132:135], v[76:79]
    v_fma_f32 v36, v111, s35, v27
    v_cvt_pk_bf16_f32 v62, v38, v39
    v_mfma_f32_16x16x32_bf16 v[76:79], a[208:211], a[136:139], v[76:79]
    v_exp_f32 v36, v36
    v_mfma_f32_16x16x32_bf16 v[76:79], a[212:215], a[140:143], v[76:79]
    v_cvt_pk_bf16_f32 v63, v0, v36
    v_fma_f32 v37, v64, s35, v24
    v_mfma_f32_16x16x32_bf16 v[84:87], a[204:207], a[156:159], v[84:87]
    v_exp_f32 v37, v37
    v_mfma_f32_16x16x32_bf16 v[84:87], a[208:211], a[160:163], v[84:87]
    v_fma_f32 v38, v65, s35, v24
    v_fma_f32 v39, v66, s35, v24
    v_mfma_f32_16x16x32_bf16 v[84:87], a[212:215], a[164:167], v[84:87]
    buffer_store_dwordx4 a[240:243], v11, s[96:99], s86 offen sc1
    v_mfma_f32_16x16x32_bf16 v[92:95], a[204:207], a[180:183], v[92:95]
    ds_read_b64_tr_b16 a[204:205], v7 offset:12288
    ds_read_b64_tr_b16 a[206:207], v7 offset:18432
    v_mfma_f32_16x16x32_bf16 v[92:95], a[208:211], a[184:187], v[92:95]
    s_mov_b32 m0, s48
    v_fma_f32 v0, v67, s35, v24
    v_mfma_f32_16x16x32_bf16 v[92:95], a[212:215], a[188:191], v[92:95]
    ds_read_b64_tr_b16 a[208:209], v4 offset:12416
    ds_read_b64_tr_b16 a[210:211], v4 offset:18560
    v_mfma_f32_16x16x32_bf16 v[28:31], a[248:251], v[56:59], 0
    buffer_load_dwordx4 v8, s[16:19], s59 offen nt lds
    v_mfma_f32_16x16x32_bf16 v[28:31], a[252:255], v[60:63], v[28:31]
    ds_read_b64_tr_b16 a[212:213], v5 offset:12416
    ds_read_b64_tr_b16 a[214:215], v5 offset:18560
    s_waitcnt lgkmcnt(6)
    v_mfma_f32_16x16x32_bf16 v[112:115], a[192:195], v[48:51], v[112:115]
    v_mfma_f32_16x16x32_bf16 v[116:119], a[192:195], v[52:55], v[116:119]
    v_exp_f32 v38, v38
    v_mfma_f32_16x16x32_bf16 v[120:123], a[196:199], v[48:51], v[120:123]
    v_cvt_pk_bf16_f32 v40, v37, v38
    v_cmp_nge_f32 vcc, s37, v30
    v_mfma_f32_16x16x32_bf16 v[124:127], a[196:199], v[52:55], v[124:127]
    v_exp_f32 v39, v39
    v_mfma_f32_16x16x32_bf16 v[128:131], a[200:203], v[48:51], v[128:131]
    v_exp_f32 v0, v0
    v_mfma_f32_16x16x32_bf16 v[132:135], a[200:203], v[52:55], v[132:135]
    s_cbranch_vccnz L_tr_T5_B
L_ret_T5_B:
    v_mfma_f32_16x16x32_bf16 a[0:3], a[192:195], v[56:59], a[0:3]
    v_add_f32 v21, v21, v28
    v_add_f32 v23, v23, v29
    v_mfma_f32_16x16x32_bf16 a[4:7], a[192:195], v[60:63], a[4:7]
    ds_read_b64_tr_b16 a[192:193], v6 offset:12416
    ds_read_b64_tr_b16 a[194:195], v6 offset:18560
    v_mfma_f32_16x16x32_bf16 a[8:11], a[196:199], v[56:59], a[8:11]
    buffer_load_dwordx4 v9, s[16:19], s59 offen offset:1024 nt lds
    v_mfma_f32_16x16x32_bf16 a[12:15], a[196:199], v[60:63], a[12:15]
    ds_read_b64_tr_b16 a[196:197], v7 offset:12416
    ds_read_b64_tr_b16 a[198:199], v7 offset:18560
    v_mfma_f32_16x16x32_bf16 a[16:19], a[200:203], v[56:59], a[16:19]
    s_waitcnt lgkmcnt(4)
    v_fma_f32 v36, v72, s35, v25
    v_mfma_f32_16x16x32_bf16 a[20:23], a[200:203], v[60:63], a[20:23]
    ds_read_b64_tr_b16 a[200:201], v4 offset:12544
    ds_read_b64_tr_b16 a[202:203], v4 offset:18688
    v_mfma_f32_16x16x32_bf16 v[136:139], a[204:207], v[48:51], v[136:139]
    v_exp_f32 v36, v36
    v_mfma_f32_16x16x32_bf16 v[140:143], a[204:207], v[52:55], v[140:143]
    v_fma_f32 v37, v73, s35, v25
    v_cvt_pk_bf16_f32 v41, v39, v0
    v_mfma_f32_16x16x32_bf16 a[24:27], a[204:207], v[56:59], a[24:27]
    v_exp_f32 v37, v37
    v_mfma_f32_16x16x32_bf16 a[28:31], a[204:207], v[60:63], a[28:31]
    ds_read_b64_tr_b16 a[204:205], v5 offset:12544
    ds_read_b64_tr_b16 a[206:207], v5 offset:18688
    v_mfma_f32_16x16x32_bf16 v[144:147], a[208:211], v[48:51], v[144:147]
    buffer_load_dwordx4 v10, s[16:19], s59 offen offset:2048 nt lds
    v_mfma_f32_16x16x32_bf16 v[148:151], a[208:211], v[52:55], v[148:151]
    v_fma_f32 v38, v74, s35, v25
    v_fma_f32 v39, v75, s35, v25
    v_mfma_f32_16x16x32_bf16 a[32:35], a[208:211], v[56:59], a[32:35]
    v_exp_f32 v38, v38
    v_mfma_f32_16x16x32_bf16 a[36:39], a[208:211], v[60:63], a[36:39]
    ds_read_b64_tr_b16 a[208:209], v6 offset:12544
    ds_read_b64_tr_b16 a[210:211], v6 offset:18688
    v_mfma_f32_16x16x32_bf16 v[152:155], a[212:215], v[48:51], v[152:155]
    v_exp_f32 v39, v39
    v_mfma_f32_16x16x32_bf16 v[156:159], a[212:215], v[52:55], v[156:159]
    s_mov_b32 m0, s89
    v_cvt_pk_bf16_f32 v44, v36, v37
    v_mfma_f32_16x16x32_bf16 a[40:43], a[212:215], v[56:59], a[40:43]
    s_waitcnt lgkmcnt(4)
    v_fma_f32 v0, v68, s35, v24
    v_mfma_f32_16x16x32_bf16 a[44:47], a[212:215], v[60:63], a[44:47]
    ds_read_b64_tr_b16 a[212:213], v7 offset:12544
    ds_read_b64_tr_b16 a[214:215], v7 offset:18688
    v_mfma_f32_16x16x32_bf16 v[160:163], a[192:195], v[48:51], v[160:163]
    buffer_load_dwordx4 v8, s[20:23], s81 offen nt lds
    v_mfma_f32_16x16x32_bf16 v[164:167], a[192:195], v[52:55], v[164:167]
    v_exp_f32 v0, v0
    v_mfma_f32_16x16x32_bf16 a[48:51], a[192:195], v[56:59], a[48:51]
L_hop_7:
    s_cbranch_execz L_hop_11
    v_fma_f32 v36, v69, s35, v24
    v_cvt_pk_bf16_f32 v45, v38, v39
    v_mfma_f32_16x16x32_bf16 a[52:55], a[192:195], v[60:63], a[52:55]
    ds_read_b128 a[192:195], v2 offset:36864
    v_fma_f32 v37, v70, s35, v24
    v_mfma_f32_16x16x32_bf16 v[168:171], a[196:199], v[48:51], v[168:171]
    v_exp_f32 v36, v36
    v_mfma_f32_16x16x32_bf16 v[172:175], a[196:199], v[52:55], v[172:175]
    v_exp_f32 v37, v37
    v_mfma_f32_16x16x32_bf16 a[56:59], a[196:199], v[56:59], a[56:59]
    v_fma_f32 v38, v71, s35, v24
    v_mfma_f32_16x16x32_bf16 a[60:63], a[196:199], v[60:63], a[60:63]
    ds_read_b128 a[196:199], v3 offset:36864
    v_cvt_pk_bf16_f32 v42, v0, v36
    v_mfma_f32_16x16x32_bf16 v[176:179], a[200:203], v[48:51], v[176:179]
    buffer_load_dwordx4 v9, s[20:23], s81 offen offset:1024 nt lds
    v_mfma_f32_16x16x32_bf16 v[180:183], a[200:203], v[52:55], v[180:183]
    v_exp_f32 v38, v38
    v_mfma_f32_16x16x32_bf16 a[64:67], a[200:203], v[56:59], a[64:67]
    v_fma_f32 v39, v76, s35, v25
    v_fma_f32 v0, v77, s35, v25
    v_mfma_f32_16x16x32_bf16 a[68:71], a[200:203], v[60:63], a[68:71]
    ds_read_b128 a[200:203], v2 offset:36992
    s_waitcnt lgkmcnt(3)
    v_mfma_f32_16x16x32_bf16 v[184:187], a[204:207], v[48:51], v[184:187]
    v_exp_f32 v39, v39
    v_mfma_f32_16x16x32_bf16 v[188:191], a[204:207], v[52:55], v[188:191]
    v_exp_f32 v0, v0
    v_mfma_f32_16x16x32_bf16 a[72:75], a[204:207], v[56:59], a[72:75]
    v_cvt_pk_bf16_f32 v43, v37, v38
    v_mfma_f32_16x16x32_bf16 a[76:79], a[204:207], v[60:63], a[76:79]
    ds_read_b128 a[204:207], v3 offset:36992
    v_fma_f32 v36, v78, s35, v25
    v_mfma_f32_16x16x32_bf16 v[192:195], a[208:211], v[48:51], v[192:195]
    buffer_load_dwordx4 v10, s[20:23], s81 offen offset:2048 nt lds
    v_mfma_f32_16x16x32_bf16 v[196:199], a[208:211], v[52:55], v[196:199]
    v_exp_f32 v36, v36
    v_mfma_f32_16x16x32_bf16 a[80:83], a[208:211], v[56:59], a[80:83]
    v_fma_f32 v37, v79, s35, v25
    v_cvt_pk_bf16_f32 v46, v39, v0
    v_mfma_f32_16x16x32_bf16 a[84:87], a[208:211], v[60:63], a[84:87]
    ds_read_b128 a[208:211], v2 offset:37120
    v_mfma_f32_16x16x32_bf16 v[200:203], a[212:215], v[48:51], v[200:203]
    v_exp_f32 v37, v37
    v_mfma_f32_16x16x32_bf16 v[204:207], a[212:215], v[52:55], v[204:207]
    v_cvt_pk_bf16_f32 v47, v36, v37
    v_mfma_f32_16x16x32_bf16 a[88:91], a[212:215], v[56:59], a[88:91]
    v_mfma_f32_16x16x32_bf16 a[92:95], a[212:215], v[60:63], a[92:95]
    ds_read_b128 a[212:215], v3 offset:37120
    v_mfma_f32_16x16x32_bf16 v[28:31], a[248:251], v[40:43], 0
    s_waitcnt vmcnt(21)
    s_barrier
    v_mfma_f32_16x16x32_bf16 v[28:31], a[252:255], v[44:47], v[28:31]
    s_waitcnt lgkmcnt(3)
    v_mfma_f32_16x16x32_bf16 v[96:99], a[192:195], a[144:147], 0
    v_fma_f32 v36, v80, s35, v26
    v_fma_f32 v37, v81, s35, v26
    v_mfma_f32_16x16x32_bf16 v[96:99], a[196:199], a[148:151], v[96:99]
    v_exp_f32 v36, v36
    v_mfma_f32_16x16x32_bf16 v[96:99], a[200:203], a[152:155], v[96:99]
    s_mov_b32 m0, s44
    v_cmp_nge_f32 vcc, s37, v30
    v_mfma_f32_16x16x32_bf16 v[104:107], a[192:195], a[168:171], 0
    v_exp_f32 v37, v37
    v_mfma_f32_16x16x32_bf16 v[104:107], a[196:199], a[172:175], v[104:107]
    buffer_load_dwordx4 v8, s[12:15], s61 offen nt lds
    v_mfma_f32_16x16x32_bf16 v[104:107], a[200:203], a[176:179], v[104:107]
    v_fma_f32 v38, v82, s35, v26
    s_cbranch_vccnz L_tr_T6_A
L_ret_T6_A:
    v_mfma_f32_16x16x32_bf16 v[64:67], a[192:195], a[96:99], 0
    v_exp_f32 v38, v38
    v_mfma_f32_16x16x32_bf16 v[64:67], a[196:199], a[100:103], v[64:67]
    v_add_f32 v17, v17, v28
    v_add_f32 v19, v19, v29
    v_mfma_f32_16x16x32_bf16 v[64:67], a[200:203], a[104:107], v[64:67]
    buffer_load_dwordx4 v9, s[12:15], s61 offen offset:1024 nt lds
    v_mfma_f32_16x16x32_bf16 v[72:75], a[192:195], a[120:123], 0
    ds_read_b128 a[192:195], v2 offset:43008
    v_fma_f32 v39, v83, s35, v26
    v_mfma_f32_16x16x32_bf16 v[72:75], a[196:199], a[124:127], v[72:75]
    v_exp_f32 v39, v39
    v_mfma_f32_16x16x32_bf16 v[72:75], a[200:203], a[128:131], v[72:75]
    ds_read_b128 a[196:199], v3 offset:43008
    s_waitcnt lgkmcnt(2)
    v_cvt_pk_bf16_f32 v56, v36, v37
    v_mfma_f32_16x16x32_bf16 v[64:67], a[204:207], a[108:111], v[64:67]
    buffer_load_dwordx4 v10, s[12:15], s61 offen offset:2048 nt lds
    v_mfma_f32_16x16x32_bf16 v[64:67], a[208:211], a[112:115], v[64:67]
    ds_read_b128 a[200:203], v2 offset:43136
    v_fma_f32 v0, v84, s35, v26
    v_mfma_f32_16x16x32_bf16 v[64:67], a[212:215], a[116:119], v[64:67]
    v_exp_f32 v0, v0
    v_mfma_f32_16x16x32_bf16 v[72:75], a[204:207], a[132:135], v[72:75]
    v_fma_f32 v36, v85, s35, v26
    v_cvt_pk_bf16_f32 v57, v38, v39
    v_mfma_f32_16x16x32_bf16 v[72:75], a[208:211], a[136:139], v[72:75]
    v_exp_f32 v36, v36
    v_mfma_f32_16x16x32_bf16 v[72:75], a[212:215], a[140:143], v[72:75]
    v_fma_f32 v37, v86, s35, v26
    v_fma_f32 v38, v87, s35, v26
    v_mfma_f32_16x16x32_bf16 v[96:99], a[204:207], a[156:159], v[96:99]
    v_exp_f32 v37, v37
    v_mfma_f32_16x16x32_bf16 v[96:99], a[208:211], a[160:163], v[96:99]
    v_exp_f32 v38, v38
    v_mfma_f32_16x16x32_bf16 v[96:99], a[212:215], a[164:167], v[96:99]
    buffer_store_dwordx4 a[244:247], v12, s[96:99], s86 offen offset:1024 sc1
    v_mfma_f32_16x16x32_bf16 v[104:107], a[204:207], a[180:183], v[104:107]
    ds_read_b128 a[204:207], v3 offset:43136
    v_cvt_pk_bf16_f32 v58, v0, v36
    v_mfma_f32_16x16x32_bf16 v[104:107], a[208:211], a[184:187], v[104:107]
    v_fma_f32 v39, v88, s35, v27
    v_fma_f32 v0, v89, s35, v27
    v_mfma_f32_16x16x32_bf16 v[104:107], a[212:215], a[188:191], v[104:107]
    ds_read_b128 a[208:211], v2 offset:43264
    s_waitcnt lgkmcnt(2)
    v_mfma_f32_16x16x32_bf16 v[68:71], a[192:195], a[96:99], 0
    v_exp_f32 v39, v39
    v_mfma_f32_16x16x32_bf16 v[68:71], a[196:199], a[100:103], v[68:71]
    ds_read_b128 a[212:215], v3 offset:43264
    v_cvt_pk_bf16_f32 v59, v37, v38
    v_mfma_f32_16x16x32_bf16 v[68:71], a[200:203], a[104:107], v[68:71]
    v_exp_f32 v0, v0
    v_mfma_f32_16x16x32_bf16 v[76:79], a[192:195], a[120:123], 0
    v_fma_f32 v36, v90, s35, v27
    v_fma_f32 v37, v91, s35, v27
    v_mfma_f32_16x16x32_bf16 v[76:79], a[196:199], a[124:127], v[76:79]
    v_exp_f32 v36, v36
    v_cvt_pk_bf16_f32 v60, v39, v0
    v_mfma_f32_16x16x32_bf16 v[76:79], a[200:203], a[128:131], v[76:79]
    v_exp_f32 v37, v37
    v_mfma_f32_16x16x32_bf16 v[100:103], a[192:195], a[144:147], 0
    v_fma_f32 v38, v92, s35, v27
    v_fma_f32 v39, v93, s35, v27
    v_mfma_f32_16x16x32_bf16 v[100:103], a[196:199], a[148:151], v[100:103]
    v_exp_f32 v38, v38
    v_mfma_f32_16x16x32_bf16 v[100:103], a[200:203], a[152:155], v[100:103]
    s_waitcnt lgkmcnt(0)
    buffer_store_dwordx4 a[216:219], v13, s[96:99], s86 offen offset:2048 sc1
    v_mfma_f32_16x16x32_bf16 v[108:111], a[192:195], a[168:171], 0
    ds_read_b64_tr_b16 a[192:193], v4 offset:24576
    ds_read_b64_tr_b16 a[194:195], v4 offset:30720
    v_mfma_f32_16x16x32_bf16 v[108:111], a[196:199], a[172:175], v[108:111]
    v_exp_f32 v39, v39
    v_mfma_f32_16x16x32_bf16 v[108:111], a[200:203], a[176:179], v[108:111]
    ds_read_b64_tr_b16 a[196:197], v5 offset:24576
    ds_read_b64_tr_b16 a[198:199], v5 offset:30720
    v_mfma_f32_16x16x32_bf16 v[68:71], a[204:207], a[108:111], v[68:71]
    v_cvt_pk_bf16_f32 v61, v36, v37
    v_fma_f32 v0, v94, s35, v27
    v_mfma_f32_16x16x32_bf16 v[68:71], a[208:211], a[112:115], v[68:71]
    ds_read_b64_tr_b16 a[200:201], v6 offset:24576
    ds_read_b64_tr_b16 a[202:203], v6 offset:30720
    v_mfma_f32_16x16x32_bf16 v[68:71], a[212:215], a[116:119], v[68:71]
    v_exp_f32 v0, v0
    v_mfma_f32_16x16x32_bf16 v[76:79], a[204:207], a[132:135], v[76:79]
    v_fma_f32 v36, v95, s35, v27
    v_cvt_pk_bf16_f32 v62, v38, v39
    v_mfma_f32_16x16x32_bf16 v[76:79], a[208:211], a[136:139], v[76:79]
    v_exp_f32 v36, v36
    v_mfma_f32_16x16x32_bf16 v[76:79], a[212:215], a[140:143], v[76:79]
    v_cvt_pk_bf16_f32 v63, v0, v36
    v_fma_f32 v37, v64, s35, v24
    v_mfma_f32_16x16x32_bf16 v[100:103], a[204:207], a[156:159], v[100:103]
    v_exp_f32 v37, v37
    v_mfma_f32_16x16x32_bf16 v[100:103], a[208:211], a[160:163], v[100:103]
    v_fma_f32 v38, v65, s35, v24
    v_fma_f32 v39, v66, s35, v24
    v_mfma_f32_16x16x32_bf16 v[100:103], a[212:215], a[164:167], v[100:103]
    global_load_dwordx4 v[252:255], v1, s[74:75]
    v_mfma_f32_16x16x32_bf16 v[108:111], a[204:207], a[180:183], v[108:111]
    ds_read_b64_tr_b16 a[204:205], v7 offset:24576
    ds_read_b64_tr_b16 a[206:207], v7 offset:30720
    v_mfma_f32_16x16x32_bf16 v[108:111], a[208:211], a[184:187], v[108:111]
    s_mov_b32 m0, s49
    v_fma_f32 v0, v67, s35, v24
    v_mfma_f32_16x16x32_bf16 v[108:111], a[212:215], a[188:191], v[108:111]
    ds_read_b64_tr_b16 a[208:209], v4 offset:24704
    ds_read_b64_tr_b16 a[210:211], v4 offset:30848
    v_mfma_f32_16x16x32_bf16 v[28:31], a[248:251], v[56:59], 0
    buffer_load_dwordx4 v8, s[16:19], s60 offen nt lds
    v_mfma_f32_16x16x32_bf16 v[28:31], a[252:255], v[60:63], v[28:31]
    ds_read_b64_tr_b16 a[212:213], v5 offset:24704
    ds_read_b64_tr_b16 a[214:215], v5 offset:30848
    s_waitcnt lgkmcnt(6)
    v_mfma_f32_16x16x32_bf16 v[112:115], a[192:195], v[40:43], v[112:115]
    v_mfma_f32_16x16x32_bf16 v[116:119], a[192:195], v[44:47], v[116:119]
    v_exp_f32 v38, v38
    v_mfma_f32_16x16x32_bf16 v[120:123], a[196:199], v[40:43], v[120:123]
    v_cvt_pk_bf16_f32 v48, v37, v38
    v_cmp_nge_f32 vcc, s37, v30
    v_mfma_f32_16x16x32_bf16 v[124:127], a[196:199], v[44:47], v[124:127]
    v_exp_f32 v39, v39
    v_mfma_f32_16x16x32_bf16 v[128:131], a[200:203], v[40:43], v[128:131]
    v_exp_f32 v0, v0
    v_mfma_f32_16x16x32_bf16 v[132:135], a[200:203], v[44:47], v[132:135]
    s_cbranch_vccnz L_tr_T6_B
L_ret_T6_B:
    v_mfma_f32_16x16x32_bf16 a[0:3], a[192:195], v[56:59], a[0:3]
    v_add_f32 v21, v21, v28
    v_add_f32 v23, v23, v29
    v_mfma_f32_16x16x32_bf16 a[4:7], a[192:195], v[60:63], a[4:7]
    ds_read_b64_tr_b16 a[192:193], v6 offset:24704
    ds_read_b64_tr_b16 a[194:195], v6 offset:30848
    v_mfma_f32_16x16x32_bf16 a[8:11], a[196:199], v[56:59], a[8:11]
    buffer_load_dwordx4 v9, s[16:19], s60 offen offset:1024 nt lds
    v_mfma_f32_16x16x32_bf16 a[12:15], a[196:199], v[60:63], a[12:15]
    ds_read_b64_tr_b16 a[196:197], v7 offset:24704
    ds_read_b64_tr_b16 a[198:199], v7 offset:30848
    v_mfma_f32_16x16x32_bf16 a[16:19], a[200:203], v[56:59], a[16:19]
    s_waitcnt lgkmcnt(4)
    v_fma_f32 v36, v72, s35, v25
    v_mfma_f32_16x16x32_bf16 a[20:23], a[200:203], v[60:63], a[20:23]
    ds_read_b64_tr_b16 a[200:201], v4 offset:24832
    ds_read_b64_tr_b16 a[202:203], v4 offset:30976
    v_mfma_f32_16x16x32_bf16 v[136:139], a[204:207], v[40:43], v[136:139]
    v_exp_f32 v36, v36
    v_mfma_f32_16x16x32_bf16 v[140:143], a[204:207], v[44:47], v[140:143]
    v_fma_f32 v37, v73, s35, v25
    v_cvt_pk_bf16_f32 v49, v39, v0
    v_mfma_f32_16x16x32_bf16 a[24:27], a[204:207], v[56:59], a[24:27]
    v_exp_f32 v37, v37
    v_mfma_f32_16x16x32_bf16 a[28:31], a[204:207], v[60:63], a[28:31]
    ds_read_b64_tr_b16 a[204:205], v5 offset:24832
    ds_read_b64_tr_b16 a[206:207], v5 offset:30976
    v_mfma_f32_16x16x32_bf16 v[144:147], a[208:211], v[40:43], v[144:147]
    buffer_load_dwordx4 v10, s[16:19], s60 offen offset:2048 nt lds
    v_mfma_f32_16x16x32_bf16 v[148:151], a[208:211], v[44:47], v[148:151]
    v_fma_f32 v38, v74, s35, v25
    v_fma_f32 v39, v75, s35, v25
    v_mfma_f32_16x16x32_bf16 a[32:35], a[208:211], v[56:59], a[32:35]
    v_exp_f32 v38, v38
    v_mfma_f32_16x16x32_bf16 a[36:39], a[208:211], v[60:63], a[36:39]
    ds_read_b64_tr_b16 a[208:209], v6 offset:24832
    ds_read_b64_tr_b16 a[210:211], v6 offset:30976
    v_mfma_f32_16x16x32_bf16 v[152:155], a[212:215], v[40:43], v[152:155]
    v_exp_f32 v39, v39
    v_mfma_f32_16x16x32_bf16 v[156:159], a[212:215], v[44:47], v[156:159]
    s_mov_b32 m0, s90
    v_cvt_pk_bf16_f32 v52, v36, v37
    v_mfma_f32_16x16x32_bf16 a[40:43], a[212:215], v[56:59], a[40:43]
    s_waitcnt lgkmcnt(4)
    v_fma_f32 v0, v68, s35, v24
    v_mfma_f32_16x16x32_bf16 a[44:47], a[212:215], v[60:63], a[44:47]
    ds_read_b64_tr_b16 a[212:213], v7 offset:24832
    ds_read_b64_tr_b16 a[214:215], v7 offset:30976
    v_mfma_f32_16x16x32_bf16 v[160:163], a[192:195], v[40:43], v[160:163]
    buffer_load_dwordx4 v8, s[20:23], s82 offen nt lds
    v_mfma_f32_16x16x32_bf16 v[164:167], a[192:195], v[44:47], v[164:167]
    v_exp_f32 v0, v0
    v_mfma_f32_16x16x32_bf16 a[48:51], a[192:195], v[56:59], a[48:51]
    v_fma_f32 v36, v69, s35, v24
    v_cvt_pk_bf16_f32 v53, v38, v39
    v_mfma_f32_16x16x32_bf16 a[52:55], a[192:195], v[60:63], a[52:55]
    ds_read_b128 a[192:195], v2 offset:0
    v_fma_f32 v37, v70, s35, v24
    v_mfma_f32_16x16x32_bf16 v[168:171], a[196:199], v[40:43], v[168:171]
    v_exp_f32 v36, v36
    v_mfma_f32_16x16x32_bf16 v[172:175], a[196:199], v[44:47], v[172:175]
    v_exp_f32 v37, v37
    v_mfma_f32_16x16x32_bf16 a[56:59], a[196:199], v[56:59], a[56:59]
    v_fma_f32 v38, v71, s35, v24
    v_mfma_f32_16x16x32_bf16 a[60:63], a[196:199], v[60:63], a[60:63]
    ds_read_b128 a[196:199], v3 offset:0
    v_cvt_pk_bf16_f32 v50, v0, v36
    v_mfma_f32_16x16x32_bf16 v[176:179], a[200:203], v[40:43], v[176:179]
    buffer_load_dwordx4 v9, s[20:23], s82 offen offset:1024 nt lds
    v_mfma_f32_16x16x32_bf16 v[180:183], a[200:203], v[44:47], v[180:183]
    v_exp_f32 v38, v38
    v_mfma_f32_16x16x32_bf16 a[64:67], a[200:203], v[56:59], a[64:67]
    v_fma_f32 v39, v76, s35, v25
    v_fma_f32 v0, v77, s35, v25
    v_mfma_f32_16x16x32_bf16 a[68:71], a[200:203], v[60:63], a[68:71]
    ds_read_b128 a[200:203], v2 offset:128
    s_waitcnt lgkmcnt(3)
    v_mfma_f32_16x16x32_bf16 v[184:187], a[204:207], v[40:43], v[184:187]
    v_exp_f32 v39, v39
    v_mfma_f32_16x16x32_bf16 v[188:191], a[204:207], v[44:47], v[188:191]
    v_exp_f32 v0, v0
    v_mfma_f32_16x16x32_bf16 a[72:75], a[204:207], v[56:59], a[72:75]
    v_cvt_pk_bf16_f32 v51, v37, v38
    v_mfma_f32_16x16x32_bf16 a[76:79], a[204:207], v[60:63], a[76:79]
    ds_read_b128 a[204:207], v3 offset:128
    v_fma_f32 v36, v78, s35, v25
    v_mfma_f32_16x16x32_bf16 v[192:195], a[208:211], v[40:43], v[192:195]
    buffer_load_dwordx4 v10, s[20:23], s82 offen offset:2048 nt lds
    v_mfma_f32_16x16x32_bf16 v[196:199], a[208:211], v[44:47], v[196:199]
    v_exp_f32 v36, v36
    v_mfma_f32_16x16x32_bf16 a[80:83], a[208:211], v[56:59], a[80:83]
    v_fma_f32 v37, v79, s35, v25
    v_cvt_pk_bf16_f32 v54, v39, v0
    v_mfma_f32_16x16x32_bf16 a[84:87], a[208:211], v[60:63], a[84:87]
    ds_read_b128 a[208:211], v2 offset:256
    v_mfma_f32_16x16x32_bf16 v[200:203], a[212:215], v[40:43], v[200:203]
    v_exp_f32 v37, v37
    v_mfma_f32_16x16x32_bf16 v[204:207], a[212:215], v[44:47], v[204:207]
    v_cvt_pk_bf16_f32 v55, v36, v37
    v_mfma_f32_16x16x32_bf16 a[88:91], a[212:215], v[56:59], a[88:91]
    v_mfma_f32_16x16x32_bf16 a[92:95], a[212:215], v[60:63], a[92:95]
    ds_read_b128 a[212:215], v3 offset:256
    v_mfma_f32_16x16x32_bf16 v[28:31], a[248:251], v[48:51], 0
    s_waitcnt vmcnt(21)
    s_barrier
    v_mfma_f32_16x16x32_bf16 v[28:31], a[252:255], v[52:55], v[28:31]
    s_waitcnt lgkmcnt(3)
    v_mfma_f32_16x16x32_bf16 v[80:83], a[192:195], a[144:147], 0
    v_fma_f32 v36, v96, s35, v26
    v_fma_f32 v37, v97, s35, v26
    v_mfma_f32_16x16x32_bf16 v[80:83], a[196:199], a[148:151], v[80:83]
    v_exp_f32 v36, v36
    v_mfma_f32_16x16x32_bf16 v[80:83], a[200:203], a[152:155], v[80:83]
    s_mov_b32 m0, s45
    v_cmp_nge_f32 vcc, s37, v30
    v_mfma_f32_16x16x32_bf16 v[88:91], a[192:195], a[168:171], 0
    v_exp_f32 v37, v37
    v_mfma_f32_16x16x32_bf16 v[88:91], a[196:199], a[172:175], v[88:91]
    buffer_load_dwordx4 v8, s[12:15], s62 offen nt lds
    v_mfma_f32_16x16x32_bf16 v[88:91], a[200:203], a[176:179], v[88:91]
    v_fma_f32 v38, v98, s35, v26
    s_cbranch_vccnz L_tr_T7_A
L_ret_T7_A:
    v_mfma_f32_16x16x32_bf16 v[64:67], a[192:195], a[96:99], 0
    v_exp_f32 v38, v38
    v_mfma_f32_16x16x32_bf16 v[64:67], a[196:199], a[100:103], v[64:67]
    v_add_f32 v17, v17, v28
    v_add_f32 v19, v19, v29
    v_mfma_f32_16x16x32_bf16 v[64:67], a[200:203], a[104:107], v[64:67]
    buffer_load_dwordx4 v9, s[12:15], s62 offen offset:1024 nt lds
    v_mfma_f32_16x16x32_bf16 v[72:75], a[192:195], a[120:123], 0
    ds_read_b128 a[192:195], v2 offset:6144
    v_fma_f32 v39, v99, s35, v26
    v_mfma_f32_16x16x32_bf16 v[72:75], a[196:199], a[124:127], v[72:75]
    v_exp_f32 v39, v39
    v_mfma_f32_16x16x32_bf16 v[72:75], a[200:203], a[128:131], v[72:75]
    ds_read_b128 a[196:199], v3 offset:6144
    s_waitcnt lgkmcnt(2)
    v_cvt_pk_bf16_f32 v56, v36, v37
    v_mfma_f32_16x16x32_bf16 v[64:67], a[204:207], a[108:111], v[64:67]
    buffer_load_dwordx4 v10, s[12:15], s62 offen offset:2048 nt lds
    v_mfma_f32_16x16x32_bf16 v[64:67], a[208:211], a[112:115], v[64:67]
    ds_read_b128 a[200:203], v2 offset:6272
    v_fma_f32 v0, v100, s35, v26
    v_mfma_f32_16x16x32_bf16 v[64:67], a[212:215], a[116:119], v[64:67]
    v_exp_f32 v0, v0
    v_mfma_f32_16x16x32_bf16 v[72:75], a[204:207], a[132:135], v[72:75]
    v_fma_f32 v36, v101, s35, v26
    v_cvt_pk_bf16_f32 v57, v38, v39
    v_mfma_f32_16x16x32_bf16 v[72:75], a[208:211], a[136:139], v[72:75]
    v_exp_f32 v36, v36
    v_mfma_f32_16x16x32_bf16 v[72:75], a[212:215], a[140:143], v[72:75]
    v_fma_f32 v37, v102, s35, v26
    v_fma_f32 v38, v103, s35, v26
    v_mfma_f32_16x16x32_bf16 v[80:83], a[204:207], a[156:159], v[80:83]
    s_mov_b32 m0, s91
    v_cvt_pk_bf16_f32 v58, v0, v36
    v_mfma_f32_16x16x32_bf16 v[80:83], a[208:211], a[160:163], v[80:83]
    v_exp_f32 v37, v37
    v_mfma_f32_16x16x32_bf16 v[80:83], a[212:215], a[164:167], v[80:83]
    buffer_load_dwordx4 v8, s[20:23], s83 offen nt lds
    v_mfma_f32_16x16x32_bf16 v[88:91], a[204:207], a[180:183], v[88:91]
    ds_read_b128 a[204:207], v3 offset:6272
    v_fma_f32 v39, v104, s35, v27
    v_mfma_f32_16x16x32_bf16 v[88:91], a[208:211], a[184:187], v[88:91]
    v_exp_f32 v38, v38
    v_mfma_f32_16x16x32_bf16 v[88:91], a[212:215], a[188:191], v[88:91]
    ds_read_b128 a[208:211], v2 offset:6400
    s_waitcnt lgkmcnt(2)
    v_mfma_f32_16x16x32_bf16 v[68:71], a[192:195], a[96:99], 0
    v_exp_f32 v39, v39
    v_mfma_f32_16x16x32_bf16 v[68:71], a[196:199], a[100:103], v[68:71]
    ds_read_b128 a[212:215], v3 offset:6400
    v_fma_f32 v0, v105, s35, v27
    v_mfma_f32_16x16x32_bf16 v[68:71], a[200:203], a[104:107], v[68:71]
    v_exp_f32 v0, v0
    v_mfma_f32_16x16x32_bf16 v[76:79], a[192:195], a[120:123], 0
    v_cvt_pk_bf16_f32 v59, v37, v38
    v_fma_f32 v36, v106, s35, v27
    v_fma_f32 v37, v107, s35, v27
    v_mfma_f32_16x16x32_bf16 v[76:79], a[196:199], a[124:127], v[76:79]
    buffer_load_dwordx4 v9, s[20:23], s83 offen offset:1024 nt lds
    v_mfma_f32_16x16x32_bf16 v[76:79], a[200:203], a[128:131], v[76:79]
    v_exp_f32 v36, v36
    v_mfma_f32_16x16x32_bf16 v[84:87], a[192:195], a[144:147], 0
    v_exp_f32 v37, v37
    v_mfma_f32_16x16x32_bf16 v[84:87], a[196:199], a[148:151], v[84:87]
    v_cvt_pk_bf16_f32 v60, v39, v0
    v_fma_f32 v38, v108, s35, v27
    v_mfma_f32_16x16x32_bf16 v[84:87], a[200:203], a[152:155], v[84:87]
    s_waitcnt lgkmcnt(0)
    v_fma_f32 v39, v109, s35, v27
    v_mfma_f32_16x16x32_bf16 v[92:95], a[192:195], a[168:171], 0
    ds_read_b64_tr_b16 a[192:193], v4 offset:36864
    ds_read_b64_tr_b16 a[194:195], v4 offset:43008
    v_mfma_f32_16x16x32_bf16 v[92:95], a[196:199], a[172:175], v[92:95]
    v_exp_f32 v38, v38
    v_mfma_f32_16x16x32_bf16 v[92:95], a[200:203], a[176:179], v[92:95]
    ds_read_b64_tr_b16 a[196:197], v5 offset:36864
    ds_read_b64_tr_b16 a[198:199], v5 offset:43008
    v_mfma_f32_16x16x32_bf16 v[68:71], a[204:207], a[108:111], v[68:71]
    buffer_load_dwordx4 v10, s[20:23], s83 offen offset:2048 nt lds
    v_mfma_f32_16x16x32_bf16 v[68:71], a[208:211], a[112:115], v[68:71]
    ds_read_b64_tr_b16 a[200:201], v6 offset:36864
    ds_read_b64_tr_b16 a[202:203], v6 offset:43008
    v_mfma_f32_16x16x32_bf16 v[68:71], a[212:215], a[116:119], v[68:71]
    v_exp_f32 v39, v39
    v_mfma_f32_16x16x32_bf16 v[76:79], a[204:207], a[132:135], v[76:79]
    v_cvt_pk_bf16_f32 v61, v36, v37
    v_fma_f32 v0, v110, s35, v27
    v_mfma_f32_16x16x32_bf16 v[76:79], a[208:211], a[136:139], v[76:79]
    v_exp_f32 v0, v0
    v_mfma_f32_16x16x32_bf16 v[76:79], a[212:215], a[140:143], v[76:79]
    v_fma_f32 v36, v111, s35, v27
    v_cvt_pk_bf16_f32 v62, v38, v39
    v_mfma_f32_16x16x32_bf16 v[84:87], a[204:207], a[156:159], v[84:87]
    v_exp_f32 v36, v36
    v_mfma_f32_16x16x32_bf16 v[84:87], a[208:211], a[160:163], v[84:87]
    v_cvt_pk_bf16_f32 v63, v0, v36
    v_fma_f32 v37, v64, s35, v24
    v_mfma_f32_16x16x32_bf16 v[84:87], a[212:215], a[164:167], v[84:87]
    v_exp_f32 v37, v37
    v_mfma_f32_16x16x32_bf16 v[92:95], a[204:207], a[180:183], v[92:95]
    ds_read_b64_tr_b16 a[204:205], v7 offset:36864
    ds_read_b64_tr_b16 a[206:207], v7 offset:43008
    v_mfma_f32_16x16x32_bf16 v[92:95], a[208:211], a[184:187], v[92:95]
    s_mov_b32 m0, s50
    v_fma_f32 v38, v65, s35, v24
    v_mfma_f32_16x16x32_bf16 v[92:95], a[212:215], a[188:191], v[92:95]
    ds_read_b64_tr_b16 a[208:209], v4 offset:36992
    ds_read_b64_tr_b16 a[210:211], v4 offset:43136
    v_mfma_f32_16x16x32_bf16 v[28:31], a[248:251], v[56:59], 0
    buffer_load_dwordx4 v8, s[16:19], s61 offen nt lds
    v_mfma_f32_16x16x32_bf16 v[28:31], a[252:255], v[60:63], v[28:31]
    ds_read_b64_tr_b16 a[212:213], v5 offset:36992
    ds_read_b64_tr_b16 a[214:215], v5 offset:43136
    s_waitcnt lgkmcnt(6)
    v_mfma_f32_16x16x32_bf16 v[112:115], a[192:195], v[48:51], v[112:115]
    v_exp_f32 v38, v38
    v_mfma_f32_16x16x32_bf16 v[116:119], a[192:195], v[52:55], v[116:119]
    v_fma_f32 v39, v66, s35, v24
    v_mfma_f32_16x16x32_bf16 v[120:123], a[196:199], v[48:51], v[120:123]
    v_fma_f32 v0, v67, s35, v24
    v_cmp_nge_f32 vcc, s37, v30
    v_mfma_f32_16x16x32_bf16 v[124:127], a[196:199], v[52:55], v[124:127]
    v_exp_f32 v39, v39
    v_mfma_f32_16x16x32_bf16 v[128:131], a[200:203], v[48:51], v[128:131]
    v_exp_f32 v0, v0
    v_mfma_f32_16x16x32_bf16 v[132:135], a[200:203], v[52:55], v[132:135]
    s_cbranch_vccnz L_tr_T7_B
L_ret_T7_B:
    v_mfma_f32_16x16x32_bf16 a[0:3], a[192:195], v[56:59], a[0:3]
    v_add_f32 v21, v21, v28
    v_add_f32 v23, v23, v29
    v_mfma_f32_16x16x32_bf16 a[4:7], a[192:195], v[60:63], a[4:7]
    ds_read_b64_tr_b16 a[192:193], v6 offset:36992
    ds_read_b64_tr_b16 a[194:195], v6 offset:43136
    v_mfma_f32_16x16x32_bf16 a[8:11], a[196:199], v[56:59], a[8:11]
    buffer_load_dwordx4 v9, s[16:19], s61 offen offset:1024 nt lds
    v_mfma_f32_16x16x32_bf16 a[12:15], a[196:199], v[60:63], a[12:15]
    ds_read_b64_tr_b16 a[196:197], v7 offset:36992
    ds_read_b64_tr_b16 a[198:199], v7 offset:43136
    v_mfma_f32_16x16x32_bf16 a[16:19], a[200:203], v[56:59], a[16:19]
    s_waitcnt lgkmcnt(4)
    v_cvt_pk_bf16_f32 v40, v37, v38
    v_mfma_f32_16x16x32_bf16 a[20:23], a[200:203], v[60:63], a[20:23]
    ds_read_b64_tr_b16 a[200:201], v4 offset:37120
    ds_read_b64_tr_b16 a[202:203], v4 offset:43264
    v_mfma_f32_16x16x32_bf16 v[136:139], a[204:207], v[48:51], v[136:139]
    v_fma_f32 v36, v72, s35, v25
    v_fma_f32 v37, v73, s35, v25
    v_mfma_f32_16x16x32_bf16 v[140:143], a[204:207], v[52:55], v[140:143]
    v_exp_f32 v36, v36
    v_mfma_f32_16x16x32_bf16 a[24:27], a[204:207], v[56:59], a[24:27]
    v_exp_f32 v37, v37
    v_mfma_f32_16x16x32_bf16 a[28:31], a[204:207], v[60:63], a[28:31]
    ds_read_b64_tr_b16 a[204:205], v5 offset:37120
    ds_read_b64_tr_b16 a[206:207], v5 offset:43264
    v_mfma_f32_16x16x32_bf16 v[144:147], a[208:211], v[48:51], v[144:147]
    buffer_load_dwordx4 v10, s[16:19], s61 offen offset:2048 nt lds
    v_mfma_f32_16x16x32_bf16 v[148:151], a[208:211], v[52:55], v[148:151]
    v_cvt_pk_bf16_f32 v41, v39, v0
    v_fma_f32 v38, v74, s35, v25
    v_mfma_f32_16x16x32_bf16 a[32:35], a[208:211], v[56:59], a[32:35]
    v_exp_f32 v38, v38
    v_mfma_f32_16x16x32_bf16 a[36:39], a[208:211], v[60:63], a[36:39]
    ds_read_b64_tr_b16 a[208:209], v6 offset:37120
    ds_read_b64_tr_b16 a[210:211], v6 offset:43264
    v_mfma_f32_16x16x32_bf16 v[152:155], a[212:215], v[48:51], v[152:155]
    v_fma_f32 v39, v75, s35, v25
    v_cvt_pk_bf16_f32 v44, v36, v37
    v_mfma_f32_16x16x32_bf16 v[156:159], a[212:215], v[52:55], v[156:159]
    v_exp_f32 v39, v39
    v_mfma_f32_16x16x32_bf16 a[40:43], a[212:215], v[56:59], a[40:43]
    s_waitcnt lgkmcnt(4)
    v_fma_f32 v0, v68, s35, v24
    v_mfma_f32_16x16x32_bf16 a[44:47], a[212:215], v[60:63], a[44:47]
    ds_read_b64_tr_b16 a[212:213], v7 offset:37120
    ds_read_b64_tr_b16 a[214:215], v7 offset:43264
    v_mfma_f32_16x16x32_bf16 v[160:163], a[192:195], v[48:51], v[160:163]
    buffer_store_dwordx4 a[220:223], v11, s[96:99], s87 offen sc1
    v_mfma_f32_16x16x32_bf16 v[164:167], a[192:195], v[52:55], v[164:167]
    v_exp_f32 v0, v0
    v_mfma_f32_16x16x32_bf16 a[48:51], a[192:195], v[56:59], a[48:51]
    v_fma_f32 v36, v69, s35, v24
    v_cvt_pk_bf16_f32 v45, v38, v39
    v_mfma_f32_16x16x32_bf16 a[52:55], a[192:195], v[60:63], a[52:55]
    ds_read_b128 a[192:195], v2 offset:12288
    v_fma_f32 v37, v70, s35, v24
    v_mfma_f32_16x16x32_bf16 v[168:171], a[196:199], v[48:51], v[168:171]
    v_exp_f32 v36, v36
    v_mfma_f32_16x16x32_bf16 v[172:175], a[196:199], v[52:55], v[172:175]
    v_exp_f32 v37, v37
    v_mfma_f32_16x16x32_bf16 a[56:59], a[196:199], v[56:59], a[56:59]
    v_fma_f32 v38, v71, s35, v24
    v_mfma_f32_16x16x32_bf16 a[60:63], a[196:199], v[60:63], a[60:63]
    ds_read_b128 a[196:199], v3 offset:12288
    v_cvt_pk_bf16_f32 v42, v0, v36
    v_mfma_f32_16x16x32_bf16 v[176:179], a[200:203], v[48:51], v[176:179]
    buffer_store_dwordx4 a[224:227], v12, s[96:99], s87 offen offset:1024 sc1
    v_mfma_f32_16x16x32_bf16 v[180:183], a[200:203], v[52:55], v[180:183]
    v_exp_f32 v38, v38
    v_mfma_f32_16x16x32_bf16 a[64:67], a[200:203], v[56:59], a[64:67]
    v_fma_f32 v39, v76, s35, v25
    v_fma_f32 v0, v77, s35, v25
    v_mfma_f32_16x16x32_bf16 a[68:71], a[200:203], v[60:63], a[68:71]
    ds_read_b128 a[200:203], v2 offset:12416
    s_waitcnt lgkmcnt(3)
    v_mfma_f32_16x16x32_bf16 v[184:187], a[204:207], v[48:51], v[184:187]
    v_exp_f32 v39, v39
    v_mfma_f32_16x16x32_bf16 v[188:191], a[204:207], v[52:55], v[188:191]
    v_exp_f32 v0, v0
    v_mfma_f32_16x16x32_bf16 a[72:75], a[204:207], v[56:59], a[72:75]
    v_cvt_pk_bf16_f32 v43, v37, v38
    v_mfma_f32_16x16x32_bf16 a[76:79], a[204:207], v[60:63], a[76:79]
    ds_read_b128 a[204:207], v3 offset:12416
    v_fma_f32 v36, v78, s35, v25
    v_mfma_f32_16x16x32_bf16 v[192:195], a[208:211], v[48:51], v[192:195]
    buffer_store_dwordx4 a[228:231], v13, s[96:99], s87 offen offset:2048 sc1
    v_mfma_f32_16x16x32_bf16 v[196:199], a[208:211], v[52:55], v[196:199]
    v_exp_f32 v36, v36
    v_mfma_f32_16x16x32_bf16 a[80:83], a[208:211], v[56:59], a[80:83]
    v_fma_f32 v37, v79, s35, v25
    v_mfma_f32_16x16x32_bf16 a[84:87], a[208:211], v[60:63], a[84:87]
    ds_read_b128 a[208:211], v2 offset:12544
    v_cvt_pk_bf16_f32 v46, v39, v0
    v_mfma_f32_16x16x32_bf16 v[200:203], a[212:215], v[48:51], v[200:203]
    v_exp_f32 v37, v37
    v_mfma_f32_16x16x32_bf16 v[204:207], a[212:215], v[52:55], v[204:207]
    v_cvt_pk_bf16_f32 v47, v36, v37
    v_mfma_f32_16x16x32_bf16 a[88:91], a[212:215], v[56:59], a[88:91]
    v_mfma_f32_16x16x32_bf16 a[92:95], a[212:215], v[60:63], a[92:95]
    ds_read_b128 a[212:215], v3 offset:12544
    v_mfma_f32_16x16x32_bf16 v[28:31], a[248:251], v[40:43], 0
    s_waitcnt vmcnt(21)
    s_barrier
    v_mfma_f32_16x16x32_bf16 v[28:31], a[252:255], v[44:47], v[28:31]
    s_waitcnt lgkmcnt(3)
    v_mfma_f32_16x16x32_bf16 v[96:99], a[192:195], a[144:147], 0
    v_fma_f32 v36, v80, s35, v26
    v_fma_f32 v37, v81, s35, v26
    v_mfma_f32_16x16x32_bf16 v[96:99], a[196:199], a[148:151], v[96:99]
    v_exp_f32 v36, v36
    v_mfma_f32_16x16x32_bf16 v[96:99], a[200:203], a[152:155], v[96:99]
    s_mov_b32 m0, s42
    v_cmp_nge_f32 vcc, s37, v30
    v_mfma_f32_16x16x32_bf16 v[104:107], a[192:195], a[168:171], 0
    v_exp_f32 v37, v37
    v_mfma_f32_16x16x32_bf16 v[104:107], a[196:199], a[172:175], v[104:107]
    buffer_load_dwordx4 v8, s[12:15], s63 offen nt lds
    v_mfma_f32_16x16x32_bf16 v[104:107], a[200:203], a[176:179], v[104:107]
    v_fma_f32 v38, v82, s35, v26
    s_cbranch_vccnz L_tr_T8_A
L_ret_T8_A:
    v_mfma_f32_16x16x32_bf16 v[64:67], a[192:195], a[96:99], 0
    v_add_f32 v17, v17, v28
    v_add_f32 v19, v19, v29
    v_mfma_f32_16x16x32_bf16 v[64:67], a[196:199], a[100:103], v[64:67]
    v_exp_f32 v38, v38
    v_mfma_f32_16x16x32_bf16 v[64:67], a[200:203], a[104:107], v[64:67]
    buffer_load_dwordx4 v9, s[12:15], s63 offen offset:1024 nt lds
L_hop_8:
    s_cbranch_execz L_hop_12
    v_mfma_f32_16x16x32_bf16 v[72:75], a[192:195], a[120:123], 0
    ds_read_b128 a[192:195], v2 offset:18432
    v_fma_f32 v39, v83, s35, v26
    v_mfma_f32_16x16x32_bf16 v[72:75], a[196:199], a[124:127], v[72:75]
    v_exp_f32 v39, v39
    v_mfma_f32_16x16x32_bf16 v[72:75], a[200:203], a[128:131], v[72:75]
    ds_read_b128 a[196:199], v3 offset:18432
    s_waitcnt lgkmcnt(2)
    v_mfma_f32_16x16x32_bf16 v[64:67], a[204:207], a[108:111], v[64:67]
    buffer_load_dwordx4 v10, s[12:15], s63 offen offset:2048 nt lds
    v_mfma_f32_16x16x32_bf16 v[64:67], a[208:211], a[112:115], v[64:67]
    ds_read_b128 a[200:203], v2 offset:18560
    v_cvt_pk_bf16_f32 v56, v36, v37
    v_mfma_f32_16x16x32_bf16 v[64:67], a[212:215], a[116:119], v[64:67]
    v_fma_f32 v0, v84, s35, v26
    v_fma_f32 v36, v85, s35, v26
    v_mfma_f32_16x16x32_bf16 v[72:75], a[204:207], a[132:135], v[72:75]
    v_exp_f32 v0, v0
    v_mfma_f32_16x16x32_bf16 v[72:75], a[208:211], a[136:139], v[72:75]
    v_exp_f32 v36, v36
    v_mfma_f32_16x16x32_bf16 v[72:75], a[212:215], a[140:143], v[72:75]
    v_cvt_pk_bf16_f32 v57, v38, v39
    v_fma_f32 v37, v86, s35, v26
    v_mfma_f32_16x16x32_bf16 v[96:99], a[204:207], a[156:159], v[96:99]
    v_exp_f32 v37, v37
    v_mfma_f32_16x16x32_bf16 v[96:99], a[208:211], a[160:163], v[96:99]
    v_fma_f32 v38, v87, s35, v26
    v_cvt_pk_bf16_f32 v58, v0, v36
    v_mfma_f32_16x16x32_bf16 v[96:99], a[212:215], a[164:167], v[96:99]
    buffer_store_dwordx4 v[208:211], v11, s[24:27], s84 offen sc1
    v_mfma_f32_16x16x32_bf16 v[104:107], a[204:207], a[180:183], v[104:107]
    ds_read_b128 a[204:207], v3 offset:18560
    v_fma_f32 v39, v88, s35, v27
    v_mfma_f32_16x16x32_bf16 v[104:107], a[208:211], a[184:187], v[104:107]
    v_exp_f32 v38, v38
    v_mfma_f32_16x16x32_bf16 v[104:107], a[212:215], a[188:191], v[104:107]
    ds_read_b128 a[208:211], v2 offset:18688
    s_waitcnt lgkmcnt(2)
    v_mfma_f32_16x16x32_bf16 v[68:71], a[192:195], a[96:99], 0
    v_exp_f32 v39, v39
    v_mfma_f32_16x16x32_bf16 v[68:71], a[196:199], a[100:103], v[68:71]
    ds_read_b128 a[212:215], v3 offset:18688
    v_fma_f32 v0, v89, s35, v27
    v_mfma_f32_16x16x32_bf16 v[68:71], a[200:203], a[104:107], v[68:71]
    v_exp_f32 v0, v0
    v_mfma_f32_16x16x32_bf16 v[76:79], a[192:195], a[120:123], 0
    v_cvt_pk_bf16_f32 v59, v37, v38
    v_fma_f32 v36, v90, s35, v27
    v_mfma_f32_16x16x32_bf16 v[76:79], a[196:199], a[124:127], v[76:79]
    v_exp_f32 v36, v36
    v_mfma_f32_16x16x32_bf16 v[76:79], a[200:203], a[128:131], v[76:79]
    v_fma_f32 v37, v91, s35, v27
    v_cvt_pk_bf16_f32 v60, v39, v0
    v_mfma_f32_16x16x32_bf16 v[100:103], a[192:195], a[144:147], 0
    v_exp_f32 v37, v37
    v_mfma_f32_16x16x32_bf16 v[100:103], a[196:199], a[148:151], v[100:103]
    v_fma_f32 v38, v92, s35, v27
    v_mfma_f32_16x16x32_bf16 v[100:103], a[200:203], a[152:155], v[100:103]
    s_waitcnt lgkmcnt(0)
    v_fma_f32 v39, v93, s35, v27
    v_mfma_f32_16x16x32_bf16 v[108:111], a[192:195], a[168:171], 0
    ds_read_b64_tr_b16 a[192:193], v4 offset:0
    ds_read_b64_tr_b16 a[194:195], v4 offset:6144
    v_mfma_f32_16x16x32_bf16 v[108:111], a[196:199], a[172:175], v[108:111]
    v_exp_f32 v38, v38
    v_mfma_f32_16x16x32_bf16 v[108:111], a[200:203], a[176:179], v[108:111]
    ds_read_b64_tr_b16 a[196:197], v5 offset:0
    ds_read_b64_tr_b16 a[198:199], v5 offset:6144
    v_mfma_f32_16x16x32_bf16 v[68:71], a[204:207], a[108:111], v[68:71]
    buffer_store_dwordx4 v[212:215], v12, s[24:27], s84 offen offset:1024 sc1
    v_mfma_f32_16x16x32_bf16 v[68:71], a[208:211], a[112:115], v[68:71]
    ds_read_b64_tr_b16 a[200:201], v6 offset:0
    ds_read_b64_tr_b16 a[202:203], v6 offset:6144
    v_mfma_f32_16x16x32_bf16 v[68:71], a[212:215], a[116:119], v[68:71]
    v_exp_f32 v39, v39
    v_mfma_f32_16x16x32_bf16 v[76:79], a[204:207], a[132:135], v[76:79]
    v_cvt_pk_bf16_f32 v61, v36, v37
    v_fma_f32 v0, v94, s35, v27
    v_mfma_f32_16x16x32_bf16 v[76:79], a[208:211], a[136:139], v[76:79]
    v_exp_f32 v0, v0
    v_mfma_f32_16x16x32_bf16 v[76:79], a[212:215], a[140:143], v[76:79]
    v_fma_f32 v36, v95, s35, v27
    v_mfma_f32_16x16x32_bf16 v[100:103], a[204:207], a[156:159], v[100:103]
    v_exp_f32 v36, v36
    v_mfma_f32_16x16x32_bf16 v[100:103], a[208:211], a[160:163], v[100:103]
    v_cvt_pk_bf16_f32 v62, v38, v39
    v_cvt_pk_bf16_f32 v63, v0, v36
    v_mfma_f32_16x16x32_bf16 v[100:103], a[212:215], a[164:167], v[100:103]
    v_fma_f32 v37, v64, s35, v24
    v_mfma_f32_16x16x32_bf16 v[108:111], a[204:207], a[180:183], v[108:111]
    ds_read_b64_tr_b16 a[204:205], v7 offset:0
    ds_read_b64_tr_b16 a[206:207], v7 offset:6144
    v_mfma_f32_16x16x32_bf16 v[108:111], a[208:211], a[184:187], v[108:111]
    s_mov_b32 m0, s51
    v_fma_f32 v38, v65, s35, v24
    v_mfma_f32_16x16x32_bf16 v[108:111], a[212:215], a[188:191], v[108:111]
    ds_read_b64_tr_b16 a[208:209], v4 offset:128
    ds_read_b64_tr_b16 a[210:211], v4 offset:6272
    v_mfma_f32_16x16x32_bf16 v[28:31], a[248:251], v[56:59], 0
    buffer_load_dwordx4 v8, s[16:19], s62 offen nt lds
    v_mfma_f32_16x16x32_bf16 v[28:31], a[252:255], v[60:63], v[28:31]
    ds_read_b64_tr_b16 a[212:213], v5 offset:128
    ds_read_b64_tr_b16 a[214:215], v5 offset:6272
    s_waitcnt lgkmcnt(6)
    v_mfma_f32_16x16x32_bf16 v[112:115], a[192:195], v[40:43], v[112:115]
    v_exp_f32 v37, v37
    v_mfma_f32_16x16x32_bf16 v[116:119], a[192:195], v[44:47], v[116:119]
    v_exp_f32 v38, v38
    v_mfma_f32_16x16x32_bf16 v[120:123], a[196:199], v[40:43], v[120:123]
    v_fma_f32 v39, v66, s35, v24
    v_cmp_nge_f32 vcc, s37, v30
    v_mfma_f32_16x16x32_bf16 v[124:127], a[196:199], v[44:47], v[124:127]
    v_exp_f32 v39, v39
    v_mfma_f32_16x16x32_bf16 v[128:131], a[200:203], v[40:43], v[128:131]
    v_fma_f32 v0, v67, s35, v24
    v_mfma_f32_16x16x32_bf16 v[132:135], a[200:203], v[44:47], v[132:135]
    v_cvt_pk_bf16_f32 v48, v37, v38
    s_cbranch_vccnz L_tr_T8_B
L_ret_T8_B:
    v_mfma_f32_16x16x32_bf16 a[0:3], a[192:195], v[56:59], a[0:3]
    v_add_f32 v21, v21, v28
    v_add_f32 v23, v23, v29
    v_mfma_f32_16x16x32_bf16 a[4:7], a[192:195], v[60:63], a[4:7]
    ds_read_b64_tr_b16 a[192:193], v6 offset:128
    ds_read_b64_tr_b16 a[194:195], v6 offset:6272
    v_mfma_f32_16x16x32_bf16 a[8:11], a[196:199], v[56:59], a[8:11]
    buffer_load_dwordx4 v9, s[16:19], s62 offen offset:1024 nt lds
    v_mfma_f32_16x16x32_bf16 a[12:15], a[196:199], v[60:63], a[12:15]
    ds_read_b64_tr_b16 a[196:197], v7 offset:128
    ds_read_b64_tr_b16 a[198:199], v7 offset:6272
    v_mfma_f32_16x16x32_bf16 a[16:19], a[200:203], v[56:59], a[16:19]
    s_waitcnt lgkmcnt(4)
    v_fma_f32 v36, v72, s35, v25
    v_mfma_f32_16x16x32_bf16 a[20:23], a[200:203], v[60:63], a[20:23]
    ds_read_b64_tr_b16 a[200:201], v4 offset:256
    ds_read_b64_tr_b16 a[202:203], v4 offset:6400
    v_mfma_f32_16x16x32_bf16 v[136:139], a[204:207], v[40:43], v[136:139]
    v_exp_f32 v0, v0
    v_mfma_f32_16x16x32_bf16 v[140:143], a[204:207], v[44:47], v[140:143]
    v_exp_f32 v36, v36
    v_mfma_f32_16x16x32_bf16 a[24:27], a[204:207], v[56:59], a[24:27]
    v_fma_f32 v37, v73, s35, v25
    v_cvt_pk_bf16_f32 v49, v39, v0
    v_mfma_f32_16x16x32_bf16 a[28:31], a[204:207], v[60:63], a[28:31]
    ds_read_b64_tr_b16 a[204:205], v5 offset:256
    ds_read_b64_tr_b16 a[206:207], v5 offset:6400
    v_mfma_f32_16x16x32_bf16 v[144:147], a[208:211], v[40:43], v[144:147]
    buffer_load_dwordx4 v10, s[16:19], s62 offen offset:2048 nt lds
    v_mfma_f32_16x16x32_bf16 v[148:151], a[208:211], v[44:47], v[148:151]
    v_exp_f32 v37, v37
    v_mfma_f32_16x16x32_bf16 a[32:35], a[208:211], v[56:59], a[32:35]
    v_fma_f32 v38, v74, s35, v25
    v_fma_f32 v39, v75, s35, v25
    v_mfma_f32_16x16x32_bf16 a[36:39], a[208:211], v[60:63], a[36:39]
    ds_read_b64_tr_b16 a[208:209], v6 offset:256
    ds_read_b64_tr_b16 a[210:211], v6 offset:6400
    v_mfma_f32_16x16x32_bf16 v[152:155], a[212:215], v[40:43], v[152:155]
    v_exp_f32 v38, v38
    v_mfma_f32_16x16x32_bf16 v[156:159], a[212:215], v[44:47], v[156:159]
    v_exp_f32 v39, v39
    v_mfma_f32_16x16x32_bf16 a[40:43], a[212:215], v[56:59], a[40:43]
    s_waitcnt lgkmcnt(4)
    v_cvt_pk_bf16_f32 v52, v36, v37
    v_mfma_f32_16x16x32_bf16 a[44:47], a[212:215], v[60:63], a[44:47]
    ds_read_b64_tr_b16 a[212:213], v7 offset:256
    ds_read_b64_tr_b16 a[214:215], v7 offset:6400
    v_mfma_f32_16x16x32_bf16 v[160:163], a[192:195], v[40:43], v[160:163]
    buffer_store_dwordx4 v[216:219], v13, s[24:27], s84 offen offset:2048 sc1
    v_mfma_f32_16x16x32_bf16 v[164:167], a[192:195], v[44:47], v[164:167]
    v_fma_f32 v0, v68, s35, v24
    v_fma_f32 v36, v69, s35, v24
    v_mfma_f32_16x16x32_bf16 a[48:51], a[192:195], v[56:59], a[48:51]
    v_exp_f32 v0, v0
    v_mfma_f32_16x16x32_bf16 a[52:55], a[192:195], v[60:63], a[52:55]
    ds_read_b128 a[192:195], v2 offset:24576
    v_mfma_f32_16x16x32_bf16 v[168:171], a[196:199], v[40:43], v[168:171]
    v_exp_f32 v36, v36
    v_mfma_f32_16x16x32_bf16 v[172:175], a[196:199], v[44:47], v[172:175]
    v_cvt_pk_bf16_f32 v53, v38, v39
    v_fma_f32 v37, v70, s35, v24
    v_mfma_f32_16x16x32_bf16 a[56:59], a[196:199], v[56:59], a[56:59]
    v_exp_f32 v37, v37
    v_mfma_f32_16x16x32_bf16 a[60:63], a[196:199], v[60:63], a[60:63]
    ds_read_b128 a[196:199], v3 offset:24576
    v_fma_f32 v38, v71, s35, v24
    v_mfma_f32_16x16x32_bf16 v[176:179], a[200:203], v[40:43], v[176:179]
    v_exp_f32 v38, v38
    v_mfma_f32_16x16x32_bf16 v[180:183], a[200:203], v[44:47], v[180:183]
    v_cvt_pk_bf16_f32 v50, v0, v36
    v_mfma_f32_16x16x32_bf16 a[64:67], a[200:203], v[56:59], a[64:67]
    v_fma_f32 v39, v76, s35, v25
    v_fma_f32 v0, v77, s35, v25
    v_mfma_f32_16x16x32_bf16 a[68:71], a[200:203], v[60:63], a[68:71]
    ds_read_b128 a[200:203], v2 offset:24704
    s_waitcnt lgkmcnt(3)
    v_mfma_f32_16x16x32_bf16 v[184:187], a[204:207], v[40:43], v[184:187]
    v_exp_f32 v39, v39
    v_mfma_f32_16x16x32_bf16 v[188:191], a[204:207], v[44:47], v[188:191]
    v_exp_f32 v0, v0
    v_mfma_f32_16x16x32_bf16 a[72:75], a[204:207], v[56:59], a[72:75]
    v_cvt_pk_bf16_f32 v51, v37, v38
    v_mfma_f32_16x16x32_bf16 a[76:79], a[204:207], v[60:63], a[76:79]
    ds_read_b128 a[204:207], v3 offset:24704
    v_fma_f32 v36, v78, s35, v25
    v_mfma_f32_16x16x32_bf16 v[192:195], a[208:211], v[40:43], v[192:195]
    buffer_store_dwordx4 v[220:223], v11, s[24:27], s85 offen sc1
    v_mfma_f32_16x16x32_bf16 v[196:199], a[208:211], v[44:47], v[196:199]
    v_exp_f32 v36, v36
    v_mfma_f32_16x16x32_bf16 a[80:83], a[208:211], v[56:59], a[80:83]
    v_fma_f32 v37, v79, s35, v25
    v_cvt_pk_bf16_f32 v54, v39, v0
    v_mfma_f32_16x16x32_bf16 a[84:87], a[208:211], v[60:63], a[84:87]
    ds_read_b128 a[208:211], v2 offset:24832
    v_mfma_f32_16x16x32_bf16 v[200:203], a[212:215], v[40:43], v[200:203]
    v_exp_f32 v37, v37
    v_mfma_f32_16x16x32_bf16 v[204:207], a[212:215], v[44:47], v[204:207]
    v_cvt_pk_bf16_f32 v55, v36, v37
    v_mfma_f32_16x16x32_bf16 a[88:91], a[212:215], v[56:59], a[88:91]
    v_mfma_f32_16x16x32_bf16 a[92:95], a[212:215], v[60:63], a[92:95]
    ds_read_b128 a[212:215], v3 offset:24832
    v_mfma_f32_16x16x32_bf16 v[28:31], a[248:251], v[48:51], 0
    s_waitcnt vmcnt(19)
    s_barrier
    v_mfma_f32_16x16x32_bf16 v[28:31], a[252:255], v[52:55], v[28:31]
    s_waitcnt lgkmcnt(3)
    v_mfma_f32_16x16x32_bf16 v[80:83], a[192:195], a[144:147], 0
    s_waitcnt vmcnt(16)
    v_fma_f32 v36, v96, s35, v26
    v_mfma_f32_16x16x32_bf16 v[80:83], a[196:199], a[148:151], v[80:83]
    ds_read_b128 v[208:211], v14 offset:0
    v_fma_f32 v37, v97, s35, v26
    v_mfma_f32_16x16x32_bf16 v[80:83], a[200:203], a[152:155], v[80:83]
    s_mov_b32 m0, s43
    v_cmp_nge_f32 vcc, s37, v30
    v_mfma_f32_16x16x32_bf16 v[88:91], a[192:195], a[168:171], 0
    v_exp_f32 v36, v36
    v_mfma_f32_16x16x32_bf16 v[88:91], a[196:199], a[172:175], v[88:91]
    buffer_load_dwordx4 v8, s[12:15], s64 offen nt lds
    v_mfma_f32_16x16x32_bf16 v[88:91], a[200:203], a[176:179], v[88:91]
    ds_read_b128 v[212:215], v15 offset:0
    s_cbranch_vccnz L_tr_T9_A
L_ret_T9_A:
    v_mfma_f32_16x16x32_bf16 v[64:67], a[192:195], a[96:99], 0
    v_exp_f32 v37, v37
    v_mfma_f32_16x16x32_bf16 v[64:67], a[196:199], a[100:103], v[64:67]
    v_add_f32 v17, v17, v28
    v_add_f32 v19, v19, v29
    v_mfma_f32_16x16x32_bf16 v[64:67], a[200:203], a[104:107], v[64:67]
    buffer_load_dwordx4 v9, s[12:15], s64 offen offset:1024 nt lds
    v_mfma_f32_16x16x32_bf16 v[72:75], a[192:195], a[120:123], 0
    ds_read_b128 a[192:195], v2 offset:30720
    ds_read_b128 v[216:219], v14 offset:128
    v_mfma_f32_16x16x32_bf16 v[72:75], a[196:199], a[124:127], v[72:75]
    v_fma_f32 v38, v98, s35, v26
    v_fma_f32 v39, v99, s35, v26
    v_mfma_f32_16x16x32_bf16 v[72:75], a[200:203], a[128:131], v[72:75]
    ds_read_b128 a[196:199], v3 offset:30720
    s_waitcnt lgkmcnt(5)
    v_cvt_pk_bf16_f32 v56, v36, v37
    v_mfma_f32_16x16x32_bf16 v[64:67], a[204:207], a[108:111], v[64:67]
    buffer_load_dwordx4 v10, s[12:15], s64 offen offset:2048 nt lds
    v_mfma_f32_16x16x32_bf16 v[64:67], a[208:211], a[112:115], v[64:67]
    ds_read_b128 a[200:203], v2 offset:30848
    ds_read_b128 v[220:223], v15 offset:128
    v_mfma_f32_16x16x32_bf16 v[64:67], a[212:215], a[116:119], v[64:67]
    v_exp_f32 v38, v38
    v_mfma_f32_16x16x32_bf16 v[72:75], a[204:207], a[132:135], v[72:75]
    v_exp_f32 v39, v39
    v_mfma_f32_16x16x32_bf16 v[72:75], a[208:211], a[136:139], v[72:75]
    v_fma_f32 v0, v100, s35, v26
    v_fma_f32 v36, v101, s35, v26
    v_mfma_f32_16x16x32_bf16 v[72:75], a[212:215], a[140:143], v[72:75]
    ds_read_b128 v[224:227], v14 offset:256
    v_cvt_pk_bf16_f32 v57, v38, v39
    v_mfma_f32_16x16x32_bf16 v[80:83], a[204:207], a[156:159], v[80:83]
    v_exp_f32 v0, v0
    v_mfma_f32_16x16x32_bf16 v[80:83], a[208:211], a[160:163], v[80:83]
    v_exp_f32 v36, v36
    v_mfma_f32_16x16x32_bf16 v[80:83], a[212:215], a[164:167], v[80:83]
    v_fma_f32 v37, v102, s35, v26
    v_fma_f32 v38, v103, s35, v26
    v_mfma_f32_16x16x32_bf16 v[88:91], a[204:207], a[180:183], v[88:91]
    ds_read_b128 a[204:207], v3 offset:30848
    ds_read_b128 v[228:231], v15 offset:256
    v_mfma_f32_16x16x32_bf16 v[88:91], a[208:211], a[184:187], v[88:91]
    v_exp_f32 v37, v37
    v_mfma_f32_16x16x32_bf16 v[88:91], a[212:215], a[188:191], v[88:91]
    ds_read_b128 a[208:211], v2 offset:30976
    s_waitcnt lgkmcnt(5)
    v_mfma_f32_16x16x32_bf16 v[68:71], a[192:195], a[96:99], 0
    v_exp_f32 v38, v38
    v_mfma_f32_16x16x32_bf16 v[68:71], a[196:199], a[100:103], v[68:71]
    ds_read_b128 a[212:215], v3 offset:30976
    ds_read_b128 v[232:235], v14 offset:6144
    v_mfma_f32_16x16x32_bf16 v[68:71], a[200:203], a[104:107], v[68:71]
    v_cvt_pk_bf16_f32 v58, v0, v36
    v_fma_f32 v39, v104, s35, v27
    v_mfma_f32_16x16x32_bf16 v[76:79], a[192:195], a[120:123], 0
    v_exp_f32 v39, v39
    v_fma_f32 v0, v105, s35, v27
    v_mfma_f32_16x16x32_bf16 v[76:79], a[196:199], a[124:127], v[76:79]
    v_exp_f32 v0, v0
    v_mfma_f32_16x16x32_bf16 v[76:79], a[200:203], a[128:131], v[76:79]
    ds_read_b128 v[236:239], v15 offset:6144
    v_cvt_pk_bf16_f32 v59, v37, v38
    v_mfma_f32_16x16x32_bf16 v[84:87], a[192:195], a[144:147], 0
    v_fma_f32 v36, v106, s35, v27
    v_fma_f32 v37, v107, s35, v27
    v_mfma_f32_16x16x32_bf16 v[84:87], a[196:199], a[148:151], v[84:87]
    v_exp_f32 v36, v36
    v_mfma_f32_16x16x32_bf16 v[84:87], a[200:203], a[152:155], v[84:87]
    s_waitcnt lgkmcnt(2)
    v_cvt_pk_bf16_f32 v60, v39, v0
    v_mfma_f32_16x16x32_bf16 v[92:95], a[192:195], a[168:171], 0
    ds_read_b64_tr_b16 a[192:193], v4 offset:12288
    ds_read_b64_tr_b16 a[194:195], v4 offset:18432
    ds_read_b128 v[240:243], v14 offset:6272
    v_mfma_f32_16x16x32_bf16 v[92:95], a[196:199], a[172:175], v[92:95]
    v_exp_f32 v37, v37
    v_mfma_f32_16x16x32_bf16 v[92:95], a[200:203], a[176:179], v[92:95]
    ds_read_b64_tr_b16 a[196:197], v5 offset:12288
    ds_read_b64_tr_b16 a[198:199], v5 offset:18432
    v_mfma_f32_16x16x32_bf16 v[68:71], a[204:207], a[108:111], v[68:71]
    v_fma_f32 v38, v108, s35, v27
    v_fma_f32 v39, v109, s35, v27
    v_mfma_f32_16x16x32_bf16 v[68:71], a[208:211], a[112:115], v[68:71]
    ds_read_b64_tr_b16 a[200:201], v6 offset:12288
    ds_read_b64_tr_b16 a[202:203], v6 offset:18432
    ds_read_b128 v[244:247], v15 offset:6272
    v_mfma_f32_16x16x32_bf16 v[68:71], a[212:215], a[116:119], v[68:71]
    v_exp_f32 v38, v38
    v_mfma_f32_16x16x32_bf16 v[76:79], a[204:207], a[132:135], v[76:79]
    v_exp_f32 v39, v39
    v_mfma_f32_16x16x32_bf16 v[76:79], a[208:211], a[136:139], v[76:79]
    v_cvt_pk_bf16_f32 v61, v36, v37
    v_fma_f32 v0, v110, s35, v27
    v_mfma_f32_16x16x32_bf16 v[76:79], a[212:215], a[140:143], v[76:79]
    ds_read_b128 v[248:251], v14 offset:6400
    v_fma_f32 v36, v111, s35, v27
    v_mfma_f32_16x16x32_bf16 v[84:87], a[204:207], a[156:159], v[84:87]
    v_exp_f32 v0, v0
    v_mfma_f32_16x16x32_bf16 v[84:87], a[208:211], a[160:163], v[84:87]
    v_exp_f32 v36, v36
    v_mfma_f32_16x16x32_bf16 v[84:87], a[212:215], a[164:167], v[84:87]
    v_cvt_pk_bf16_f32 v62, v38, v39
    v_cvt_pk_bf16_f32 v63, v0, v36
    v_mfma_f32_16x16x32_bf16 v[92:95], a[204:207], a[180:183], v[92:95]
    ds_read_b64_tr_b16 a[204:205], v7 offset:12288
    ds_read_b64_tr_b16 a[206:207], v7 offset:18432
    ds_read_b128 v[252:255], v15 offset:6400
    v_mfma_f32_16x16x32_bf16 v[92:95], a[208:211], a[184:187], v[92:95]
    s_mov_b32 m0, s48
    v_fma_f32 v37, v64, s35, v24
    v_fma_f32 v38, v65, s35, v24
    v_mfma_f32_16x16x32_bf16 v[92:95], a[212:215], a[188:191], v[92:95]
    ds_read_b64_tr_b16 a[208:209], v4 offset:12416
    ds_read_b64_tr_b16 a[210:211], v4 offset:18560
    v_mfma_f32_16x16x32_bf16 v[28:31], a[248:251], v[56:59], 0
    buffer_load_dwordx4 v8, s[16:19], s63 offen nt lds
    v_mfma_f32_16x16x32_bf16 v[28:31], a[252:255], v[60:63], v[28:31]
    ds_read_b64_tr_b16 a[212:213], v5 offset:12416
    ds_read_b64_tr_b16 a[214:215], v5 offset:18560
    s_waitcnt lgkmcnt(9)
    v_mfma_f32_16x16x32_bf16 v[112:115], a[192:195], v[48:51], v[112:115]
    v_exp_f32 v37, v37
    v_mfma_f32_16x16x32_bf16 v[116:119], a[192:195], v[52:55], v[116:119]
    v_exp_f32 v38, v38
    v_mfma_f32_16x16x32_bf16 v[120:123], a[196:199], v[48:51], v[120:123]
    v_fma_f32 v39, v66, s35, v24
    v_cmp_nge_f32 vcc, s37, v30
    v_mfma_f32_16x16x32_bf16 v[124:127], a[196:199], v[52:55], v[124:127]
    v_exp_f32 v39, v39
    v_mfma_f32_16x16x32_bf16 v[128:131], a[200:203], v[48:51], v[128:131]
    v_fma_f32 v0, v67, s35, v24
    v_cvt_pk_bf16_f32 v40, v37, v38
    v_mfma_f32_16x16x32_bf16 v[132:135], a[200:203], v[52:55], v[132:135]
    s_cbranch_vccnz L_tr_T9_B
L_ret_T9_B:
    v_mfma_f32_16x16x32_bf16 a[0:3], a[192:195], v[56:59], a[0:3]
    v_add_f32 v21, v21, v28
    v_add_f32 v23, v23, v29
    v_mfma_f32_16x16x32_bf16 a[4:7], a[192:195], v[60:63], a[4:7]
    ds_read_b64_tr_b16 a[192:193], v6 offset:12416
    ds_read_b64_tr_b16 a[194:195], v6 offset:18560
    v_mfma_f32_16x16x32_bf16 a[8:11], a[196:199], v[56:59], a[8:11]
    buffer_load_dwordx4 v9, s[16:19], s63 offen offset:1024 nt lds
    v_mfma_f32_16x16x32_bf16 a[12:15], a[196:199], v[60:63], a[12:15]
    ds_read_b64_tr_b16 a[196:197], v7 offset:12416
    ds_read_b64_tr_b16 a[198:199], v7 offset:18560
    v_mfma_f32_16x16x32_bf16 a[16:19], a[200:203], v[56:59], a[16:19]
    s_waitcnt lgkmcnt(4)
    v_fma_f32 v36, v72, s35, v25
    v_mfma_f32_16x16x32_bf16 a[20:23], a[200:203], v[60:63], a[20:23]
    ds_read_b64_tr_b16 a[200:201], v4 offset:12544
    ds_read_b64_tr_b16 a[202:203], v4 offset:18688
    v_mfma_f32_16x16x32_bf16 v[136:139], a[204:207], v[48:51], v[136:139]
    v_exp_f32 v0, v0
    v_mfma_f32_16x16x32_bf16 v[140:143], a[204:207], v[52:55], v[140:143]
    v_exp_f32 v36, v36
    v_mfma_f32_16x16x32_bf16 a[24:27], a[204:207], v[56:59], a[24:27]
    v_fma_f32 v37, v73, s35, v25
    v_cvt_pk_bf16_f32 v41, v39, v0
    v_mfma_f32_16x16x32_bf16 a[28:31], a[204:207], v[60:63], a[28:31]
    ds_read_b64_tr_b16 a[204:205], v5 offset:12544
    ds_read_b64_tr_b16 a[206:207], v5 offset:18688
    v_mfma_f32_16x16x32_bf16 v[144:147], a[208:211], v[48:51], v[144:147]
    buffer_load_dwordx4 v10, s[16:19], s63 offen offset:2048 nt lds
    v_mfma_f32_16x16x32_bf16 v[148:151], a[208:211], v[52:55], v[148:151]
    v_exp_f32 v37, v37
    v_mfma_f32_16x16x32_bf16 a[32:35], a[208:211], v[56:59], a[32:35]
    v_fma_f32 v38, v74, s35, v25
    v_fma_f32 v39, v75, s35, v25
    v_mfma_f32_16x16x32_bf16 a[36:39], a[208:211], v[60:63], a[36:39]
    ds_read_b64_tr_b16 a[208:209], v6 offset:12544
    ds_read_b64_tr_b16 a[210:211], v6 offset:18688
    v_mfma_f32_16x16x32_bf16 v[152:155], a[212:215], v[48:51], v[152:155]
    v_exp_f32 v38, v38
    v_mfma_f32_16x16x32_bf16 v[156:159], a[212:215], v[52:55], v[156:159]
    s_mov_b32 m0, s88
    v_cvt_pk_bf16_f32 v44, v36, v37
    v_mfma_f32_16x16x32_bf16 a[40:43], a[212:215], v[56:59], a[40:43]
    s_waitcnt lgkmcnt(4)
    v_fma_f32 v0, v68, s35, v24
    v_mfma_f32_16x16x32_bf16 a[44:47], a[212:215], v[60:63], a[44:47]
    ds_read_b64_tr_b16 a[212:213], v7 offset:12544
    ds_read_b64_tr_b16 a[214:215], v7 offset:18688
    v_mfma_f32_16x16x32_bf16 v[160:163], a[192:195], v[48:51], v[160:163]
    buffer_load_dwordx4 v8, s[20:23], s84 offen nt lds
    v_mfma_f32_16x16x32_bf16 v[164:167], a[192:195], v[52:55], v[164:167]
    v_exp_f32 v39, v39
    v_mfma_f32_16x16x32_bf16 a[48:51], a[192:195], v[56:59], a[48:51]
    v_exp_f32 v0, v0
    v_mfma_f32_16x16x32_bf16 a[52:55], a[192:195], v[60:63], a[52:55]
    ds_read_b128 a[192:195], v2 offset:36864
    v_fma_f32 v36, v69, s35, v24
    v_mfma_f32_16x16x32_bf16 v[168:171], a[196:199], v[48:51], v[168:171]
    v_exp_f32 v36, v36
    v_mfma_f32_16x16x32_bf16 v[172:175], a[196:199], v[52:55], v[172:175]
    v_cvt_pk_bf16_f32 v45, v38, v39
    v_fma_f32 v37, v70, s35, v24
    v_mfma_f32_16x16x32_bf16 a[56:59], a[196:199], v[56:59], a[56:59]
    v_exp_f32 v37, v37
    v_mfma_f32_16x16x32_bf16 a[60:63], a[196:199], v[60:63], a[60:63]
    ds_read_b128 a[196:199], v3 offset:36864
    v_fma_f32 v38, v71, s35, v24
    v_mfma_f32_16x16x32_bf16 v[176:179], a[200:203], v[48:51], v[176:179]
    buffer_load_dwordx4 v9, s[20:23], s84 offen offset:1024 nt lds
    v_mfma_f32_16x16x32_bf16 v[180:183], a[200:203], v[52:55], v[180:183]
    v_exp_f32 v38, v38
    v_mfma_f32_16x16x32_bf16 a[64:67], a[200:203], v[56:59], a[64:67]
    v_cvt_pk_bf16_f32 v42, v0, v36
    v_fma_f32 v39, v76, s35, v25
    v_mfma_f32_16x16x32_bf16 a[68:71], a[200:203], v[60:63], a[68:71]
    ds_read_b128 a[200:203], v2 offset:36992
    s_waitcnt lgkmcnt(3)
    v_mfma_f32_16x16x32_bf16 v[184:187], a[204:207], v[48:51], v[184:187]
    v_exp_f32 v39, v39
    v_mfma_f32_16x16x32_bf16 v[188:191], a[204:207], v[52:55], v[188:191]
    v_fma_f32 v0, v77, s35, v25
    v_cvt_pk_bf16_f32 v43, v37, v38
    v_mfma_f32_16x16x32_bf16 a[72:75], a[204:207], v[56:59], a[72:75]
    v_exp_f32 v0, v0
    v_mfma_f32_16x16x32_bf16 a[76:79], a[204:207], v[60:63], a[76:79]
    ds_read_b128 a[204:207], v3 offset:36992
    v_fma_f32 v36, v78, s35, v25
    v_mfma_f32_16x16x32_bf16 v[192:195], a[208:211], v[48:51], v[192:195]
    buffer_load_dwordx4 v10, s[20:23], s84 offen offset:2048 nt lds
    v_mfma_f32_16x16x32_bf16 v[196:199], a[208:211], v[52:55], v[196:199]
    v_exp_f32 v36, v36
    v_mfma_f32_16x16x32_bf16 a[80:83], a[208:211], v[56:59], a[80:83]
    v_fma_f32 v37, v79, s35, v25
    v_mfma_f32_16x16x32_bf16 a[84:87], a[208:211], v[60:63], a[84:87]
    ds_read_b128 a[208:211], v2 offset:37120
    v_cvt_pk_bf16_f32 v46, v39, v0
    v_mfma_f32_16x16x32_bf16 v[200:203], a[212:215], v[48:51], v[200:203]
    v_exp_f32 v37, v37
    v_mfma_f32_16x16x32_bf16 v[204:207], a[212:215], v[52:55], v[204:207]
    v_cvt_pk_bf16_f32 v47, v36, v37
    v_mfma_f32_16x16x32_bf16 a[88:91], a[212:215], v[56:59], a[88:91]
    v_mfma_f32_16x16x32_bf16 a[92:95], a[212:215], v[60:63], a[92:95]
    ds_read_b128 a[212:215], v3 offset:37120
    v_mfma_f32_16x16x32_bf16 v[28:31], a[248:251], v[40:43], 0
    s_waitcnt vmcnt(16)
    s_barrier
    v_mfma_f32_16x16x32_bf16 v[28:31], a[252:255], v[44:47], v[28:31]
    s_waitcnt lgkmcnt(3)
L_join:
L_hop_9:
    s_cbranch_execz L_hop_13
    v_mfma_f32_16x16x32_bf16 v[96:99], a[192:195], a[144:147], 0
    v_fma_f32 v36, v80, s35, v26
    v_fma_f32 v37, v81, s35, v26
    v_mfma_f32_16x16x32_bf16 v[96:99], a[196:199], a[148:151], v[96:99]
    v_exp_f32 v36, v36
    v_mfma_f32_16x16x32_bf16 v[96:99], a[200:203], a[152:155], v[96:99]
    s_mov_b32 m0, s44
    v_cmp_nge_f32 vcc, s37, v30
    v_mfma_f32_16x16x32_bf16 v[104:107], a[192:195], a[168:171], 0
    v_exp_f32 v37, v37
    v_mfma_f32_16x16x32_bf16 v[104:107], a[196:199], a[172:175], v[104:107]
    buffer_load_dwordx4 v8, s[12:15], s65 offen nt lds
    v_mfma_f32_16x16x32_bf16 v[104:107], a[200:203], a[176:179], v[104:107]
    v_fma_f32 v38, v82, s35, v26
    s_cbranch_vccnz L_tr_T10_A
L_ret_T10_A:
    v_mfma_f32_16x16x32_bf16 v[64:67], a[192:195], a[96:99], 0
    v_add_f32 v17, v17, v28
    v_add_f32 v19, v19, v29
    v_mfma_f32_16x16x32_bf16 v[64:67], a[196:199], a[100:103], v[64:67]
    v_exp_f32 v38, v38
    v_mfma_f32_16x16x32_bf16 v[64:67], a[200:203], a[104:107], v[64:67]
    buffer_load_dwordx4 v9, s[12:15], s65 offen offset:1024 nt lds
    v_mfma_f32_16x16x32_bf16 v[72:75], a[192:195], a[120:123], 0
    ds_read_b128 a[192:195], v2 offset:43008
    v_fma_f32 v39, v83, s35, v26
    v_mfma_f32_16x16x32_bf16 v[72:75], a[196:199], a[124:127], v[72:75]
    v_exp_f32 v39, v39
    v_mfma_f32_16x16x32_bf16 v[72:75], a[200:203], a[128:131], v[72:75]
    ds_read_b128 a[196:199], v3 offset:43008
    s_waitcnt lgkmcnt(2)
    v_mfma_f32_16x16x32_bf16 v[64:67], a[204:207], a[108:111], v[64:67]
    buffer_load_dwordx4 v10, s[12:15], s65 offen offset:2048 nt lds
    v_mfma_f32_16x16x32_bf16 v[64:67], a[208:211], a[112:115], v[64:67]
    ds_read_b128 a[200:203], v2 offset:43136
    v_cvt_pk_bf16_f32 v56, v36, v37
    v_mfma_f32_16x16x32_bf16 v[64:67], a[212:215], a[116:119], v[64:67]
    v_fma_f32 v0, v84, s35, v26
    v_fma_f32 v36, v85, s35, v26
    v_mfma_f32_16x16x32_bf16 v[72:75], a[204:207], a[132:135], v[72:75]
    v_exp_f32 v0, v0
    v_mfma_f32_16x16x32_bf16 v[72:75], a[208:211], a[136:139], v[72:75]
    v_exp_f32 v36, v36
    v_mfma_f32_16x16x32_bf16 v[72:75], a[212:215], a[140:143], v[72:75]
    v_cvt_pk_bf16_f32 v57, v38, v39
    v_fma_f32 v37, v86, s35, v26
    v_mfma_f32_16x16x32_bf16 v[96:99], a[204:207], a[156:159], v[96:99]
    v_exp_f32 v37, v37
    v_mfma_f32_16x16x32_bf16 v[96:99], a[208:211], a[160:163], v[96:99]
    v_fma_f32 v38, v87, s35, v26
    v_cvt_pk_bf16_f32 v58, v0, v36
    v_mfma_f32_16x16x32_bf16 v[96:99], a[212:215], a[164:167], v[96:99]
    v_exp_f32 v38, v38
    v_mfma_f32_16x16x32_bf16 v[104:107], a[204:207], a[180:183], v[104:107]
    ds_read_b128 a[204:207], v3 offset:43136
    v_fma_f32 v39, v88, s35, v27
    v_mfma_f32_16x16x32_bf16 v[104:107], a[208:211], a[184:187], v[104:107]
    v_exp_f32 v39, v39
    v_mfma_f32_16x16x32_bf16 v[104:107], a[212:215], a[188:191], v[104:107]
    ds_read_b128 a[208:211], v2 offset:43264
    s_waitcnt lgkmcnt(2)
    v_mfma_f32_16x16x32_bf16 v[68:71], a[192:195], a[96:99], 0
    v_fma_f32 v0, v89, s35, v27
    v_cvt_pk_bf16_f32 v59, v37, v38
    v_mfma_f32_16x16x32_bf16 v[68:71], a[196:199], a[100:103], v[68:71]
    ds_read_b128 a[212:215], v3 offset:43264
    v_fma_f32 v36, v90, s35, v27
    v_mfma_f32_16x16x32_bf16 v[68:71], a[200:203], a[104:107], v[68:71]
    v_exp_f32 v0, v0
    v_mfma_f32_16x16x32_bf16 v[76:79], a[192:195], a[120:123], 0
    v_exp_f32 v36, v36
    v_mfma_f32_16x16x32_bf16 v[76:79], a[196:199], a[124:127], v[76:79]
    v_fma_f32 v37, v91, s35, v27
    v_cvt_pk_bf16_f32 v60, v39, v0
    v_mfma_f32_16x16x32_bf16 v[76:79], a[200:203], a[128:131], v[76:79]
    v_exp_f32 v37, v37
    v_mfma_f32_16x16x32_bf16 v[100:103], a[192:195], a[144:147], 0
    v_fma_f32 v38, v92, s35, v27
    v_mfma_f32_16x16x32_bf16 v[100:103], a[196:199], a[148:151], v[100:103]
    v_exp_f32 v38, v38
    v_mfma_f32_16x16x32_bf16 v[100:103], a[200:203], a[152:155], v[100:103]
    s_waitcnt lgkmcnt(0)
    v_fma_f32 v39, v93, s35, v27
    v_mfma_f32_16x16x32_bf16 v[108:111], a[192:195], a[168:171], 0
    ds_read_b64_tr_b16 a[192:193], v4 offset:24576
    ds_read_b64_tr_b16 a[194:195], v4 offset:30720
    v_mfma_f32_16x16x32_bf16 v[108:111], a[196:199], a[172:175], v[108:111]
    v_exp_f32 v39, v39
    v_mfma_f32_16x16x32_bf16 v[108:111], a[200:203], a[176:179], v[108:111]
L_hop_10:
    s_cbranch_execz L_hop_14
    ds_read_b64_tr_b16 a[196:197], v5 offset:24576
    ds_read_b64_tr_b16 a[198:199], v5 offset:30720
    v_mfma_f32_16x16x32_bf16 v[68:71], a[204:207], a[108:111], v[68:71]
    v_cvt_pk_bf16_f32 v61, v36, v37
    v_mfma_f32_16x16x32_bf16 v[68:71], a[208:211], a[112:115], v[68:71]
    ds_read_b64_tr_b16 a[200:201], v6 offset:24576
    ds_read_b64_tr_b16 a[202:203], v6 offset:30720
    v_mfma_f32_16x16x32_bf16 v[68:71], a[212:215], a[116:119], v[68:71]
    v_fma_f32 v0, v94, s35, v27
    v_fma_f32 v36, v95, s35, v27
    v_mfma_f32_16x16x32_bf16 v[76:79], a[204:207], a[132:135], v[76:79]
    v_exp_f32 v0, v0
    v_mfma_f32_16x16x32_bf16 v[76:79], a[208:211], a[136:139], v[76:79]
    v_exp_f32 v36, v36
    v_mfma_f32_16x16x32_bf16 v[76:79], a[212:215], a[140:143], v[76:79]
    v_cvt_pk_bf16_f32 v62, v38, v39
    v_mfma_f32_16x16x32_bf16 v[100:103], a[204:207], a[156:159], v[100:103]
    v_cvt_pk_bf16_f32 v63, v0, v36
    v_fma_f32 v37, v64, s35, v24
    v_mfma_f32_16x16x32_bf16 v[100:103], a[208:211], a[160:163], v[100:103]
    v_exp_f32 v37, v37
    v_mfma_f32_16x16x32_bf16 v[100:103], a[212:215], a[164:167], v[100:103]
    v_fma_f32 v38, v65, s35, v24
    v_mfma_f32_16x16x32_bf16 v[108:111], a[204:207], a[180:183], v[108:111]
    ds_read_b64_tr_b16 a[204:205], v7 offset:24576
    ds_read_b64_tr_b16 a[206:207], v7 offset:30720
    v_mfma_f32_16x16x32_bf16 v[108:111], a[208:211], a[184:187], v[108:111]
    s_mov_b32 m0, s49
    v_fma_f32 v39, v66, s35, v24
    v_mfma_f32_16x16x32_bf16 v[108:111], a[212:215], a[188:191], v[108:111]
    ds_read_b64_tr_b16 a[208:209], v4 offset:24704
    ds_read_b64_tr_b16 a[210:211], v4 offset:30848
    v_mfma_f32_16x16x32_bf16 v[28:31], a[248:251], v[56:59], 0
    buffer_load_dwordx4 v8, s[16:19], s64 offen nt lds
    v_mfma_f32_16x16x32_bf16 v[28:31], a[252:255], v[60:63], v[28:31]
    ds_read_b64_tr_b16 a[212:213], v5 offset:24704
    ds_read_b64_tr_b16 a[214:215], v5 offset:30848
    s_waitcnt lgkmcnt(6)
    v_mfma_f32_16x16x32_bf16 v[112:115], a[192:195], v[40:43], v[112:115]
    v_exp_f32 v38, v38
    v_mfma_f32_16x16x32_bf16 v[116:119], a[192:195], v[44:47], v[116:119]
    v_exp_f32 v39, v39
    v_mfma_f32_16x16x32_bf16 v[120:123], a[196:199], v[40:43], v[120:123]
    v_fma_f32 v0, v67, s35, v24
    v_cmp_nge_f32 vcc, s37, v30
    v_mfma_f32_16x16x32_bf16 v[124:127], a[196:199], v[44:47], v[124:127]
    v_exp_f32 v0, v0
    v_mfma_f32_16x16x32_bf16 v[128:131], a[200:203], v[40:43], v[128:131]
    v_cvt_pk_bf16_f32 v48, v37, v38
    v_mfma_f32_16x16x32_bf16 v[132:135], a[200:203], v[44:47], v[132:135]
    v_fma_f32 v36, v72, s35, v25
    s_cbranch_vccnz L_tr_T10_B
L_ret_T10_B:
    v_mfma_f32_16x16x32_bf16 a[0:3], a[192:195], v[56:59], a[0:3]
    v_add_f32 v21, v21, v28
    v_add_f32 v23, v23, v29
    v_mfma_f32_16x16x32_bf16 a[4:7], a[192:195], v[60:63], a[4:7]
    ds_read_b64_tr_b16 a[192:193], v6 offset:24704
    ds_read_b64_tr_b16 a[194:195], v6 offset:30848
    v_mfma_f32_16x16x32_bf16 a[8:11], a[196:199], v[56:59], a[8:11]
    buffer_load_dwordx4 v9, s[16:19], s64 offen offset:1024 nt lds
    v_mfma_f32_16x16x32_bf16 a[12:15], a[196:199], v[60:63], a[12:15]
    ds_read_b64_tr_b16 a[196:197], v7 offset:24704
    ds_read_b64_tr_b16 a[198:199], v7 offset:30848
    v_mfma_f32_16x16x32_bf16 a[16:19], a[200:203], v[56:59], a[16:19]
    s_waitcnt lgkmcnt(4)
    v_fma_f32 v37, v73, s35, v25
    v_mfma_f32_16x16x32_bf16 a[20:23], a[200:203], v[60:63], a[20:23]
    ds_read_b64_tr_b16 a[200:201], v4 offset:24832
    ds_read_b64_tr_b16 a[202:203], v4 offset:30976
    v_mfma_f32_16x16x32_bf16 v[136:139], a[204:207], v[40:43], v[136:139]
    v_exp_f32 v36, v36
    v_mfma_f32_16x16x32_bf16 v[140:143], a[204:207], v[44:47], v[140:143]
    v_exp_f32 v37, v37
    v_mfma_f32_16x16x32_bf16 a[24:27], a[204:207], v[56:59], a[24:27]
    v_cvt_pk_bf16_f32 v49, v39, v0
    v_fma_f32 v38, v74, s35, v25
    v_mfma_f32_16x16x32_bf16 a[28:31], a[204:207], v[60:63], a[28:31]
    ds_read_b64_tr_b16 a[204:205], v5 offset:24832
    ds_read_b64_tr_b16 a[206:207], v5 offset:30976
    v_mfma_f32_16x16x32_bf16 v[144:147], a[208:211], v[40:43], v[144:147]
    buffer_load_dwordx4 v10, s[16:19], s64 offen offset:2048 nt lds
    v_mfma_f32_16x16x32_bf16 v[148:151], a[208:211], v[44:47], v[148:151]
    v_exp_f32 v38, v38
    v_mfma_f32_16x16x32_bf16 a[32:35], a[208:211], v[56:59], a[32:35]
    v_fma_f32 v39, v75, s35, v25
    v_cvt_pk_bf16_f32 v52, v36, v37
    v_mfma_f32_16x16x32_bf16 a[36:39], a[208:211], v[60:63], a[36:39]
    ds_read_b64_tr_b16 a[208:209], v6 offset:24832
    ds_read_b64_tr_b16 a[210:211], v6 offset:30976
    v_mfma_f32_16x16x32_bf16 v[152:155], a[212:215], v[40:43], v[152:155]
    v_exp_f32 v39, v39
    v_mfma_f32_16x16x32_bf16 v[156:159], a[212:215], v[44:47], v[156:159]
    s_mov_b32 m0, s89
    v_fma_f32 v0, v68, s35, v24
    v_mfma_f32_16x16x32_bf16 a[40:43], a[212:215], v[56:59], a[40:43]
    s_waitcnt lgkmcnt(4)
    v_fma_f32 v36, v69, s35, v24
    v_mfma_f32_16x16x32_bf16 a[44:47], a[212:215], v[60:63], a[44:47]
    ds_read_b64_tr_b16 a[212:213], v7 offset:24832
    ds_read_b64_tr_b16 a[214:215], v7 offset:30976
    v_mfma_f32_16x16x32_bf16 v[160:163], a[192:195], v[40:43], v[160:163]
    buffer_load_dwordx4 v8, s[20:23], s85 offen nt lds
    v_mfma_f32_16x16x32_bf16 v[164:167], a[192:195], v[44:47], v[164:167]
    v_exp_f32 v0, v0
    v_mfma_f32_16x16x32_bf16 a[48:51], a[192:195], v[56:59], a[48:51]
    v_exp_f32 v36, v36
    v_mfma_f32_16x16x32_bf16 a[52:55], a[192:195], v[60:63], a[52:55]
    ds_read_b128 a[192:195], v2 offset:0
    v_mfma_f32_16x16x32_bf16 v[168:171], a[196:199], v[40:43], v[168:171]
    v_cvt_pk_bf16_f32 v53, v38, v39
    v_fma_f32 v37, v70, s35, v24
    v_mfma_f32_16x16x32_bf16 v[172:175], a[196:199], v[44:47], v[172:175]
    v_exp_f32 v37, v37
    v_mfma_f32_16x16x32_bf16 a[56:59], a[196:199], v[56:59], a[56:59]
    v_fma_f32 v38, v71, s35, v24
    v_cvt_pk_bf16_f32 v50, v0, v36
    v_mfma_f32_16x16x32_bf16 a[60:63], a[196:199], v[60:63], a[60:63]
    ds_read_b128 a[196:199], v3 offset:0
    v_mfma_f32_16x16x32_bf16 v[176:179], a[200:203], v[40:43], v[176:179]
    buffer_load_dwordx4 v9, s[20:23], s85 offen offset:1024 nt lds
    v_mfma_f32_16x16x32_bf16 v[180:183], a[200:203], v[44:47], v[180:183]
    v_exp_f32 v38, v38
    v_mfma_f32_16x16x32_bf16 a[64:67], a[200:203], v[56:59], a[64:67]
    v_fma_f32 v39, v76, s35, v25
    v_fma_f32 v0, v77, s35, v25
    v_mfma_f32_16x16x32_bf16 a[68:71], a[200:203], v[60:63], a[68:71]
    ds_read_b128 a[200:203], v2 offset:128
    s_waitcnt lgkmcnt(3)
    v_mfma_f32_16x16x32_bf16 v[184:187], a[204:207], v[40:43], v[184:187]
    v_exp_f32 v39, v39
    v_mfma_f32_16x16x32_bf16 v[188:191], a[204:207], v[44:47], v[188:191]
    v_exp_f32 v0, v0
    v_mfma_f32_16x16x32_bf16 a[72:75], a[204:207], v[56:59], a[72:75]
    v_cvt_pk_bf16_f32 v51, v37, v38
    v_mfma_f32_16x16x32_bf16 a[76:79], a[204:207], v[60:63], a[76:79]
    ds_read_b128 a[204:207], v3 offset:128
    v_fma_f32 v36, v78, s35, v25
    v_mfma_f32_16x16x32_bf16 v[192:195], a[208:211], v[40:43], v[192:195]
    buffer_load_dwordx4 v10, s[20:23], s85 offen offset:2048 nt lds
    v_mfma_f32_16x16x32_bf16 v[196:199], a[208:211], v[44:47], v[196:199]
    v_exp_f32 v36, v36
    v_mfma_f32_16x16x32_bf16 a[80:83], a[208:211], v[56:59], a[80:83]
    v_fma_f32 v37, v79, s35, v25
    v_cvt_pk_bf16_f32 v54, v39, v0
    v_mfma_f32_16x16x32_bf16 a[84:87], a[208:211], v[60:63], a[84:87]
    ds_read_b128 a[208:211], v2 offset:256
    v_mfma_f32_16x16x32_bf16 v[200:203], a[212:215], v[40:43], v[200:203]
    v_exp_f32 v37, v37
    v_mfma_f32_16x16x32_bf16 v[204:207], a[212:215], v[44:47], v[204:207]
    v_cvt_pk_bf16_f32 v55, v36, v37
    v_mfma_f32_16x16x32_bf16 a[88:91], a[212:215], v[56:59], a[88:91]
    v_mfma_f32_16x16x32_bf16 a[92:95], a[212:215], v[60:63], a[92:95]
    ds_read_b128 a[212:215], v3 offset:256
    v_mfma_f32_16x16x32_bf16 v[28:31], a[248:251], v[48:51], 0
    s_waitcnt vmcnt(15)
    s_barrier
    v_mfma_f32_16x16x32_bf16 v[28:31], a[252:255], v[52:55], v[28:31]
    s_waitcnt lgkmcnt(3)
    v_mfma_f32_16x16x32_bf16 v[80:83], a[192:195], a[144:147], 0
    v_fma_f32 v36, v96, s35, v26
    v_fma_f32 v37, v97, s35, v26
    v_mfma_f32_16x16x32_bf16 v[80:83], a[196:199], a[148:151], v[80:83]
    v_exp_f32 v36, v36
    v_mfma_f32_16x16x32_bf16 v[80:83], a[200:203], a[152:155], v[80:83]
    s_mov_b32 m0, s45
    v_cmp_nge_f32 vcc, s37, v30
    v_mfma_f32_16x16x32_bf16 v[88:91], a[192:195], a[168:171], 0
    v_exp_f32 v37, v37
    v_mfma_f32_16x16x32_bf16 v[88:91], a[196:199], a[172:175], v[88:91]
    buffer_load_dwordx4 v8, s[12:15], s66 offen nt lds
    v_mfma_f32_16x16x32_bf16 v[88:91], a[200:203], a[176:179], v[88:91]
    v_fma_f32 v38, v98, s35, v26
    s_cbranch_vccnz L_tr_T11_A
L_ret_T11_A:
    v_mfma_f32_16x16x32_bf16 v[64:67], a[192:195], a[96:99], 0
    v_add_f32 v17, v17, v28
    v_add_f32 v19, v19, v29
    v_mfma_f32_16x16x32_bf16 v[64:67], a[196:199], a[100:103], v[64:67]
    v_exp_f32 v38, v38
    v_mfma_f32_16x16x32_bf16 v[64:67], a[200:203], a[104:107], v[64:67]
    buffer_load_dwordx4 v9, s[12:15], s66 offen offset:1024 nt lds
    v_mfma_f32_16x16x32_bf16 v[72:75], a[192:195], a[120:123], 0
    ds_read_b128 a[192:195], v2 offset:6144
    v_fma_f32 v39, v99, s35, v26
    v_mfma_f32_16x16x32_bf16 v[72:75], a[196:199], a[124:127], v[72:75]
    v_exp_f32 v39, v39
    v_mfma_f32_16x16x32_bf16 v[72:75], a[200:203], a[128:131], v[72:75]
    ds_read_b128 a[196:199], v3 offset:6144
    s_waitcnt lgkmcnt(2)
    v_mfma_f32_16x16x32_bf16 v[64:67], a[204:207], a[108:111], v[64:67]
    buffer_load_dwordx4 v10, s[12:15], s66 offen offset:2048 nt lds
    v_mfma_f32_16x16x32_bf16 v[64:67], a[208:211], a[112:115], v[64:67]
    ds_read_b128 a[200:203], v2 offset:6272
    v_cvt_pk_bf16_f32 v56, v36, v37
    v_mfma_f32_16x16x32_bf16 v[64:67], a[212:215], a[116:119], v[64:67]
    v_fma_f32 v0, v100, s35, v26
    v_fma_f32 v36, v101, s35, v26
    v_mfma_f32_16x16x32_bf16 v[72:75], a[204:207], a[132:135], v[72:75]
    v_exp_f32 v0, v0
    v_mfma_f32_16x16x32_bf16 v[72:75], a[208:211], a[136:139], v[72:75]
    v_exp_f32 v36, v36
    v_mfma_f32_16x16x32_bf16 v[72:75], a[212:215], a[140:143], v[72:75]
    s_add_u32 s12, s6, s30
    v_cvt_pk_bf16_f32 v57, v38, v39
    v_mfma_f32_16x16x32_bf16 v[80:83], a[204:207], a[156:159], v[80:83]
    v_fma_f32 v37, v102, s35, v26
    v_fma_f32 v38, v103, s35, v26
    v_mfma_f32_16x16x32_bf16 v[80:83], a[208:211], a[160:163], v[80:83]
    v_exp_f32 v37, v37
    v_mfma_f32_16x16x32_bf16 v[80:83], a[212:215], a[164:167], v[80:83]
    v_exp_f32 v38, v38
    v_mfma_f32_16x16x32_bf16 v[88:91], a[204:207], a[180:183], v[88:91]
    ds_read_b128 a[204:207], v3 offset:6272
    v_cvt_pk_bf16_f32 v58, v0, v36
    v_mfma_f32_16x16x32_bf16 v[88:91], a[208:211], a[184:187], v[88:91]
    v_fma_f32 v39, v104, s35, v27
    v_fma_f32 v0, v105, s35, v27
    v_mfma_f32_16x16x32_bf16 v[88:91], a[212:215], a[188:191], v[88:91]
    ds_read_b128 a[208:211], v2 offset:6400
    s_waitcnt lgkmcnt(2)
    v_mfma_f32_16x16x32_bf16 v[68:71], a[192:195], a[96:99], 0
    v_exp_f32 v39, v39
    v_mfma_f32_16x16x32_bf16 v[68:71], a[196:199], a[100:103], v[68:71]
    ds_read_b128 a[212:215], v3 offset:6400
    v_cvt_pk_bf16_f32 v59, v37, v38
    v_mfma_f32_16x16x32_bf16 v[68:71], a[200:203], a[104:107], v[68:71]
    v_exp_f32 v0, v0
    v_mfma_f32_16x16x32_bf16 v[76:79], a[192:195], a[120:123], 0
    v_fma_f32 v36, v106, s35, v27
    v_fma_f32 v37, v107, s35, v27
    v_mfma_f32_16x16x32_bf16 v[76:79], a[196:199], a[124:127], v[76:79]
    v_exp_f32 v36, v36
    v_mfma_f32_16x16x32_bf16 v[76:79], a[200:203], a[128:131], v[76:79]
    v_exp_f32 v37, v37
    v_mfma_f32_16x16x32_bf16 v[84:87], a[192:195], a[144:147], 0
    v_cvt_pk_bf16_f32 v60, v39, v0
    v_fma_f32 v38, v108, s35, v27
    v_mfma_f32_16x16x32_bf16 v[84:87], a[196:199], a[148:151], v[84:87]
    v_exp_f32 v38, v38
    v_mfma_f32_16x16x32_bf16 v[84:87], a[200:203], a[152:155], v[84:87]
    s_waitcnt lgkmcnt(0)
    s_addc_u32 s13, s7, 0
    v_mfma_f32_16x16x32_bf16 v[92:95], a[192:195], a[168:171], 0
    ds_read_b64_tr_b16 a[192:193], v4 offset:36864
    ds_read_b64_tr_b16 a[194:195], v4 offset:43008
    v_mfma_f32_16x16x32_bf16 v[92:95], a[196:199], a[172:175], v[92:95]
    v_fma_f32 v39, v109, s35, v27
    v_cvt_pk_bf16_f32 v61, v36, v37
    v_mfma_f32_16x16x32_bf16 v[92:95], a[200:203], a[176:179], v[92:95]
    ds_read_b64_tr_b16 a[196:197], v5 offset:36864
    ds_read_b64_tr_b16 a[198:199], v5 offset:43008
    v_mfma_f32_16x16x32_bf16 v[68:71], a[204:207], a[108:111], v[68:71]
    v_exp_f32 v39, v39
    v_mfma_f32_16x16x32_bf16 v[68:71], a[208:211], a[112:115], v[68:71]
    ds_read_b64_tr_b16 a[200:201], v6 offset:36864
    ds_read_b64_tr_b16 a[202:203], v6 offset:43008
    v_mfma_f32_16x16x32_bf16 v[68:71], a[212:215], a[116:119], v[68:71]
    v_fma_f32 v0, v110, s35, v27
    v_mfma_f32_16x16x32_bf16 v[76:79], a[204:207], a[132:135], v[76:79]
    v_exp_f32 v0, v0
    v_mfma_f32_16x16x32_bf16 v[76:79], a[208:211], a[136:139], v[76:79]
    v_fma_f32 v36, v111, s35, v27
    v_cvt_pk_bf16_f32 v62, v38, v39
    v_mfma_f32_16x16x32_bf16 v[76:79], a[212:215], a[140:143], v[76:79]
    v_exp_f32 v36, v36
    v_mfma_f32_16x16x32_bf16 v[84:87], a[204:207], a[156:159], v[84:87]
    v_cvt_pk_bf16_f32 v63, v0, v36
    v_mfma_f32_16x16x32_bf16 v[84:87], a[208:211], a[160:163], v[84:87]
    v_fma_f32 v37, v64, s35, v24
    v_fma_f32 v38, v65, s35, v24
    v_mfma_f32_16x16x32_bf16 v[84:87], a[212:215], a[164:167], v[84:87]
    v_exp_f32 v37, v37
    v_mfma_f32_16x16x32_bf16 v[92:95], a[204:207], a[180:183], v[92:95]
    ds_read_b64_tr_b16 a[204:205], v7 offset:36864
    ds_read_b64_tr_b16 a[206:207], v7 offset:43008
    v_mfma_f32_16x16x32_bf16 v[92:95], a[208:211], a[184:187], v[92:95]
    s_mov_b32 m0, s50
    v_mfma_f32_16x16x32_bf16 v[92:95], a[212:215], a[188:191], v[92:95]
    ds_read_b64_tr_b16 a[208:209], v4 offset:36992
    ds_read_b64_tr_b16 a[210:211], v4 offset:43136
    v_mfma_f32_16x16x32_bf16 v[28:31], a[248:251], v[56:59], 0
    buffer_load_dwordx4 v8, s[16:19], s65 offen nt lds
    v_mfma_f32_16x16x32_bf16 v[28:31], a[252:255], v[60:63], v[28:31]
    ds_read_b64_tr_b16 a[212:213], v5 offset:36992
    ds_read_b64_tr_b16 a[214:215], v5 offset:43136
    s_waitcnt lgkmcnt(6)
    v_mfma_f32_16x16x32_bf16 v[112:115], a[192:195], v[48:51], v[112:115]
    v_exp_f32 v38, v38
    v_mfma_f32_16x16x32_bf16 v[116:119], a[192:195], v[52:55], v[116:119]
    v_fma_f32 v39, v66, s35, v24
    v_fma_f32 v0, v67, s35, v24
    v_mfma_f32_16x16x32_bf16 v[120:123], a[196:199], v[48:51], v[120:123]
    v_cvt_pk_bf16_f32 v40, v37, v38
    v_cmp_nge_f32 vcc, s37, v30
    v_mfma_f32_16x16x32_bf16 v[124:127], a[196:199], v[52:55], v[124:127]
    v_exp_f32 v39, v39
    v_mfma_f32_16x16x32_bf16 v[128:131], a[200:203], v[48:51], v[128:131]
    v_exp_f32 v0, v0
    v_mfma_f32_16x16x32_bf16 v[132:135], a[200:203], v[52:55], v[132:135]
    v_fma_f32 v36, v72, s35, v25
    s_cbranch_vccnz L_tr_T11_B
L_ret_T11_B:
    v_mfma_f32_16x16x32_bf16 a[0:3], a[192:195], v[56:59], a[0:3]
    v_exp_f32 v36, v36
    v_mfma_f32_16x16x32_bf16 a[4:7], a[192:195], v[60:63], a[4:7]
    ds_read_b64_tr_b16 a[192:193], v6 offset:36992
    ds_read_b64_tr_b16 a[194:195], v6 offset:43136
    v_mfma_f32_16x16x32_bf16 a[8:11], a[196:199], v[56:59], a[8:11]
    buffer_load_dwordx4 v9, s[16:19], s65 offen offset:1024 nt lds
    v_add_f32 v21, v21, v28
    v_add_f32 v23, v23, v29
    v_mfma_f32_16x16x32_bf16 a[12:15], a[196:199], v[60:63], a[12:15]
    ds_read_b64_tr_b16 a[196:197], v7 offset:36992
    ds_read_b64_tr_b16 a[198:199], v7 offset:43136
    v_mfma_f32_16x16x32_bf16 a[16:19], a[200:203], v[56:59], a[16:19]
    s_waitcnt lgkmcnt(4)
    v_fma_f32 v37, v73, s35, v25
    v_mfma_f32_16x16x32_bf16 a[20:23], a[200:203], v[60:63], a[20:23]
    ds_read_b64_tr_b16 a[200:201], v4 offset:37120
    ds_read_b64_tr_b16 a[202:203], v4 offset:43264
    v_mfma_f32_16x16x32_bf16 v[136:139], a[204:207], v[48:51], v[136:139]
    v_exp_f32 v37, v37
    v_mfma_f32_16x16x32_bf16 v[140:143], a[204:207], v[52:55], v[140:143]
    v_cvt_pk_bf16_f32 v41, v39, v0
    v_fma_f32 v38, v74, s35, v25
    v_mfma_f32_16x16x32_bf16 a[24:27], a[204:207], v[56:59], a[24:27]
    v_exp_f32 v38, v38
    v_mfma_f32_16x16x32_bf16 a[28:31], a[204:207], v[60:63], a[28:31]
    ds_read_b64_tr_b16 a[204:205], v5 offset:37120
    ds_read_b64_tr_b16 a[206:207], v5 offset:43264
    v_mfma_f32_16x16x32_bf16 v[144:147], a[208:211], v[48:51], v[144:147]
    buffer_load_dwordx4 v10, s[16:19], s65 offen offset:2048 nt lds
    v_mfma_f32_16x16x32_bf16 v[148:151], a[208:211], v[52:55], v[148:151]
    s_mov_b32 s14, s33
    v_fma_f32 v39, v75, s35, v25
    v_mfma_f32_16x16x32_bf16 a[32:35], a[208:211], v[56:59], a[32:35]
    v_exp_f32 v39, v39
    v_mfma_f32_16x16x32_bf16 a[36:39], a[208:211], v[60:63], a[36:39]
    ds_read_b64_tr_b16 a[208:209], v6 offset:37120
    ds_read_b64_tr_b16 a[210:211], v6 offset:43264
    v_mfma_f32_16x16x32_bf16 v[152:155], a[212:215], v[48:51], v[152:155]
    v_cvt_pk_bf16_f32 v44, v36, v37
    v_fma_f32 v0, v68, s35, v24
    v_mfma_f32_16x16x32_bf16 v[156:159], a[212:215], v[52:55], v[156:159]
    s_mov_b32 m0, s90
    v_fma_f32 v36, v69, s35, v24
    v_mfma_f32_16x16x32_bf16 a[40:43], a[212:215], v[56:59], a[40:43]
    s_waitcnt lgkmcnt(4)
    v_cvt_pk_bf16_f32 v45, v38, v39
    v_mfma_f32_16x16x32_bf16 a[44:47], a[212:215], v[60:63], a[44:47]
    ds_read_b64_tr_b16 a[212:213], v7 offset:37120
    ds_read_b64_tr_b16 a[214:215], v7 offset:43264
    v_mfma_f32_16x16x32_bf16 v[160:163], a[192:195], v[48:51], v[160:163]
    buffer_load_dwordx4 v8, s[20:23], s86 offen nt lds
    v_mfma_f32_16x16x32_bf16 v[164:167], a[192:195], v[52:55], v[164:167]
    v_exp_f32 v0, v0
    v_mfma_f32_16x16x32_bf16 a[48:51], a[192:195], v[56:59], a[48:51]
    v_exp_f32 v36, v36
    v_mfma_f32_16x16x32_bf16 a[52:55], a[192:195], v[60:63], a[52:55]
    ds_read_b128 a[192:195], v2 offset:12288
    v_fma_f32 v37, v70, s35, v24
    v_mfma_f32_16x16x32_bf16 v[168:171], a[196:199], v[48:51], v[168:171]
    v_exp_f32 v37, v37
    v_mfma_f32_16x16x32_bf16 v[172:175], a[196:199], v[52:55], v[172:175]
    v_fma_f32 v38, v71, s35, v24
    v_cvt_pk_bf16_f32 v42, v0, v36
    v_mfma_f32_16x16x32_bf16 a[56:59], a[196:199], v[56:59], a[56:59]
    v_exp_f32 v38, v38
    v_mfma_f32_16x16x32_bf16 a[60:63], a[196:199], v[60:63], a[60:63]
    ds_read_b128 a[196:199], v3 offset:12288
    v_fma_f32 v39, v76, s35, v25
    v_mfma_f32_16x16x32_bf16 v[176:179], a[200:203], v[48:51], v[176:179]
    buffer_load_dwordx4 v9, s[20:23], s86 offen offset:1024 nt lds
    v_mfma_f32_16x16x32_bf16 v[180:183], a[200:203], v[52:55], v[180:183]
    v_exp_f32 v39, v39
    v_mfma_f32_16x16x32_bf16 a[64:67], a[200:203], v[56:59], a[64:67]
    v_fma_f32 v0, v77, s35, v25
    v_cvt_pk_bf16_f32 v43, v37, v38
    v_mfma_f32_16x16x32_bf16 a[68:71], a[200:203], v[60:63], a[68:71]
    ds_read_b128 a[200:203], v2 offset:12416
    s_waitcnt lgkmcnt(3)
    v_mfma_f32_16x16x32_bf16 v[184:187], a[204:207], v[48:51], v[184:187]
    v_exp_f32 v0, v0
    v_mfma_f32_16x16x32_bf16 v[188:191], a[204:207], v[52:55], v[188:191]
    v_fma_f32 v36, v78, s35, v25
    v_fma_f32 v37, v79, s35, v25
    v_mfma_f32_16x16x32_bf16 a[72:75], a[204:207], v[56:59], a[72:75]
    v_exp_f32 v36, v36
    v_mfma_f32_16x16x32_bf16 a[76:79], a[204:207], v[60:63], a[76:79]
    ds_read_b128 a[204:207], v3 offset:12416
    v_cvt_pk_bf16_f32 v46, v39, v0
    v_mfma_f32_16x16x32_bf16 v[192:195], a[208:211], v[48:51], v[192:195]
    buffer_load_dwordx4 v10, s[20:23], s86 offen offset:2048 nt lds
    v_mfma_f32_16x16x32_bf16 v[196:199], a[208:211], v[52:55], v[196:199]
    v_exp_f32 v37, v37
    v_mfma_f32_16x16x32_bf16 a[80:83], a[208:211], v[56:59], a[80:83]
    v_cvt_pk_bf16_f32 v47, v36, v37
    v_mfma_f32_16x16x32_bf16 a[84:87], a[208:211], v[60:63], a[84:87]
    ds_read_b128 a[208:211], v2 offset:12544
    v_mfma_f32_16x16x32_bf16 v[200:203], a[212:215], v[48:51], v[200:203]
    v_mfma_f32_16x16x32_bf16 v[204:207], a[212:215], v[52:55], v[204:207]
    v_mfma_f32_16x16x32_bf16 a[88:91], a[212:215], v[56:59], a[88:91]
    s_cmp_eq_u32 s34, 2
    v_mfma_f32_16x16x32_bf16 a[92:95], a[212:215], v[60:63], a[92:95]
    ds_read_b128 a[212:215], v3 offset:12544
    v_mfma_f32_16x16x32_bf16 v[28:31], a[248:251], v[40:43], 0
    s_waitcnt vmcnt(15)
    s_barrier
    v_mfma_f32_16x16x32_bf16 v[28:31], a[252:255], v[44:47], v[28:31]
    s_waitcnt lgkmcnt(3)
    s_cbranch_scc1 L_fin
    v_mfma_f32_16x16x32_bf16 v[96:99], a[192:195], a[144:147], 0
    v_fma_f32 v36, v80, s35, v26
    v_fma_f32 v37, v81, s35, v26
    v_mfma_f32_16x16x32_bf16 v[96:99], a[196:199], a[148:151], v[96:99]
    v_exp_f32 v36, v36
    v_mfma_f32_16x16x32_bf16 v[96:99], a[200:203], a[152:155], v[96:99]
    s_mov_b32 m0, s42
    v_cmp_nge_f32 vcc, s37, v30
    v_mfma_f32_16x16x32_bf16 v[104:107], a[192:195], a[168:171], 0
    v_exp_f32 v37, v37
    v_mfma_f32_16x16x32_bf16 v[104:107], a[196:199], a[172:175], v[104:107]
    buffer_load_dwordx4 v8, s[12:15], 0 offen nt lds
    v_mfma_f32_16x16x32_bf16 v[104:107], a[200:203], a[176:179], v[104:107]
    v_fma_f32 v38, v82, s35, v26
    s_cbranch_vccnz L_tr_T12_A
L_ret_T12_A:
    v_mfma_f32_16x16x32_bf16 v[64:67], a[192:195], a[96:99], 0
    v_add_f32 v17, v17, v28
    v_add_f32 v19, v19, v29
    v_mfma_f32_16x16x32_bf16 v[64:67], a[196:199], a[100:103], v[64:67]
    v_exp_f32 v38, v38
    v_mfma_f32_16x16x32_bf16 v[64:67], a[200:203], a[104:107], v[64:67]
    buffer_load_dwordx4 v9, s[12:15], 0 offen offset:1024 nt lds
    v_mfma_f32_16x16x32_bf16 v[72:75], a[192:195], a[120:123], 0
    ds_read_b128 a[192:195], v2 offset:18432
    v_fma_f32 v39, v83, s35, v26
    v_mfma_f32_16x16x32_bf16 v[72:75], a[196:199], a[124:127], v[72:75]
    v_exp_f32 v39, v39
    v_mfma_f32_16x16x32_bf16 v[72:75], a[200:203], a[128:131], v[72:75]
    ds_read_b128 a[196:199], v3 offset:18432
    s_waitcnt lgkmcnt(2)
    v_mfma_f32_16x16x32_bf16 v[64:67], a[204:207], a[108:111], v[64:67]
    buffer_load_dwordx4 v10, s[12:15], 0 offen offset:2048 nt lds
    v_mfma_f32_16x16x32_bf16 v[64:67], a[208:211], a[112:115], v[64:67]
    ds_read_b128 a[200:203], v2 offset:18560
    v_cvt_pk_bf16_f32 v56, v36, v37
    v_mfma_f32_16x16x32_bf16 v[64:67], a[212:215], a[116:119], v[64:67]
    v_fma_f32 v0, v84, s35, v26
    v_fma_f32 v36, v85, s35, v26
    v_mfma_f32_16x16x32_bf16 v[72:75], a[204:207], a[132:135], v[72:75]
    v_exp_f32 v0, v0
    v_mfma_f32_16x16x32_bf16 v[72:75], a[208:211], a[136:139], v[72:75]
    v_exp_f32 v36, v36
    v_mfma_f32_16x16x32_bf16 v[72:75], a[212:215], a[140:143], v[72:75]
    v_cvt_pk_bf16_f32 v57, v38, v39
    v_fma_f32 v37, v86, s35, v26
    v_mfma_f32_16x16x32_bf16 v[96:99], a[204:207], a[156:159], v[96:99]
    v_exp_f32 v37, v37
    v_mfma_f32_16x16x32_bf16 v[96:99], a[208:211], a[160:163], v[96:99]
    v_fma_f32 v38, v87, s35, v26
    v_cvt_pk_bf16_f32 v58, v0, v36
    v_mfma_f32_16x16x32_bf16 v[96:99], a[212:215], a[164:167], v[96:99]
    v_exp_f32 v38, v38
    v_mfma_f32_16x16x32_bf16 v[104:107], a[204:207], a[180:183], v[104:107]
    ds_read_b128 a[204:207], v3 offset:18560
    v_fma_f32 v39, v88, s35, v27
    v_mfma_f32_16x16x32_bf16 v[104:107], a[208:211], a[184:187], v[104:107]
    v_exp_f32 v39, v39
    v_mfma_f32_16x16x32_bf16 v[104:107], a[212:215], a[188:191], v[104:107]
    ds_read_b128 a[208:211], v2 offset:18688
    s_waitcnt lgkmcnt(2)
    v_mfma_f32_16x16x32_bf16 v[68:71], a[192:195], a[96:99], 0
    v_fma_f32 v0, v89, s35, v27
    v_cvt_pk_bf16_f32 v59, v37, v38
    v_mfma_f32_16x16x32_bf16 v[68:71], a[196:199], a[100:103], v[68:71]
    ds_read_b128 a[212:215], v3 offset:18688
    v_fma_f32 v36, v90, s35, v27
    v_mfma_f32_16x16x32_bf16 v[68:71], a[200:203], a[104:107], v[68:71]
    v_exp_f32 v0, v0
    v_mfma_f32_16x16x32_bf16 v[76:79], a[192:195], a[120:123], 0
    v_exp_f32 v36, v36
    v_mfma_f32_16x16x32_bf16 v[76:79], a[196:199], a[124:127], v[76:79]
    v_fma_f32 v37, v91, s35, v27
    v_mfma_f32_16x16x32_bf16 v[76:79], a[200:203], a[128:131], v[76:79]
    v_exp_f32 v37, v37
    v_mfma_f32_16x16x32_bf16 v[100:103], a[192:195], a[144:147], 0
    v_cvt_pk_bf16_f32 v60, v39, v0
    v_mfma_f32_16x16x32_bf16 v[100:103], a[196:199], a[148:151], v[100:103]
    v_fma_f32 v38, v92, s35, v27
    v_fma_f32 v39, v93, s35, v27
    v_mfma_f32_16x16x32_bf16 v[100:103], a[200:203], a[152:155], v[100:103]
    s_waitcnt lgkmcnt(0)
    v_cvt_pk_bf16_f32 v61, v36, v37
    v_mfma_f32_16x16x32_bf16 v[108:111], a[192:195], a[168:171], 0
    ds_read_b64_tr_b16 a[192:193], v4 offset:0
    ds_read_b64_tr_b16 a[194:195], v4 offset:6144
    v_mfma_f32_16x16x32_bf16 v[108:111], a[196:199], a[172:175], v[108:111]
    v_exp_f32 v38, v38
    v_mfma_f32_16x16x32_bf16 v[108:111], a[200:203], a[176:179], v[108:111]
    ds_read_b64_tr_b16 a[196:197], v5 offset:0
    ds_read_b64_tr_b16 a[198:199], v5 offset:6144
    v_mfma_f32_16x16x32_bf16 v[68:71], a[204:207], a[108:111], v[68:71]
    v_exp_f32 v39, v39
    v_mfma_f32_16x16x32_bf16 v[68:71], a[208:211], a[112:115], v[68:71]
    ds_read_b64_tr_b16 a[200:201], v6 offset:0
    ds_read_b64_tr_b16 a[202:203], v6 offset:6144
    v_mfma_f32_16x16x32_bf16 v[68:71], a[212:215], a[116:119], v[68:71]
    v_fma_f32 v0, v94, s35, v27
    v_mfma_f32_16x16x32_bf16 v[76:79], a[204:207], a[132:135], v[76:79]
    v_exp_f32 v0, v0
    v_mfma_f32_16x16x32_bf16 v[76:79], a[208:211], a[136:139], v[76:79]
    v_fma_f32 v36, v95, s35, v27
    v_mfma_f32_16x16x32_bf16 v[76:79], a[212:215], a[140:143], v[76:79]
    v_exp_f32 v36, v36
    v_mfma_f32_16x16x32_bf16 v[100:103], a[204:207], a[156:159], v[100:103]
    v_cvt_pk_bf16_f32 v62, v38, v39
    v_cvt_pk_bf16_f32 v63, v0, v36
    v_mfma_f32_16x16x32_bf16 v[100:103], a[208:211], a[160:163], v[100:103]
    v_fma_f32 v37, v64, s35, v24
    v_mfma_f32_16x16x32_bf16 v[100:103], a[212:215], a[164:167], v[100:103]
    v_exp_f32 v37, v37
    v_mfma_f32_16x16x32_bf16 v[108:111], a[204:207], a[180:183], v[108:111]
    ds_read_b64_tr_b16 a[204:205], v7 offset:0
    ds_read_b64_tr_b16 a[206:207], v7 offset:6144
    v_mfma_f32_16x16x32_bf16 v[108:111], a[208:211], a[184:187], v[108:111]
    s_mov_b32 m0, s51
    v_fma_f32 v38, v65, s35, v24
    v_mfma_f32_16x16x32_bf16 v[108:111], a[212:215], a[188:191], v[108:111]
    ds_read_b64_tr_b16 a[208:209], v4 offset:128
    ds_read_b64_tr_b16 a[210:211], v4 offset:6272
    v_mfma_f32_16x16x32_bf16 v[28:31], a[248:251], v[56:59], 0
    buffer_load_dwordx4 v8, s[16:19], s66 offen nt lds
    v_mfma_f32_16x16x32_bf16 v[28:31], a[252:255], v[60:63], v[28:31]
    ds_read_b64_tr_b16 a[212:213], v5 offset:128
    ds_read_b64_tr_b16 a[214:215], v5 offset:6272
    s_waitcnt lgkmcnt(6)
    v_mfma_f32_16x16x32_bf16 v[112:115], a[192:195], v[40:43], v[112:115]
    v_exp_f32 v38, v38
    v_mfma_f32_16x16x32_bf16 v[116:119], a[192:195], v[44:47], v[116:119]
    v_fma_f32 v39, v66, s35, v24
    v_fma_f32 v0, v67, s35, v24
    v_mfma_f32_16x16x32_bf16 v[120:123], a[196:199], v[40:43], v[120:123]
    v_cvt_pk_bf16_f32 v48, v37, v38
    v_cmp_nge_f32 vcc, s37, v30
    v_mfma_f32_16x16x32_bf16 v[124:127], a[196:199], v[44:47], v[124:127]
    v_exp_f32 v39, v39
    v_mfma_f32_16x16x32_bf16 v[128:131], a[200:203], v[40:43], v[128:131]
    v_exp_f32 v0, v0
    v_mfma_f32_16x16x32_bf16 v[132:135], a[200:203], v[44:47], v[132:135]
    v_fma_f32 v36, v72, s35, v25
    s_cbranch_vccnz L_tr_T12_B
L_ret_T12_B:
    v_mfma_f32_16x16x32_bf16 a[0:3], a[192:195], v[56:59], a[0:3]
    v_exp_f32 v36, v36
    v_mfma_f32_16x16x32_bf16 a[4:7], a[192:195], v[60:63], a[4:7]
    ds_read_b64_tr_b16 a[192:193], v6 offset:128
    ds_read_b64_tr_b16 a[194:195], v6 offset:6272
    v_mfma_f32_16x16x32_bf16 a[8:11], a[196:199], v[56:59], a[8:11]
    buffer_load_dwordx4 v9, s[16:19], s66 offen offset:1024 nt lds
    v_add_f32 v21, v21, v28
    v_add_f32 v23, v23, v29
    v_mfma_f32_16x16x32_bf16 a[12:15], a[196:199], v[60:63], a[12:15]
    ds_read_b64_tr_b16 a[196:197], v7 offset:128
    ds_read_b64_tr_b16 a[198:199], v7 offset:6272
    v_mfma_f32_16x16x32_bf16 a[16:19], a[200:203], v[56:59], a[16:19]
    s_waitcnt lgkmcnt(4)
    v_fma_f32 v37, v73, s35, v25
    v_mfma_f32_16x16x32_bf16 a[20:23], a[200:203], v[60:63], a[20:23]
    ds_read_b64_tr_b16 a[200:201], v4 offset:256
    ds_read_b64_tr_b16 a[202:203], v4 offset:6400
    v_mfma_f32_16x16x32_bf16 v[136:139], a[204:207], v[40:43], v[136:139]
    v_exp_f32 v37, v37
    v_mfma_f32_16x16x32_bf16 v[140:143], a[204:207], v[44:47], v[140:143]
    v_cvt_pk_bf16_f32 v49, v39, v0
    v_fma_f32 v38, v74, s35, v25
    v_mfma_f32_16x16x32_bf16 a[24:27], a[204:207], v[56:59], a[24:27]
    v_exp_f32 v38, v38
    v_mfma_f32_16x16x32_bf16 a[28:31], a[204:207], v[60:63], a[28:31]
L_hop_11:
    s_cbranch_execz L_hop_15
    ds_read_b64_tr_b16 a[204:205], v5 offset:256
    ds_read_b64_tr_b16 a[206:207], v5 offset:6400
    v_mfma_f32_16x16x32_bf16 v[144:147], a[208:211], v[40:43], v[144:147]
    buffer_load_dwordx4 v10, s[16:19], s66 offen offset:2048 nt lds
    v_mfma_f32_16x16x32_bf16 v[148:151], a[208:211], v[44:47], v[148:151]
    v_fma_f32 v39, v75, s35, v25
    v_cvt_pk_bf16_f32 v52, v36, v37
    v_mfma_f32_16x16x32_bf16 a[32:35], a[208:211], v[56:59], a[32:35]
    v_exp_f32 v39, v39
    v_mfma_f32_16x16x32_bf16 a[36:39], a[208:211], v[60:63], a[36:39]
    ds_read_b64_tr_b16 a[208:209], v6 offset:256
    ds_read_b64_tr_b16 a[210:211], v6 offset:6400
    v_mfma_f32_16x16x32_bf16 v[152:155], a[212:215], v[40:43], v[152:155]
    v_fma_f32 v0, v68, s35, v24
    v_fma_f32 v36, v69, s35, v24
    v_mfma_f32_16x16x32_bf16 v[156:159], a[212:215], v[44:47], v[156:159]
    s_mov_b32 m0, s91
    s_add_u32 s16, s8, s30
    v_mfma_f32_16x16x32_bf16 a[40:43], a[212:215], v[56:59], a[40:43]
    s_waitcnt lgkmcnt(4)
    v_cvt_pk_bf16_f32 v53, v38, v39
    v_mfma_f32_16x16x32_bf16 a[44:47], a[212:215], v[60:63], a[44:47]
    ds_read_b64_tr_b16 a[212:213], v7 offset:256
    ds_read_b64_tr_b16 a[214:215], v7 offset:6400
    v_mfma_f32_16x16x32_bf16 v[160:163], a[192:195], v[40:43], v[160:163]
    buffer_load_dwordx4 v8, s[20:23], s87 offen nt lds
    v_mfma_f32_16x16x32_bf16 v[164:167], a[192:195], v[44:47], v[164:167]
    v_exp_f32 v0, v0
    v_mfma_f32_16x16x32_bf16 a[48:51], a[192:195], v[56:59], a[48:51]
    v_exp_f32 v36, v36
    v_mfma_f32_16x16x32_bf16 a[52:55], a[192:195], v[60:63], a[52:55]
    ds_read_b128 a[192:195], v2 offset:24576
    v_fma_f32 v37, v70, s35, v24
    v_mfma_f32_16x16x32_bf16 v[168:171], a[196:199], v[40:43], v[168:171]
    v_exp_f32 v37, v37
    v_mfma_f32_16x16x32_bf16 v[172:175], a[196:199], v[44:47], v[172:175]
    s_addc_u32 s17, s9, 0
    v_fma_f32 v38, v71, s35, v24
    v_mfma_f32_16x16x32_bf16 a[56:59], a[196:199], v[56:59], a[56:59]
    v_exp_f32 v38, v38
    v_mfma_f32_16x16x32_bf16 a[60:63], a[196:199], v[60:63], a[60:63]
    ds_read_b128 a[196:199], v3 offset:24576
    v_cvt_pk_bf16_f32 v50, v0, v36
    v_mfma_f32_16x16x32_bf16 v[176:179], a[200:203], v[40:43], v[176:179]
    buffer_load_dwordx4 v9, s[20:23], s87 offen offset:1024 nt lds
    v_mfma_f32_16x16x32_bf16 v[180:183], a[200:203], v[44:47], v[180:183]
    v_fma_f32 v39, v76, s35, v25
    v_fma_f32 v0, v77, s35, v25
    v_mfma_f32_16x16x32_bf16 a[64:67], a[200:203], v[56:59], a[64:67]
    v_exp_f32 v39, v39
    v_mfma_f32_16x16x32_bf16 a[68:71], a[200:203], v[60:63], a[68:71]
    ds_read_b128 a[200:203], v2 offset:24704
    s_waitcnt lgkmcnt(3)
    v_mfma_f32_16x16x32_bf16 v[184:187], a[204:207], v[40:43], v[184:187]
    v_exp_f32 v0, v0
    v_mfma_f32_16x16x32_bf16 v[188:191], a[204:207], v[44:47], v[188:191]
    s_mov_b32 s18, s33
    v_cvt_pk_bf16_f32 v51, v37, v38
    v_mfma_f32_16x16x32_bf16 a[72:75], a[204:207], v[56:59], a[72:75]
    v_fma_f32 v36, v78, s35, v25
    v_fma_f32 v37, v79, s35, v25
    v_mfma_f32_16x16x32_bf16 a[76:79], a[204:207], v[60:63], a[76:79]
    ds_read_b128 a[204:207], v3 offset:24704
    v_cvt_pk_bf16_f32 v54, v39, v0
    v_mfma_f32_16x16x32_bf16 v[192:195], a[208:211], v[40:43], v[192:195]
    buffer_load_dwordx4 v10, s[20:23], s87 offen offset:2048 nt lds
    v_mfma_f32_16x16x32_bf16 v[196:199], a[208:211], v[44:47], v[196:199]
    v_exp_f32 v36, v36
    v_mfma_f32_16x16x32_bf16 a[80:83], a[208:211], v[56:59], a[80:83]
    v_exp_f32 v37, v37
    v_mfma_f32_16x16x32_bf16 a[84:87], a[208:211], v[60:63], a[84:87]
    ds_read_b128 a[208:211], v2 offset:24832
    v_cvt_pk_bf16_f32 v55, v36, v37
    v_mfma_f32_16x16x32_bf16 v[200:203], a[212:215], v[40:43], v[200:203]
    v_mfma_f32_16x16x32_bf16 v[204:207], a[212:215], v[44:47], v[204:207]
    v_mfma_f32_16x16x32_bf16 a[88:91], a[212:215], v[56:59], a[88:91]
    v_mfma_f32_16x16x32_bf16 a[92:95], a[212:215], v[60:63], a[92:95]
    ds_read_b128 a[212:215], v3 offset:24832
    v_mfma_f32_16x16x32_bf16 v[28:31], a[248:251], v[48:51], 0
    s_waitcnt vmcnt(15)
    s_barrier
    v_mfma_f32_16x16x32_bf16 v[28:31], a[252:255], v[52:55], v[28:31]
    s_waitcnt lgkmcnt(3)
    v_mfma_f32_16x16x32_bf16 v[80:83], a[192:195], a[144:147], 0
    v_fma_f32 v36, v96, s35, v26
    v_fma_f32 v37, v97, s35, v26
    v_mfma_f32_16x16x32_bf16 v[80:83], a[196:199], a[148:151], v[80:83]
    v_exp_f32 v36, v36
    v_mfma_f32_16x16x32_bf16 v[80:83], a[200:203], a[152:155], v[80:83]
    s_mov_b32 m0, s43
    v_cmp_nge_f32 vcc, s37, v30
    v_mfma_f32_16x16x32_bf16 v[88:91], a[192:195], a[168:171], 0
    v_exp_f32 v37, v37
    v_mfma_f32_16x16x32_bf16 v[88:91], a[196:199], a[172:175], v[88:91]
    buffer_load_dwordx4 v8, s[12:15], s52 offen nt lds
    v_mfma_f32_16x16x32_bf16 v[88:91], a[200:203], a[176:179], v[88:91]
    v_fma_f32 v38, v98, s35, v26
    s_cbranch_vccnz L_tr_T13_A
L_ret_T13_A:
    v_mfma_f32_16x16x32_bf16 v[64:67], a[192:195], a[96:99], 0
    v_add_f32 v17, v17, v28
    v_add_f32 v19, v19, v29
    v_mfma_f32_16x16x32_bf16 v[64:67], a[196:199], a[100:103], v[64:67]
    v_exp_f32 v38, v38
    v_mfma_f32_16x16x32_bf16 v[64:67], a[200:203], a[104:107], v[64:67]
    buffer_load_dwordx4 v9, s[12:15], s52 offen offset:1024 nt lds
    v_mfma_f32_16x16x32_bf16 v[72:75], a[192:195], a[120:123], 0
    ds_read_b128 a[192:195], v2 offset:30720
    v_fma_f32 v39, v99, s35, v26
    v_mfma_f32_16x16x32_bf16 v[72:75], a[196:199], a[124:127], v[72:75]
    v_exp_f32 v39, v39
    v_mfma_f32_16x16x32_bf16 v[72:75], a[200:203], a[128:131], v[72:75]
    ds_read_b128 a[196:199], v3 offset:30720
    s_waitcnt lgkmcnt(2)
    v_mfma_f32_16x16x32_bf16 v[64:67], a[204:207], a[108:111], v[64:67]
    buffer_load_dwordx4 v10, s[12:15], s52 offen offset:2048 nt lds
    v_mfma_f32_16x16x32_bf16 v[64:67], a[208:211], a[112:115], v[64:67]
    ds_read_b128 a[200:203], v2 offset:30848
    v_cvt_pk_bf16_f32 v56, v36, v37
    v_mfma_f32_16x16x32_bf16 v[64:67], a[212:215], a[116:119], v[64:67]
    v_fma_f32 v0, v100, s35, v26
    v_fma_f32 v36, v101, s35, v26
    v_mfma_f32_16x16x32_bf16 v[72:75], a[204:207], a[132:135], v[72:75]
    v_exp_f32 v0, v0
    v_mfma_f32_16x16x32_bf16 v[72:75], a[208:211], a[136:139], v[72:75]
    v_exp_f32 v36, v36
    v_mfma_f32_16x16x32_bf16 v[72:75], a[212:215], a[140:143], v[72:75]
    v_cvt_pk_bf16_f32 v57, v38, v39
    v_fma_f32 v37, v102, s35, v26
    v_mfma_f32_16x16x32_bf16 v[80:83], a[204:207], a[156:159], v[80:83]
    v_exp_f32 v37, v37
    v_mfma_f32_16x16x32_bf16 v[80:83], a[208:211], a[160:163], v[80:83]
    v_fma_f32 v38, v103, s35, v26
    v_cvt_pk_bf16_f32 v58, v0, v36
    v_mfma_f32_16x16x32_bf16 v[80:83], a[212:215], a[164:167], v[80:83]
    buffer_store_dwordx4 a[232:235], v12, s[24:27], s85 offen offset:1024 sc1
    v_mfma_f32_16x16x32_bf16 v[88:91], a[204:207], a[180:183], v[88:91]
    ds_read_b128 a[204:207], v3 offset:30848
    v_fma_f32 v39, v104, s35, v27
    v_mfma_f32_16x16x32_bf16 v[88:91], a[208:211], a[184:187], v[88:91]
    v_exp_f32 v38, v38
    v_mfma_f32_16x16x32_bf16 v[88:91], a[212:215], a[188:191], v[88:91]
    ds_read_b128 a[208:211], v2 offset:30976
    s_waitcnt lgkmcnt(2)
    v_mfma_f32_16x16x32_bf16 v[68:71], a[192:195], a[96:99], 0
    v_exp_f32 v39, v39
    v_mfma_f32_16x16x32_bf16 v[68:71], a[196:199], a[100:103], v[68:71]
    ds_read_b128 a[212:215], v3 offset:30976
    v_fma_f32 v0, v105, s35, v27
    v_mfma_f32_16x16x32_bf16 v[68:71], a[200:203], a[104:107], v[68:71]
    v_exp_f32 v0, v0
    v_mfma_f32_16x16x32_bf16 v[76:79], a[192:195], a[120:123], 0
    v_cvt_pk_bf16_f32 v59, v37, v38
    v_fma_f32 v36, v106, s35, v27
    v_mfma_f32_16x16x32_bf16 v[76:79], a[196:199], a[124:127], v[76:79]
    v_exp_f32 v36, v36
    v_mfma_f32_16x16x32_bf16 v[76:79], a[200:203], a[128:131], v[76:79]
    v_fma_f32 v37, v107, s35, v27
    v_mfma_f32_16x16x32_bf16 v[84:87], a[192:195], a[144:147], 0
    v_exp_f32 v37, v37
    v_mfma_f32_16x16x32_bf16 v[84:87], a[196:199], a[148:151], v[84:87]
    v_cvt_pk_bf16_f32 v60, v39, v0
    v_fma_f32 v38, v108, s35, v27
    v_mfma_f32_16x16x32_bf16 v[84:87], a[200:203], a[152:155], v[84:87]
    s_waitcnt lgkmcnt(0)
    v_fma_f32 v39, v109, s35, v27
    v_mfma_f32_16x16x32_bf16 v[92:95], a[192:195], a[168:171], 0
    ds_read_b64_tr_b16 a[192:193], v4 offset:12288
    ds_read_b64_tr_b16 a[194:195], v4 offset:18432
    v_mfma_f32_16x16x32_bf16 v[92:95], a[196:199], a[172:175], v[92:95]
    v_exp_f32 v38, v38
    v_mfma_f32_16x16x32_bf16 v[92:95], a[200:203], a[176:179], v[92:95]
    ds_read_b64_tr_b16 a[196:197], v5 offset:12288
    ds_read_b64_tr_b16 a[198:199], v5 offset:18432
    v_mfma_f32_16x16x32_bf16 v[68:71], a[204:207], a[108:111], v[68:71]
    v_exp_f32 v39, v39
    v_mfma_f32_16x16x32_bf16 v[68:71], a[208:211], a[112:115], v[68:71]
    ds_read_b64_tr_b16 a[200:201], v6 offset:12288
    ds_read_b64_tr_b16 a[202:203], v6 offset:18432
    v_mfma_f32_16x16x32_bf16 v[68:71], a[212:215], a[116:119], v[68:71]
    v_cvt_pk_bf16_f32 v61, v36, v37
    v_mfma_f32_16x16x32_bf16 v[76:79], a[204:207], a[132:135], v[76:79]
    v_fma_f32 v0, v110, s35, v27
    v_fma_f32 v36, v111, s35, v27
    v_mfma_f32_16x16x32_bf16 v[76:79], a[208:211], a[136:139], v[76:79]
    v_exp_f32 v0, v0
    v_mfma_f32_16x16x32_bf16 v[76:79], a[212:215], a[140:143], v[76:79]
    v_exp_f32 v36, v36
    v_mfma_f32_16x16x32_bf16 v[84:87], a[204:207], a[156:159], v[84:87]
    v_cvt_pk_bf16_f32 v62, v38, v39
    v_mfma_f32_16x16x32_bf16 v[84:87], a[208:211], a[160:163], v[84:87]
    v_cvt_pk_bf16_f32 v63, v0, v36
    v_fma_f32 v37, v64, s35, v24
    v_mfma_f32_16x16x32_bf16 v[84:87], a[212:215], a[164:167], v[84:87]
    buffer_store_dwordx4 a[236:239], v13, s[24:27], s85 offen offset:2048 sc1
    v_mfma_f32_16x16x32_bf16 v[92:95], a[204:207], a[180:183], v[92:95]
    ds_read_b64_tr_b16 a[204:205], v7 offset:12288
    ds_read_b64_tr_b16 a[206:207], v7 offset:18432
    v_mfma_f32_16x16x32_bf16 v[92:95], a[208:211], a[184:187], v[92:95]
    s_mov_b32 m0, s48
    v_mfma_f32_16x16x32_bf16 v[92:95], a[212:215], a[188:191], v[92:95]
    ds_read_b64_tr_b16 a[208:209], v4 offset:12416
    ds_read_b64_tr_b16 a[210:211], v4 offset:18560
    v_mfma_f32_16x16x32_bf16 v[28:31], a[248:251], v[56:59], 0
    buffer_load_dwordx4 v8, s[16:19], 0 offen nt lds
    v_mfma_f32_16x16x32_bf16 v[28:31], a[252:255], v[60:63], v[28:31]
    ds_read_b64_tr_b16 a[212:213], v5 offset:12416
    ds_read_b64_tr_b16 a[214:215], v5 offset:18560
    s_waitcnt lgkmcnt(6)
    v_mfma_f32_16x16x32_bf16 v[112:115], a[192:195], v[48:51], v[112:115]
    v_exp_f32 v37, v37
    v_mfma_f32_16x16x32_bf16 v[116:119], a[192:195], v[52:55], v[116:119]
    v_fma_f32 v38, v65, s35, v24
    v_fma_f32 v39, v66, s35, v24
    v_mfma_f32_16x16x32_bf16 v[120:123], a[196:199], v[48:51], v[120:123]
    v_fma_f32 v0, v67, s35, v24
    v_cmp_nge_f32 vcc, s37, v30
    v_mfma_f32_16x16x32_bf16 v[124:127], a[196:199], v[52:55], v[124:127]
    v_exp_f32 v38, v38
    v_mfma_f32_16x16x32_bf16 v[128:131], a[200:203], v[48:51], v[128:131]
    v_exp_f32 v39, v39
    v_mfma_f32_16x16x32_bf16 v[132:135], a[200:203], v[52:55], v[132:135]
    s_cbranch_vccnz L_tr_T13_B
L_ret_T13_B:
    v_mfma_f32_16x16x32_bf16 a[0:3], a[192:195], v[56:59], a[0:3]
    v_add_f32 v21, v21, v28
    v_add_f32 v23, v23, v29
    v_mfma_f32_16x16x32_bf16 a[4:7], a[192:195], v[60:63], a[4:7]
    ds_read_b64_tr_b16 a[192:193], v6 offset:12416
    ds_read_b64_tr_b16 a[194:195], v6 offset:18560
    v_mfma_f32_16x16x32_bf16 a[8:11], a[196:199], v[56:59], a[8:11]
    buffer_load_dwordx4 v9, s[16:19], 0 offen offset:1024 nt lds
    v_mfma_f32_16x16x32_bf16 a[12:15], a[196:199], v[60:63], a[12:15]
    ds_read_b64_tr_b16 a[196:197], v7 offset:12416
    ds_read_b64_tr_b16 a[198:199], v7 offset:18560
    v_mfma_f32_16x16x32_bf16 a[16:19], a[200:203], v[56:59], a[16:19]
    s_waitcnt lgkmcnt(4)
    v_cvt_pk_bf16_f32 v40, v37, v38
    v_mfma_f32_16x16x32_bf16 a[20:23], a[200:203], v[60:63], a[20:23]
    ds_read_b64_tr_b16 a[200:201], v4 offset:12544
    ds_read_b64_tr_b16 a[202:203], v4 offset:18688
    v_mfma_f32_16x16x32_bf16 v[136:139], a[204:207], v[48:51], v[136:139]
    v_exp_f32 v0, v0
    v_mfma_f32_16x16x32_bf16 v[140:143], a[204:207], v[52:55], v[140:143]
    v_fma_f32 v36, v72, s35, v25
    v_fma_f32 v37, v73, s35, v25
    v_mfma_f32_16x16x32_bf16 a[24:27], a[204:207], v[56:59], a[24:27]
    v_exp_f32 v36, v36
    v_mfma_f32_16x16x32_bf16 a[28:31], a[204:207], v[60:63], a[28:31]
    ds_read_b64_tr_b16 a[204:205], v5 offset:12544
    ds_read_b64_tr_b16 a[206:207], v5 offset:18688
    v_mfma_f32_16x16x32_bf16 v[144:147], a[208:211], v[48:51], v[144:147]
    buffer_load_dwordx4 v10, s[16:19], 0 offen offset:2048 nt lds
    v_mfma_f32_16x16x32_bf16 v[148:151], a[208:211], v[52:55], v[148:151]
    v_exp_f32 v37, v37
    v_mfma_f32_16x16x32_bf16 a[32:35], a[208:211], v[56:59], a[32:35]
    v_cvt_pk_bf16_f32 v41, v39, v0
    v_fma_f32 v38, v74, s35, v25
    v_mfma_f32_16x16x32_bf16 a[36:39], a[208:211], v[60:63], a[36:39]
    ds_read_b64_tr_b16 a[208:209], v6 offset:12544
    ds_read_b64_tr_b16 a[210:211], v6 offset:18688
    v_mfma_f32_16x16x32_bf16 v[152:155], a[212:215], v[48:51], v[152:155]
    v_exp_f32 v38, v38
    v_mfma_f32_16x16x32_bf16 v[156:159], a[212:215], v[52:55], v[156:159]
    v_fma_f32 v39, v75, s35, v25
    v_cvt_pk_bf16_f32 v44, v36, v37
    v_mfma_f32_16x16x32_bf16 a[40:43], a[212:215], v[56:59], a[40:43]
    s_waitcnt lgkmcnt(4)
    v_fma_f32 v0, v68, s35, v24
    v_mfma_f32_16x16x32_bf16 a[44:47], a[212:215], v[60:63], a[44:47]
    ds_read_b64_tr_b16 a[212:213], v7 offset:12544
    ds_read_b64_tr_b16 a[214:215], v7 offset:18688
    v_mfma_f32_16x16x32_bf16 v[160:163], a[192:195], v[48:51], v[160:163]
    buffer_store_dwordx4 a[240:243], v11, s[24:27], s86 offen sc1
    v_mfma_f32_16x16x32_bf16 v[164:167], a[192:195], v[52:55], v[164:167]
    v_exp_f32 v39, v39
    v_mfma_f32_16x16x32_bf16 a[48:51], a[192:195], v[56:59], a[48:51]
    v_exp_f32 v0, v0
    v_mfma_f32_16x16x32_bf16 a[52:55], a[192:195], v[60:63], a[52:55]
    ds_read_b128 a[192:195], v2 offset:36864
    v_mfma_f32_16x16x32_bf16 v[168:171], a[196:199], v[48:51], v[168:171]
    v_fma_f32 v36, v69, s35, v24
    v_cvt_pk_bf16_f32 v45, v38, v39
    v_mfma_f32_16x16x32_bf16 v[172:175], a[196:199], v[52:55], v[172:175]
    v_exp_f32 v36, v36
    v_mfma_f32_16x16x32_bf16 a[56:59], a[196:199], v[56:59], a[56:59]
    v_fma_f32 v37, v70, s35, v24
    v_mfma_f32_16x16x32_bf16 a[60:63], a[196:199], v[60:63], a[60:63]
    ds_read_b128 a[196:199], v3 offset:36864
    v_fma_f32 v38, v71, s35, v24
    v_mfma_f32_16x16x32_bf16 v[176:179], a[200:203], v[48:51], v[176:179]
    v_exp_f32 v37, v37
    v_mfma_f32_16x16x32_bf16 v[180:183], a[200:203], v[52:55], v[180:183]
    v_exp_f32 v38, v38
    v_mfma_f32_16x16x32_bf16 a[64:67], a[200:203], v[56:59], a[64:67]
    v_cvt_pk_bf16_f32 v42, v0, v36
    v_mfma_f32_16x16x32_bf16 a[68:71], a[200:203], v[60:63], a[68:71]
    ds_read_b128 a[200:203], v2 offset:36992
    s_waitcnt lgkmcnt(3)
    v_mfma_f32_16x16x32_bf16 v[184:187], a[204:207], v[48:51], v[184:187]
    v_fma_f32 v39, v76, s35, v25
    v_fma_f32 v0, v77, s35, v25
    v_mfma_f32_16x16x32_bf16 v[188:191], a[204:207], v[52:55], v[188:191]
    v_exp_f32 v39, v39
    v_mfma_f32_16x16x32_bf16 a[72:75], a[204:207], v[56:59], a[72:75]
    v_exp_f32 v0, v0
    v_mfma_f32_16x16x32_bf16 a[76:79], a[204:207], v[60:63], a[76:79]
    ds_read_b128 a[204:207], v3 offset:36992
    v_mfma_f32_16x16x32_bf16 v[192:195], a[208:211], v[48:51], v[192:195]
    v_cvt_pk_bf16_f32 v43, v37, v38
    v_fma_f32 v36, v78, s35, v25
    v_mfma_f32_16x16x32_bf16 v[196:199], a[208:211], v[52:55], v[196:199]
    v_exp_f32 v36, v36
    v_mfma_f32_16x16x32_bf16 a[80:83], a[208:211], v[56:59], a[80:83]
    v_fma_f32 v37, v79, s35, v25
    v_cvt_pk_bf16_f32 v46, v39, v0
    v_mfma_f32_16x16x32_bf16 a[84:87], a[208:211], v[60:63], a[84:87]
    ds_read_b128 a[208:211], v2 offset:37120
    v_mfma_f32_16x16x32_bf16 v[200:203], a[212:215], v[48:51], v[200:203]
    v_exp_f32 v37, v37
    v_mfma_f32_16x16x32_bf16 v[204:207], a[212:215], v[52:55], v[204:207]
    v_cvt_pk_bf16_f32 v47, v36, v37
    v_mfma_f32_16x16x32_bf16 a[88:91], a[212:215], v[56:59], a[88:91]
    v_mfma_f32_16x16x32_bf16 a[92:95], a[212:215], v[60:63], a[92:95]
    ds_read_b128 a[212:215], v3 offset:37120
    v_mfma_f32_16x16x32_bf16 v[28:31], a[248:251], v[40:43], 0
    s_waitcnt vmcnt(15)
    s_barrier
    v_mfma_f32_16x16x32_bf16 v[28:31], a[252:255], v[44:47], v[28:31]
    s_waitcnt lgkmcnt(3)
    v_mfma_f32_16x16x32_bf16 v[96:99], a[192:195], a[144:147], 0
    v_fma_f32 v36, v80, s35, v26
    v_fma_f32 v37, v81, s35, v26
    v_mfma_f32_16x16x32_bf16 v[96:99], a[196:199], a[148:151], v[96:99]
    v_exp_f32 v36, v36
    v_mfma_f32_16x16x32_bf16 v[96:99], a[200:203], a[152:155], v[96:99]
    s_mov_b32 m0, s44
    v_fma_f32 v38, v82, s35, v26
    v_cmp_nge_f32 vcc, s37, v30
    v_mfma_f32_16x16x32_bf16 v[104:107], a[192:195], a[168:171], 0
    v_exp_f32 v37, v37
    v_mfma_f32_16x16x32_bf16 v[104:107], a[196:199], a[172:175], v[104:107]
    buffer_load_dwordx4 v8, s[12:15], s53 offen nt lds
    v_mfma_f32_16x16x32_bf16 v[104:107], a[200:203], a[176:179], v[104:107]
    v_fma_f32 v39, v83, s35, v26
    v_cvt_pk_bf16_f32 v56, v36, v37
    s_cbranch_vccnz L_tr_T14_A
L_ret_T14_A:
    v_mfma_f32_16x16x32_bf16 v[64:67], a[192:195], a[96:99], 0
    v_exp_f32 v38, v38
    v_mfma_f32_16x16x32_bf16 v[64:67], a[196:199], a[100:103], v[64:67]
    v_exp_f32 v39, v39
    v_mfma_f32_16x16x32_bf16 v[64:67], a[200:203], a[104:107], v[64:67]
    buffer_load_dwordx4 v9, s[12:15], s53 offen offset:1024 nt lds
    v_add_f32 v17, v17, v28
    v_add_f32 v19, v19, v29
    v_mfma_f32_16x16x32_bf16 v[72:75], a[192:195], a[120:123], 0
    ds_read_b128 a[192:195], v2 offset:43008
    v_fma_f32 v0, v84, s35, v26
    v_mfma_f32_16x16x32_bf16 v[72:75], a[196:199], a[124:127], v[72:75]
    v_exp_f32 v0, v0
    v_mfma_f32_16x16x32_bf16 v[72:75], a[200:203], a[128:131], v[72:75]
    ds_read_b128 a[196:199], v3 offset:43008
    s_waitcnt lgkmcnt(2)
    v_mfma_f32_16x16x32_bf16 v[64:67], a[204:207], a[108:111], v[64:67]
    buffer_load_dwordx4 v10, s[12:15], s53 offen offset:2048 nt lds
    v_mfma_f32_16x16x32_bf16 v[64:67], a[208:211], a[112:115], v[64:67]
    ds_read_b128 a[200:203], v2 offset:43136
    v_fma_f32 v36, v85, s35, v26
    v_mfma_f32_16x16x32_bf16 v[64:67], a[212:215], a[116:119], v[64:67]
    v_exp_f32 v36, v36
    v_mfma_f32_16x16x32_bf16 v[72:75], a[204:207], a[132:135], v[72:75]
    v_cvt_pk_bf16_f32 v57, v38, v39
    v_fma_f32 v37, v86, s35, v26
    v_mfma_f32_16x16x32_bf16 v[72:75], a[208:211], a[136:139], v[72:75]
    v_exp_f32 v37, v37
    v_mfma_f32_16x16x32_bf16 v[72:75], a[212:215], a[140:143], v[72:75]
    v_fma_f32 v38, v87, s35, v26
    v_cvt_pk_bf16_f32 v58, v0, v36
    v_mfma_f32_16x16x32_bf16 v[96:99], a[204:207], a[156:159], v[96:99]
    v_exp_f32 v38, v38
    v_mfma_f32_16x16x32_bf16 v[96:99], a[208:211], a[160:163], v[96:99]
    v_fma_f32 v39, v88, s35, v27
    v_fma_f32 v0, v89, s35, v27
    v_mfma_f32_16x16x32_bf16 v[96:99], a[212:215], a[164:167], v[96:99]
    buffer_store_dwordx4 a[244:247], v12, s[24:27], s86 offen offset:1024 sc1
    v_mfma_f32_16x16x32_bf16 v[104:107], a[204:207], a[180:183], v[104:107]
    ds_read_b128 a[204:207], v3 offset:43136
    v_cvt_pk_bf16_f32 v59, v37, v38
    v_mfma_f32_16x16x32_bf16 v[104:107], a[208:211], a[184:187], v[104:107]
    v_exp_f32 v39, v39
    v_mfma_f32_16x16x32_bf16 v[104:107], a[212:215], a[188:191], v[104:107]
    ds_read_b128 a[208:211], v2 offset:43264
    s_waitcnt lgkmcnt(2)
    v_mfma_f32_16x16x32_bf16 v[68:71], a[192:195], a[96:99], 0
    v_exp_f32 v0, v0
    v_mfma_f32_16x16x32_bf16 v[68:71], a[196:199], a[100:103], v[68:71]
    ds_read_b128 a[212:215], v3 offset:43264
    v_fma_f32 v36, v90, s35, v27
    v_mfma_f32_16x16x32_bf16 v[68:71], a[200:203], a[104:107], v[68:71]
    v_exp_f32 v36, v36
    v_mfma_f32_16x16x32_bf16 v[76:79], a[192:195], a[120:123], 0
    v_fma_f32 v37, v91, s35, v27
    v_cvt_pk_bf16_f32 v60, v39, v0
    v_mfma_f32_16x16x32_bf16 v[76:79], a[196:199], a[124:127], v[76:79]
    v_exp_f32 v37, v37
    v_mfma_f32_16x16x32_bf16 v[76:79], a[200:203], a[128:131], v[76:79]
    v_fma_f32 v38, v92, s35, v27
    v_fma_f32 v39, v93, s35, v27
    v_mfma_f32_16x16x32_bf16 v[100:103], a[192:195], a[144:147], 0
    v_accvgpr_write_b32 a96, v208
    v_accvgpr_write_b32 a97, v209
    v_accvgpr_write_b32 a98, v210
    v_accvgpr_write_b32 a99, v211
    v_mfma_f32_16x16x32_bf16 v[100:103], a[196:199], a[148:151], v[100:103]
    v_exp_f32 v38, v38
    v_mfma_f32_16x16x32_bf16 v[100:103], a[200:203], a[152:155], v[100:103]
    s_waitcnt lgkmcnt(0)
    v_accvgpr_write_b32 a120, v232
    v_accvgpr_write_b32 a121, v233
    v_mfma_f32_16x16x32_bf16 v[108:111], a[192:195], a[168:171], 0
    ds_read_b64_tr_b16 a[192:193], v4 offset:24576
    ds_read_b64_tr_b16 a[194:195], v4 offset:30720
    v_mfma_f32_16x16x32_bf16 v[108:111], a[196:199], a[172:175], v[108:111]
    v_exp_f32 v39, v39
    v_mfma_f32_16x16x32_bf16 v[108:111], a[200:203], a[176:179], v[108:111]
    ds_read_b64_tr_b16 a[196:197], v5 offset:24576
    ds_read_b64_tr_b16 a[198:199], v5 offset:30720
    v_accvgpr_write_b32 a122, v234
    v_mfma_f32_16x16x32_bf16 v[68:71], a[204:207], a[108:111], v[68:71]
    v_accvgpr_write_b32 a123, v235
    v_accvgpr_write_b32 a100, v212
    v_mfma_f32_16x16x32_bf16 v[68:71], a[208:211], a[112:115], v[68:71]
    ds_read_b64_tr_b16 a[200:201], v6 offset:24576
    ds_read_b64_tr_b16 a[202:203], v6 offset:30720
    v_mfma_f32_16x16x32_bf16 v[68:71], a[212:215], a[116:119], v[68:71]
    v_cvt_pk_bf16_f32 v61, v36, v37
    v_accvgpr_write_b32 a101, v213
    v_accvgpr_write_b32 a102, v214
    v_mfma_f32_16x16x32_bf16 v[76:79], a[204:207], a[132:135], v[76:79]
    v_fma_f32 v0, v94, s35, v27
    v_fma_f32 v36, v95, s35, v27
    v_mfma_f32_16x16x32_bf16 v[76:79], a[208:211], a[136:139], v[76:79]
    v_exp_f32 v0, v0
    v_mfma_f32_16x16x32_bf16 v[76:79], a[212:215], a[140:143], v[76:79]
    v_exp_f32 v36, v36
    v_accvgpr_write_b32 a103, v215
    v_mfma_f32_16x16x32_bf16 v[100:103], a[204:207], a[156:159], v[100:103]
    v_accvgpr_write_b32 a124, v236
    v_cvt_pk_bf16_f32 v62, v38, v39
    v_mfma_f32_16x16x32_bf16 v[100:103], a[208:211], a[160:163], v[100:103]
    v_accvgpr_write_b32 a125, v237
    v_cvt_pk_bf16_f32 v63, v0, v36
    v_mfma_f32_16x16x32_bf16 v[100:103], a[212:215], a[164:167], v[100:103]
    buffer_store_dwordx4 a[216:219], v13, s[24:27], s86 offen offset:2048 sc1
    v_mfma_f32_16x16x32_bf16 v[108:111], a[204:207], a[180:183], v[108:111]
    ds_read_b64_tr_b16 a[204:205], v7 offset:24576
    ds_read_b64_tr_b16 a[206:207], v7 offset:30720
    v_mfma_f32_16x16x32_bf16 v[108:111], a[208:211], a[184:187], v[108:111]
    s_mov_b32 m0, s49
    v_fma_f32 v37, v64, s35, v24
    v_accvgpr_write_b32 a126, v238
    v_mfma_f32_16x16x32_bf16 v[108:111], a[212:215], a[188:191], v[108:111]
    ds_read_b64_tr_b16 a[208:209], v4 offset:24704
    ds_read_b64_tr_b16 a[210:211], v4 offset:30848
    v_mfma_f32_16x16x32_bf16 v[28:31], a[248:251], v[56:59], 0
    buffer_load_dwordx4 v8, s[16:19], s52 offen nt lds
    v_mfma_f32_16x16x32_bf16 v[28:31], a[252:255], v[60:63], v[28:31]
    ds_read_b64_tr_b16 a[212:213], v5 offset:24704
    ds_read_b64_tr_b16 a[214:215], v5 offset:30848
    s_waitcnt lgkmcnt(6)
    v_mfma_f32_16x16x32_bf16 v[112:115], a[192:195], v[40:43], v[112:115]
    s_waitcnt vmcnt(15)
    v_fma_f32 v38, v65, s35, v24
    v_accvgpr_write_b32 a127, v239
    v_mfma_f32_16x16x32_bf16 v[116:119], a[192:195], v[44:47], v[116:119]
    ds_read_b128 a[144:147], v14 offset:0
    ds_read_b128 a[168:171], v14 offset:6144
    v_accvgpr_write_b32 a104, v216
    v_mfma_f32_16x16x32_bf16 v[120:123], a[196:199], v[40:43], v[120:123]
    v_fma_f32 v39, v66, s35, v24
    v_cmp_nge_f32 vcc, s37, v30
    v_mfma_f32_16x16x32_bf16 v[124:127], a[196:199], v[44:47], v[124:127]
    v_exp_f32 v37, v37
    v_accvgpr_write_b32 a105, v217
    v_mfma_f32_16x16x32_bf16 v[128:131], a[200:203], v[40:43], v[128:131]
    v_exp_f32 v38, v38
    v_accvgpr_write_b32 a106, v218
    v_mfma_f32_16x16x32_bf16 v[132:135], a[200:203], v[44:47], v[132:135]
    v_fma_f32 v0, v67, s35, v24
    v_accvgpr_write_b32 a107, v219
    s_cbranch_vccnz L_tr_T14_B
L_ret_T14_B:
    v_mfma_f32_16x16x32_bf16 a[0:3], a[192:195], v[56:59], a[0:3]
    v_exp_f32 v39, v39
    v_mfma_f32_16x16x32_bf16 a[4:7], a[192:195], v[60:63], a[4:7]
    ds_read_b64_tr_b16 a[192:193], v6 offset:24704
    ds_read_b64_tr_b16 a[194:195], v6 offset:30848
    v_add_f32 v21, v21, v28
    v_mfma_f32_16x16x32_bf16 a[8:11], a[196:199], v[56:59], a[8:11]
    buffer_load_dwordx4 v9, s[16:19], s52 offen offset:1024 nt lds
    v_add_f32 v23, v23, v29
    v_mfma_f32_16x16x32_bf16 a[12:15], a[196:199], v[60:63], a[12:15]
    ds_read_b64_tr_b16 a[196:197], v7 offset:24704
    ds_read_b64_tr_b16 a[198:199], v7 offset:30848
    v_mfma_f32_16x16x32_bf16 a[16:19], a[200:203], v[56:59], a[16:19]
    s_waitcnt lgkmcnt(6)
    v_cvt_pk_bf16_f32 v48, v37, v38
    v_accvgpr_write_b32 a128, v240
    v_mfma_f32_16x16x32_bf16 a[20:23], a[200:203], v[60:63], a[20:23]
    ds_read_b64_tr_b16 a[200:201], v4 offset:24832
    ds_read_b64_tr_b16 a[202:203], v4 offset:30976
    v_fma_f32 v36, v72, s35, v25
    v_mfma_f32_16x16x32_bf16 v[136:139], a[204:207], v[40:43], v[136:139]
    v_exp_f32 v0, v0
    v_mfma_f32_16x16x32_bf16 v[140:143], a[204:207], v[44:47], v[140:143]
    ds_read_b128 a[148:151], v15 offset:0
    ds_read_b128 a[172:175], v15 offset:6144
    v_accvgpr_write_b32 a129, v241
    v_mfma_f32_16x16x32_bf16 a[24:27], a[204:207], v[56:59], a[24:27]
    v_exp_f32 v36, v36
    v_accvgpr_write_b32 a130, v242
    v_mfma_f32_16x16x32_bf16 a[28:31], a[204:207], v[60:63], a[28:31]
    ds_read_b64_tr_b16 a[204:205], v5 offset:24832
    ds_read_b64_tr_b16 a[206:207], v5 offset:30976
    v_mfma_f32_16x16x32_bf16 v[144:147], a[208:211], v[40:43], v[144:147]
    buffer_load_dwordx4 v10, s[16:19], s52 offen offset:2048 nt lds
    v_fma_f32 v37, v73, s35, v25
    v_mfma_f32_16x16x32_bf16 v[148:151], a[208:211], v[44:47], v[148:151]
    ds_read_b128 a[152:155], v14 offset:128
    ds_read_b128 a[176:179], v14 offset:6272
    v_accvgpr_write_b32 a131, v243
    v_mfma_f32_16x16x32_bf16 a[32:35], a[208:211], v[56:59], a[32:35]
    v_exp_f32 v37, v37
    v_mfma_f32_16x16x32_bf16 a[36:39], a[208:211], v[60:63], a[36:39]
    ds_read_b64_tr_b16 a[208:209], v6 offset:24832
    ds_read_b64_tr_b16 a[210:211], v6 offset:30976
    v_accvgpr_write_b32 a108, v220
    v_mfma_f32_16x16x32_bf16 v[152:155], a[212:215], v[40:43], v[152:155]
    v_cvt_pk_bf16_f32 v49, v39, v0
    v_fma_f32 v38, v74, s35, v25
    v_accvgpr_write_b32 a109, v221
    v_mfma_f32_16x16x32_bf16 v[156:159], a[212:215], v[44:47], v[156:159]
    ds_read_b128 a[156:159], v15 offset:128
    ds_read_b128 a[180:183], v15 offset:6272
    v_fma_f32 v39, v75, s35, v25
    v_mfma_f32_16x16x32_bf16 a[40:43], a[212:215], v[56:59], a[40:43]
    s_waitcnt lgkmcnt(10)
    v_cvt_pk_bf16_f32 v52, v36, v37
    v_mfma_f32_16x16x32_bf16 a[44:47], a[212:215], v[60:63], a[44:47]
    ds_read_b64_tr_b16 a[212:213], v7 offset:24832
    ds_read_b64_tr_b16 a[214:215], v7 offset:30976
    v_accvgpr_write_b32 a110, v222
    v_mfma_f32_16x16x32_bf16 v[160:163], a[192:195], v[40:43], v[160:163]
    v_exp_f32 v38, v38
    v_accvgpr_write_b32 a111, v223
    v_mfma_f32_16x16x32_bf16 v[164:167], a[192:195], v[44:47], v[164:167]
    ds_read_b128 a[160:163], v14 offset:256
    ds_read_b128 a[184:187], v14 offset:6400
    v_mfma_f32_16x16x32_bf16 a[48:51], a[192:195], v[56:59], a[48:51]
    v_exp_f32 v39, v39
    v_accvgpr_write_b32 a132, v244
    v_mfma_f32_16x16x32_bf16 a[52:55], a[192:195], v[60:63], a[52:55]
    ds_read_b128 a[192:195], v2 offset:0
    v_fma_f32 v0, v68, s35, v24
    v_accvgpr_write_b32 a133, v245
    v_mfma_f32_16x16x32_bf16 v[168:171], a[196:199], v[40:43], v[168:171]
    v_exp_f32 v0, v0
    v_mfma_f32_16x16x32_bf16 v[172:175], a[196:199], v[44:47], v[172:175]
    ds_read_b128 a[164:167], v15 offset:256
    ds_read_b128 a[188:191], v15 offset:6400
    v_accvgpr_write_b32 a134, v246
L_hop_12:
    s_cbranch_execz L_hop_16
    v_mfma_f32_16x16x32_bf16 a[56:59], a[196:199], v[56:59], a[56:59]
    v_fma_f32 v36, v69, s35, v24
    v_cvt_pk_bf16_f32 v53, v38, v39
    v_accvgpr_write_b32 a135, v247
    v_mfma_f32_16x16x32_bf16 a[60:63], a[196:199], v[60:63], a[60:63]
    ds_read_b128 a[196:199], v3 offset:0
    v_fma_f32 v37, v70, s35, v24
    v_mfma_f32_16x16x32_bf16 v[176:179], a[200:203], v[40:43], v[176:179]
    v_exp_f32 v36, v36
    v_accvgpr_write_b32 a112, v224
    v_mfma_f32_16x16x32_bf16 v[180:183], a[200:203], v[44:47], v[180:183]
    v_exp_f32 v37, v37
    v_accvgpr_write_b32 a113, v225
    v_mfma_f32_16x16x32_bf16 a[64:67], a[200:203], v[56:59], a[64:67]
    v_accvgpr_write_b32 a114, v226
    v_fma_f32 v38, v71, s35, v24
    v_mfma_f32_16x16x32_bf16 a[68:71], a[200:203], v[60:63], a[68:71]
    ds_read_b128 a[200:203], v2 offset:128
    s_waitcnt lgkmcnt(7)
    v_cvt_pk_bf16_f32 v50, v0, v36
    v_mfma_f32_16x16x32_bf16 v[184:187], a[204:207], v[40:43], v[184:187]
    v_exp_f32 v38, v38
    v_accvgpr_write_b32 a115, v227
    v_mfma_f32_16x16x32_bf16 v[188:191], a[204:207], v[44:47], v[188:191]
    v_accvgpr_write_b32 a136, v248
    v_fma_f32 v39, v76, s35, v25
    v_fma_f32 v0, v77, s35, v25
    v_mfma_f32_16x16x32_bf16 a[72:75], a[204:207], v[56:59], a[72:75]
    v_exp_f32 v39, v39
    v_mfma_f32_16x16x32_bf16 a[76:79], a[204:207], v[60:63], a[76:79]
    ds_read_b128 a[204:207], v3 offset:128
    v_accvgpr_write_b32 a137, v249
    v_accvgpr_write_b32 a138, v250
    v_mfma_f32_16x16x32_bf16 v[192:195], a[208:211], v[40:43], v[192:195]
    v_exp_f32 v0, v0
    v_accvgpr_write_b32 a139, v251
    v_mfma_f32_16x16x32_bf16 v[196:199], a[208:211], v[44:47], v[196:199]
    v_cvt_pk_bf16_f32 v51, v37, v38
    v_accvgpr_write_b32 a116, v228
    v_mfma_f32_16x16x32_bf16 a[80:83], a[208:211], v[56:59], a[80:83]
    v_fma_f32 v36, v78, s35, v25
    v_fma_f32 v37, v79, s35, v25
    v_accvgpr_write_b32 a117, v229
    v_mfma_f32_16x16x32_bf16 a[84:87], a[208:211], v[60:63], a[84:87]
    ds_read_b128 a[208:211], v2 offset:256
    v_cvt_pk_bf16_f32 v54, v39, v0
    v_accvgpr_write_b32 a118, v230
    v_mfma_f32_16x16x32_bf16 v[200:203], a[212:215], v[40:43], v[200:203]
    v_exp_f32 v36, v36
    v_mfma_f32_16x16x32_bf16 v[204:207], a[212:215], v[44:47], v[204:207]
    v_exp_f32 v37, v37
    v_accvgpr_write_b32 a119, v231
    v_mfma_f32_16x16x32_bf16 a[88:91], a[212:215], v[56:59], a[88:91]
    v_cvt_pk_bf16_f32 v55, v36, v37
    v_accvgpr_write_b32 a140, v252
    v_accvgpr_write_b32 a141, v253
    v_mfma_f32_16x16x32_bf16 a[92:95], a[212:215], v[60:63], a[92:95]
    ds_read_b128 a[212:215], v3 offset:256
    v_accvgpr_write_b32 a142, v254
    v_mfma_f32_16x16x32_bf16 v[28:31], a[248:251], v[48:51], 0
    s_waitcnt vmcnt(14)
    s_barrier
    v_mfma_f32_16x16x32_bf16 v[28:31], a[252:255], v[52:55], v[28:31]
    s_waitcnt lgkmcnt(3)
    v_accvgpr_write_b32 a143, v255
L_x:
    v_mfma_f32_16x16x32_bf16 v[80:83], a[192:195], a[144:147], 0
    v_fma_f32 v36, v96, s35, v26
    v_fma_f32 v37, v97, s35, v26
    v_mfma_f32_16x16x32_bf16 v[80:83], a[196:199], a[148:151], v[80:83]
    v_exp_f32 v36, v36
    v_fma_f32 v38, v98, s35, v26
    v_mfma_f32_16x16x32_bf16 v[80:83], a[200:203], a[152:155], v[80:83]
    s_mov_b32 m0, s45
    v_cmp_nge_f32 vcc, s37, v30
    v_mfma_f32_16x16x32_bf16 v[88:91], a[192:195], a[168:171], 0
    v_exp_f32 v37, v37
    v_mfma_f32_16x16x32_bf16 v[88:91], a[196:199], a[172:175], v[88:91]
    buffer_load_dwordx4 v8, s[12:15], s54 offen nt lds
    v_mfma_f32_16x16x32_bf16 v[88:91], a[200:203], a[176:179], v[88:91]
    v_fma_f32 v39, v99, s35, v26
    s_cbranch_vccnz L_tr_T15_A
L_ret_T15_A:
    v_mfma_f32_16x16x32_bf16 v[64:67], a[192:195], a[96:99], 0
    v_exp_f32 v38, v38
    v_add_f32 v17, v17, v28
    v_mfma_f32_16x16x32_bf16 v[64:67], a[196:199], a[100:103], v[64:67]
    v_exp_f32 v39, v39
    v_add_f32 v19, v19, v29
    v_mfma_f32_16x16x32_bf16 v[64:67], a[200:203], a[104:107], v[64:67]
    buffer_load_dwordx4 v9, s[12:15], s54 offen offset:1024 nt lds
    v_mfma_f32_16x16x32_bf16 v[72:75], a[192:195], a[120:123], 0
    ds_read_b128 a[192:195], v2 offset:6144
    v_cvt_pk_bf16_f32 v56, v36, v37
    v_permlane32_swap_b32 v17, v19
    v_mfma_f32_16x16x32_bf16 v[72:75], a[196:199], a[124:127], v[72:75]
    v_fma_f32 v0, v100, s35, v26
    v_fma_f32 v36, v101, s35, v26
    v_mfma_f32_16x16x32_bf16 v[72:75], a[200:203], a[128:131], v[72:75]
    ds_read_b128 a[196:199], v3 offset:6144
    s_waitcnt lgkmcnt(2)
    v_mfma_f32_16x16x32_bf16 v[64:67], a[204:207], a[108:111], v[64:67]
    buffer_load_dwordx4 v10, s[12:15], s54 offen offset:2048 nt lds
    v_mfma_f32_16x16x32_bf16 v[64:67], a[208:211], a[112:115], v[64:67]
    ds_read_b128 a[200:203], v2 offset:6272
    v_cvt_pk_bf16_f32 v57, v38, v39
    v_mfma_f32_16x16x32_bf16 v[64:67], a[212:215], a[116:119], v[64:67]
    v_exp_f32 v0, v0
    v_add_f32 v17, v17, v19
    v_mfma_f32_16x16x32_bf16 v[72:75], a[204:207], a[132:135], v[72:75]
    v_exp_f32 v36, v36
    v_mfma_f32_16x16x32_bf16 v[72:75], a[208:211], a[136:139], v[72:75]
    v_mov_b32 v19, v17
    v_fma_f32 v37, v102, s35, v26
    v_mfma_f32_16x16x32_bf16 v[72:75], a[212:215], a[140:143], v[72:75]
    v_exp_f32 v37, v37
    v_mfma_f32_16x16x32_bf16 v[80:83], a[204:207], a[156:159], v[80:83]
    v_permlane16_swap_b32 v17, v19
    v_mfma_f32_16x16x32_bf16 v[80:83], a[208:211], a[160:163], v[80:83]
    v_fma_f32 v38, v103, s35, v26
    v_cvt_pk_bf16_f32 v58, v0, v36
    v_mfma_f32_16x16x32_bf16 v[80:83], a[212:215], a[164:167], v[80:83]
    buffer_store_dwordx4 a[220:223], v11, s[24:27], s87 offen sc1
    v_mfma_f32_16x16x32_bf16 v[88:91], a[204:207], a[180:183], v[88:91]
    ds_read_b128 a[204:207], v3 offset:6272
    v_fma_f32 v39, v104, s35, v27
    v_mfma_f32_16x16x32_bf16 v[88:91], a[208:211], a[184:187], v[88:91]
    v_exp_f32 v38, v38
    v_mfma_f32_16x16x32_bf16 v[88:91], a[212:215], a[188:191], v[88:91]
    ds_read_b128 a[208:211], v2 offset:6400
    s_waitcnt lgkmcnt(2)
    v_add_f32 v17, v17, v19
    v_mfma_f32_16x16x32_bf16 v[68:71], a[192:195], a[96:99], 0
    v_exp_f32 v39, v39
    v_mfma_f32_16x16x32_bf16 v[68:71], a[196:199], a[100:103], v[68:71]
    ds_read_b128 a[212:215], v3 offset:6400
    v_fma_f32 v0, v105, s35, v27
    v_mfma_f32_16x16x32_bf16 v[68:71], a[200:203], a[104:107], v[68:71]
    v_rcp_f32 v16, v17
    v_mfma_f32_16x16x32_bf16 v[76:79], a[192:195], a[120:123], 0
    v_exp_f32 v0, v0
    v_mfma_f32_16x16x32_bf16 v[76:79], a[196:199], a[124:127], v[76:79]
    v_rcp_f32 v18, v17
    v_mfma_f32_16x16x32_bf16 v[76:79], a[200:203], a[128:131], v[76:79]
    v_cvt_pk_bf16_f32 v59, v37, v38
    v_fma_f32 v36, v106, s35, v27
    v_mfma_f32_16x16x32_bf16 v[84:87], a[192:195], a[144:147], 0
    v_exp_f32 v36, v36
    v_mfma_f32_16x16x32_bf16 v[84:87], a[196:199], a[148:151], v[84:87]
    v_fma_f32 v37, v107, s35, v27
    v_cvt_pk_bf16_f32 v60, v39, v0
    v_mfma_f32_16x16x32_bf16 v[84:87], a[200:203], a[152:155], v[84:87]
    s_waitcnt lgkmcnt(0)
    v_permlane32_swap_b32 v16, v18
    v_mfma_f32_16x16x32_bf16 v[92:95], a[192:195], a[168:171], 0
    ds_read_b64_tr_b16 a[192:193], v4 offset:36864
    ds_read_b64_tr_b16 a[194:195], v4 offset:43008
    v_mfma_f32_16x16x32_bf16 v[92:95], a[196:199], a[172:175], v[92:95]
    v_exp_f32 v37, v37
    v_mfma_f32_16x16x32_bf16 v[92:95], a[200:203], a[176:179], v[92:95]
    ds_read_b64_tr_b16 a[196:197], v5 offset:36864
    ds_read_b64_tr_b16 a[198:199], v5 offset:43008
    v_mfma_f32_16x16x32_bf16 v[68:71], a[204:207], a[108:111], v[68:71]
    buffer_store_dwordx4 a[224:227], v12, s[24:27], s87 offen offset:1024 sc1
    v_mfma_f32_16x16x32_bf16 v[68:71], a[208:211], a[112:115], v[68:71]
    ds_read_b64_tr_b16 a[200:201], v6 offset:36864
    ds_read_b64_tr_b16 a[202:203], v6 offset:43008
    v_mfma_f32_16x16x32_bf16 v[68:71], a[212:215], a[116:119], v[68:71]
    v_fma_f32 v38, v108, s35, v27
    v_fma_f32 v39, v109, s35, v27
    v_mfma_f32_16x16x32_bf16 v[76:79], a[204:207], a[132:135], v[76:79]
    v_exp_f32 v38, v38
    v_mfma_f32_16x16x32_bf16 v[76:79], a[208:211], a[136:139], v[76:79]
    v_exp_f32 v39, v39
    v_mfma_f32_16x16x32_bf16 v[76:79], a[212:215], a[140:143], v[76:79]
    v_cvt_pk_bf16_f32 v61, v36, v37
    v_fma_f32 v0, v110, s35, v27
    v_mfma_f32_16x16x32_bf16 v[84:87], a[204:207], a[156:159], v[84:87]
    v_exp_f32 v0, v0
    v_mfma_f32_16x16x32_bf16 v[84:87], a[208:211], a[160:163], v[84:87]
    v_fma_f32 v36, v111, s35, v27
    v_cvt_pk_bf16_f32 v62, v38, v39
    v_mfma_f32_16x16x32_bf16 v[84:87], a[212:215], a[164:167], v[84:87]
    buffer_store_dwordx4 a[228:231], v13, s[24:27], s87 offen offset:2048 sc1
    v_mfma_f32_16x16x32_bf16 v[92:95], a[204:207], a[180:183], v[92:95]
    ds_read_b64_tr_b16 a[204:205], v7 offset:36864
    ds_read_b64_tr_b16 a[206:207], v7 offset:43008
    v_mfma_f32_16x16x32_bf16 v[92:95], a[208:211], a[184:187], v[92:95]
    s_mov_b32 m0, s50
    v_exp_f32 v36, v36
    s_nop 0
    v_cvt_pk_bf16_f32 v63, v0, v36
    v_mfma_f32_16x16x32_bf16 v[92:95], a[212:215], a[188:191], v[92:95]
    ds_read_b64_tr_b16 a[208:209], v4 offset:36992
    ds_read_b64_tr_b16 a[210:211], v4 offset:43136
    s_add_u32 s24, s10, s32
    v_mfma_f32_16x16x32_bf16 v[28:31], a[248:251], v[56:59], 0
    buffer_load_dwordx4 v8, s[16:19], s53 offen nt lds
    v_mfma_f32_16x16x32_bf16 v[28:31], a[252:255], v[60:63], v[28:31]
    ds_read_b64_tr_b16 a[212:213], v5 offset:36992
    ds_read_b64_tr_b16 a[214:215], v5 offset:43136
    s_waitcnt lgkmcnt(6)
    v_mfma_f32_16x16x32_bf16 v[112:115], a[192:195], v[48:51], v[112:115]
    s_addc_u32 s25, s11, 0
    s_mov_b32 s26, 98304
    v_mfma_f32_16x16x32_bf16 v[116:119], a[192:195], v[52:55], v[116:119]
    s_mov_b32 s96, s24
    s_mov_b32 s97, s25
    v_mfma_f32_16x16x32_bf16 v[120:123], a[196:199], v[48:51], v[120:123]
    s_cmp_eq_u32 s34, 1
    v_cmp_nge_f32 vcc, s37, v30
    v_mfma_f32_16x16x32_bf16 v[124:127], a[196:199], v[52:55], v[124:127]
    s_cselect_b32 s98, 98304, 0
    v_mfma_f32_16x16x32_bf16 v[128:131], a[200:203], v[48:51], v[128:131]
    v_mfma_f32_16x16x32_bf16 v[132:135], a[200:203], v[52:55], v[132:135]
    s_cbranch_vccnz L_tr_T15_B
L_ret_T15_B:
    v_mfma_f32_16x16x32_bf16 a[0:3], a[192:195], v[56:59], a[0:3]
    v_add_f32 v21, v21, v28
    v_add_f32 v23, v23, v29
    v_max3_f32 v33, v64, v65, v66
    v_max3_f32 v34, v72, v73, v74
    v_mfma_f32_16x16x32_bf16 a[4:7], a[192:195], v[60:63], a[4:7]
    ds_read_b64_tr_b16 a[192:193], v6 offset:36992
    ds_read_b64_tr_b16 a[194:195], v6 offset:43136
    v_max3_f32 v33, v33, v67, v68
    v_max3_f32 v34, v34, v75, v76
    v_mfma_f32_16x16x32_bf16 a[8:11], a[196:199], v[56:59], a[8:11]
    buffer_load_dwordx4 v9, s[16:19], s53 offen offset:1024 nt lds
    v_max3_f32 v33, v33, v69, v70
    v_mfma_f32_16x16x32_bf16 a[12:15], a[196:199], v[60:63], a[12:15]
    ds_read_b64_tr_b16 a[196:197], v7 offset:36992
    ds_read_b64_tr_b16 a[198:199], v7 offset:43136
    v_permlane32_swap_b32 v21, v23
    v_max3_f32 v34, v34, v77, v78
    v_pk_mul_f32 v[112:113], v[112:113], v[16:17] op_sel_hi:[1,0]
    v_pk_mul_f32 v[114:115], v[114:115], v[16:17] op_sel_hi:[1,0]
    v_pk_mul_f32 v[116:117], v[116:117], v[18:19] op_sel_hi:[1,0]
    v_pk_mul_f32 v[118:119], v[118:119], v[18:19] op_sel_hi:[1,0]
    v_pk_mul_f32 v[120:121], v[120:121], v[16:17] op_sel_hi:[1,0]
    v_pk_mul_f32 v[122:123], v[122:123], v[16:17] op_sel_hi:[1,0]
    v_pk_mul_f32 v[124:125], v[124:125], v[18:19] op_sel_hi:[1,0]
    v_pk_mul_f32 v[126:127], v[126:127], v[18:19] op_sel_hi:[1,0]
    v_add_f32 v21, v21, v23
    v_mfma_f32_16x16x32_bf16 a[16:19], a[200:203], v[56:59], a[16:19]
    s_waitcnt lgkmcnt(4)
    v_mov_b32 v23, v21
    v_mfma_f32_16x16x32_bf16 a[20:23], a[200:203], v[60:63], a[20:23]
    ds_read_b64_tr_b16 a[200:201], v4 offset:37120
    ds_read_b64_tr_b16 a[202:203], v4 offset:43264
    v_mfma_f32_16x16x32_bf16 v[136:139], a[204:207], v[48:51], v[136:139]
    v_permlane16_swap_b32 v21, v23
    v_mfma_f32_16x16x32_bf16 v[140:143], a[204:207], v[52:55], v[140:143]
    v_add_f32 v21, v21, v23
    v_max_f32 v33, v33, v71
    v_rcp_f32 v20, v21
    v_max_f32 v34, v34, v79
    v_mfma_f32_16x16x32_bf16 a[24:27], a[204:207], v[56:59], a[24:27]
    v_rcp_f32 v22, v21
    v_permlane32_swap_b32 v33, v34
    v_max_f32 v33, v33, v34
    v_mfma_f32_16x16x32_bf16 a[28:31], a[204:207], v[60:63], a[28:31]
    ds_read_b64_tr_b16 a[204:205], v5 offset:37120
    ds_read_b64_tr_b16 a[206:207], v5 offset:43264
    v_permlane32_swap_b32 v20, v22
    v_mfma_f32_16x16x32_bf16 v[144:147], a[208:211], v[48:51], v[144:147]
    buffer_load_dwordx4 v10, s[16:19], s53 offen offset:2048 nt lds
    v_mov_b32 v34, v33
    v_cvt_pk_bf16_f32 v112, v112, v113
    v_cvt_pk_bf16_f32 v113, v114, v115
    v_mfma_f32_16x16x32_bf16 v[148:151], a[208:211], v[52:55], v[148:151]
    ds_write_b64 v32, v[112:113] offset:0
    v_permlane16_swap_b32 v33, v34
    v_mfma_f32_16x16x32_bf16 a[32:35], a[208:211], v[56:59], a[32:35]
    v_max_f32 v33, v33, v34
    v_mul_f32 v24, s36, v33
    v_mul_f32 v25, s36, v33
    v_cvt_pk_bf16_f32 v114, v116, v117
    v_mfma_f32_16x16x32_bf16 a[36:39], a[208:211], v[60:63], a[36:39]
    ds_read_b64_tr_b16 a[208:209], v6 offset:37120
    ds_read_b64_tr_b16 a[210:211], v6 offset:43264
    v_permlane32_swap_b32 v24, v25
    v_fma_f32 v37, v64, s35, v24
    v_mfma_f32_16x16x32_bf16 v[152:155], a[212:215], v[48:51], v[152:155]
    v_exp_f32 v37, v37
    v_fma_f32 v38, v65, s35, v24
    v_fma_f32 v39, v66, s35, v24
    v_mfma_f32_16x16x32_bf16 v[156:159], a[212:215], v[52:55], v[156:159]
    v_exp_f32 v38, v38
    v_cvt_pk_bf16_f32 v115, v118, v119
    v_cvt_pk_bf16_f32 v116, v120, v121
    v_cvt_pk_bf16_f32 v117, v122, v123
    v_mfma_f32_16x16x32_bf16 a[40:43], a[212:215], v[56:59], a[40:43]
    s_waitcnt lgkmcnt(5)
    v_fma_f32 v0, v67, s35, v24
    v_cvt_pk_bf16_f32 v118, v124, v125
    v_cvt_pk_bf16_f32 v119, v126, v127
    v_cvt_pk_bf16_f32 v40, v37, v38
    v_mfma_f32_16x16x32_bf16 a[44:47], a[212:215], v[60:63], a[44:47]
    ds_read_b64_tr_b16 a[212:213], v7 offset:37120
    ds_read_b64_tr_b16 a[214:215], v7 offset:43264
    v_accvgpr_read_b32 v120, a0
    v_exp_f32 v39, v39
    v_mfma_f32_16x16x32_bf16 v[160:163], a[192:195], v[48:51], v[160:163]
    ds_write_b64 v32, v[114:115] offset:6144
    v_accvgpr_read_b32 v121, a1
    v_mfma_f32_16x16x32_bf16 v[164:167], a[192:195], v[52:55], v[164:167]
    v_exp_f32 v0, v0
    v_accvgpr_read_b32 v122, a2
    v_accvgpr_read_b32 v123, a3
    v_accvgpr_read_b32 v124, a4
    v_accvgpr_read_b32 v125, a5
    v_accvgpr_read_b32 v126, a6
    v_accvgpr_read_b32 v127, a7
    v_pk_mul_f32 v[120:121], v[120:121], v[20:21] op_sel_hi:[1,0]
    v_pk_mul_f32 v[122:123], v[122:123], v[20:21] op_sel_hi:[1,0]
    v_pk_mul_f32 v[124:125], v[124:125], v[22:23] op_sel_hi:[1,0]
    v_pk_mul_f32 v[126:127], v[126:127], v[22:23] op_sel_hi:[1,0]
    v_fma_f32 v36, v68, s35, v24
    v_mfma_f32_16x16x32_bf16 a[48:51], a[192:195], v[56:59], a[48:51]
    v_exp_f32 v36, v36
    v_mfma_f32_16x16x32_bf16 a[52:55], a[192:195], v[60:63], a[52:55]
    ds_read_b128 a[192:195], v2 offset:12288
    v_xor_b32 v35, 32, v32
    v_mfma_f32_16x16x32_bf16 v[168:171], a[196:199], v[48:51], v[168:171]
    ds_write_b64 v35, v[116:117] offset:0
    v_mfma_f32_16x16x32_bf16 v[172:175], a[196:199], v[52:55], v[172:175]
    ds_write_b64 v35, v[118:119] offset:6144
    v_mfma_f32_16x16x32_bf16 a[56:59], a[196:199], v[56:59], a[56:59]
    v_fma_f32 v37, v69, s35, v24
    v_cvt_pk_bf16_f32 v41, v39, v0
    v_fma_f32 v38, v70, s35, v24
    v_exp_f32 v37, v37
    v_mfma_f32_16x16x32_bf16 a[60:63], a[196:199], v[60:63], a[60:63]
    ds_read_b128 a[196:199], v3 offset:12288
    v_fma_f32 v39, v71, s35, v24
    v_cvt_pk_bf16_f32 v208, v120, v121
    v_exp_f32 v38, v38
    v_mfma_f32_16x16x32_bf16 v[176:179], a[200:203], v[48:51], v[176:179]
    v_exp_f32 v39, v39
    v_cvt_pk_bf16_f32 v209, v122, v123
    v_cvt_pk_bf16_f32 v210, v124, v125
    v_mfma_f32_16x16x32_bf16 v[180:183], a[200:203], v[52:55], v[180:183]
    v_cvt_pk_bf16_f32 v211, v126, v127
    v_accvgpr_read_b32 v120, a8
    v_cvt_pk_bf16_f32 v42, v36, v37
    v_accvgpr_read_b32 v121, a9
    v_mfma_f32_16x16x32_bf16 a[64:67], a[200:203], v[56:59], a[64:67]
    v_fma_f32 v0, v72, s35, v25
    v_accvgpr_read_b32 v122, a10
    v_fma_f32 v36, v73, s35, v25
    v_accvgpr_read_b32 v123, a11
    v_accvgpr_read_b32 v124, a12
    v_accvgpr_read_b32 v125, a13
    v_accvgpr_read_b32 v126, a14
    v_accvgpr_read_b32 v127, a15
    v_pk_mul_f32 v[120:121], v[120:121], v[20:21] op_sel_hi:[1,0]
    v_pk_mul_f32 v[122:123], v[122:123], v[20:21] op_sel_hi:[1,0]
    v_pk_mul_f32 v[124:125], v[124:125], v[22:23] op_sel_hi:[1,0]
    v_pk_mul_f32 v[126:127], v[126:127], v[22:23] op_sel_hi:[1,0]
    v_exp_f32 v0, v0
    v_mfma_f32_16x16x32_bf16 a[68:71], a[200:203], v[60:63], a[68:71]
    ds_read_b128 a[200:203], v2 offset:12416
    s_waitcnt lgkmcnt(6)
    v_mfma_f32_16x16x32_bf16 v[184:187], a[204:207], v[48:51], v[184:187]
    v_exp_f32 v36, v36
    v_mfma_f32_16x16x32_bf16 v[188:191], a[204:207], v[52:55], v[188:191]
    v_cvt_pk_bf16_f32 v43, v38, v39
    v_fma_f32 v37, v74, s35, v25
    v_mfma_f32_16x16x32_bf16 a[72:75], a[204:207], v[56:59], a[72:75]
    v_exp_f32 v37, v37
    v_cvt_pk_bf16_f32 v212, v120, v121
    v_cvt_pk_bf16_f32 v213, v122, v123
    v_cvt_pk_bf16_f32 v214, v124, v125
    v_cvt_pk_bf16_f32 v215, v126, v127
    v_pk_mul_f32 v[128:129], v[128:129], v[16:17] op_sel_hi:[1,0]
    v_pk_mul_f32 v[130:131], v[130:131], v[16:17] op_sel_hi:[1,0]
    v_pk_mul_f32 v[132:133], v[132:133], v[18:19] op_sel_hi:[1,0]
    v_pk_mul_f32 v[134:135], v[134:135], v[18:19] op_sel_hi:[1,0]
    v_pk_mul_f32 v[136:137], v[136:137], v[16:17] op_sel_hi:[1,0]
    v_pk_mul_f32 v[138:139], v[138:139], v[16:17] op_sel_hi:[1,0]
    v_pk_mul_f32 v[140:141], v[140:141], v[18:19] op_sel_hi:[1,0]
    v_pk_mul_f32 v[142:143], v[142:143], v[18:19] op_sel_hi:[1,0]
    v_fma_f32 v38, v75, s35, v25
    v_mfma_f32_16x16x32_bf16 a[76:79], a[204:207], v[60:63], a[76:79]
    ds_read_b128 a[204:207], v3 offset:12416
    v_xor_b32 v35, 64, v32
    v_mfma_f32_16x16x32_bf16 v[192:195], a[208:211], v[48:51], v[192:195]
    v_exp_f32 v38, v38
    v_mfma_f32_16x16x32_bf16 v[196:199], a[208:211], v[52:55], v[196:199]
    v_cvt_pk_bf16_f32 v44, v0, v36
    v_fma_f32 v39, v76, s35, v25
    v_mfma_f32_16x16x32_bf16 a[80:83], a[208:211], v[56:59], a[80:83]
    v_exp_f32 v39, v39
    v_mfma_f32_16x16x32_bf16 a[84:87], a[208:211], v[60:63], a[84:87]
    ds_read_b128 a[208:211], v2 offset:12544
    v_fma_f32 v0, v77, s35, v25
    v_cvt_pk_bf16_f32 v45, v37, v38
    v_fma_f32 v36, v78, s35, v25
    v_mfma_f32_16x16x32_bf16 v[200:203], a[212:215], v[48:51], v[200:203]
    v_exp_f32 v0, v0
    v_cvt_pk_bf16_f32 v128, v128, v129
    v_cvt_pk_bf16_f32 v129, v130, v131
    v_mfma_f32_16x16x32_bf16 v[204:207], a[212:215], v[52:55], v[204:207]
    ds_write_b64 v35, v[128:129] offset:0
    v_fma_f32 v37, v79, s35, v25
    v_cvt_pk_bf16_f32 v130, v132, v133
    v_mfma_f32_16x16x32_bf16 a[88:91], a[212:215], v[56:59], a[88:91]
    v_exp_f32 v36, v36
    v_cvt_pk_bf16_f32 v46, v39, v0
    v_exp_f32 v37, v37
    s_nop 0
    v_cvt_pk_bf16_f32 v47, v36, v37
    v_mfma_f32_16x16x32_bf16 a[92:95], a[212:215], v[60:63], a[92:95]
    ds_read_b128 a[212:215], v3 offset:12544
    v_cvt_pk_bf16_f32 v131, v134, v135
    v_cvt_pk_bf16_f32 v132, v136, v137
    v_mfma_f32_16x16x32_bf16 v[28:31], a[248:251], v[40:43], 0
    s_waitcnt vmcnt(14)
    s_barrier
    v_cvt_pk_bf16_f32 v133, v138, v139
    v_cvt_pk_bf16_f32 v134, v140, v141
    v_mfma_f32_16x16x32_bf16 v[28:31], a[252:255], v[44:47], v[28:31]
    s_waitcnt lgkmcnt(4)
    v_cvt_pk_bf16_f32 v135, v142, v143
    v_accvgpr_read_b32 v136, a16
    v_accvgpr_read_b32 v137, a17
    v_mfma_f32_16x16x32_bf16 v[96:99], a[192:195], a[144:147], 0
    ds_write_b64 v35, v[130:131] offset:6144
    v_accvgpr_read_b32 v138, a18
    v_accvgpr_read_b32 v139, a19
    v_accvgpr_read_b32 v140, a20
    v_accvgpr_read_b32 v141, a21
    v_accvgpr_read_b32 v142, a22
    v_accvgpr_read_b32 v143, a23
    v_pk_mul_f32 v[136:137], v[136:137], v[20:21] op_sel_hi:[1,0]
    v_pk_mul_f32 v[138:139], v[138:139], v[20:21] op_sel_hi:[1,0]
    v_pk_mul_f32 v[140:141], v[140:141], v[22:23] op_sel_hi:[1,0]
    v_pk_mul_f32 v[142:143], v[142:143], v[22:23] op_sel_hi:[1,0]
    v_xor_b32 v35, 96, v32
    v_mfma_f32_16x16x32_bf16 v[96:99], a[196:199], a[148:151], v[96:99]
    ds_write_b64 v35, v[132:133] offset:0
    v_mfma_f32_16x16x32_bf16 v[96:99], a[200:203], a[152:155], v[96:99]
    s_mov_b32 m0, s42
    v_max3_f32 v33, v80, v81, v82
    v_mfma_f32_16x16x32_bf16 v[104:107], a[192:195], a[168:171], 0
    ds_write_b64 v35, v[134:135] offset:6144
    v_mfma_f32_16x16x32_bf16 v[104:107], a[196:199], a[172:175], v[104:107]
    buffer_load_dwordx4 v8, s[12:15], s55 offen nt lds
    v_max3_f32 v34, v88, v89, v90
    v_mfma_f32_16x16x32_bf16 v[104:107], a[200:203], a[176:179], v[104:107]
    v_max3_f32 v33, v33, v83, v84
    v_cvt_pk_bf16_f32 v216, v136, v137
    v_cvt_pk_bf16_f32 v217, v138, v139
    v_max3_f32 v34, v34, v91, v92
    v_cvt_pk_bf16_f32 v218, v140, v141
    v_mfma_f32_16x16x32_bf16 v[64:67], a[192:195], a[96:99], 0
    v_mov_b32 v17, v28
    v_max3_f32 v33, v33, v85, v86
    v_cvt_pk_bf16_f32 v219, v142, v143
    v_accvgpr_read_b32 v136, a24
    v_max3_f32 v34, v34, v93, v94
    v_mfma_f32_16x16x32_bf16 v[64:67], a[196:199], a[100:103], v[64:67]
    v_mov_b32 v19, v29
    v_accvgpr_read_b32 v137, a25
    v_accvgpr_read_b32 v138, a26
    v_max_f32 v33, v33, v87
    v_mfma_f32_16x16x32_bf16 v[64:67], a[200:203], a[104:107], v[64:67]
    buffer_load_dwordx4 v9, s[12:15], s55 offen offset:1024 nt lds
    v_accvgpr_read_b32 v139, a27
    v_accvgpr_read_b32 v140, a28
    v_accvgpr_read_b32 v141, a29
    v_accvgpr_read_b32 v142, a30
    v_accvgpr_read_b32 v143, a31
    v_pk_mul_f32 v[136:137], v[136:137], v[20:21] op_sel_hi:[1,0]
    v_pk_mul_f32 v[138:139], v[138:139], v[20:21] op_sel_hi:[1,0]
    v_pk_mul_f32 v[140:141], v[140:141], v[22:23] op_sel_hi:[1,0]
    v_pk_mul_f32 v[142:143], v[142:143], v[22:23] op_sel_hi:[1,0]
    v_max_f32 v34, v34, v95
    v_mfma_f32_16x16x32_bf16 v[72:75], a[192:195], a[120:123], 0
    ds_read_b128 a[192:195], v2 offset:18432
    s_add_u32 s34, s34, 1
    v_mfma_f32_16x16x32_bf16 v[72:75], a[196:199], a[124:127], v[72:75]
    v_permlane32_swap_b32 v33, v34
    v_mfma_f32_16x16x32_bf16 v[72:75], a[200:203], a[128:131], v[72:75]
    ds_read_b128 a[196:199], v3 offset:18432
    s_waitcnt lgkmcnt(5)
    v_max_f32 v33, v33, v34
    v_mov_b32 v34, v33
    v_mfma_f32_16x16x32_bf16 v[64:67], a[204:207], a[108:111], v[64:67]
    buffer_load_dwordx4 v10, s[12:15], s55 offen offset:2048 nt lds
    v_cvt_pk_bf16_f32 v220, v136, v137
    v_cvt_pk_bf16_f32 v221, v138, v139
    v_cvt_pk_bf16_f32 v222, v140, v141
    v_cvt_pk_bf16_f32 v223, v142, v143
    v_pk_mul_f32 v[144:145], v[144:145], v[16:17] op_sel_hi:[1,0]
    v_pk_mul_f32 v[146:147], v[146:147], v[16:17] op_sel_hi:[1,0]
    v_pk_mul_f32 v[148:149], v[148:149], v[18:19] op_sel_hi:[1,0]
    v_pk_mul_f32 v[150:151], v[150:151], v[18:19] op_sel_hi:[1,0]
    v_pk_mul_f32 v[152:153], v[152:153], v[16:17] op_sel_hi:[1,0]
    v_pk_mul_f32 v[154:155], v[154:155], v[16:17] op_sel_hi:[1,0]
    v_pk_mul_f32 v[156:157], v[156:157], v[18:19] op_sel_hi:[1,0]
    v_pk_mul_f32 v[158:159], v[158:159], v[18:19] op_sel_hi:[1,0]
    v_permlane16_swap_b32 v33, v34
    v_mfma_f32_16x16x32_bf16 v[64:67], a[208:211], a[112:115], v[64:67]
    ds_read_b128 a[200:203], v2 offset:18560
    v_max_f32 v33, v33, v34
    v_mfma_f32_16x16x32_bf16 v[64:67], a[212:215], a[116:119], v[64:67]
    v_mul_f32 v26, s36, v33
    v_mul_f32 v27, s36, v33
    v_mfma_f32_16x16x32_bf16 v[72:75], a[204:207], a[132:135], v[72:75]
    v_cvt_pk_bf16_f32 v144, v144, v145
    v_cvt_pk_bf16_f32 v145, v146, v147
    v_mfma_f32_16x16x32_bf16 v[72:75], a[208:211], a[136:139], v[72:75]
    ds_write_b64 v32, v[144:145] offset:128
    v_mfma_f32_16x16x32_bf16 v[72:75], a[212:215], a[140:143], v[72:75]
    v_permlane32_swap_b32 v26, v27
    v_fma_f32 v36, v80, s35, v26
    v_fma_f32 v37, v81, s35, v26
    v_mfma_f32_16x16x32_bf16 v[96:99], a[204:207], a[156:159], v[96:99]
    v_exp_f32 v36, v36
    v_cvt_pk_bf16_f32 v146, v148, v149
    v_cvt_pk_bf16_f32 v147, v150, v151
    v_cvt_pk_bf16_f32 v148, v152, v153
    v_mfma_f32_16x16x32_bf16 v[96:99], a[208:211], a[160:163], v[96:99]
    ds_write_b64 v32, v[146:147] offset:6272
    v_cvt_pk_bf16_f32 v149, v154, v155
    v_fma_f32 v38, v82, s35, v26
    v_mfma_f32_16x16x32_bf16 v[96:99], a[212:215], a[164:167], v[96:99]
    v_exp_f32 v37, v37
    v_cvt_pk_bf16_f32 v150, v156, v157
    v_cvt_pk_bf16_f32 v151, v158, v159
    v_accvgpr_read_b32 v152, a32
    v_mfma_f32_16x16x32_bf16 v[104:107], a[204:207], a[180:183], v[104:107]
    ds_read_b128 a[204:207], v3 offset:18560
    v_accvgpr_read_b32 v153, a33
    v_accvgpr_read_b32 v154, a34
    v_fma_f32 v39, v83, s35, v26
    v_accvgpr_read_b32 v155, a35
    v_accvgpr_read_b32 v156, a36
    v_accvgpr_read_b32 v157, a37
    v_accvgpr_read_b32 v158, a38
    v_accvgpr_read_b32 v159, a39
    v_pk_mul_f32 v[152:153], v[152:153], v[20:21] op_sel_hi:[1,0]
    v_pk_mul_f32 v[154:155], v[154:155], v[20:21] op_sel_hi:[1,0]
    v_pk_mul_f32 v[156:157], v[156:157], v[22:23] op_sel_hi:[1,0]
    v_pk_mul_f32 v[158:159], v[158:159], v[22:23] op_sel_hi:[1,0]
    v_exp_f32 v38, v38
    v_mfma_f32_16x16x32_bf16 v[104:107], a[208:211], a[184:187], v[104:107]
    v_exp_f32 v39, v39
    v_mfma_f32_16x16x32_bf16 v[104:107], a[212:215], a[188:191], v[104:107]
    ds_read_b128 a[208:211], v2 offset:18688
    s_waitcnt lgkmcnt(4)
    v_mfma_f32_16x16x32_bf16 v[68:71], a[192:195], a[96:99], 0
    v_xor_b32 v35, 32, v32
    v_cvt_pk_bf16_f32 v56, v36, v37
    v_mfma_f32_16x16x32_bf16 v[68:71], a[196:199], a[100:103], v[68:71]
    ds_read_b128 a[212:215], v3 offset:18688
    v_cvt_pk_bf16_f32 v224, v152, v153
    v_fma_f32 v0, v84, s35, v26
    v_mfma_f32_16x16x32_bf16 v[68:71], a[200:203], a[104:107], v[68:71]
    ds_write_b64 v35, v[148:149] offset:128
    v_cvt_pk_bf16_f32 v225, v154, v155
    v_cvt_pk_bf16_f32 v226, v156, v157
    v_mfma_f32_16x16x32_bf16 v[76:79], a[192:195], a[120:123], 0
    ds_write_b64 v35, v[150:151] offset:6272
    v_fma_f32 v36, v85, s35, v26
    v_cvt_pk_bf16_f32 v227, v158, v159
    v_mfma_f32_16x16x32_bf16 v[76:79], a[196:199], a[124:127], v[76:79]
    v_exp_f32 v0, v0
    v_accvgpr_read_b32 v152, a40
    v_accvgpr_read_b32 v153, a41
    v_accvgpr_read_b32 v154, a42
    v_mfma_f32_16x16x32_bf16 v[76:79], a[200:203], a[128:131], v[76:79]
L_hop_13:
    s_cbranch_execz L_hop_17
    v_exp_f32 v36, v36
    v_accvgpr_read_b32 v155, a43
    v_accvgpr_read_b32 v156, a44
    v_accvgpr_read_b32 v157, a45
    v_accvgpr_read_b32 v158, a46
    v_accvgpr_read_b32 v159, a47
    v_pk_mul_f32 v[152:153], v[152:153], v[20:21] op_sel_hi:[1,0]
    v_pk_mul_f32 v[154:155], v[154:155], v[20:21] op_sel_hi:[1,0]
    v_pk_mul_f32 v[156:157], v[156:157], v[22:23] op_sel_hi:[1,0]
    v_pk_mul_f32 v[158:159], v[158:159], v[22:23] op_sel_hi:[1,0]
    v_cvt_pk_bf16_f32 v57, v38, v39
    v_mfma_f32_16x16x32_bf16 v[100:103], a[192:195], a[144:147], 0
    v_fma_f32 v37, v86, s35, v26
    v_fma_f32 v38, v87, s35, v26
    v_mfma_f32_16x16x32_bf16 v[100:103], a[196:199], a[148:151], v[100:103]
    v_exp_f32 v37, v37
    v_mfma_f32_16x16x32_bf16 v[100:103], a[200:203], a[152:155], v[100:103]
    s_waitcnt lgkmcnt(2)
    v_cvt_pk_bf16_f32 v228, v152, v153
    v_cvt_pk_bf16_f32 v229, v154, v155
    v_cvt_pk_bf16_f32 v230, v156, v157
    v_cvt_pk_bf16_f32 v231, v158, v159
    v_pk_mul_f32 v[160:161], v[160:161], v[16:17] op_sel_hi:[1,0]
    v_pk_mul_f32 v[162:163], v[162:163], v[16:17] op_sel_hi:[1,0]
    v_pk_mul_f32 v[164:165], v[164:165], v[18:19] op_sel_hi:[1,0]
    v_pk_mul_f32 v[166:167], v[166:167], v[18:19] op_sel_hi:[1,0]
    v_pk_mul_f32 v[168:169], v[168:169], v[16:17] op_sel_hi:[1,0]
    v_pk_mul_f32 v[170:171], v[170:171], v[16:17] op_sel_hi:[1,0]
    v_pk_mul_f32 v[172:173], v[172:173], v[18:19] op_sel_hi:[1,0]
    v_pk_mul_f32 v[174:175], v[174:175], v[18:19] op_sel_hi:[1,0]
    v_xor_b32 v35, 64, v32
    v_mfma_f32_16x16x32_bf16 v[108:111], a[192:195], a[168:171], 0
    ds_read_b64_tr_b16 a[192:193], v4 offset:0
    ds_read_b64_tr_b16 a[194:195], v4 offset:6144
    v_mfma_f32_16x16x32_bf16 v[108:111], a[196:199], a[172:175], v[108:111]
    v_exp_f32 v38, v38
    v_mfma_f32_16x16x32_bf16 v[108:111], a[200:203], a[176:179], v[108:111]
    ds_read_b64_tr_b16 a[196:197], v5 offset:0
    ds_read_b64_tr_b16 a[198:199], v5 offset:6144
    v_mfma_f32_16x16x32_bf16 v[68:71], a[204:207], a[108:111], v[68:71]
    v_cvt_pk_bf16_f32 v58, v0, v36
    v_fma_f32 v39, v88, s35, v27
    v_fma_f32 v0, v89, s35, v27
    v_mfma_f32_16x16x32_bf16 v[68:71], a[208:211], a[112:115], v[68:71]
    ds_read_b64_tr_b16 a[200:201], v6 offset:0
    ds_read_b64_tr_b16 a[202:203], v6 offset:6144
    v_exp_f32 v39, v39
    v_cvt_pk_bf16_f32 v160, v160, v161
    v_mfma_f32_16x16x32_bf16 v[68:71], a[212:215], a[116:119], v[68:71]
    v_exp_f32 v0, v0
    v_cvt_pk_bf16_f32 v161, v162, v163
    v_cvt_pk_bf16_f32 v162, v164, v165
    v_cvt_pk_bf16_f32 v163, v166, v167
    v_mfma_f32_16x16x32_bf16 v[76:79], a[204:207], a[132:135], v[76:79]
    ds_write_b64 v35, v[160:161] offset:128
    v_cvt_pk_bf16_f32 v164, v168, v169
    v_mfma_f32_16x16x32_bf16 v[76:79], a[208:211], a[136:139], v[76:79]
    ds_write_b64 v35, v[162:163] offset:6272
    v_cvt_pk_bf16_f32 v59, v37, v38
    v_cvt_pk_bf16_f32 v165, v170, v171
    v_mfma_f32_16x16x32_bf16 v[76:79], a[212:215], a[140:143], v[76:79]
    v_fma_f32 v36, v90, s35, v27
    v_cvt_pk_bf16_f32 v166, v172, v173
    v_cvt_pk_bf16_f32 v167, v174, v175
    v_fma_f32 v37, v91, s35, v27
    v_accvgpr_read_b32 v168, a48
    v_mfma_f32_16x16x32_bf16 v[100:103], a[204:207], a[156:159], v[100:103]
    v_exp_f32 v36, v36
    v_accvgpr_read_b32 v169, a49
    v_accvgpr_read_b32 v170, a50
    v_accvgpr_read_b32 v171, a51
    v_accvgpr_read_b32 v172, a52
    v_accvgpr_read_b32 v173, a53
    v_accvgpr_read_b32 v174, a54
    v_accvgpr_read_b32 v175, a55
    v_pk_mul_f32 v[168:169], v[168:169], v[20:21] op_sel_hi:[1,0]
    v_pk_mul_f32 v[170:171], v[170:171], v[20:21] op_sel_hi:[1,0]
    v_pk_mul_f32 v[172:173], v[172:173], v[22:23] op_sel_hi:[1,0]
    v_pk_mul_f32 v[174:175], v[174:175], v[22:23] op_sel_hi:[1,0]
    v_cvt_pk_bf16_f32 v60, v39, v0
    v_mfma_f32_16x16x32_bf16 v[100:103], a[208:211], a[160:163], v[100:103]
    v_exp_f32 v37, v37
    v_mfma_f32_16x16x32_bf16 v[100:103], a[212:215], a[164:167], v[100:103]
    v_xor_b32 v35, 96, v32
    v_fma_f32 v38, v92, s35, v27
    v_mfma_f32_16x16x32_bf16 v[108:111], a[204:207], a[180:183], v[108:111]
    ds_read_b64_tr_b16 a[204:205], v7 offset:0
    ds_read_b64_tr_b16 a[206:207], v7 offset:6144
    v_mfma_f32_16x16x32_bf16 v[108:111], a[208:211], a[184:187], v[108:111]
    s_mov_b32 m0, s51
    v_fma_f32 v39, v93, s35, v27
    v_exp_f32 v38, v38
    v_cvt_pk_bf16_f32 v61, v36, v37
    v_fma_f32 v0, v94, s35, v27
    v_exp_f32 v39, v39
    v_fma_f32 v36, v95, s35, v27
    v_exp_f32 v0, v0
    v_cvt_pk_bf16_f32 v62, v38, v39
    v_exp_f32 v36, v36
    v_fma_f32 v37, v64, s35, v24
    v_cvt_pk_bf16_f32 v63, v0, v36
    v_mfma_f32_16x16x32_bf16 v[108:111], a[212:215], a[188:191], v[108:111]
    ds_read_b64_tr_b16 a[208:209], v4 offset:128
    ds_read_b64_tr_b16 a[210:211], v4 offset:6272
    v_mfma_f32_16x16x32_bf16 v[28:31], a[248:251], v[56:59], 0
    buffer_load_dwordx4 v8, s[16:19], s54 offen nt lds
    v_mfma_f32_16x16x32_bf16 v[28:31], a[252:255], v[60:63], v[28:31]
    ds_read_b64_tr_b16 a[212:213], v5 offset:128
    ds_read_b64_tr_b16 a[214:215], v5 offset:6272
    s_waitcnt lgkmcnt(8)
    v_mfma_f32_16x16x32_bf16 v[112:115], a[192:195], v[40:43], 0
    ds_write_b64 v35, v[164:165] offset:128
    v_mfma_f32_16x16x32_bf16 v[116:119], a[192:195], v[44:47], 0
    ds_write_b64 v35, v[166:167] offset:6272
    v_mfma_f32_16x16x32_bf16 v[120:123], a[196:199], v[40:43], 0
    v_exp_f32 v37, v37
    v_cvt_pk_bf16_f32 v232, v168, v169
    v_mfma_f32_16x16x32_bf16 v[124:127], a[196:199], v[44:47], 0
    v_cvt_pk_bf16_f32 v233, v170, v171
    v_cvt_pk_bf16_f32 v234, v172, v173
    v_cvt_pk_bf16_f32 v235, v174, v175
    v_accvgpr_read_b32 v168, a56
    v_mfma_f32_16x16x32_bf16 v[128:131], a[200:203], v[40:43], 0
    v_accvgpr_read_b32 v169, a57
    v_accvgpr_read_b32 v170, a58
    v_accvgpr_read_b32 v171, a59
    v_accvgpr_read_b32 v172, a60
    v_accvgpr_read_b32 v173, a61
    v_accvgpr_read_b32 v174, a62
    v_accvgpr_read_b32 v175, a63
    v_pk_mul_f32 v[168:169], v[168:169], v[20:21] op_sel_hi:[1,0]
    v_pk_mul_f32 v[170:171], v[170:171], v[20:21] op_sel_hi:[1,0]
    v_pk_mul_f32 v[172:173], v[172:173], v[22:23] op_sel_hi:[1,0]
    v_pk_mul_f32 v[174:175], v[174:175], v[22:23] op_sel_hi:[1,0]
    v_cvt_pk_bf16_f32 v236, v168, v169
    v_mfma_f32_16x16x32_bf16 v[132:135], a[200:203], v[44:47], 0
    v_cvt_pk_bf16_f32 v237, v170, v171
    v_cvt_pk_bf16_f32 v238, v172, v173
    v_cvt_pk_bf16_f32 v239, v174, v175
    v_fma_f32 v38, v65, s35, v24
    v_fma_f32 v39, v66, s35, v24
    v_pk_mul_f32 v[176:177], v[176:177], v[16:17] op_sel_hi:[1,0]
    v_pk_mul_f32 v[178:179], v[178:179], v[16:17] op_sel_hi:[1,0]
    v_pk_mul_f32 v[180:181], v[180:181], v[18:19] op_sel_hi:[1,0]
    v_pk_mul_f32 v[182:183], v[182:183], v[18:19] op_sel_hi:[1,0]
    v_pk_mul_f32 v[184:185], v[184:185], v[16:17] op_sel_hi:[1,0]
    v_pk_mul_f32 v[186:187], v[186:187], v[16:17] op_sel_hi:[1,0]
    v_pk_mul_f32 v[188:189], v[188:189], v[18:19] op_sel_hi:[1,0]
    v_pk_mul_f32 v[190:191], v[190:191], v[18:19] op_sel_hi:[1,0]
    v_cvt_pk_bf16_f32 v176, v176, v177
    v_mfma_f32_16x16x32_bf16 a[0:3], a[192:195], v[56:59], 0
    v_exp_f32 v38, v38
    v_mfma_f32_16x16x32_bf16 a[4:7], a[192:195], v[60:63], 0
    ds_read_b64_tr_b16 a[192:193], v6 offset:128
    ds_read_b64_tr_b16 a[194:195], v6 offset:6272
    v_mfma_f32_16x16x32_bf16 a[8:11], a[196:199], v[56:59], 0
    buffer_load_dwordx4 v9, s[16:19], s54 offen offset:1024 nt lds
    v_mov_b32 v21, v28
    v_mov_b32 v23, v29
    v_mfma_f32_16x16x32_bf16 a[12:15], a[196:199], v[60:63], 0
    ds_read_b64_tr_b16 a[196:197], v7 offset:128
    ds_read_b64_tr_b16 a[198:199], v7 offset:6272
    v_mfma_f32_16x16x32_bf16 a[16:19], a[200:203], v[56:59], 0
    s_waitcnt lgkmcnt(6)
    v_cvt_pk_bf16_f32 v177, v178, v179
    v_mfma_f32_16x16x32_bf16 a[20:23], a[200:203], v[60:63], 0
    ds_read_b64_tr_b16 a[200:201], v4 offset:256
    ds_read_b64_tr_b16 a[202:203], v4 offset:6400
    v_mfma_f32_16x16x32_bf16 v[136:139], a[204:207], v[40:43], 0
    ds_write_b64 v32, v[176:177] offset:256
    v_mfma_f32_16x16x32_bf16 v[140:143], a[204:207], v[44:47], 0
    v_exp_f32 v39, v39
    v_mfma_f32_16x16x32_bf16 a[24:27], a[204:207], v[56:59], 0
    v_cvt_pk_bf16_f32 v178, v180, v181
    v_cvt_pk_bf16_f32 v179, v182, v183
    v_cvt_pk_bf16_f32 v180, v184, v185
    v_mfma_f32_16x16x32_bf16 a[28:31], a[204:207], v[60:63], 0
    ds_read_b64_tr_b16 a[204:205], v5 offset:256
    ds_read_b64_tr_b16 a[206:207], v5 offset:6400
    v_cvt_pk_bf16_f32 v181, v186, v187
    v_cvt_pk_bf16_f32 v182, v188, v189
    v_mfma_f32_16x16x32_bf16 v[144:147], a[208:211], v[40:43], 0
    buffer_load_dwordx4 v10, s[16:19], s54 offen offset:2048 nt lds
    v_cvt_pk_bf16_f32 v183, v190, v191
    v_accvgpr_read_b32 v184, a64
    v_mfma_f32_16x16x32_bf16 v[148:151], a[208:211], v[44:47], 0
    ds_write_b64 v32, v[178:179] offset:6400
    v_fma_f32 v0, v67, s35, v24
    v_accvgpr_read_b32 v185, a65
    v_mfma_f32_16x16x32_bf16 a[32:35], a[208:211], v[56:59], 0
    v_exp_f32 v0, v0
    v_accvgpr_read_b32 v186, a66
    v_accvgpr_read_b32 v187, a67
    v_accvgpr_read_b32 v188, a68
    v_accvgpr_read_b32 v189, a69
    v_accvgpr_read_b32 v190, a70
    v_accvgpr_read_b32 v191, a71
    v_pk_mul_f32 v[184:185], v[184:185], v[20:21] op_sel_hi:[1,0]
    v_pk_mul_f32 v[186:187], v[186:187], v[20:21] op_sel_hi:[1,0]
    v_pk_mul_f32 v[188:189], v[188:189], v[22:23] op_sel_hi:[1,0]
    v_pk_mul_f32 v[190:191], v[190:191], v[22:23] op_sel_hi:[1,0]
    v_xor_b32 v35, 32, v32
    v_mfma_f32_16x16x32_bf16 a[36:39], a[208:211], v[60:63], 0
    ds_read_b64_tr_b16 a[208:209], v6 offset:256
    ds_read_b64_tr_b16 a[210:211], v6 offset:6400
    v_mfma_f32_16x16x32_bf16 v[152:155], a[212:215], v[40:43], 0
    ds_write_b64 v35, v[180:181] offset:256
    v_mfma_f32_16x16x32_bf16 v[156:159], a[212:215], v[44:47], 0
    ds_write_b64 v35, v[182:183] offset:6400
    v_mfma_f32_16x16x32_bf16 a[40:43], a[212:215], v[56:59], 0
    s_waitcnt lgkmcnt(8)
    v_cvt_pk_bf16_f32 v48, v37, v38
    v_mfma_f32_16x16x32_bf16 a[44:47], a[212:215], v[60:63], 0
    ds_read_b64_tr_b16 a[212:213], v7 offset:256
    ds_read_b64_tr_b16 a[214:215], v7 offset:6400
    v_fma_f32 v36, v72, s35, v25
    v_mfma_f32_16x16x32_bf16 v[160:163], a[192:195], v[40:43], 0
    v_exp_f32 v36, v36
    v_fma_f32 v37, v73, s35, v25
    v_cvt_pk_bf16_f32 v240, v184, v185
    v_mfma_f32_16x16x32_bf16 v[164:167], a[192:195], v[44:47], 0
    v_exp_f32 v37, v37
    v_cvt_pk_bf16_f32 v241, v186, v187
    v_cvt_pk_bf16_f32 v242, v188, v189
    v_mfma_f32_16x16x32_bf16 a[48:51], a[192:195], v[56:59], 0
    v_cvt_pk_bf16_f32 v243, v190, v191
    v_cvt_pk_bf16_f32 v49, v39, v0
    v_accvgpr_read_b32 v184, a72
    v_accvgpr_read_b32 v185, a73
    v_fma_f32 v38, v74, s35, v25
    v_mfma_f32_16x16x32_bf16 a[52:55], a[192:195], v[60:63], 0
    ds_read_b128 a[192:195], v2 offset:24576
    v_accvgpr_read_b32 v186, a74
    v_accvgpr_read_b32 v187, a75
    v_accvgpr_read_b32 v188, a76
    v_accvgpr_read_b32 v189, a77
    v_accvgpr_read_b32 v190, a78
    v_accvgpr_read_b32 v191, a79
    v_pk_mul_f32 v[184:185], v[184:185], v[20:21] op_sel_hi:[1,0]
    v_pk_mul_f32 v[186:187], v[186:187], v[20:21] op_sel_hi:[1,0]
    v_pk_mul_f32 v[188:189], v[188:189], v[22:23] op_sel_hi:[1,0]
    v_pk_mul_f32 v[190:191], v[190:191], v[22:23] op_sel_hi:[1,0]
    v_fma_f32 v39, v75, s35, v25
    v_mfma_f32_16x16x32_bf16 v[168:171], a[196:199], v[40:43], 0
    v_exp_f32 v38, v38
    v_mfma_f32_16x16x32_bf16 v[172:175], a[196:199], v[44:47], 0
    v_exp_f32 v39, v39
    v_mfma_f32_16x16x32_bf16 a[56:59], a[196:199], v[56:59], 0
    v_cvt_pk_bf16_f32 v52, v36, v37
    v_cvt_pk_bf16_f32 v244, v184, v185
    v_cvt_pk_bf16_f32 v245, v186, v187
    v_cvt_pk_bf16_f32 v246, v188, v189
    v_cvt_pk_bf16_f32 v247, v190, v191
    v_pk_mul_f32 v[192:193], v[192:193], v[16:17] op_sel_hi:[1,0]
    v_pk_mul_f32 v[194:195], v[194:195], v[16:17] op_sel_hi:[1,0]
    v_pk_mul_f32 v[196:197], v[196:197], v[18:19] op_sel_hi:[1,0]
    v_pk_mul_f32 v[198:199], v[198:199], v[18:19] op_sel_hi:[1,0]
    v_pk_mul_f32 v[200:201], v[200:201], v[16:17] op_sel_hi:[1,0]
    v_pk_mul_f32 v[202:203], v[202:203], v[16:17] op_sel_hi:[1,0]
    v_pk_mul_f32 v[204:205], v[204:205], v[18:19] op_sel_hi:[1,0]
    v_pk_mul_f32 v[206:207], v[206:207], v[18:19] op_sel_hi:[1,0]
    v_fma_f32 v0, v68, s35, v24
    v_mfma_f32_16x16x32_bf16 a[60:63], a[196:199], v[60:63], 0
    ds_read_b128 a[196:199], v3 offset:24576
    v_xor_b32 v35, 64, v32
    v_mfma_f32_16x16x32_bf16 v[176:179], a[200:203], v[40:43], 0
    v_exp_f32 v0, v0
    v_mfma_f32_16x16x32_bf16 v[180:183], a[200:203], v[44:47], 0
    v_fma_f32 v36, v69, s35, v24
    v_cvt_pk_bf16_f32 v53, v38, v39
    v_mfma_f32_16x16x32_bf16 a[64:67], a[200:203], v[56:59], 0
    v_exp_f32 v36, v36
    v_mfma_f32_16x16x32_bf16 a[68:71], a[200:203], v[60:63], 0
    ds_read_b128 a[200:203], v2 offset:24704
    s_waitcnt lgkmcnt(3)
    v_mfma_f32_16x16x32_bf16 v[184:187], a[204:207], v[40:43], 0
    v_cvt_pk_bf16_f32 v192, v192, v193
    v_cvt_pk_bf16_f32 v193, v194, v195
    v_fma_f32 v37, v70, s35, v24
    v_mfma_f32_16x16x32_bf16 v[188:191], a[204:207], v[44:47], 0
    ds_write_b64 v35, v[192:193] offset:256
    v_cvt_pk_bf16_f32 v194, v196, v197
    v_mfma_f32_16x16x32_bf16 a[72:75], a[204:207], v[56:59], 0
    v_exp_f32 v37, v37
    v_cvt_pk_bf16_f32 v195, v198, v199
    v_cvt_pk_bf16_f32 v196, v200, v201
    v_mfma_f32_16x16x32_bf16 a[76:79], a[204:207], v[60:63], 0
    ds_read_b128 a[204:207], v3 offset:24704
    ds_write_b64 v35, v[194:195] offset:6400
    v_cvt_pk_bf16_f32 v197, v202, v203
    v_cvt_pk_bf16_f32 v198, v204, v205
    v_cvt_pk_bf16_f32 v199, v206, v207
    v_accvgpr_read_b32 v200, a80
    v_accvgpr_read_b32 v201, a81
    v_accvgpr_read_b32 v202, a82
    v_accvgpr_read_b32 v203, a83
    v_accvgpr_read_b32 v204, a84
    v_accvgpr_read_b32 v205, a85
    v_accvgpr_read_b32 v206, a86
    v_accvgpr_read_b32 v207, a87
    v_pk_mul_f32 v[200:201], v[200:201], v[20:21] op_sel_hi:[1,0]
    v_pk_mul_f32 v[202:203], v[202:203], v[20:21] op_sel_hi:[1,0]
    v_pk_mul_f32 v[204:205], v[204:205], v[22:23] op_sel_hi:[1,0]
    v_pk_mul_f32 v[206:207], v[206:207], v[22:23] op_sel_hi:[1,0]
    v_fma_f32 v38, v71, s35, v24
    v_xor_b32 v35, 96, v32
    ds_write_b64 v35, v[196:197] offset:256
    v_cvt_pk_bf16_f32 v248, v200, v201
    v_cvt_pk_bf16_f32 v249, v202, v203
    v_cvt_pk_bf16_f32 v250, v204, v205
    v_cvt_pk_bf16_f32 v251, v206, v207
    v_accvgpr_read_b32 v200, a88
    v_accvgpr_read_b32 v201, a89
    v_accvgpr_read_b32 v202, a90
    v_accvgpr_read_b32 v203, a91
    v_accvgpr_read_b32 v204, a92
    v_accvgpr_read_b32 v205, a93
    ds_write_b64 v35, v[198:199] offset:6400
    v_accvgpr_read_b32 v206, a94
    v_accvgpr_read_b32 v207, a95
    v_pk_mul_f32 v[200:201], v[200:201], v[20:21] op_sel_hi:[1,0]
    v_pk_mul_f32 v[202:203], v[202:203], v[20:21] op_sel_hi:[1,0]
    v_pk_mul_f32 v[204:205], v[204:205], v[22:23] op_sel_hi:[1,0]
    v_pk_mul_f32 v[206:207], v[206:207], v[22:23] op_sel_hi:[1,0]
    v_cvt_pk_bf16_f32 v50, v0, v36
    v_cvt_pk_bf16_f32 v252, v200, v201
    v_cvt_pk_bf16_f32 v253, v202, v203
    v_cvt_pk_bf16_f32 v254, v204, v205
    v_cvt_pk_bf16_f32 v255, v206, v207
    v_mfma_f32_16x16x32_bf16 v[192:195], a[208:211], v[40:43], 0
    v_exp_f32 v38, v38
    v_mfma_f32_16x16x32_bf16 v[196:199], a[208:211], v[44:47], 0
    v_fma_f32 v39, v76, s35, v25
    v_fma_f32 v0, v77, s35, v25
    v_mfma_f32_16x16x32_bf16 a[80:83], a[208:211], v[56:59], 0
    v_exp_f32 v39, v39
    v_mfma_f32_16x16x32_bf16 a[84:87], a[208:211], v[60:63], 0
    ds_read_b128 a[208:211], v2 offset:24832
    v_cvt_pk_bf16_f32 v51, v37, v38
    v_mfma_f32_16x16x32_bf16 v[200:203], a[212:215], v[40:43], 0
    v_exp_f32 v0, v0
    v_mfma_f32_16x16x32_bf16 v[204:207], a[212:215], v[44:47], 0
    v_fma_f32 v36, v78, s35, v25
    v_fma_f32 v37, v79, s35, v25
    v_mfma_f32_16x16x32_bf16 a[88:91], a[212:215], v[56:59], 0
    v_exp_f32 v36, v36
    v_cvt_pk_bf16_f32 v54, v39, v0
    v_exp_f32 v37, v37
    s_nop 0
    v_cvt_pk_bf16_f32 v55, v36, v37
    v_mfma_f32_16x16x32_bf16 a[92:95], a[212:215], v[60:63], 0
    ds_read_b128 a[212:215], v3 offset:24832
    v_mfma_f32_16x16x32_bf16 v[28:31], a[248:251], v[48:51], 0
    s_waitcnt vmcnt(12)
    s_barrier
    v_mfma_f32_16x16x32_bf16 v[28:31], a[252:255], v[52:55], v[28:31]
    s_waitcnt lgkmcnt(7)
    s_branch L_loop
L_hop_14:
    s_cbranch_execz L_hop_end
L_fin:
    v_mfma_f32_16x16x32_bf16 v[96:99], a[192:195], a[144:147], 0
    v_fma_f32 v36, v80, s35, v26
    v_fma_f32 v37, v81, s35, v26
    v_mfma_f32_16x16x32_bf16 v[104:107], a[192:195], a[168:171], 0
    s_mov_b32 m0, s51
    v_fma_f32 v38, v82, s35, v26
    v_mfma_f32_16x16x32_bf16 v[96:99], a[196:199], a[148:151], v[96:99]
    v_fma_f32 v39, v83, s35, v26
    v_cmp_nge_f32 vcc, s37, v30
    v_mfma_f32_16x16x32_bf16 v[104:107], a[196:199], a[172:175], v[104:107]
    v_exp_f32 v36, v36
    v_mfma_f32_16x16x32_bf16 v[96:99], a[200:203], a[152:155], v[96:99]
    buffer_load_dwordx4 v8, s[16:19], s66 offen nt lds
    v_mfma_f32_16x16x32_bf16 v[104:107], a[200:203], a[176:179], v[104:107]
    v_fma_f32 v0, v84, s35, v26
    s_cbranch_vccnz L_tr_F12_A
L_ret_F12_A:
    v_mfma_f32_16x16x32_bf16 v[64:67], a[192:195], a[96:99], 0
    v_exp_f32 v37, v37
    v_mfma_f32_16x16x32_bf16 v[72:75], a[192:195], a[120:123], 0
    ds_read_b128 a[192:195], v2 offset:18432
    v_add_f32 v17, v17, v28
    v_mfma_f32_16x16x32_bf16 v[64:67], a[196:199], a[100:103], v[64:67]
    buffer_load_dwordx4 v9, s[16:19], s66 offen offset:1024 nt lds
    v_add_f32 v19, v19, v29
    v_mfma_f32_16x16x32_bf16 v[72:75], a[196:199], a[124:127], v[72:75]
    ds_read_b128 a[196:199], v3 offset:18432
    v_cvt_pk_bf16_f32 v56, v36, v37
    v_mfma_f32_16x16x32_bf16 v[64:67], a[200:203], a[104:107], v[64:67]
    v_exp_f32 v38, v38
    v_mfma_f32_16x16x32_bf16 v[72:75], a[200:203], a[128:131], v[72:75]
    ds_read_b128 a[200:203], v2 offset:18560
    s_waitcnt lgkmcnt(3)
    v_mfma_f32_16x16x32_bf16 v[64:67], a[204:207], a[108:111], v[64:67]
    buffer_load_dwordx4 v10, s[16:19], s66 offen offset:2048 nt lds
    v_mfma_f32_16x16x32_bf16 v[72:75], a[204:207], a[132:135], v[72:75]
    v_exp_f32 v39, v39
    v_mfma_f32_16x16x32_bf16 v[96:99], a[204:207], a[156:159], v[96:99]
    v_exp_f32 v0, v0
    v_mfma_f32_16x16x32_bf16 v[104:107], a[204:207], a[180:183], v[104:107]
    ds_read_b128 a[204:207], v3 offset:18560
    v_fma_f32 v36, v85, s35, v26
    v_mfma_f32_16x16x32_bf16 v[64:67], a[208:211], a[112:115], v[64:67]
    v_exp_f32 v36, v36
    v_mfma_f32_16x16x32_bf16 v[72:75], a[208:211], a[136:139], v[72:75]
    v_cvt_pk_bf16_f32 v57, v38, v39
    v_fma_f32 v37, v86, s35, v26
    v_mfma_f32_16x16x32_bf16 v[96:99], a[208:211], a[160:163], v[96:99]
    v_exp_f32 v37, v37
    v_mfma_f32_16x16x32_bf16 v[104:107], a[208:211], a[184:187], v[104:107]
    ds_read_b128 a[208:211], v2 offset:18688
    v_fma_f32 v38, v87, s35, v26
    v_mfma_f32_16x16x32_bf16 v[64:67], a[212:215], a[116:119], v[64:67]
    v_exp_f32 v38, v38
    v_mfma_f32_16x16x32_bf16 v[72:75], a[212:215], a[140:143], v[72:75]
    v_cvt_pk_bf16_f32 v58, v0, v36
    v_fma_f32 v39, v88, s35, v27
    v_mfma_f32_16x16x32_bf16 v[96:99], a[212:215], a[164:167], v[96:99]
    v_exp_f32 v39, v39
    v_mfma_f32_16x16x32_bf16 v[104:107], a[212:215], a[188:191], v[104:107]
    ds_read_b128 a[212:215], v3 offset:18688
    s_waitcnt lgkmcnt(3)
    v_mfma_f32_16x16x32_bf16 v[68:71], a[192:195], a[96:99], 0
    v_fma_f32 v0, v89, s35, v27
    v_cvt_pk_bf16_f32 v59, v37, v38
    v_mfma_f32_16x16x32_bf16 v[76:79], a[192:195], a[120:123], 0
    v_exp_f32 v0, v0
    v_mfma_f32_16x16x32_bf16 v[100:103], a[192:195], a[144:147], 0
    v_fma_f32 v36, v90, s35, v27
    v_fma_f32 v37, v91, s35, v27
    v_mfma_f32_16x16x32_bf16 v[108:111], a[192:195], a[168:171], 0
    ds_read_b128 a[192:195], v2 offset:24576
    v_cvt_pk_bf16_f32 v60, v39, v0
    v_mfma_f32_16x16x32_bf16 v[68:71], a[196:199], a[100:103], v[68:71]
    v_exp_f32 v36, v36
    v_mfma_f32_16x16x32_bf16 v[76:79], a[196:199], a[124:127], v[76:79]
    v_exp_f32 v37, v37
    v_mfma_f32_16x16x32_bf16 v[100:103], a[196:199], a[148:151], v[100:103]
    v_fma_f32 v38, v92, s35, v27
    v_fma_f32 v39, v93, s35, v27
    v_mfma_f32_16x16x32_bf16 v[108:111], a[196:199], a[172:175], v[108:111]
    ds_read_b128 a[196:199], v3 offset:24576
    v_cvt_pk_bf16_f32 v61, v36, v37
    v_mfma_f32_16x16x32_bf16 v[68:71], a[200:203], a[104:107], v[68:71]
    v_exp_f32 v38, v38
    v_mfma_f32_16x16x32_bf16 v[76:79], a[200:203], a[128:131], v[76:79]
    v_exp_f32 v39, v39
    v_mfma_f32_16x16x32_bf16 v[100:103], a[200:203], a[152:155], v[100:103]
    v_fma_f32 v0, v94, s35, v27
    v_fma_f32 v36, v95, s35, v27
    v_mfma_f32_16x16x32_bf16 v[108:111], a[200:203], a[176:179], v[108:111]
    ds_read_b128 a[200:203], v2 offset:24704
    s_waitcnt lgkmcnt(3)
    v_mfma_f32_16x16x32_bf16 v[68:71], a[204:207], a[108:111], v[68:71]
    v_exp_f32 v0, v0
    v_mfma_f32_16x16x32_bf16 v[76:79], a[204:207], a[132:135], v[76:79]
    v_exp_f32 v36, v36
    v_mfma_f32_16x16x32_bf16 v[100:103], a[204:207], a[156:159], v[100:103]
    v_cvt_pk_bf16_f32 v62, v38, v39
    v_cvt_pk_bf16_f32 v63, v0, v36
    v_mfma_f32_16x16x32_bf16 v[108:111], a[204:207], a[180:183], v[108:111]
    ds_read_b128 a[204:207], v3 offset:24704
    v_mfma_f32_16x16x32_bf16 v[68:71], a[208:211], a[112:115], v[68:71]
    v_mfma_f32_16x16x32_bf16 v[76:79], a[208:211], a[136:139], v[76:79]
    v_mfma_f32_16x16x32_bf16 v[28:31], a[248:251], v[56:59], 0
    v_mfma_f32_16x16x32_bf16 v[28:31], a[252:255], v[60:63], v[28:31]
    v_mfma_f32_16x16x32_bf16 v[100:103], a[208:211], a[160:163], v[100:103]
    v_mfma_f32_16x16x32_bf16 v[108:111], a[208:211], a[184:187], v[108:111]
    ds_read_b128 a[208:211], v2 offset:24832
    v_mfma_f32_16x16x32_bf16 v[68:71], a[212:215], a[116:119], v[68:71]
    v_mfma_f32_16x16x32_bf16 v[76:79], a[212:215], a[140:143], v[76:79]
    s_nop 2
    v_cmp_nge_f32 vcc, s37, v30
    v_mfma_f32_16x16x32_bf16 v[100:103], a[212:215], a[164:167], v[100:103]
    v_mfma_f32_16x16x32_bf16 v[108:111], a[212:215], a[188:191], v[108:111]
    ds_read_b128 a[212:215], v3 offset:24832
    s_waitcnt lgkmcnt(3)
    s_cbranch_vccnz L_tr_F12_B
L_ret_F12_B:
    v_mfma_f32_16x16x32_bf16 v[80:83], a[192:195], a[144:147], 0
    v_add_f32 v21, v21, v28
    v_add_f32 v23, v23, v29
    v_mfma_f32_16x16x32_bf16 v[88:91], a[192:195], a[168:171], 0
    ds_read_b128 a[192:195], v2 offset:30720
    v_mfma_f32_16x16x32_bf16 v[80:83], a[196:199], a[148:151], v[80:83]
    v_mfma_f32_16x16x32_bf16 v[88:91], a[196:199], a[172:175], v[88:91]
    ds_read_b128 a[196:199], v3 offset:30720
    v_fma_f32 v37, v96, s35, v26
    v_fma_f32 v38, v97, s35, v26
    v_exp_f32 v37, v37
    v_mfma_f32_16x16x32_bf16 v[80:83], a[200:203], a[152:155], v[80:83]
    v_exp_f32 v38, v38
    v_mfma_f32_16x16x32_bf16 v[88:91], a[200:203], a[176:179], v[88:91]
    ds_read_b128 a[200:203], v2 offset:30848
    s_waitcnt lgkmcnt(3)
    v_mfma_f32_16x16x32_bf16 v[80:83], a[204:207], a[156:159], v[80:83]
    v_fma_f32 v39, v98, s35, v26
    v_fma_f32 v0, v99, s35, v26
    v_mfma_f32_16x16x32_bf16 v[88:91], a[204:207], a[180:183], v[88:91]
    ds_read_b128 a[204:207], v3 offset:30848
    v_cvt_pk_bf16_f32 v48, v37, v38
    v_mfma_f32_16x16x32_bf16 v[80:83], a[208:211], a[160:163], v[80:83]
    v_exp_f32 v39, v39
    v_fma_f32 v36, v100, s35, v26
    v_mfma_f32_16x16x32_bf16 v[88:91], a[208:211], a[184:187], v[88:91]
    ds_read_b128 a[208:211], v2 offset:30976
    v_fma_f32 v37, v101, s35, v26
    v_mfma_f32_16x16x32_bf16 v[80:83], a[212:215], a[164:167], v[80:83]
    v_exp_f32 v0, v0
    v_mfma_f32_16x16x32_bf16 v[88:91], a[212:215], a[188:191], v[88:91]
    ds_read_b128 a[212:215], v3 offset:30976
    s_waitcnt lgkmcnt(3)
    v_cvt_pk_bf16_f32 v49, v39, v0
    v_mfma_f32_16x16x32_bf16 v[84:87], a[192:195], a[144:147], 0
    v_exp_f32 v36, v36
    v_mfma_f32_16x16x32_bf16 v[92:95], a[192:195], a[168:171], 0
    ds_read_b64_tr_b16 a[192:193], v4 offset:0
    ds_read_b64_tr_b16 a[194:195], v4 offset:6144
    v_mfma_f32_16x16x32_bf16 v[84:87], a[196:199], a[148:151], v[84:87]
    v_exp_f32 v37, v37
    v_fma_f32 v38, v102, s35, v26
    v_mfma_f32_16x16x32_bf16 v[92:95], a[196:199], a[172:175], v[92:95]
    ds_read_b64_tr_b16 a[196:197], v5 offset:0
    ds_read_b64_tr_b16 a[198:199], v5 offset:6144
    v_mfma_f32_16x16x32_bf16 v[84:87], a[200:203], a[152:155], v[84:87]
    s_waitcnt lgkmcnt(4)
    v_fma_f32 v39, v103, s35, v26
    v_mfma_f32_16x16x32_bf16 v[92:95], a[200:203], a[176:179], v[92:95]
    ds_read_b64_tr_b16 a[200:201], v6 offset:0
    ds_read_b64_tr_b16 a[202:203], v6 offset:6144
    v_mfma_f32_16x16x32_bf16 v[84:87], a[204:207], a[156:159], v[84:87]
    v_exp_f32 v38, v38
    v_cvt_pk_bf16_f32 v50, v36, v37
    v_mfma_f32_16x16x32_bf16 v[92:95], a[204:207], a[180:183], v[92:95]
    ds_read_b64_tr_b16 a[204:205], v7 offset:0
    ds_read_b64_tr_b16 a[206:207], v7 offset:6144
    v_mfma_f32_16x16x32_bf16 v[84:87], a[208:211], a[160:163], v[84:87]
    v_exp_f32 v39, v39
    v_mfma_f32_16x16x32_bf16 v[92:95], a[208:211], a[184:187], v[92:95]
    ds_read_b64_tr_b16 a[208:209], v4 offset:128
    ds_read_b64_tr_b16 a[210:211], v4 offset:6272
    v_fma_f32 v0, v104, s35, v27
    v_mfma_f32_16x16x32_bf16 v[84:87], a[212:215], a[164:167], v[84:87]
    s_waitcnt lgkmcnt(4)
    v_fma_f32 v36, v105, s35, v27
    v_mfma_f32_16x16x32_bf16 v[92:95], a[212:215], a[188:191], v[92:95]
    ds_read_b64_tr_b16 a[212:213], v5 offset:128
    ds_read_b64_tr_b16 a[214:215], v5 offset:6272
    v_mfma_f32_16x16x32_bf16 a[0:3], a[192:195], v[56:59], a[0:3]
    v_exp_f32 v0, v0
    v_cvt_pk_bf16_f32 v51, v38, v39
    v_mfma_f32_16x16x32_bf16 a[4:7], a[192:195], v[60:63], a[4:7]
    ds_read_b64_tr_b16 a[192:193], v6 offset:128
    ds_read_b64_tr_b16 a[194:195], v6 offset:6272
    v_fma_f32 v37, v106, s35, v27
    v_mfma_f32_16x16x32_bf16 a[8:11], a[196:199], v[56:59], a[8:11]
    s_waitcnt vmcnt(6)
    s_barrier
    v_mfma_f32_16x16x32_bf16 a[12:15], a[196:199], v[60:63], a[12:15]
L_hop_15:
    s_cbranch_execz L_hop_end
    ds_read_b64_tr_b16 a[196:197], v7 offset:128
    ds_read_b64_tr_b16 a[198:199], v7 offset:6272
    v_mfma_f32_16x16x32_bf16 a[16:19], a[200:203], v[56:59], a[16:19]
    s_waitcnt lgkmcnt(4)
    v_fma_f32 v38, v107, s35, v27
    v_fma_f32 v39, v108, s35, v27
    v_mfma_f32_16x16x32_bf16 a[20:23], a[200:203], v[60:63], a[20:23]
    ds_read_b64_tr_b16 a[200:201], v4 offset:256
    ds_read_b64_tr_b16 a[202:203], v4 offset:6400
    v_mfma_f32_16x16x32_bf16 a[24:27], a[204:207], v[56:59], a[24:27]
    v_exp_f32 v36, v36
    v_exp_f32 v37, v37
    v_mfma_f32_16x16x32_bf16 a[28:31], a[204:207], v[60:63], a[28:31]
    ds_read_b64_tr_b16 a[204:205], v5 offset:256
    ds_read_b64_tr_b16 a[206:207], v5 offset:6400
    v_mfma_f32_16x16x32_bf16 a[32:35], a[208:211], v[56:59], a[32:35]
    v_exp_f32 v38, v38
    v_mfma_f32_16x16x32_bf16 a[36:39], a[208:211], v[60:63], a[36:39]
    ds_read_b64_tr_b16 a[208:209], v6 offset:256
    ds_read_b64_tr_b16 a[210:211], v6 offset:6400
    v_cvt_pk_bf16_f32 v52, v0, v36
    v_mfma_f32_16x16x32_bf16 a[40:43], a[212:215], v[56:59], a[40:43]
    s_waitcnt lgkmcnt(4)
    v_fma_f32 v0, v109, s35, v27
    v_cvt_pk_bf16_f32 v53, v37, v38
    v_mfma_f32_16x16x32_bf16 a[44:47], a[212:215], v[60:63], a[44:47]
    ds_read_b64_tr_b16 a[212:213], v7 offset:256
    ds_read_b64_tr_b16 a[214:215], v7 offset:6400
    v_mfma_f32_16x16x32_bf16 a[48:51], a[192:195], v[56:59], a[48:51]
    v_exp_f32 v39, v39
    v_fma_f32 v36, v110, s35, v27
    v_mfma_f32_16x16x32_bf16 a[52:55], a[192:195], v[60:63], a[52:55]
    ds_read_b128 a[192:195], v2 offset:36864
    v_fma_f32 v37, v111, s35, v27
    v_mfma_f32_16x16x32_bf16 a[56:59], a[196:199], v[56:59], a[56:59]
    v_exp_f32 v0, v0
    v_exp_f32 v36, v36
    v_mfma_f32_16x16x32_bf16 a[60:63], a[196:199], v[60:63], a[60:63]
    ds_read_b128 a[196:199], v3 offset:36864
    v_cvt_pk_bf16_f32 v54, v39, v0
    v_mfma_f32_16x16x32_bf16 a[64:67], a[200:203], v[56:59], a[64:67]
    v_exp_f32 v37, v37
    s_nop 0
    v_cvt_pk_bf16_f32 v55, v36, v37
    v_mfma_f32_16x16x32_bf16 a[68:71], a[200:203], v[60:63], a[68:71]
    ds_read_b128 a[200:203], v2 offset:36992
    s_waitcnt lgkmcnt(3)
    v_mfma_f32_16x16x32_bf16 v[28:31], a[248:251], v[48:51], 0
    v_mfma_f32_16x16x32_bf16 v[28:31], a[252:255], v[52:55], v[28:31]
    v_mfma_f32_16x16x32_bf16 a[72:75], a[204:207], v[56:59], a[72:75]
    v_mfma_f32_16x16x32_bf16 a[76:79], a[204:207], v[60:63], a[76:79]
    ds_read_b128 a[204:207], v3 offset:36992
    v_mfma_f32_16x16x32_bf16 a[80:83], a[208:211], v[56:59], a[80:83]
    v_mfma_f32_16x16x32_bf16 a[84:87], a[208:211], v[60:63], a[84:87]
    ds_read_b128 a[208:211], v2 offset:37120
    s_nop 1
    v_cmp_nge_f32 vcc, s37, v30
    v_mfma_f32_16x16x32_bf16 a[88:91], a[212:215], v[56:59], a[88:91]
    v_mfma_f32_16x16x32_bf16 a[92:95], a[212:215], v[60:63], a[92:95]
    ds_read_b128 a[212:215], v3 offset:37120
    s_waitcnt lgkmcnt(3)
    s_cbranch_vccnz L_tr_F13_B
L_ret_F13_B:
    v_mfma_f32_16x16x32_bf16 v[96:99], a[192:195], a[144:147], 0
    v_add_f32 v21, v21, v28
    v_fma_f32 v38, v80, s35, v26
    v_mfma_f32_16x16x32_bf16 v[104:107], a[192:195], a[168:171], 0
    ds_read_b128 a[192:195], v2 offset:43008
    v_add_f32 v23, v23, v29
    v_fma_f32 v39, v81, s35, v26
    v_mfma_f32_16x16x32_bf16 v[96:99], a[196:199], a[148:151], v[96:99]
    v_exp_f32 v38, v38
    v_mfma_f32_16x16x32_bf16 v[104:107], a[196:199], a[172:175], v[104:107]
    ds_read_b128 a[196:199], v3 offset:43008
    v_fma_f32 v0, v82, s35, v26
    v_mfma_f32_16x16x32_bf16 v[96:99], a[200:203], a[152:155], v[96:99]
    v_exp_f32 v39, v39
    v_fma_f32 v36, v83, s35, v26
    v_mfma_f32_16x16x32_bf16 v[104:107], a[200:203], a[176:179], v[104:107]
    ds_read_b128 a[200:203], v2 offset:43136
    s_waitcnt lgkmcnt(3)
    v_mfma_f32_16x16x32_bf16 v[96:99], a[204:207], a[156:159], v[96:99]
    v_exp_f32 v0, v0
    v_mfma_f32_16x16x32_bf16 v[104:107], a[204:207], a[180:183], v[104:107]
    ds_read_b128 a[204:207], v3 offset:43136
    v_cvt_pk_bf16_f32 v56, v38, v39
    v_fma_f32 v37, v84, s35, v26
    v_mfma_f32_16x16x32_bf16 v[96:99], a[208:211], a[160:163], v[96:99]
    v_exp_f32 v36, v36
    v_mfma_f32_16x16x32_bf16 v[104:107], a[208:211], a[184:187], v[104:107]
    ds_read_b128 a[208:211], v2 offset:43264
    v_fma_f32 v38, v85, s35, v26
    v_cvt_pk_bf16_f32 v57, v0, v36
    v_mfma_f32_16x16x32_bf16 v[96:99], a[212:215], a[164:167], v[96:99]
    v_exp_f32 v37, v37
    v_mfma_f32_16x16x32_bf16 v[104:107], a[212:215], a[188:191], v[104:107]
    ds_read_b128 a[212:215], v3 offset:43264
    s_waitcnt lgkmcnt(3)
    v_mfma_f32_16x16x32_bf16 v[100:103], a[192:195], a[144:147], 0
    v_exp_f32 v38, v38
    v_fma_f32 v39, v86, s35, v26
    v_mfma_f32_16x16x32_bf16 v[108:111], a[192:195], a[168:171], 0
    ds_read_b64_tr_b16 a[192:193], v4 offset:12288
    ds_read_b64_tr_b16 a[194:195], v4 offset:18432
    v_mfma_f32_16x16x32_bf16 v[100:103], a[196:199], a[148:151], v[100:103]
    v_exp_f32 v39, v39
    v_mfma_f32_16x16x32_bf16 v[108:111], a[196:199], a[172:175], v[108:111]
    ds_read_b64_tr_b16 a[196:197], v5 offset:12288
    ds_read_b64_tr_b16 a[198:199], v5 offset:18432
    v_fma_f32 v0, v87, s35, v26
    v_mfma_f32_16x16x32_bf16 v[100:103], a[200:203], a[152:155], v[100:103]
    s_waitcnt lgkmcnt(4)
    v_cvt_pk_bf16_f32 v58, v37, v38
    v_mfma_f32_16x16x32_bf16 v[108:111], a[200:203], a[176:179], v[108:111]
    ds_read_b64_tr_b16 a[200:201], v6 offset:12288
    ds_read_b64_tr_b16 a[202:203], v6 offset:18432
    v_fma_f32 v36, v88, s35, v27
    v_mfma_f32_16x16x32_bf16 v[100:103], a[204:207], a[156:159], v[100:103]
    v_exp_f32 v0, v0
    v_mfma_f32_16x16x32_bf16 v[108:111], a[204:207], a[180:183], v[108:111]
    ds_read_b64_tr_b16 a[204:205], v7 offset:12288
    ds_read_b64_tr_b16 a[206:207], v7 offset:18432
    v_mfma_f32_16x16x32_bf16 v[100:103], a[208:211], a[160:163], v[100:103]
    v_exp_f32 v36, v36
    v_fma_f32 v37, v89, s35, v27
    v_mfma_f32_16x16x32_bf16 v[108:111], a[208:211], a[184:187], v[108:111]
    ds_read_b64_tr_b16 a[208:209], v4 offset:12416
    ds_read_b64_tr_b16 a[210:211], v4 offset:18560
    v_mfma_f32_16x16x32_bf16 v[100:103], a[212:215], a[164:167], v[100:103]
    s_waitcnt lgkmcnt(4)
    v_cvt_pk_bf16_f32 v59, v39, v0
    v_mfma_f32_16x16x32_bf16 v[108:111], a[212:215], a[188:191], v[108:111]
    ds_read_b64_tr_b16 a[212:213], v5 offset:12416
    ds_read_b64_tr_b16 a[214:215], v5 offset:18560
    v_fma_f32 v38, v90, s35, v27
    v_mfma_f32_16x16x32_bf16 a[0:3], a[192:195], v[48:51], a[0:3]
    v_exp_f32 v37, v37
    v_mfma_f32_16x16x32_bf16 a[4:7], a[192:195], v[52:55], a[4:7]
    ds_read_b64_tr_b16 a[192:193], v6 offset:12416
    ds_read_b64_tr_b16 a[194:195], v6 offset:18560
    v_fma_f32 v39, v91, s35, v27
    v_mfma_f32_16x16x32_bf16 a[8:11], a[196:199], v[48:51], a[8:11]
    v_exp_f32 v38, v38
    v_mfma_f32_16x16x32_bf16 a[12:15], a[196:199], v[52:55], a[12:15]
    ds_read_b64_tr_b16 a[196:197], v7 offset:12416
    ds_read_b64_tr_b16 a[198:199], v7 offset:18560
    v_cvt_pk_bf16_f32 v60, v36, v37
    v_mfma_f32_16x16x32_bf16 a[16:19], a[200:203], v[48:51], a[16:19]
    s_waitcnt lgkmcnt(4)
    v_fma_f32 v0, v92, s35, v27
    v_mfma_f32_16x16x32_bf16 a[20:23], a[200:203], v[52:55], a[20:23]
    ds_read_b64_tr_b16 a[200:201], v4 offset:12544
    ds_read_b64_tr_b16 a[202:203], v4 offset:18688
    v_fma_f32 v36, v93, s35, v27
    v_mfma_f32_16x16x32_bf16 a[24:27], a[204:207], v[48:51], a[24:27]
    v_exp_f32 v39, v39
    v_mfma_f32_16x16x32_bf16 a[28:31], a[204:207], v[52:55], a[28:31]
    ds_read_b64_tr_b16 a[204:205], v5 offset:12544
    ds_read_b64_tr_b16 a[206:207], v5 offset:18688
    v_cvt_pk_bf16_f32 v61, v38, v39
    v_mfma_f32_16x16x32_bf16 a[32:35], a[208:211], v[48:51], a[32:35]
    v_exp_f32 v0, v0
    v_mfma_f32_16x16x32_bf16 a[36:39], a[208:211], v[52:55], a[36:39]
    ds_read_b64_tr_b16 a[208:209], v6 offset:12544
    ds_read_b64_tr_b16 a[210:211], v6 offset:18688
    v_fma_f32 v37, v94, s35, v27
    v_mfma_f32_16x16x32_bf16 a[40:43], a[212:215], v[48:51], a[40:43]
    s_waitcnt lgkmcnt(4)
    v_fma_f32 v38, v95, s35, v27
    v_mfma_f32_16x16x32_bf16 a[44:47], a[212:215], v[52:55], a[44:47]
    ds_read_b64_tr_b16 a[212:213], v7 offset:12544
    ds_read_b64_tr_b16 a[214:215], v7 offset:18688
    v_mfma_f32_16x16x32_bf16 a[48:51], a[192:195], v[48:51], a[48:51]
    v_exp_f32 v36, v36
    v_exp_f32 v37, v37
    v_mfma_f32_16x16x32_bf16 a[52:55], a[192:195], v[52:55], a[52:55]
    ds_read_b64_tr_b16 a[192:193], v4 offset:24576
    ds_read_b64_tr_b16 a[194:195], v4 offset:30720
    v_mfma_f32_16x16x32_bf16 a[56:59], a[196:199], v[48:51], a[56:59]
    v_exp_f32 v38, v38
    v_mfma_f32_16x16x32_bf16 a[60:63], a[196:199], v[52:55], a[60:63]
    ds_read_b64_tr_b16 a[196:197], v5 offset:24576
    ds_read_b64_tr_b16 a[198:199], v5 offset:30720
    v_cvt_pk_bf16_f32 v62, v0, v36
    v_mfma_f32_16x16x32_bf16 a[64:67], a[200:203], v[48:51], a[64:67]
    s_waitcnt lgkmcnt(4)
    v_cvt_pk_bf16_f32 v63, v37, v38
    v_mfma_f32_16x16x32_bf16 a[68:71], a[200:203], v[52:55], a[68:71]
    ds_read_b64_tr_b16 a[200:201], v6 offset:24576
    ds_read_b64_tr_b16 a[202:203], v6 offset:30720
    v_mfma_f32_16x16x32_bf16 v[28:31], a[248:251], v[56:59], 0
    s_waitcnt vmcnt(0)
    s_barrier
    v_mfma_f32_16x16x32_bf16 v[28:31], a[252:255], v[60:63], v[28:31]
    s_add_u32 s24, s10, s32
    s_addc_u32 s25, s11, 0
    v_mfma_f32_16x16x32_bf16 a[72:75], a[204:207], v[48:51], a[72:75]
    s_mov_b32 s26, 98304
    v_xor_b32 v208, 32, v32
    v_mfma_f32_16x16x32_bf16 a[76:79], a[204:207], v[52:55], a[76:79]
    ds_read_b64_tr_b16 a[204:205], v7 offset:24576
    ds_read_b64_tr_b16 a[206:207], v7 offset:30720
    v_mfma_f32_16x16x32_bf16 a[80:83], a[208:211], v[48:51], a[80:83]
    v_xor_b32 v209, 64, v32
    v_xor_b32 v210, 96, v32
    v_mfma_f32_16x16x32_bf16 a[84:87], a[208:211], v[52:55], a[84:87]
    ds_read_b64_tr_b16 a[208:209], v4 offset:24704
    ds_read_b64_tr_b16 a[210:211], v4 offset:30848
    v_cmp_nge_f32 vcc, s37, v30
    v_mfma_f32_16x16x32_bf16 a[88:91], a[212:215], v[48:51], a[88:91]
    s_waitcnt lgkmcnt(4)
    v_mfma_f32_16x16x32_bf16 a[92:95], a[212:215], v[52:55], a[92:95]
    ds_read_b64_tr_b16 a[212:213], v5 offset:24704
    ds_read_b64_tr_b16 a[214:215], v5 offset:30848
    s_cbranch_vccnz L_tr_F14_B
L_ret_F14_B:
    v_mfma_f32_16x16x32_bf16 a[0:3], a[192:195], v[56:59], a[0:3]
    v_add_f32 v21, v21, v28
    v_fma_f32 v39, v96, s35, v26
    v_fma_f32 v0, v97, s35, v26
    v_exp_f32 v39, v39
    v_mfma_f32_16x16x32_bf16 a[4:7], a[192:195], v[60:63], a[4:7]
    ds_read_b64_tr_b16 a[192:193], v6 offset:24704
    ds_read_b64_tr_b16 a[194:195], v6 offset:30848
    v_add_f32 v23, v23, v29
    v_fma_f32 v36, v98, s35, v26
    v_mfma_f32_16x16x32_bf16 a[8:11], a[196:199], v[56:59], a[8:11]
    v_exp_f32 v0, v0
    v_fma_f32 v37, v99, s35, v26
    v_exp_f32 v36, v36
    v_mfma_f32_16x16x32_bf16 a[12:15], a[196:199], v[60:63], a[12:15]
    ds_read_b64_tr_b16 a[196:197], v7 offset:24704
    ds_read_b64_tr_b16 a[198:199], v7 offset:30848
    v_cvt_pk_bf16_f32 v48, v39, v0
    v_fma_f32 v38, v100, s35, v26
    v_mfma_f32_16x16x32_bf16 a[16:19], a[200:203], v[56:59], a[16:19]
    s_waitcnt lgkmcnt(4)
    v_fma_f32 v39, v101, s35, v26
    v_exp_f32 v37, v37
    v_fma_f32 v0, v102, s35, v26
    v_mfma_f32_16x16x32_bf16 a[20:23], a[200:203], v[60:63], a[20:23]
    ds_read_b64_tr_b16 a[200:201], v4 offset:24832
    ds_read_b64_tr_b16 a[202:203], v4 offset:30976
    v_exp_f32 v38, v38
    v_mfma_f32_16x16x32_bf16 a[24:27], a[204:207], v[56:59], a[24:27]
    v_exp_f32 v39, v39
    v_cvt_pk_bf16_f32 v49, v36, v37
    v_fma_f32 v36, v103, s35, v26
    v_cvt_pk_bf16_f32 v50, v38, v39
    v_mfma_f32_16x16x32_bf16 a[28:31], a[204:207], v[60:63], a[28:31]
    ds_read_b64_tr_b16 a[204:205], v5 offset:24832
    ds_read_b64_tr_b16 a[206:207], v5 offset:30976
    v_exp_f32 v0, v0
    v_mfma_f32_16x16x32_bf16 a[32:35], a[208:211], v[56:59], a[32:35]
    v_exp_f32 v36, v36
    v_fma_f32 v37, v104, s35, v27
    v_fma_f32 v38, v105, s35, v27
    v_cvt_pk_bf16_f32 v51, v0, v36
    v_mfma_f32_16x16x32_bf16 a[36:39], a[208:211], v[60:63], a[36:39]
    ds_read_b64_tr_b16 a[208:209], v6 offset:24832
    ds_read_b64_tr_b16 a[210:211], v6 offset:30976
    v_exp_f32 v37, v37
    v_mfma_f32_16x16x32_bf16 a[40:43], a[212:215], v[56:59], a[40:43]
    s_waitcnt lgkmcnt(4)
    v_fma_f32 v39, v106, s35, v27
    v_exp_f32 v38, v38
    v_fma_f32 v0, v107, s35, v27
    v_mfma_f32_16x16x32_bf16 a[44:47], a[212:215], v[60:63], a[44:47]
    ds_read_b64_tr_b16 a[212:213], v7 offset:24832
    ds_read_b64_tr_b16 a[214:215], v7 offset:30976
    v_exp_f32 v39, v39
    v_cvt_pk_bf16_f32 v52, v37, v38
    v_mfma_f32_16x16x32_bf16 a[48:51], a[192:195], v[56:59], a[48:51]
    v_exp_f32 v0, v0
    v_fma_f32 v36, v108, s35, v27
    v_fma_f32 v37, v109, s35, v27
    v_mfma_f32_16x16x32_bf16 a[52:55], a[192:195], v[60:63], a[52:55]
    ds_read_b64_tr_b16 a[192:193], v4 offset:36864
    ds_read_b64_tr_b16 a[194:195], v4 offset:43008
    v_exp_f32 v36, v36
    v_cvt_pk_bf16_f32 v53, v39, v0
    v_mfma_f32_16x16x32_bf16 a[56:59], a[196:199], v[56:59], a[56:59]
    v_exp_f32 v37, v37
    v_fma_f32 v38, v110, s35, v27
    v_fma_f32 v39, v111, s35, v27
    v_mfma_f32_16x16x32_bf16 a[60:63], a[196:199], v[60:63], a[60:63]
    ds_read_b64_tr_b16 a[196:197], v5 offset:36864
    ds_read_b64_tr_b16 a[198:199], v5 offset:43008
    v_exp_f32 v38, v38
    v_cvt_pk_bf16_f32 v54, v36, v37
    v_mfma_f32_16x16x32_bf16 a[64:67], a[200:203], v[56:59], a[64:67]
    s_waitcnt lgkmcnt(4)
    v_exp_f32 v39, v39
    s_nop 0
    v_cvt_pk_bf16_f32 v55, v38, v39
    v_mfma_f32_16x16x32_bf16 a[68:71], a[200:203], v[60:63], a[68:71]
    ds_read_b64_tr_b16 a[200:201], v6 offset:36864
    ds_read_b64_tr_b16 a[202:203], v6 offset:43008
    v_mfma_f32_16x16x32_bf16 v[28:31], a[248:251], v[48:51], 0
    v_mfma_f32_16x16x32_bf16 v[28:31], a[252:255], v[52:55], v[28:31]
    v_mfma_f32_16x16x32_bf16 a[72:75], a[204:207], v[56:59], a[72:75]
    v_mfma_f32_16x16x32_bf16 a[76:79], a[204:207], v[60:63], a[76:79]
    ds_read_b64_tr_b16 a[204:205], v7 offset:36864
    ds_read_b64_tr_b16 a[206:207], v7 offset:43008
    v_mfma_f32_16x16x32_bf16 a[80:83], a[208:211], v[56:59], a[80:83]
    v_mfma_f32_16x16x32_bf16 a[84:87], a[208:211], v[60:63], a[84:87]
    ds_read_b64_tr_b16 a[208:209], v4 offset:36992
    ds_read_b64_tr_b16 a[210:211], v4 offset:43136
    v_cmp_nge_f32 vcc, s37, v30
    v_mfma_f32_16x16x32_bf16 a[88:91], a[212:215], v[56:59], a[88:91]
    s_waitcnt lgkmcnt(4)
    v_mfma_f32_16x16x32_bf16 a[92:95], a[212:215], v[60:63], a[92:95]
    ds_read_b64_tr_b16 a[212:213], v5 offset:36992
    ds_read_b64_tr_b16 a[214:215], v5 offset:43136
    s_cbranch_vccnz L_tr_F15_B
L_ret_F15_B:
    v_mfma_f32_16x16x32_bf16 a[0:3], a[192:195], v[48:51], a[0:3]
    v_add_f32 v21, v21, v28
    v_add_f32 v23, v23, v29
    v_mfma_f32_16x16x32_bf16 a[4:7], a[192:195], v[52:55], a[4:7]
    ds_read_b64_tr_b16 a[192:193], v6 offset:36992
    ds_read_b64_tr_b16 a[194:195], v6 offset:43136
    v_mfma_f32_16x16x32_bf16 a[8:11], a[196:199], v[48:51], a[8:11]
    v_mfma_f32_16x16x32_bf16 a[12:15], a[196:199], v[52:55], a[12:15]
    ds_read_b64_tr_b16 a[196:197], v7 offset:36992
    ds_read_b64_tr_b16 a[198:199], v7 offset:43136
    v_permlane32_swap_b32 v21, v23
    v_mfma_f32_16x16x32_bf16 a[16:19], a[200:203], v[48:51], a[16:19]
    s_waitcnt lgkmcnt(4)
    v_add_f32 v21, v21, v23
    v_mov_b32 v23, v21
    v_mfma_f32_16x16x32_bf16 a[20:23], a[200:203], v[52:55], a[20:23]
    ds_read_b64_tr_b16 a[200:201], v4 offset:37120
    ds_read_b64_tr_b16 a[202:203], v4 offset:43264
    v_mfma_f32_16x16x32_bf16 a[24:27], a[204:207], v[48:51], a[24:27]
    v_permlane16_swap_b32 v21, v23
    v_add_f32 v21, v21, v23
    v_mfma_f32_16x16x32_bf16 a[28:31], a[204:207], v[52:55], a[28:31]
    ds_read_b64_tr_b16 a[204:205], v5 offset:37120
    ds_read_b64_tr_b16 a[206:207], v5 offset:43264
    v_mfma_f32_16x16x32_bf16 a[32:35], a[208:211], v[48:51], a[32:35]
    v_rcp_f32 v20, v21
    v_rcp_f32 v22, v21
    v_mfma_f32_16x16x32_bf16 a[36:39], a[208:211], v[52:55], a[36:39]
    ds_read_b64_tr_b16 a[208:209], v6 offset:37120
    ds_read_b64_tr_b16 a[210:211], v6 offset:43264
    v_permlane32_swap_b32 v20, v22
    v_mfma_f32_16x16x32_bf16 a[40:43], a[212:215], v[48:51], a[40:43]
    s_waitcnt lgkmcnt(4)
    v_accvgpr_read_b32 v80, a0
    v_accvgpr_read_b32 v81, a1
    v_mfma_f32_16x16x32_bf16 a[44:47], a[212:215], v[52:55], a[44:47]
    ds_read_b64_tr_b16 a[212:213], v7 offset:37120
    ds_read_b64_tr_b16 a[214:215], v7 offset:43264
    v_accvgpr_read_b32 v82, a2
    v_accvgpr_read_b32 v83, a3
    v_mfma_f32_16x16x32_bf16 a[48:51], a[192:195], v[48:51], a[48:51]
    v_accvgpr_read_b32 v84, a8
    v_accvgpr_read_b32 v85, a9
    v_accvgpr_read_b32 v86, a10
    v_accvgpr_read_b32 v87, a11
    v_accvgpr_read_b32 v88, a16
    v_mfma_f32_16x16x32_bf16 a[52:55], a[192:195], v[52:55], a[52:55]
    ds_read_b64_tr_b16 a[192:193], v4 offset:0
    ds_read_b64_tr_b16 a[194:195], v4 offset:6144
    v_accvgpr_read_b32 v89, a17
    v_accvgpr_read_b32 v90, a18
    v_mfma_f32_16x16x32_bf16 a[56:59], a[196:199], v[48:51], a[56:59]
    v_accvgpr_read_b32 v91, a19
    v_accvgpr_read_b32 v92, a24
    v_accvgpr_read_b32 v93, a25
    v_accvgpr_read_b32 v94, a26
    v_accvgpr_read_b32 v95, a27
    v_pk_mul_f32 v[80:81], v[80:81], v[20:21] op_sel_hi:[1,0]
    v_pk_mul_f32 v[82:83], v[82:83], v[20:21] op_sel_hi:[1,0]
    v_pk_mul_f32 v[84:85], v[84:85], v[20:21] op_sel_hi:[1,0]
    v_pk_mul_f32 v[86:87], v[86:87], v[20:21] op_sel_hi:[1,0]
    v_pk_mul_f32 v[88:89], v[88:89], v[20:21] op_sel_hi:[1,0]
    v_pk_mul_f32 v[90:91], v[90:91], v[20:21] op_sel_hi:[1,0]
    v_pk_mul_f32 v[92:93], v[92:93], v[20:21] op_sel_hi:[1,0]
    v_pk_mul_f32 v[94:95], v[94:95], v[20:21] op_sel_hi:[1,0]
    v_cvt_pk_bf16_f32 v80, v80, v81
    v_mfma_f32_16x16x32_bf16 a[60:63], a[196:199], v[52:55], a[60:63]
    ds_read_b64_tr_b16 a[196:197], v5 offset:0
    ds_read_b64_tr_b16 a[198:199], v5 offset:6144
    v_mfma_f32_16x16x32_bf16 a[64:67], a[200:203], v[48:51], a[64:67]
    s_waitcnt lgkmcnt(4)
    v_cvt_pk_bf16_f32 v81, v82, v83
    v_mfma_f32_16x16x32_bf16 a[68:71], a[200:203], v[52:55], a[68:71]
    ds_read_b64_tr_b16 a[200:201], v6 offset:0
    ds_read_b64_tr_b16 a[202:203], v6 offset:6144
    ds_write_b64 v32, v[80:81] offset:0
    v_mfma_f32_16x16x32_bf16 a[72:75], a[204:207], v[48:51], a[72:75]
    v_cvt_pk_bf16_f32 v84, v84, v85
    v_cvt_pk_bf16_f32 v85, v86, v87
    v_mfma_f32_16x16x32_bf16 a[76:79], a[204:207], v[52:55], a[76:79]
    ds_read_b64_tr_b16 a[204:205], v7 offset:0
    ds_read_b64_tr_b16 a[206:207], v7 offset:6144
    ds_write_b64 v208, v[84:85] offset:0
    v_mfma_f32_16x16x32_bf16 a[80:83], a[208:211], v[48:51], a[80:83]
    v_cvt_pk_bf16_f32 v88, v88, v89
    v_cvt_pk_bf16_f32 v89, v90, v91
    v_mfma_f32_16x16x32_bf16 a[84:87], a[208:211], v[52:55], a[84:87]
    ds_read_b64_tr_b16 a[208:209], v4 offset:128
    ds_read_b64_tr_b16 a[210:211], v4 offset:6272
    ds_write_b64 v209, v[88:89] offset:0
    v_mfma_f32_16x16x32_bf16 a[88:91], a[212:215], v[48:51], a[88:91]
    s_waitcnt lgkmcnt(7)
    v_cvt_pk_bf16_f32 v92, v92, v93
    v_mfma_f32_16x16x32_bf16 a[92:95], a[212:215], v[52:55], a[92:95]
    ds_read_b64_tr_b16 a[212:213], v5 offset:128
    ds_read_b64_tr_b16 a[214:215], v5 offset:6272
    v_mfma_f32_16x16x32_bf16 v[112:115], a[192:195], v[40:43], v[112:115]
    v_cvt_pk_bf16_f32 v93, v94, v95
    v_accvgpr_read_b32 v96, a32
    v_fma_f32 v0, v64, s35, v24
    v_fma_f32 v36, v65, s35, v24
    v_exp_f32 v0, v0
    v_fma_f32 v37, v66, s35, v24
    v_mfma_f32_16x16x32_bf16 v[116:119], a[192:195], v[44:47], v[116:119]
    ds_read_b64_tr_b16 a[192:193], v6 offset:128
    ds_read_b64_tr_b16 a[194:195], v6 offset:6272
    ds_write_b64 v210, v[92:93] offset:0
    v_exp_f32 v36, v36
    v_fma_f32 v38, v67, s35, v24
    v_mfma_f32_16x16x32_bf16 v[120:123], a[196:199], v[40:43], v[120:123]
    v_exp_f32 v37, v37
    v_accvgpr_read_b32 v97, a33
    v_accvgpr_read_b32 v98, a34
    v_accvgpr_read_b32 v99, a35
    v_cvt_pk_bf16_f32 v48, v0, v36
    v_fma_f32 v39, v68, s35, v24
    v_mfma_f32_16x16x32_bf16 v[124:127], a[196:199], v[44:47], v[124:127]
    ds_read_b64_tr_b16 a[196:197], v7 offset:128
    ds_read_b64_tr_b16 a[198:199], v7 offset:6272
    v_accvgpr_read_b32 v100, a40
    v_accvgpr_read_b32 v101, a41
    v_accvgpr_read_b32 v102, a42
    v_exp_f32 v38, v38
    v_fma_f32 v0, v69, s35, v24
    v_mfma_f32_16x16x32_bf16 v[128:131], a[200:203], v[40:43], v[128:131]
    s_waitcnt lgkmcnt(5)
    v_accvgpr_read_b32 v103, a43
    v_accvgpr_read_b32 v104, a48
    v_accvgpr_read_b32 v105, a49
    v_exp_f32 v39, v39
    v_cvt_pk_bf16_f32 v49, v37, v38
    v_mfma_f32_16x16x32_bf16 v[132:135], a[200:203], v[44:47], v[132:135]
    ds_read_b64_tr_b16 a[200:201], v4 offset:256
    ds_read_b64_tr_b16 a[202:203], v4 offset:6400
    v_accvgpr_read_b32 v106, a50
    v_accvgpr_read_b32 v107, a51
    v_accvgpr_read_b32 v108, a56
    v_accvgpr_read_b32 v109, a57
    v_accvgpr_read_b32 v110, a58
    v_accvgpr_read_b32 v111, a59
    v_pk_mul_f32 v[96:97], v[96:97], v[20:21] op_sel_hi:[1,0]
    v_pk_mul_f32 v[98:99], v[98:99], v[20:21] op_sel_hi:[1,0]
    v_pk_mul_f32 v[100:101], v[100:101], v[20:21] op_sel_hi:[1,0]
    v_pk_mul_f32 v[102:103], v[102:103], v[20:21] op_sel_hi:[1,0]
    v_pk_mul_f32 v[104:105], v[104:105], v[20:21] op_sel_hi:[1,0]
    v_pk_mul_f32 v[106:107], v[106:107], v[20:21] op_sel_hi:[1,0]
    v_pk_mul_f32 v[108:109], v[108:109], v[20:21] op_sel_hi:[1,0]
    v_pk_mul_f32 v[110:111], v[110:111], v[20:21] op_sel_hi:[1,0]
    v_cvt_pk_bf16_f32 v96, v96, v97
    v_mfma_f32_16x16x32_bf16 v[136:139], a[204:207], v[40:43], v[136:139]
    v_exp_f32 v0, v0
    v_mfma_f32_16x16x32_bf16 v[140:143], a[204:207], v[44:47], v[140:143]
    ds_read_b64_tr_b16 a[204:205], v5 offset:256
    ds_read_b64_tr_b16 a[206:207], v5 offset:6400
    v_fma_f32 v36, v70, s35, v24
    v_fma_f32 v37, v71, s35, v24
    v_exp_f32 v36, v36
    v_mfma_f32_16x16x32_bf16 v[144:147], a[208:211], v[40:43], v[144:147]
    v_exp_f32 v37, v37
    v_cvt_pk_bf16_f32 v50, v39, v0
    v_fma_f32 v38, v72, s35, v25
    v_fma_f32 v39, v73, s35, v25
    v_exp_f32 v38, v38
    v_mfma_f32_16x16x32_bf16 v[148:151], a[208:211], v[44:47], v[148:151]
    ds_read_b64_tr_b16 a[208:209], v6 offset:256
    ds_read_b64_tr_b16 a[210:211], v6 offset:6400
    v_cvt_pk_bf16_f32 v97, v98, v99
    v_cvt_pk_bf16_f32 v51, v36, v37
    v_fma_f32 v0, v74, s35, v25
    v_exp_f32 v39, v39
    v_mfma_f32_16x16x32_bf16 v[152:155], a[212:215], v[40:43], v[152:155]
    s_waitcnt lgkmcnt(4)
    ds_write_b64 v32, v[96:97] offset:128
    v_cvt_pk_bf16_f32 v100, v100, v101
    v_cvt_pk_bf16_f32 v101, v102, v103
    v_cvt_pk_bf16_f32 v104, v104, v105
    v_fma_f32 v36, v75, s35, v25
    v_exp_f32 v0, v0
    v_mfma_f32_16x16x32_bf16 v[156:159], a[212:215], v[44:47], v[156:159]
    ds_read_b64_tr_b16 a[212:213], v7 offset:256
    ds_read_b64_tr_b16 a[214:215], v7 offset:6400
    ds_write_b64 v208, v[100:101] offset:128
    v_cvt_pk_bf16_f32 v105, v106, v107
    v_cvt_pk_bf16_f32 v108, v108, v109
    v_mfma_f32_16x16x32_bf16 v[160:163], a[192:195], v[40:43], v[160:163]
    ds_write_b64 v209, v[104:105] offset:128
    v_cvt_pk_bf16_f32 v109, v110, v111
    v_accvgpr_read_b32 v224, a64
    v_accvgpr_read_b32 v225, a65
    v_accvgpr_read_b32 v226, a66
    v_accvgpr_read_b32 v227, a67
    v_mfma_f32_16x16x32_bf16 v[164:167], a[192:195], v[44:47], v[164:167]
    ds_read_b128 a[192:195], v2 offset:24576
    ds_write_b64 v210, v[108:109] offset:128
    v_accvgpr_read_b32 v228, a72
    v_accvgpr_read_b32 v229, a73
    v_accvgpr_read_b32 v230, a74
    v_cvt_pk_bf16_f32 v52, v38, v39
    v_mfma_f32_16x16x32_bf16 v[168:171], a[196:199], v[40:43], v[168:171]
    v_exp_f32 v36, v36
    v_accvgpr_read_b32 v231, a75
    v_accvgpr_read_b32 v232, a80
    v_accvgpr_read_b32 v233, a81
    v_accvgpr_read_b32 v234, a82
    v_fma_f32 v37, v76, s35, v25
    v_fma_f32 v38, v77, s35, v25
    v_mfma_f32_16x16x32_bf16 v[172:175], a[196:199], v[44:47], v[172:175]
    ds_read_b128 a[196:199], v3 offset:24576
    v_accvgpr_read_b32 v235, a83
    v_accvgpr_read_b32 v236, a88
    v_accvgpr_read_b32 v237, a89
    v_accvgpr_read_b32 v238, a90
    v_accvgpr_read_b32 v239, a91
    v_pk_mul_f32 v[224:225], v[224:225], v[20:21] op_sel_hi:[1,0]
    v_pk_mul_f32 v[226:227], v[226:227], v[20:21] op_sel_hi:[1,0]
    v_pk_mul_f32 v[228:229], v[228:229], v[20:21] op_sel_hi:[1,0]
    v_pk_mul_f32 v[230:231], v[230:231], v[20:21] op_sel_hi:[1,0]
    v_pk_mul_f32 v[232:233], v[232:233], v[20:21] op_sel_hi:[1,0]
    v_pk_mul_f32 v[234:235], v[234:235], v[20:21] op_sel_hi:[1,0]
    v_pk_mul_f32 v[236:237], v[236:237], v[20:21] op_sel_hi:[1,0]
    v_pk_mul_f32 v[238:239], v[238:239], v[20:21] op_sel_hi:[1,0]
    v_cvt_pk_bf16_f32 v224, v224, v225
    v_mfma_f32_16x16x32_bf16 v[176:179], a[200:203], v[40:43], v[176:179]
    v_exp_f32 v37, v37
    v_cvt_pk_bf16_f32 v53, v0, v36
    v_fma_f32 v39, v78, s35, v25
    v_exp_f32 v38, v38
    v_fma_f32 v0, v79, s35, v25
    v_exp_f32 v39, v39
    v_cvt_pk_bf16_f32 v54, v37, v38
    v_exp_f32 v0, v0
    s_nop 0
    v_cvt_pk_bf16_f32 v55, v39, v0
    v_mfma_f32_16x16x32_bf16 v[180:183], a[200:203], v[44:47], v[180:183]
    ds_read_b128 a[200:203], v2 offset:24704
    s_waitcnt lgkmcnt(6)
    v_mfma_f32_16x16x32_bf16 v[28:31], a[248:251], v[48:51], 0
    v_cvt_pk_bf16_f32 v225, v226, v227
    v_cvt_pk_bf16_f32 v228, v228, v229
    v_mfma_f32_16x16x32_bf16 v[28:31], a[252:255], v[52:55], v[28:31]
    ds_write_b64 v32, v[224:225] offset:256
    v_mfma_f32_16x16x32_bf16 v[184:187], a[204:207], v[40:43], v[184:187]
    v_cvt_pk_bf16_f32 v229, v230, v231
    v_cvt_pk_bf16_f32 v232, v232, v233
    v_mfma_f32_16x16x32_bf16 v[188:191], a[204:207], v[44:47], v[188:191]
    ds_read_b128 a[204:207], v3 offset:24704
    ds_write_b64 v208, v[228:229] offset:256
    v_mfma_f32_16x16x32_bf16 v[192:195], a[208:211], v[40:43], v[192:195]
    v_cvt_pk_bf16_f32 v233, v234, v235
    v_cvt_pk_bf16_f32 v236, v236, v237
    v_mfma_f32_16x16x32_bf16 v[196:199], a[208:211], v[44:47], v[196:199]
    ds_read_b128 a[208:211], v2 offset:24832
    ds_write_b64 v209, v[232:233] offset:256
L_hop_16:
    s_cbranch_execz L_hop_end
    v_cvt_pk_bf16_f32 v237, v238, v239
    v_cmp_nge_f32 vcc, s37, v30
    v_mfma_f32_16x16x32_bf16 v[200:203], a[212:215], v[40:43], v[200:203]
    ds_write_b64 v210, v[236:237] offset:256
    v_accvgpr_read_b32 v80, a4
    v_accvgpr_read_b32 v81, a5
    v_mfma_f32_16x16x32_bf16 v[204:207], a[212:215], v[44:47], v[204:207]
    ds_read_b128 a[212:215], v3 offset:24832
    s_waitcnt lgkmcnt(7)
    ds_read_b128 a[144:147], v1 offset:0
    s_cbranch_vccnz L_tr_F13_A
L_ret_F13_A:
    v_mfma_f32_16x16x32_bf16 v[64:67], a[192:195], a[96:99], 0
    ds_read_b128 a[148:151], v1 offset:1024
    ds_read_b128 a[152:155], v1 offset:2048
    ds_read_b128 a[156:159], v1 offset:3072
    v_add_f32 v17, v17, v28
    v_accvgpr_read_b32 v82, a6
    v_mfma_f32_16x16x32_bf16 v[72:75], a[192:195], a[120:123], 0
    ds_read_b128 a[192:195], v2 offset:30720
    ds_read_b128 a[160:163], v1 offset:4096
    ds_read_b128 a[164:167], v1 offset:5120
    v_add_f32 v19, v19, v29
    v_mfma_f32_16x16x32_bf16 v[64:67], a[196:199], a[100:103], v[64:67]
    v_accvgpr_read_b32 v83, a7
    v_accvgpr_read_b32 v84, a12
    v_accvgpr_read_b32 v85, a13
    v_accvgpr_read_b32 v86, a14
    v_accvgpr_read_b32 v87, a15
    v_mfma_f32_16x16x32_bf16 v[72:75], a[196:199], a[124:127], v[72:75]
    ds_read_b128 a[196:199], v3 offset:30720
    v_accvgpr_read_b32 v88, a20
    v_accvgpr_read_b32 v89, a21
    v_mfma_f32_16x16x32_bf16 v[64:67], a[200:203], a[104:107], v[64:67]
    v_accvgpr_read_b32 v90, a22
    v_accvgpr_read_b32 v91, a23
    v_accvgpr_read_b32 v92, a28
    v_accvgpr_read_b32 v93, a29
    v_accvgpr_read_b32 v94, a30
    v_accvgpr_read_b32 v95, a31
    v_pk_mul_f32 v[80:81], v[80:81], v[22:23] op_sel_hi:[1,0]
    v_pk_mul_f32 v[82:83], v[82:83], v[22:23] op_sel_hi:[1,0]
    v_pk_mul_f32 v[84:85], v[84:85], v[22:23] op_sel_hi:[1,0]
    v_pk_mul_f32 v[86:87], v[86:87], v[22:23] op_sel_hi:[1,0]
    v_pk_mul_f32 v[88:89], v[88:89], v[22:23] op_sel_hi:[1,0]
    v_pk_mul_f32 v[90:91], v[90:91], v[22:23] op_sel_hi:[1,0]
    v_pk_mul_f32 v[92:93], v[92:93], v[22:23] op_sel_hi:[1,0]
    v_pk_mul_f32 v[94:95], v[94:95], v[22:23] op_sel_hi:[1,0]
    v_cvt_pk_bf16_f32 v80, v80, v81
    v_mfma_f32_16x16x32_bf16 v[72:75], a[200:203], a[128:131], v[72:75]
    ds_read_b128 a[200:203], v2 offset:30848
    s_waitcnt lgkmcnt(9)
    v_mfma_f32_16x16x32_bf16 v[64:67], a[204:207], a[108:111], v[64:67]
    v_cvt_pk_bf16_f32 v81, v82, v83
    v_cvt_pk_bf16_f32 v84, v84, v85
    v_mfma_f32_16x16x32_bf16 v[72:75], a[204:207], a[132:135], v[72:75]
    ds_read_b128 a[204:207], v3 offset:30848
    ds_write_b64 v32, v[80:81] offset:6144
    v_mfma_f32_16x16x32_bf16 v[64:67], a[208:211], a[112:115], v[64:67]
    s_waitcnt lgkmcnt(4)
    buffer_store_dwordx4 a[144:147], v11, s[24:27], s84 offen sc1
    v_mfma_f32_16x16x32_bf16 v[72:75], a[208:211], a[136:139], v[72:75]
    ds_read_b128 a[208:211], v2 offset:30976
    buffer_store_dwordx4 a[148:151], v12, s[24:27], s84 offen offset:1024 sc1
    v_mfma_f32_16x16x32_bf16 v[64:67], a[212:215], a[116:119], v[64:67]
    buffer_store_dwordx4 a[152:155], v13, s[24:27], s84 offen offset:2048 sc1
    v_mfma_f32_16x16x32_bf16 v[72:75], a[212:215], a[140:143], v[72:75]
    ds_read_b128 a[212:215], v3 offset:30976
    s_waitcnt lgkmcnt(4)
    v_mfma_f32_16x16x32_bf16 v[68:71], a[192:195], a[96:99], 0
    buffer_store_dwordx4 a[156:159], v11, s[24:27], s85 offen sc1
    v_mfma_f32_16x16x32_bf16 v[76:79], a[192:195], a[120:123], 0
    ds_read_b64_tr_b16 a[192:193], v4 offset:12288
    ds_read_b64_tr_b16 a[194:195], v4 offset:18432
    v_cvt_pk_bf16_f32 v85, v86, v87
    v_mfma_f32_16x16x32_bf16 v[68:71], a[196:199], a[100:103], v[68:71]
    buffer_store_dwordx4 a[160:163], v12, s[24:27], s85 offen offset:1024 sc1
    v_cvt_pk_bf16_f32 v88, v88, v89
    v_mfma_f32_16x16x32_bf16 v[76:79], a[196:199], a[124:127], v[76:79]
    ds_read_b64_tr_b16 a[196:197], v5 offset:12288
    ds_read_b64_tr_b16 a[198:199], v5 offset:18432
    ds_write_b64 v208, v[84:85] offset:6144
    v_cvt_pk_bf16_f32 v89, v90, v91
    v_cvt_pk_bf16_f32 v92, v92, v93
    v_mfma_f32_16x16x32_bf16 v[68:71], a[200:203], a[104:107], v[68:71]
    s_waitcnt lgkmcnt(5)
    ds_write_b64 v209, v[88:89] offset:6144
    v_cvt_pk_bf16_f32 v93, v94, v95
    v_accvgpr_read_b32 v96, a36
    v_accvgpr_read_b32 v97, a37
    v_accvgpr_read_b32 v98, a38
    v_mfma_f32_16x16x32_bf16 v[76:79], a[200:203], a[128:131], v[76:79]
    ds_read_b64_tr_b16 a[200:201], v6 offset:12288
    ds_read_b64_tr_b16 a[202:203], v6 offset:18432
    ds_write_b64 v210, v[92:93] offset:6144
    v_fma_f32 v36, v64, s35, v24
    v_accvgpr_read_b32 v99, a39
    v_mfma_f32_16x16x32_bf16 v[68:71], a[204:207], a[108:111], v[68:71]
    buffer_store_dwordx4 a[164:167], v13, s[24:27], s85 offen offset:2048 sc1
    v_fma_f32 v37, v65, s35, v24
    v_exp_f32 v36, v36
    v_accvgpr_read_b32 v100, a44
    v_mfma_f32_16x16x32_bf16 v[76:79], a[204:207], a[132:135], v[76:79]
    ds_read_b64_tr_b16 a[204:205], v7 offset:12288
    ds_read_b64_tr_b16 a[206:207], v7 offset:18432
    v_fma_f32 v38, v66, s35, v24
    v_exp_f32 v37, v37
    v_accvgpr_read_b32 v101, a45
    v_accvgpr_read_b32 v102, a46
    v_mfma_f32_16x16x32_bf16 v[68:71], a[208:211], a[112:115], v[68:71]
    v_exp_f32 v38, v38
    v_accvgpr_read_b32 v103, a47
    v_accvgpr_read_b32 v104, a52
    v_accvgpr_read_b32 v105, a53
    v_accvgpr_read_b32 v106, a54
    v_accvgpr_read_b32 v107, a55
    v_accvgpr_read_b32 v108, a60
    v_accvgpr_read_b32 v109, a61
    v_accvgpr_read_b32 v110, a62
    v_accvgpr_read_b32 v111, a63
    v_pk_mul_f32 v[96:97], v[96:97], v[22:23] op_sel_hi:[1,0]
    v_pk_mul_f32 v[98:99], v[98:99], v[22:23] op_sel_hi:[1,0]
    v_pk_mul_f32 v[100:101], v[100:101], v[22:23] op_sel_hi:[1,0]
    v_pk_mul_f32 v[102:103], v[102:103], v[22:23] op_sel_hi:[1,0]
    v_pk_mul_f32 v[104:105], v[104:105], v[22:23] op_sel_hi:[1,0]
    v_pk_mul_f32 v[106:107], v[106:107], v[22:23] op_sel_hi:[1,0]
    v_pk_mul_f32 v[108:109], v[108:109], v[22:23] op_sel_hi:[1,0]
    v_pk_mul_f32 v[110:111], v[110:111], v[22:23] op_sel_hi:[1,0]
    v_fma_f32 v39, v67, s35, v24
    v_mfma_f32_16x16x32_bf16 v[76:79], a[208:211], a[136:139], v[76:79]
    ds_read_b64_tr_b16 a[208:209], v4 offset:12416
    ds_read_b64_tr_b16 a[210:211], v4 offset:18560
    v_mfma_f32_16x16x32_bf16 v[68:71], a[212:215], a[116:119], v[68:71]
    s_waitcnt lgkmcnt(5)
    v_cvt_pk_bf16_f32 v40, v36, v37
    v_mfma_f32_16x16x32_bf16 v[76:79], a[212:215], a[140:143], v[76:79]
    ds_read_b64_tr_b16 a[212:213], v5 offset:12416
    ds_read_b64_tr_b16 a[214:215], v5 offset:18560
    v_fma_f32 v0, v72, s35, v25
    v_exp_f32 v39, v39
    v_fma_f32 v36, v73, s35, v25
    v_cvt_pk_bf16_f32 v41, v38, v39
    v_mfma_f32_16x16x32_bf16 v[112:115], a[192:195], v[48:51], v[112:115]
    v_exp_f32 v0, v0
    v_fma_f32 v37, v74, s35, v25
    v_exp_f32 v36, v36
    v_cvt_pk_bf16_f32 v96, v96, v97
    v_mfma_f32_16x16x32_bf16 v[116:119], a[192:195], v[52:55], v[116:119]
    ds_read_b64_tr_b16 a[192:193], v6 offset:12416
    ds_read_b64_tr_b16 a[194:195], v6 offset:18560
    v_fma_f32 v38, v75, s35, v25
    v_exp_f32 v37, v37
    v_cvt_pk_bf16_f32 v44, v0, v36
    v_exp_f32 v38, v38
    s_nop 0
    v_cvt_pk_bf16_f32 v45, v37, v38
    v_mfma_f32_16x16x32_bf16 v[120:123], a[196:199], v[48:51], v[120:123]
    v_cvt_pk_bf16_f32 v97, v98, v99
    v_cvt_pk_bf16_f32 v100, v100, v101
    v_cvt_pk_bf16_f32 v101, v102, v103
    v_cvt_pk_bf16_f32 v104, v104, v105
    v_mfma_f32_16x16x32_bf16 v[124:127], a[196:199], v[52:55], v[124:127]
    ds_read_b64_tr_b16 a[196:197], v7 offset:12416
    ds_read_b64_tr_b16 a[198:199], v7 offset:18560
    ds_write_b64 v32, v[96:97] offset:6272
    v_cvt_pk_bf16_f32 v105, v106, v107
    v_mfma_f32_16x16x32_bf16 v[128:131], a[200:203], v[48:51], v[128:131]
    s_waitcnt lgkmcnt(5)
    ds_write_b64 v208, v[100:101] offset:6272
    v_cvt_pk_bf16_f32 v108, v108, v109
    v_cvt_pk_bf16_f32 v109, v110, v111
    v_accvgpr_read_b32 v224, a68
    v_mfma_f32_16x16x32_bf16 v[132:135], a[200:203], v[52:55], v[132:135]
    ds_read_b64_tr_b16 a[200:201], v4 offset:12544
    ds_read_b64_tr_b16 a[202:203], v4 offset:18688
    ds_write_b64 v209, v[104:105] offset:6272
    v_accvgpr_read_b32 v225, a69
    v_mfma_f32_16x16x32_bf16 v[136:139], a[204:207], v[48:51], v[136:139]
    ds_write_b64 v210, v[108:109] offset:6272
    v_fma_f32 v39, v68, s35, v24
    v_fma_f32 v0, v69, s35, v24
    v_accvgpr_read_b32 v226, a70
    v_mfma_f32_16x16x32_bf16 v[140:143], a[204:207], v[52:55], v[140:143]
    ds_read_b64_tr_b16 a[204:205], v5 offset:12544
    ds_read_b64_tr_b16 a[206:207], v5 offset:18688
    v_exp_f32 v39, v39
    v_accvgpr_read_b32 v227, a71
    v_accvgpr_read_b32 v228, a76
    v_accvgpr_read_b32 v229, a77
    v_mfma_f32_16x16x32_bf16 v[144:147], a[208:211], v[48:51], v[144:147]
    v_exp_f32 v0, v0
    v_accvgpr_read_b32 v230, a78
    v_accvgpr_read_b32 v231, a79
    v_accvgpr_read_b32 v232, a84
    v_accvgpr_read_b32 v233, a85
    v_mfma_f32_16x16x32_bf16 v[148:151], a[208:211], v[52:55], v[148:151]
    ds_read_b64_tr_b16 a[208:209], v6 offset:12544
    ds_read_b64_tr_b16 a[210:211], v6 offset:18688
    v_fma_f32 v36, v70, s35, v24
    v_accvgpr_read_b32 v234, a86
    v_fma_f32 v37, v71, s35, v24
    v_accvgpr_read_b32 v235, a87
    v_accvgpr_read_b32 v236, a92
    v_accvgpr_read_b32 v237, a93
    v_accvgpr_read_b32 v238, a94
    v_accvgpr_read_b32 v239, a95
    v_pk_mul_f32 v[224:225], v[224:225], v[22:23] op_sel_hi:[1,0]
    v_pk_mul_f32 v[226:227], v[226:227], v[22:23] op_sel_hi:[1,0]
    v_pk_mul_f32 v[228:229], v[228:229], v[22:23] op_sel_hi:[1,0]
    v_pk_mul_f32 v[230:231], v[230:231], v[22:23] op_sel_hi:[1,0]
    v_pk_mul_f32 v[232:233], v[232:233], v[22:23] op_sel_hi:[1,0]
    v_pk_mul_f32 v[234:235], v[234:235], v[22:23] op_sel_hi:[1,0]
    v_pk_mul_f32 v[236:237], v[236:237], v[22:23] op_sel_hi:[1,0]
    v_pk_mul_f32 v[238:239], v[238:239], v[22:23] op_sel_hi:[1,0]
    v_exp_f32 v36, v36
    v_mfma_f32_16x16x32_bf16 v[152:155], a[212:215], v[48:51], v[152:155]
    s_waitcnt lgkmcnt(6)
    v_cvt_pk_bf16_f32 v42, v39, v0
    v_mfma_f32_16x16x32_bf16 v[156:159], a[212:215], v[52:55], v[156:159]
    ds_read_b64_tr_b16 a[212:213], v7 offset:12544
    ds_read_b64_tr_b16 a[214:215], v7 offset:18688
    v_mfma_f32_16x16x32_bf16 v[160:163], a[192:195], v[48:51], v[160:163]
    v_exp_f32 v37, v37
    v_mfma_f32_16x16x32_bf16 v[164:167], a[192:195], v[52:55], v[164:167]
    ds_read_b128 a[192:195], v2 offset:36864
    v_fma_f32 v38, v76, s35, v25
    v_fma_f32 v39, v77, s35, v25
    v_cvt_pk_bf16_f32 v224, v224, v225
    v_exp_f32 v38, v38
    v_mfma_f32_16x16x32_bf16 v[168:171], a[196:199], v[48:51], v[168:171]
    v_exp_f32 v39, v39
    v_cvt_pk_bf16_f32 v225, v226, v227
    v_cvt_pk_bf16_f32 v228, v228, v229
    v_cvt_pk_bf16_f32 v229, v230, v231
    v_cvt_pk_bf16_f32 v232, v232, v233
    v_mfma_f32_16x16x32_bf16 v[172:175], a[196:199], v[52:55], v[172:175]
    ds_read_b128 a[196:199], v3 offset:36864
    ds_write_b64 v32, v[224:225] offset:6400
    v_cvt_pk_bf16_f32 v233, v234, v235
    v_cvt_pk_bf16_f32 v236, v236, v237
    v_cvt_pk_bf16_f32 v43, v36, v37
    v_mfma_f32_16x16x32_bf16 v[176:179], a[200:203], v[48:51], v[176:179]
    ds_write_b64 v208, v[228:229] offset:6400
    v_fma_f32 v0, v78, s35, v25
    v_cvt_pk_bf16_f32 v237, v238, v239
    v_fma_f32 v36, v79, s35, v25
    v_exp_f32 v0, v0
    v_cvt_pk_bf16_f32 v46, v38, v39
    v_exp_f32 v36, v36
    s_nop 0
    v_cvt_pk_bf16_f32 v47, v0, v36
    v_mfma_f32_16x16x32_bf16 v[180:183], a[200:203], v[52:55], v[180:183]
    ds_read_b128 a[200:203], v2 offset:36992
    s_waitcnt lgkmcnt(5)
    ds_write_b64 v209, v[232:233] offset:6400
    v_mfma_f32_16x16x32_bf16 v[28:31], a[248:251], v[40:43], 0
    ds_write_b64 v210, v[236:237] offset:6400
    v_mfma_f32_16x16x32_bf16 v[28:31], a[252:255], v[44:47], v[28:31]
    ds_read_b128 a[168:171], v1 offset:6144
    ds_read_b128 a[172:175], v1 offset:7168
    ds_read_b128 a[176:179], v1 offset:8192
    v_mfma_f32_16x16x32_bf16 v[184:187], a[204:207], v[48:51], v[184:187]
    ds_read_b128 a[180:183], v1 offset:9216
    ds_read_b128 a[184:187], v1 offset:10240
    ds_read_b128 a[188:191], v1 offset:11264
    v_mfma_f32_16x16x32_bf16 v[188:191], a[204:207], v[52:55], v[188:191]
    ds_read_b128 a[204:207], v3 offset:36992
    v_mfma_f32_16x16x32_bf16 v[192:195], a[208:211], v[48:51], v[192:195]
    v_mfma_f32_16x16x32_bf16 v[196:199], a[208:211], v[52:55], v[196:199]
    ds_read_b128 a[208:211], v2 offset:37120
    v_cmp_nge_f32 vcc, s37, v30
    v_mfma_f32_16x16x32_bf16 v[200:203], a[212:215], v[48:51], v[200:203]
    v_mfma_f32_16x16x32_bf16 v[204:207], a[212:215], v[52:55], v[204:207]
    ds_read_b128 a[212:215], v3 offset:37120
    s_waitcnt lgkmcnt(11)
    s_cbranch_vccnz L_tr_F14_A
L_ret_F14_A:
    v_mfma_f32_16x16x32_bf16 v[64:67], a[192:195], a[96:99], 0
    v_add_f32 v17, v17, v28
    s_waitcnt lgkmcnt(3)
    v_mfma_f32_16x16x32_bf16 v[72:75], a[192:195], a[120:123], 0
    ds_read_b128 a[192:195], v2 offset:43008
    buffer_store_dwordx4 a[168:171], v11, s[24:27], s86 offen sc1
    v_mfma_f32_16x16x32_bf16 v[64:67], a[196:199], a[100:103], v[64:67]
    buffer_store_dwordx4 a[172:175], v12, s[24:27], s86 offen offset:1024 sc1
    v_add_f32 v19, v19, v29
    v_mfma_f32_16x16x32_bf16 v[72:75], a[196:199], a[124:127], v[72:75]
    ds_read_b128 a[196:199], v3 offset:43008
    buffer_store_dwordx4 a[176:179], v13, s[24:27], s86 offen offset:2048 sc1
    v_mfma_f32_16x16x32_bf16 v[64:67], a[200:203], a[104:107], v[64:67]
    buffer_store_dwordx4 a[180:183], v11, s[24:27], s87 offen sc1
    v_mfma_f32_16x16x32_bf16 v[72:75], a[200:203], a[128:131], v[72:75]
    ds_read_b128 a[200:203], v2 offset:43136
    s_waitcnt lgkmcnt(3)
    v_mfma_f32_16x16x32_bf16 v[64:67], a[204:207], a[108:111], v[64:67]
    v_mfma_f32_16x16x32_bf16 v[72:75], a[204:207], a[132:135], v[72:75]
    ds_read_b128 a[204:207], v3 offset:43136
    v_mfma_f32_16x16x32_bf16 v[64:67], a[208:211], a[112:115], v[64:67]
    v_mfma_f32_16x16x32_bf16 v[72:75], a[208:211], a[136:139], v[72:75]
    ds_read_b128 a[208:211], v2 offset:43264
    v_mfma_f32_16x16x32_bf16 v[64:67], a[212:215], a[116:119], v[64:67]
    v_mfma_f32_16x16x32_bf16 v[72:75], a[212:215], a[140:143], v[72:75]
    ds_read_b128 a[212:215], v3 offset:43264
    s_waitcnt lgkmcnt(3)
    v_mfma_f32_16x16x32_bf16 v[68:71], a[192:195], a[96:99], 0
    v_mfma_f32_16x16x32_bf16 v[76:79], a[192:195], a[120:123], 0
    ds_read_b64_tr_b16 a[192:193], v4 offset:24576
    ds_read_b64_tr_b16 a[194:195], v4 offset:30720
    v_mfma_f32_16x16x32_bf16 v[68:71], a[196:199], a[100:103], v[68:71]
    v_mfma_f32_16x16x32_bf16 v[76:79], a[196:199], a[124:127], v[76:79]
    ds_read_b64_tr_b16 a[196:197], v5 offset:24576
    ds_read_b64_tr_b16 a[198:199], v5 offset:30720
    v_fma_f32 v37, v64, s35, v24
    v_fma_f32 v38, v65, s35, v24
    v_mfma_f32_16x16x32_bf16 v[68:71], a[200:203], a[104:107], v[68:71]
    s_waitcnt lgkmcnt(4)
    buffer_store_dwordx4 a[184:187], v12, s[24:27], s87 offen offset:1024 sc1
    v_mfma_f32_16x16x32_bf16 v[76:79], a[200:203], a[128:131], v[76:79]
    ds_read_b64_tr_b16 a[200:201], v6 offset:24576
    ds_read_b64_tr_b16 a[202:203], v6 offset:30720
    v_exp_f32 v37, v37
    v_mfma_f32_16x16x32_bf16 v[68:71], a[204:207], a[108:111], v[68:71]
    v_exp_f32 v38, v38
    v_fma_f32 v39, v66, s35, v24
    v_fma_f32 v0, v67, s35, v24
    v_mfma_f32_16x16x32_bf16 v[76:79], a[204:207], a[132:135], v[76:79]
    ds_read_b64_tr_b16 a[204:205], v7 offset:24576
    ds_read_b64_tr_b16 a[206:207], v7 offset:30720
    v_exp_f32 v39, v39
    v_mfma_f32_16x16x32_bf16 v[68:71], a[208:211], a[112:115], v[68:71]
    v_exp_f32 v0, v0
    v_cvt_pk_bf16_f32 v48, v37, v38
    v_fma_f32 v36, v72, s35, v25
    v_fma_f32 v37, v73, s35, v25
    v_mfma_f32_16x16x32_bf16 v[76:79], a[208:211], a[136:139], v[76:79]
    ds_read_b64_tr_b16 a[208:209], v4 offset:24704
    ds_read_b64_tr_b16 a[210:211], v4 offset:30848
    v_exp_f32 v36, v36
    v_mfma_f32_16x16x32_bf16 v[68:71], a[212:215], a[116:119], v[68:71]
    s_waitcnt lgkmcnt(4)
    v_cvt_pk_bf16_f32 v49, v39, v0
    v_fma_f32 v38, v74, s35, v25
    v_exp_f32 v37, v37
    v_mfma_f32_16x16x32_bf16 v[76:79], a[212:215], a[140:143], v[76:79]
    ds_read_b64_tr_b16 a[212:213], v5 offset:24704
    ds_read_b64_tr_b16 a[214:215], v5 offset:30848
    v_fma_f32 v39, v75, s35, v25
    v_cvt_pk_bf16_f32 v52, v36, v37
    v_mfma_f32_16x16x32_bf16 v[112:115], a[192:195], v[40:43], v[112:115]
    v_exp_f32 v38, v38
    v_exp_f32 v39, v39
    v_mfma_f32_16x16x32_bf16 v[116:119], a[192:195], v[44:47], v[116:119]
    ds_read_b64_tr_b16 a[192:193], v6 offset:24704
    ds_read_b64_tr_b16 a[194:195], v6 offset:30848
    v_cvt_pk_bf16_f32 v53, v38, v39
    v_mfma_f32_16x16x32_bf16 v[120:123], a[196:199], v[40:43], v[120:123]
    v_fma_f32 v0, v68, s35, v24
    v_fma_f32 v36, v69, s35, v24
    v_fma_f32 v37, v70, s35, v24
    v_mfma_f32_16x16x32_bf16 v[124:127], a[196:199], v[44:47], v[124:127]
    ds_read_b64_tr_b16 a[196:197], v7 offset:24704
    ds_read_b64_tr_b16 a[198:199], v7 offset:30848
    v_exp_f32 v0, v0
    v_mfma_f32_16x16x32_bf16 v[128:131], a[200:203], v[40:43], v[128:131]
    s_waitcnt lgkmcnt(4)
    v_fma_f32 v38, v71, s35, v24
    v_fma_f32 v39, v76, s35, v25
    v_mfma_f32_16x16x32_bf16 v[132:135], a[200:203], v[44:47], v[132:135]
    ds_read_b64_tr_b16 a[200:201], v4 offset:24832
    ds_read_b64_tr_b16 a[202:203], v4 offset:30976
    v_exp_f32 v36, v36
    v_mfma_f32_16x16x32_bf16 v[136:139], a[204:207], v[40:43], v[136:139]
    buffer_store_dwordx4 a[188:191], v13, s[24:27], s87 offen offset:2048 sc1
    v_mfma_f32_16x16x32_bf16 v[140:143], a[204:207], v[44:47], v[140:143]
    ds_read_b64_tr_b16 a[204:205], v5 offset:24832
    ds_read_b64_tr_b16 a[206:207], v5 offset:30976
    v_mfma_f32_16x16x32_bf16 v[144:147], a[208:211], v[40:43], v[144:147]
    v_exp_f32 v37, v37
    v_cvt_pk_bf16_f32 v50, v0, v36
    v_fma_f32 v0, v77, s35, v25
    v_mfma_f32_16x16x32_bf16 v[148:151], a[208:211], v[44:47], v[148:151]
    ds_read_b64_tr_b16 a[208:209], v6 offset:24832
    ds_read_b64_tr_b16 a[210:211], v6 offset:30976
    v_fma_f32 v36, v78, s35, v25
    v_mfma_f32_16x16x32_bf16 v[152:155], a[212:215], v[40:43], v[152:155]
    s_waitcnt lgkmcnt(4)
    v_exp_f32 v38, v38
    v_mfma_f32_16x16x32_bf16 v[156:159], a[212:215], v[44:47], v[156:159]
    ds_read_b64_tr_b16 a[212:213], v7 offset:24832
    ds_read_b64_tr_b16 a[214:215], v7 offset:30976
    v_exp_f32 v39, v39
    v_mfma_f32_16x16x32_bf16 v[160:163], a[192:195], v[40:43], v[160:163]
    v_exp_f32 v0, v0
    v_cvt_pk_bf16_f32 v51, v37, v38
    v_mfma_f32_16x16x32_bf16 v[164:167], a[192:195], v[44:47], v[164:167]
    ds_read_b64_tr_b16 a[192:193], v4 offset:36864
    ds_read_b64_tr_b16 a[194:195], v4 offset:43008
    v_fma_f32 v37, v79, s35, v25
    v_cvt_pk_bf16_f32 v54, v39, v0
    v_mfma_f32_16x16x32_bf16 v[168:171], a[196:199], v[40:43], v[168:171]
    v_exp_f32 v36, v36
    v_exp_f32 v37, v37
    v_mfma_f32_16x16x32_bf16 v[172:175], a[196:199], v[44:47], v[172:175]
    ds_read_b64_tr_b16 a[196:197], v5 offset:36864
    ds_read_b64_tr_b16 a[198:199], v5 offset:43008
    v_mfma_f32_16x16x32_bf16 v[176:179], a[200:203], v[40:43], v[176:179]
    s_waitcnt lgkmcnt(4)
    v_cvt_pk_bf16_f32 v55, v36, v37
    v_mfma_f32_16x16x32_bf16 v[180:183], a[200:203], v[44:47], v[180:183]
    ds_read_b64_tr_b16 a[200:201], v6 offset:36864
    ds_read_b64_tr_b16 a[202:203], v6 offset:43008
    v_mfma_f32_16x16x32_bf16 v[28:31], a[248:251], v[48:51], 0
    v_mfma_f32_16x16x32_bf16 v[28:31], a[252:255], v[52:55], v[28:31]
    v_mfma_f32_16x16x32_bf16 v[184:187], a[204:207], v[40:43], v[184:187]
    v_mfma_f32_16x16x32_bf16 v[188:191], a[204:207], v[44:47], v[188:191]
    ds_read_b64_tr_b16 a[204:205], v7 offset:36864
    ds_read_b64_tr_b16 a[206:207], v7 offset:43008
    v_mfma_f32_16x16x32_bf16 v[192:195], a[208:211], v[40:43], v[192:195]
    v_mfma_f32_16x16x32_bf16 v[196:199], a[208:211], v[44:47], v[196:199]
    ds_read_b64_tr_b16 a[208:209], v4 offset:36992
    ds_read_b64_tr_b16 a[210:211], v4 offset:43136
    v_cmp_nge_f32 vcc, s37, v30
    v_mfma_f32_16x16x32_bf16 v[200:203], a[212:215], v[40:43], v[200:203]
    s_waitcnt lgkmcnt(4)
    v_mfma_f32_16x16x32_bf16 v[204:207], a[212:215], v[44:47], v[204:207]
    ds_read_b64_tr_b16 a[212:213], v5 offset:36992
    ds_read_b64_tr_b16 a[214:215], v5 offset:43136
    s_cbranch_vccnz L_tr_F15_A
L_ret_F15_A:
    v_mfma_f32_16x16x32_bf16 v[112:115], a[192:195], v[48:51], v[112:115]
    v_add_f32 v17, v17, v28
    v_add_f32 v19, v19, v29
    v_mfma_f32_16x16x32_bf16 v[116:119], a[192:195], v[52:55], v[116:119]
    ds_read_b64_tr_b16 a[192:193], v6 offset:36992
    ds_read_b64_tr_b16 a[194:195], v6 offset:43136
    v_mfma_f32_16x16x32_bf16 v[120:123], a[196:199], v[48:51], v[120:123]
    v_mfma_f32_16x16x32_bf16 v[124:127], a[196:199], v[52:55], v[124:127]
    ds_read_b64_tr_b16 a[196:197], v7 offset:36992
    ds_read_b64_tr_b16 a[198:199], v7 offset:43136
    v_permlane32_swap_b32 v17, v19
    v_mfma_f32_16x16x32_bf16 v[128:131], a[200:203], v[48:51], v[128:131]
    s_waitcnt lgkmcnt(4)
    v_add_f32 v17, v17, v19
    v_mov_b32 v19, v17
    v_mfma_f32_16x16x32_bf16 v[132:135], a[200:203], v[52:55], v[132:135]
    ds_read_b64_tr_b16 a[200:201], v4 offset:37120
    ds_read_b64_tr_b16 a[202:203], v4 offset:43264
    v_permlane16_swap_b32 v17, v19
    v_mfma_f32_16x16x32_bf16 v[136:139], a[204:207], v[48:51], v[136:139]
    v_add_f32 v17, v17, v19
    v_rcp_f32 v16, v17
    v_mfma_f32_16x16x32_bf16 v[140:143], a[204:207], v[52:55], v[140:143]
    ds_read_b64_tr_b16 a[204:205], v5 offset:37120
    ds_read_b64_tr_b16 a[206:207], v5 offset:43264
    v_rcp_f32 v18, v17
    v_mfma_f32_16x16x32_bf16 v[144:147], a[208:211], v[48:51], v[144:147]
    s_nop 0
    v_permlane32_swap_b32 v16, v18
    v_mfma_f32_16x16x32_bf16 v[148:151], a[208:211], v[52:55], v[148:151]
    ds_read_b64_tr_b16 a[208:209], v6 offset:37120
    ds_read_b64_tr_b16 a[210:211], v6 offset:43264
    v_pk_mul_f32 v[112:113], v[112:113], v[16:17] op_sel_hi:[1,0]
    v_pk_mul_f32 v[114:115], v[114:115], v[16:17] op_sel_hi:[1,0]
    v_pk_mul_f32 v[120:121], v[120:121], v[16:17] op_sel_hi:[1,0]
    v_pk_mul_f32 v[122:123], v[122:123], v[16:17] op_sel_hi:[1,0]
    v_pk_mul_f32 v[128:129], v[128:129], v[16:17] op_sel_hi:[1,0]
    v_pk_mul_f32 v[130:131], v[130:131], v[16:17] op_sel_hi:[1,0]
    v_pk_mul_f32 v[136:137], v[136:137], v[16:17] op_sel_hi:[1,0]
    v_pk_mul_f32 v[138:139], v[138:139], v[16:17] op_sel_hi:[1,0]
    v_cvt_pk_bf16_f32 v112, v112, v113
    v_mfma_f32_16x16x32_bf16 v[152:155], a[212:215], v[48:51], v[152:155]
    s_waitcnt lgkmcnt(4)
    v_cvt_pk_bf16_f32 v113, v114, v115
    v_mfma_f32_16x16x32_bf16 v[156:159], a[212:215], v[52:55], v[156:159]
    ds_read_b64_tr_b16 a[212:213], v7 offset:37120
    ds_read_b64_tr_b16 a[214:215], v7 offset:43264
    ds_write_b64 v32, v[112:113] offset:0
    v_mfma_f32_16x16x32_bf16 v[160:163], a[192:195], v[48:51], v[160:163]
    v_cvt_pk_bf16_f32 v120, v120, v121
    v_cvt_pk_bf16_f32 v121, v122, v123
    v_cvt_pk_bf16_f32 v128, v128, v129
    v_cvt_pk_bf16_f32 v129, v130, v131
    v_cvt_pk_bf16_f32 v136, v136, v137
    v_cvt_pk_bf16_f32 v137, v138, v139
    v_pk_mul_f32 v[116:117], v[116:117], v[18:19] op_sel_hi:[1,0]
    v_pk_mul_f32 v[118:119], v[118:119], v[18:19] op_sel_hi:[1,0]
    v_pk_mul_f32 v[124:125], v[124:125], v[18:19] op_sel_hi:[1,0]
    v_pk_mul_f32 v[126:127], v[126:127], v[18:19] op_sel_hi:[1,0]
    v_pk_mul_f32 v[132:133], v[132:133], v[18:19] op_sel_hi:[1,0]
    v_pk_mul_f32 v[134:135], v[134:135], v[18:19] op_sel_hi:[1,0]
    v_pk_mul_f32 v[140:141], v[140:141], v[18:19] op_sel_hi:[1,0]
    v_pk_mul_f32 v[142:143], v[142:143], v[18:19] op_sel_hi:[1,0]
    v_cvt_pk_bf16_f32 v116, v116, v117
    v_mfma_f32_16x16x32_bf16 v[164:167], a[192:195], v[52:55], v[164:167]
    ds_write_b64 v208, v[120:121] offset:0
    v_mfma_f32_16x16x32_bf16 v[168:171], a[196:199], v[48:51], v[168:171]
    ds_write_b64 v209, v[128:129] offset:0
    v_mfma_f32_16x16x32_bf16 v[172:175], a[196:199], v[52:55], v[172:175]
    ds_write_b64 v210, v[136:137] offset:0
    v_mfma_f32_16x16x32_bf16 v[176:179], a[200:203], v[48:51], v[176:179]
    v_cvt_pk_bf16_f32 v117, v118, v119
    v_cvt_pk_bf16_f32 v124, v124, v125
    v_mfma_f32_16x16x32_bf16 v[180:183], a[200:203], v[52:55], v[180:183]
    s_waitcnt lgkmcnt(4)
    ds_write_b64 v32, v[116:117] offset:6144
    v_mfma_f32_16x16x32_bf16 v[184:187], a[204:207], v[48:51], v[184:187]
    v_cvt_pk_bf16_f32 v125, v126, v127
    v_cvt_pk_bf16_f32 v132, v132, v133
    v_cvt_pk_bf16_f32 v133, v134, v135
    v_cvt_pk_bf16_f32 v140, v140, v141
    v_cvt_pk_bf16_f32 v141, v142, v143
    v_pk_mul_f32 v[144:145], v[144:145], v[16:17] op_sel_hi:[1,0]
    v_pk_mul_f32 v[146:147], v[146:147], v[16:17] op_sel_hi:[1,0]
    v_pk_mul_f32 v[152:153], v[152:153], v[16:17] op_sel_hi:[1,0]
    v_pk_mul_f32 v[154:155], v[154:155], v[16:17] op_sel_hi:[1,0]
    v_pk_mul_f32 v[160:161], v[160:161], v[16:17] op_sel_hi:[1,0]
    v_pk_mul_f32 v[162:163], v[162:163], v[16:17] op_sel_hi:[1,0]
    v_pk_mul_f32 v[168:169], v[168:169], v[16:17] op_sel_hi:[1,0]
    v_pk_mul_f32 v[170:171], v[170:171], v[16:17] op_sel_hi:[1,0]
    v_cvt_pk_bf16_f32 v144, v144, v145
    v_mfma_f32_16x16x32_bf16 v[188:191], a[204:207], v[52:55], v[188:191]
    ds_write_b64 v208, v[124:125] offset:6144
    v_mfma_f32_16x16x32_bf16 v[192:195], a[208:211], v[48:51], v[192:195]
    ds_write_b64 v209, v[132:133] offset:6144
    v_mfma_f32_16x16x32_bf16 v[196:199], a[208:211], v[52:55], v[196:199]
    ds_write_b64 v210, v[140:141] offset:6144
    v_mfma_f32_16x16x32_bf16 v[200:203], a[212:215], v[48:51], v[200:203]
    v_cvt_pk_bf16_f32 v145, v146, v147
    v_cvt_pk_bf16_f32 v152, v152, v153
    v_mfma_f32_16x16x32_bf16 v[204:207], a[212:215], v[52:55], v[204:207]
    ds_write_b64 v32, v[144:145] offset:128
    v_cvt_pk_bf16_f32 v153, v154, v155
    ds_write_b64 v208, v[152:153] offset:128
    v_cvt_pk_bf16_f32 v160, v160, v161
    v_cvt_pk_bf16_f32 v161, v162, v163
    ds_write_b64 v209, v[160:161] offset:128
    v_cvt_pk_bf16_f32 v168, v168, v169
    v_cvt_pk_bf16_f32 v169, v170, v171
    ds_write_b64 v210, v[168:169] offset:128
    v_pk_mul_f32 v[148:149], v[148:149], v[18:19] op_sel_hi:[1,0]
    v_pk_mul_f32 v[150:151], v[150:151], v[18:19] op_sel_hi:[1,0]
    v_pk_mul_f32 v[156:157], v[156:157], v[18:19] op_sel_hi:[1,0]
    v_pk_mul_f32 v[158:159], v[158:159], v[18:19] op_sel_hi:[1,0]
    v_pk_mul_f32 v[164:165], v[164:165], v[18:19] op_sel_hi:[1,0]
    v_pk_mul_f32 v[166:167], v[166:167], v[18:19] op_sel_hi:[1,0]
    v_pk_mul_f32 v[172:173], v[172:173], v[18:19] op_sel_hi:[1,0]
    v_pk_mul_f32 v[174:175], v[174:175], v[18:19] op_sel_hi:[1,0]
    v_pk_mul_f32 v[176:177], v[176:177], v[16:17] op_sel_hi:[1,0]
    v_pk_mul_f32 v[178:179], v[178:179], v[16:17] op_sel_hi:[1,0]
    v_pk_mul_f32 v[184:185], v[184:185], v[16:17] op_sel_hi:[1,0]
    v_pk_mul_f32 v[186:187], v[186:187], v[16:17] op_sel_hi:[1,0]
    v_pk_mul_f32 v[192:193], v[192:193], v[16:17] op_sel_hi:[1,0]
    v_pk_mul_f32 v[194:195], v[194:195], v[16:17] op_sel_hi:[1,0]
L_hop_17:
    s_cbranch_execz L_hop_end
    v_pk_mul_f32 v[200:201], v[200:201], v[16:17] op_sel_hi:[1,0]
    v_pk_mul_f32 v[202:203], v[202:203], v[16:17] op_sel_hi:[1,0]
    v_cvt_pk_bf16_f32 v176, v176, v177
    v_cvt_pk_bf16_f32 v177, v178, v179
    v_cvt_pk_bf16_f32 v184, v184, v185
    v_cvt_pk_bf16_f32 v185, v186, v187
    v_cvt_pk_bf16_f32 v192, v192, v193
    v_cvt_pk_bf16_f32 v193, v194, v195
    v_cvt_pk_bf16_f32 v200, v200, v201
    v_cvt_pk_bf16_f32 v201, v202, v203
    v_cvt_pk_bf16_f32 v148, v148, v149
    ds_write_b64 v32, v[176:177] offset:256
    v_cvt_pk_bf16_f32 v149, v150, v151
    v_cvt_pk_bf16_f32 v156, v156, v157
    v_cvt_pk_bf16_f32 v157, v158, v159
    v_cvt_pk_bf16_f32 v164, v164, v165
    ds_write_b64 v208, v[184:185] offset:256
    v_cvt_pk_bf16_f32 v165, v166, v167
    v_cvt_pk_bf16_f32 v172, v172, v173
    v_cvt_pk_bf16_f32 v173, v174, v175
    v_pk_mul_f32 v[180:181], v[180:181], v[18:19] op_sel_hi:[1,0]
    ds_write_b64 v209, v[192:193] offset:256
    v_pk_mul_f32 v[182:183], v[182:183], v[18:19] op_sel_hi:[1,0]
    v_pk_mul_f32 v[188:189], v[188:189], v[18:19] op_sel_hi:[1,0]
    v_pk_mul_f32 v[190:191], v[190:191], v[18:19] op_sel_hi:[1,0]
    v_pk_mul_f32 v[196:197], v[196:197], v[18:19] op_sel_hi:[1,0]
    ds_write_b64 v210, v[200:201] offset:256
    v_pk_mul_f32 v[198:199], v[198:199], v[18:19] op_sel_hi:[1,0]
    v_pk_mul_f32 v[204:205], v[204:205], v[18:19] op_sel_hi:[1,0]
    v_pk_mul_f32 v[206:207], v[206:207], v[18:19] op_sel_hi:[1,0]
    ds_read_b128 a[96:99], v1 offset:0
    ds_read_b128 a[100:103], v1 offset:1024
    ds_read_b128 a[104:107], v1 offset:2048
    ds_read_b128 a[108:111], v1 offset:3072
    ds_read_b128 a[112:115], v1 offset:4096
    ds_read_b128 a[116:119], v1 offset:5120
    v_cvt_pk_bf16_f32 v180, v180, v181
    ds_write_b64 v32, v[148:149] offset:6272
    v_cvt_pk_bf16_f32 v181, v182, v183
    v_cvt_pk_bf16_f32 v188, v188, v189
    ds_write_b64 v208, v[156:157] offset:6272
    v_cvt_pk_bf16_f32 v189, v190, v191
    v_cvt_pk_bf16_f32 v196, v196, v197
    ds_write_b64 v209, v[164:165] offset:6272
    v_cvt_pk_bf16_f32 v197, v198, v199
    v_cvt_pk_bf16_f32 v204, v204, v205
    ds_write_b64 v210, v[172:173] offset:6272
    v_cvt_pk_bf16_f32 v205, v206, v207
    s_waitcnt lgkmcnt(4)
    buffer_store_dwordx4 a[96:99], v11, s[24:27], s80 offen sc1
    ds_write_b64 v32, v[180:181] offset:6400
    buffer_store_dwordx4 a[100:103], v12, s[24:27], s80 offen offset:1024 sc1
    ds_write_b64 v208, v[188:189] offset:6400
    buffer_store_dwordx4 a[104:107], v13, s[24:27], s80 offen offset:2048 sc1
    ds_write_b64 v209, v[196:197] offset:6400
    buffer_store_dwordx4 a[108:111], v11, s[24:27], s81 offen sc1
    ds_write_b64 v210, v[204:205] offset:6400
    ds_read_b128 a[120:123], v1 offset:6144
    ds_read_b128 a[124:127], v1 offset:7168
    ds_read_b128 a[128:131], v1 offset:8192
    ds_read_b128 a[132:135], v1 offset:9216
    ds_read_b128 a[136:139], v1 offset:10240
    ds_read_b128 a[140:143], v1 offset:11264
    buffer_store_dwordx4 a[112:115], v12, s[24:27], s81 offen offset:1024 sc1
    buffer_store_dwordx4 a[116:119], v13, s[24:27], s81 offen offset:2048 sc1
    s_waitcnt lgkmcnt(5)
    buffer_store_dwordx4 a[120:123], v11, s[24:27], s82 offen sc1
    s_waitcnt lgkmcnt(4)
    buffer_store_dwordx4 a[124:127], v12, s[24:27], s82 offen offset:1024 sc1
    s_waitcnt lgkmcnt(3)
    buffer_store_dwordx4 a[128:131], v13, s[24:27], s82 offen offset:2048 sc1
    s_waitcnt lgkmcnt(2)
    buffer_store_dwordx4 a[132:135], v11, s[24:27], s83 offen sc1
    s_waitcnt lgkmcnt(1)
    buffer_store_dwordx4 a[136:139], v12, s[24:27], s83 offen offset:1024 sc1
    s_waitcnt lgkmcnt(0)
    buffer_store_dwordx4 a[140:143], v13, s[24:27], s83 offen offset:2048 sc1
L_end:
    s_endpgm
L_tr_P_A:
    s_call_b64 s[40:41], L_rare_A1
    s_branch L_ret_P_A
L_tr_P_B:
    s_call_b64 s[40:41], L_rare_B3
    s_branch L_ret_P_B
L_tr_T2f_A:
    s_call_b64 s[40:41], L_rare_A0
    s_branch L_ret_T2f_A
L_tr_T2f_B:
    s_call_b64 s[40:41], L_rare_B0
    s_branch L_ret_T2f_B
L_tr_T3f_A:
    s_call_b64 s[40:41], L_rare_A1
    s_branch L_ret_T3f_A
L_tr_T3f_B:
    s_call_b64 s[40:41], L_rare_B1
    s_branch L_ret_T3f_B
L_tr_T4f_A:
    s_call_b64 s[40:41], L_rare_A0
    s_branch L_ret_T4f_A
L_tr_T4f_B:
    s_call_b64 s[40:41], L_rare_B0
    s_branch L_ret_T4f_B
L_tr_T5f_A:
    s_call_b64 s[40:41], L_rare_A1
    s_branch L_ret_T5f_A
L_tr_T5f_B:
    s_call_b64 s[40:41], L_rare_B1
    s_branch L_ret_T5f_B
L_tr_T6f_A:
    s_call_b64 s[40:41], L_rare_A0
    s_branch L_ret_T6f_A
L_tr_T6f_B:
    s_call_b64 s[40:41], L_rare_B0
    s_branch L_ret_T6f_B
L_tr_T7f_A:
    s_call_b64 s[40:41], L_rare_A1
    s_branch L_ret_T7f_A
L_tr_T7f_B:
    s_call_b64 s[40:41], L_rare_B1
    s_branch L_ret_T7f_B
L_tr_T8f_A:
    s_call_b64 s[40:41], L_rare_A0
    s_branch L_ret_T8f_A
L_tr_T8f_B:
    s_call_b64 s[40:41], L_rare_B0
    s_branch L_ret_T8f_B
L_tr_T9f_A:
    s_call_b64 s[40:41], L_rare_A1
    s_branch L_ret_T9f_A
L_tr_T9f_B:
    s_call_b64 s[40:41], L_rare_B1
    s_branch L_ret_T9f_B
L_tr_T10_A:
    s_call_b64 s[40:41], L_rare_A0
    s_branch L_ret_T10_A
L_tr_T10_B:
    s_call_b64 s[40:41], L_rare_B0
    s_branch L_ret_T10_B
L_tr_T11_A:
    s_call_b64 s[40:41], L_rare_A1
    s_branch L_ret_T11_A
L_tr_T11_B:
    s_call_b64 s[40:41], L_rare_B1
    s_branch L_ret_T11_B
L_tr_T12_A:
    s_call_b64 s[40:41], L_rare_A0
    s_branch L_ret_T12_A
L_tr_T12_B:
    s_call_b64 s[40:41], L_rare_B0
    s_branch L_ret_T12_B
L_tr_T13_A:
    s_call_b64 s[40:41], L_rare_A1
    s_branch L_ret_T13_A
L_tr_T13_B:
    s_call_b64 s[40:41], L_rare_B1
    s_branch L_ret_T13_B
L_tr_T14_A:
    s_call_b64 s[40:41], L_rare_A0
    s_branch L_ret_T14_A
L_tr_T14_B:
    s_call_b64 s[40:41], L_rare_B0
    s_branch L_ret_T14_B
L_tr_T15_A:
    s_call_b64 s[40:41], L_rare_A1
    s_branch L_ret_T15_A
L_tr_T15_B:
    s_call_b64 s[40:41], L_rare_B1
    s_branch L_ret_T15_B
L_tr_T1_A:
    s_call_b64 s[40:41], L_rare_A1
    s_branch L_ret_T1_A
L_tr_T1_B:
    s_call_b64 s[40:41], L_rare_B1
    s_branch L_ret_T1_B
L_tr_T2_A:
    s_call_b64 s[40:41], L_rare_A0
    s_branch L_ret_T2_A
L_tr_T2_B:
    s_call_b64 s[40:41], L_rare_B0
    s_branch L_ret_T2_B
L_tr_T3_A:
    s_call_b64 s[40:41], L_rare_A1
    s_branch L_ret_T3_A
L_tr_T3_B:
    s_call_b64 s[40:41], L_rare_B1
    s_branch L_ret_T3_B
L_tr_T4_A:
    s_call_b64 s[40:41], L_rare_A0
    s_branch L_ret_T4_A
L_tr_T4_B:
    s_call_b64 s[40:41], L_rare_B0
    s_branch L_ret_T4_B
L_tr_T5_A:
    s_call_b64 s[40:41], L_rare_A1
    s_branch L_ret_T5_A
L_tr_T5_B:
    s_call_b64 s[40:41], L_rare_B1
    s_branch L_ret_T5_B
L_tr_T6_A:
    s_call_b64 s[40:41], L_rare_A0
    s_branch L_ret_T6_A
L_tr_T6_B:
    s_call_b64 s[40:41], L_rare_B0
    s_branch L_ret_T6_B
L_tr_T7_A:
    s_call_b64 s[40:41], L_rare_A1
    s_branch L_ret_T7_A
L_tr_T7_B:
    s_call_b64 s[40:41], L_rare_B1
    s_branch L_ret_T7_B
L_tr_T8_A:
    s_call_b64 s[40:41], L_rare_A0
    s_branch L_ret_T8_A
L_tr_T8_B:
    s_call_b64 s[40:41], L_rare_B0
    s_branch L_ret_T8_B
L_tr_T9_A:
    s_call_b64 s[40:41], L_rare_A1
    s_branch L_ret_T9_A
L_tr_T9_B:
    s_call_b64 s[40:41], L_rare_B1
    s_branch L_ret_T9_B
L_tr_F12_A:
    s_call_b64 s[40:41], L_rare_A0
    s_branch L_ret_F12_A
L_tr_F12_B:
    s_call_b64 s[40:41], L_rare_B0
    s_branch L_ret_F12_B
L_tr_F13_B:
    s_call_b64 s[40:41], L_rare_B3
    s_branch L_ret_F13_B
L_tr_F14_B:
    s_call_b64 s[40:41], L_rare_B0
    s_branch L_ret_F14_B
L_tr_F15_B:
    s_call_b64 s[40:41], L_rare_B3
    s_branch L_ret_F15_B
L_tr_F13_A:
    s_call_b64 s[40:41], L_rare_A1
    s_branch L_ret_F13_A
L_tr_F14_A:
    s_call_b64 s[40:41], L_rare_A0
    s_branch L_ret_F14_A
L_tr_F15_A:
    s_call_b64 s[40:41], L_rare_A1
    s_branch L_ret_F15_A
L_rare_A0:
    s_nop 15
    v_max3_f32 v33, v64, v65, v66
    v_max3_f32 v34, v72, v73, v74
    v_max3_f32 v33, v33, v67, v68
    v_max3_f32 v34, v34, v75, v76
    v_max3_f32 v33, v33, v69, v70
    v_max3_f32 v34, v34, v77, v78
    v_max_f32 v33, v33, v71
    v_max_f32 v34, v34, v79
    v_fma_f32 v33, v33, s35, v24
    v_fma_f32 v34, v34, s35, v25
    s_nop 1
    v_permlane32_swap_b32 v33, v34
    v_max_f32 v33, v33, v34
    v_mov_b32 v34, v33
    s_nop 1
    v_permlane16_swap_b32 v33, v34
    v_max_f32 v33, v33, v34
    v_max_f32 v33, 0, v33
    v_mov_b32 v34, v33
    s_nop 1
    v_permlane32_swap_b32 v33, v34
    v_sub_f32 v24, v24, v33
    v_sub_f32 v25, v25, v34
    v_exp_f32 v33, -v33
    v_exp_f32 v34, -v34
    s_nop 0
    v_mul_f32 v17, v17, v33
    v_mul_f32 v19, v19, v34
    v_mul_f32 v112, v112, v33
    v_mul_f32 v113, v113, v33
    v_mul_f32 v114, v114, v33
    v_mul_f32 v115, v115, v33
    v_mul_f32 v116, v116, v34
    v_mul_f32 v117, v117, v34
    v_mul_f32 v118, v118, v34
    v_mul_f32 v119, v119, v34
    v_mul_f32 v120, v120, v33
    v_mul_f32 v121, v121, v33
    v_mul_f32 v122, v122, v33
    v_mul_f32 v123, v123, v33
    v_mul_f32 v124, v124, v34
    v_mul_f32 v125, v125, v34
    v_mul_f32 v126, v126, v34
    v_mul_f32 v127, v127, v34
    v_mul_f32 v128, v128, v33
    v_mul_f32 v129, v129, v33
    v_mul_f32 v130, v130, v33
    v_mul_f32 v131, v131, v33
    v_mul_f32 v132, v132, v34
    v_mul_f32 v133, v133, v34
    v_mul_f32 v134, v134, v34
    v_mul_f32 v135, v135, v34
    v_mul_f32 v136, v136, v33
    v_mul_f32 v137, v137, v33
    v_mul_f32 v138, v138, v33
    v_mul_f32 v139, v139, v33
    v_mul_f32 v140, v140, v34
    v_mul_f32 v141, v141, v34
    v_mul_f32 v142, v142, v34
    v_mul_f32 v143, v143, v34
    v_mul_f32 v144, v144, v33
    v_mul_f32 v145, v145, v33
    v_mul_f32 v146, v146, v33
    v_mul_f32 v147, v147, v33
    v_mul_f32 v148, v148, v34
    v_mul_f32 v149, v149, v34
    v_mul_f32 v150, v150, v34
    v_mul_f32 v151, v151, v34
    v_mul_f32 v152, v152, v33
    v_mul_f32 v153, v153, v33
    v_mul_f32 v154, v154, v33
    v_mul_f32 v155, v155, v33
    v_mul_f32 v156, v156, v34
    v_mul_f32 v157, v157, v34
    v_mul_f32 v158, v158, v34
    v_mul_f32 v159, v159, v34
    v_mul_f32 v160, v160, v33
    v_mul_f32 v161, v161, v33
    v_mul_f32 v162, v162, v33
    v_mul_f32 v163, v163, v33
    v_mul_f32 v164, v164, v34
    v_mul_f32 v165, v165, v34
    v_mul_f32 v166, v166, v34
    v_mul_f32 v167, v167, v34
    v_mul_f32 v168, v168, v33
    v_mul_f32 v169, v169, v33
    v_mul_f32 v170, v170, v33
    v_mul_f32 v171, v171, v33
    v_mul_f32 v172, v172, v34
    v_mul_f32 v173, v173, v34
    v_mul_f32 v174, v174, v34
    v_mul_f32 v175, v175, v34
    v_mul_f32 v176, v176, v33
    v_mul_f32 v177, v177, v33
    v_mul_f32 v178, v178, v33
    v_mul_f32 v179, v179, v33
    v_mul_f32 v180, v180, v34
    v_mul_f32 v181, v181, v34
    v_mul_f32 v182, v182, v34
    v_mul_f32 v183, v183, v34
    v_mul_f32 v184, v184, v33
    v_mul_f32 v185, v185, v33
    v_mul_f32 v186, v186, v33
    v_mul_f32 v187, v187, v33
    v_mul_f32 v188, v188, v34
    v_mul_f32 v189, v189, v34
    v_mul_f32 v190, v190, v34
    v_mul_f32 v191, v191, v34
    v_mul_f32 v192, v192, v33
    v_mul_f32 v193, v193, v33
    v_mul_f32 v194, v194, v33
    v_mul_f32 v195, v195, v33
    v_mul_f32 v196, v196, v34
    v_mul_f32 v197, v197, v34
    v_mul_f32 v198, v198, v34
    v_mul_f32 v199, v199, v34
    v_mul_f32 v200, v200, v33
    v_mul_f32 v201, v201, v33
    v_mul_f32 v202, v202, v33
    v_mul_f32 v203, v203, v33
    v_mul_f32 v204, v204, v34
    v_mul_f32 v205, v205, v34
    v_mul_f32 v206, v206, v34
    v_mul_f32 v207, v207, v34
    v_fma_f32 v64, v64, s35, v24
    v_fma_f32 v65, v65, s35, v24
    v_fma_f32 v66, v66, s35, v24
    v_fma_f32 v67, v67, s35, v24
    v_fma_f32 v68, v68, s35, v24
    v_fma_f32 v69, v69, s35, v24
    v_fma_f32 v70, v70, s35, v24
    v_fma_f32 v71, v71, s35, v24
    v_fma_f32 v72, v72, s35, v25
    v_fma_f32 v73, v73, s35, v25
    v_fma_f32 v74, v74, s35, v25
    v_fma_f32 v75, v75, s35, v25
    v_fma_f32 v76, v76, s35, v25
    v_fma_f32 v77, v77, s35, v25
    v_fma_f32 v78, v78, s35, v25
    v_fma_f32 v79, v79, s35, v25
    v_exp_f32 v64, v64
    v_exp_f32 v65, v65
    v_exp_f32 v66, v66
    v_exp_f32 v67, v67
    v_exp_f32 v68, v68
    v_exp_f32 v69, v69
    v_exp_f32 v70, v70
    v_exp_f32 v71, v71
    v_exp_f32 v72, v72
    v_exp_f32 v73, v73
    v_exp_f32 v74, v74
    v_exp_f32 v75, v75
    v_exp_f32 v76, v76
    v_exp_f32 v77, v77
    v_exp_f32 v78, v78
    v_exp_f32 v79, v79
    v_cvt_pk_bf16_f32 v40, v64, v65
    v_cvt_pk_bf16_f32 v41, v66, v67
    v_cvt_pk_bf16_f32 v42, v68, v69
    v_cvt_pk_bf16_f32 v43, v70, v71
    v_cvt_pk_bf16_f32 v44, v72, v73
    v_cvt_pk_bf16_f32 v45, v74, v75
    v_cvt_pk_bf16_f32 v46, v76, v77
    v_cvt_pk_bf16_f32 v47, v78, v79
    s_nop 1
    v_mfma_f32_16x16x32_bf16 v[28:31], a[248:251], v[40:43], 0
    v_mfma_f32_16x16x32_bf16 v[28:31], a[252:255], v[44:47], v[28:31]
    s_nop 15
    s_setpc_b64 s[40:41]
L_rare_A1:
    s_nop 15
    v_max3_f32 v33, v64, v65, v66
    v_max3_f32 v34, v72, v73, v74
    v_max3_f32 v33, v33, v67, v68
    v_max3_f32 v34, v34, v75, v76
    v_max3_f32 v33, v33, v69, v70
    v_max3_f32 v34, v34, v77, v78
    v_max_f32 v33, v33, v71
    v_max_f32 v34, v34, v79
    v_fma_f32 v33, v33, s35, v24
    v_fma_f32 v34, v34, s35, v25
    s_nop 1
    v_permlane32_swap_b32 v33, v34
    v_max_f32 v33, v33, v34
    v_mov_b32 v34, v33
    s_nop 1
    v_permlane16_swap_b32 v33, v34
    v_max_f32 v33, v33, v34
    v_max_f32 v33, 0, v33
    v_mov_b32 v34, v33
    s_nop 1
    v_permlane32_swap_b32 v33, v34
    v_sub_f32 v24, v24, v33
    v_sub_f32 v25, v25, v34
    v_exp_f32 v33, -v33
    v_exp_f32 v34, -v34
    s_nop 0
    v_mul_f32 v17, v17, v33
    v_mul_f32 v19, v19, v34
    v_mul_f32 v112, v112, v33
    v_mul_f32 v113, v113, v33
    v_mul_f32 v114, v114, v33
    v_mul_f32 v115, v115, v33
    v_mul_f32 v116, v116, v34
    v_mul_f32 v117, v117, v34
    v_mul_f32 v118, v118, v34
    v_mul_f32 v119, v119, v34
    v_mul_f32 v120, v120, v33
    v_mul_f32 v121, v121, v33
    v_mul_f32 v122, v122, v33
    v_mul_f32 v123, v123, v33
    v_mul_f32 v124, v124, v34
    v_mul_f32 v125, v125, v34
    v_mul_f32 v126, v126, v34
    v_mul_f32 v127, v127, v34
    v_mul_f32 v128, v128, v33
    v_mul_f32 v129, v129, v33
    v_mul_f32 v130, v130, v33
    v_mul_f32 v131, v131, v33
    v_mul_f32 v132, v132, v34
    v_mul_f32 v133, v133, v34
    v_mul_f32 v134, v134, v34
    v_mul_f32 v135, v135, v34
    v_mul_f32 v136, v136, v33
    v_mul_f32 v137, v137, v33
    v_mul_f32 v138, v138, v33
    v_mul_f32 v139, v139, v33
    v_mul_f32 v140, v140, v34
    v_mul_f32 v141, v141, v34
    v_mul_f32 v142, v142, v34
    v_mul_f32 v143, v143, v34
    v_mul_f32 v144, v144, v33
    v_mul_f32 v145, v145, v33
    v_mul_f32 v146, v146, v33
    v_mul_f32 v147, v147, v33
    v_mul_f32 v148, v148, v34
    v_mul_f32 v149, v149, v34
    v_mul_f32 v150, v150, v34
    v_mul_f32 v151, v151, v34
    v_mul_f32 v152, v152, v33
    v_mul_f32 v153, v153, v33
    v_mul_f32 v154, v154, v33
    v_mul_f32 v155, v155, v33
    v_mul_f32 v156, v156, v34
    v_mul_f32 v157, v157, v34
    v_mul_f32 v158, v158, v34
    v_mul_f32 v159, v159, v34
    v_mul_f32 v160, v160, v33
    v_mul_f32 v161, v161, v33
    v_mul_f32 v162, v162, v33
    v_mul_f32 v163, v163, v33
    v_mul_f32 v164, v164, v34
    v_mul_f32 v165, v165, v34
    v_mul_f32 v166, v166, v34
    v_mul_f32 v167, v167, v34
    v_mul_f32 v168, v168, v33
    v_mul_f32 v169, v169, v33
    v_mul_f32 v170, v170, v33
    v_mul_f32 v171, v171, v33
    v_mul_f32 v172, v172, v34
    v_mul_f32 v173, v173, v34
    v_mul_f32 v174, v174, v34
    v_mul_f32 v175, v175, v34
    v_mul_f32 v176, v176, v33
    v_mul_f32 v177, v177, v33
    v_mul_f32 v178, v178, v33
    v_mul_f32 v179, v179, v33
    v_mul_f32 v180, v180, v34
    v_mul_f32 v181, v181, v34
    v_mul_f32 v182, v182, v34
    v_mul_f32 v183, v183, v34
    v_mul_f32 v184, v184, v33
    v_mul_f32 v185, v185, v33
    v_mul_f32 v186, v186, v33
    v_mul_f32 v187, v187, v33
    v_mul_f32 v188, v188, v34
    v_mul_f32 v189, v189, v34
    v_mul_f32 v190, v190, v34
    v_mul_f32 v191, v191, v34
    v_mul_f32 v192, v192, v33
    v_mul_f32 v193, v193, v33
    v_mul_f32 v194, v194, v33
    v_mul_f32 v195, v195, v33
    v_mul_f32 v196, v196, v34
    v_mul_f32 v197, v197, v34
    v_mul_f32 v198, v198, v34
    v_mul_f32 v199, v199, v34
    v_mul_f32 v200, v200, v33
    v_mul_f32 v201, v201, v33
    v_mul_f32 v202, v202, v33
    v_mul_f32 v203, v203, v33
    v_mul_f32 v204, v204, v34
    v_mul_f32 v205, v205, v34
    v_mul_f32 v206, v206, v34
    v_mul_f32 v207, v207, v34
    v_fma_f32 v64, v64, s35, v24
    v_fma_f32 v65, v65, s35, v24
    v_fma_f32 v66, v66, s35, v24
    v_fma_f32 v67, v67, s35, v24
    v_fma_f32 v68, v68, s35, v24
    v_fma_f32 v69, v69, s35, v24
    v_fma_f32 v70, v70, s35, v24
    v_fma_f32 v71, v71, s35, v24
    v_fma_f32 v72, v72, s35, v25
    v_fma_f32 v73, v73, s35, v25
    v_fma_f32 v74, v74, s35, v25
    v_fma_f32 v75, v75, s35, v25
    v_fma_f32 v76, v76, s35, v25
    v_fma_f32 v77, v77, s35, v25
    v_fma_f32 v78, v78, s35, v25
    v_fma_f32 v79, v79, s35, v25
    v_exp_f32 v64, v64
    v_exp_f32 v65, v65
    v_exp_f32 v66, v66
    v_exp_f32 v67, v67
    v_exp_f32 v68, v68
    v_exp_f32 v69, v69
    v_exp_f32 v70, v70
    v_exp_f32 v71, v71
    v_exp_f32 v72, v72
    v_exp_f32 v73, v73
    v_exp_f32 v74, v74
    v_exp_f32 v75, v75
    v_exp_f32 v76, v76
    v_exp_f32 v77, v77
    v_exp_f32 v78, v78
    v_exp_f32 v79, v79
    v_cvt_pk_bf16_f32 v48, v64, v65
    v_cvt_pk_bf16_f32 v49, v66, v67
    v_cvt_pk_bf16_f32 v50, v68, v69
    v_cvt_pk_bf16_f32 v51, v70, v71
    v_cvt_pk_bf16_f32 v52, v72, v73
    v_cvt_pk_bf16_f32 v53, v74, v75
    v_cvt_pk_bf16_f32 v54, v76, v77
    v_cvt_pk_bf16_f32 v55, v78, v79
    s_nop 1
    v_mfma_f32_16x16x32_bf16 v[28:31], a[248:251], v[48:51], 0
    v_mfma_f32_16x16x32_bf16 v[28:31], a[252:255], v[52:55], v[28:31]
    s_nop 15
    s_setpc_b64 s[40:41]
L_rare_B0:
    s_nop 15
    v_max3_f32 v33, v80, v81, v82
    v_max3_f32 v34, v88, v89, v90
    v_max3_f32 v33, v33, v83, v84
    v_max3_f32 v34, v34, v91, v92
    v_max3_f32 v33, v33, v85, v86
    v_max3_f32 v34, v34, v93, v94
    v_max_f32 v33, v33, v87
    v_max_f32 v34, v34, v95
    v_fma_f32 v33, v33, s35, v26
    v_fma_f32 v34, v34, s35, v27
    s_nop 1
    v_permlane32_swap_b32 v33, v34
    v_max_f32 v33, v33, v34
    v_mov_b32 v34, v33
    s_nop 1
    v_permlane16_swap_b32 v33, v34
    v_max_f32 v33, v33, v34
    v_max_f32 v33, 0, v33
    v_mov_b32 v34, v33
    s_nop 1
    v_permlane32_swap_b32 v33, v34
    v_sub_f32 v26, v26, v33
    v_sub_f32 v27, v27, v34
    v_exp_f32 v33, -v33
    v_exp_f32 v34, -v34
    s_nop 0
    v_mul_f32 v21, v21, v33
    v_mul_f32 v23, v23, v34
    v_accvgpr_read_b32 v56, a0
    v_mul_f32 v56, v56, v33
    v_accvgpr_write_b32 a0, v56
    v_accvgpr_read_b32 v57, a1
    v_mul_f32 v57, v57, v33
    v_accvgpr_write_b32 a1, v57
    v_accvgpr_read_b32 v58, a2
    v_mul_f32 v58, v58, v33
    v_accvgpr_write_b32 a2, v58
    v_accvgpr_read_b32 v59, a3
    v_mul_f32 v59, v59, v33
    v_accvgpr_write_b32 a3, v59
    v_accvgpr_read_b32 v56, a4
    v_mul_f32 v56, v56, v34
    v_accvgpr_write_b32 a4, v56
    v_accvgpr_read_b32 v57, a5
    v_mul_f32 v57, v57, v34
    v_accvgpr_write_b32 a5, v57
    v_accvgpr_read_b32 v58, a6
    v_mul_f32 v58, v58, v34
    v_accvgpr_write_b32 a6, v58
    v_accvgpr_read_b32 v59, a7
    v_mul_f32 v59, v59, v34
    v_accvgpr_write_b32 a7, v59
    v_accvgpr_read_b32 v56, a8
    v_mul_f32 v56, v56, v33
    v_accvgpr_write_b32 a8, v56
    v_accvgpr_read_b32 v57, a9
    v_mul_f32 v57, v57, v33
    v_accvgpr_write_b32 a9, v57
    v_accvgpr_read_b32 v58, a10
    v_mul_f32 v58, v58, v33
    v_accvgpr_write_b32 a10, v58
    v_accvgpr_read_b32 v59, a11
    v_mul_f32 v59, v59, v33
    v_accvgpr_write_b32 a11, v59
    v_accvgpr_read_b32 v56, a12
    v_mul_f32 v56, v56, v34
    v_accvgpr_write_b32 a12, v56
    v_accvgpr_read_b32 v57, a13
    v_mul_f32 v57, v57, v34
    v_accvgpr_write_b32 a13, v57
    v_accvgpr_read_b32 v58, a14
    v_mul_f32 v58, v58, v34
    v_accvgpr_write_b32 a14, v58
    v_accvgpr_read_b32 v59, a15
    v_mul_f32 v59, v59, v34
    v_accvgpr_write_b32 a15, v59
    v_accvgpr_read_b32 v56, a16
    v_mul_f32 v56, v56, v33
    v_accvgpr_write_b32 a16, v56
    v_accvgpr_read_b32 v57, a17
    v_mul_f32 v57, v57, v33
    v_accvgpr_write_b32 a17, v57
    v_accvgpr_read_b32 v58, a18
    v_mul_f32 v58, v58, v33
    v_accvgpr_write_b32 a18, v58
    v_accvgpr_read_b32 v59, a19
    v_mul_f32 v59, v59, v33
    v_accvgpr_write_b32 a19, v59
    v_accvgpr_read_b32 v56, a20
    v_mul_f32 v56, v56, v34
    v_accvgpr_write_b32 a20, v56
    v_accvgpr_read_b32 v57, a21
    v_mul_f32 v57, v57, v34
    v_accvgpr_write_b32 a21, v57
    v_accvgpr_read_b32 v58, a22
    v_mul_f32 v58, v58, v34
    v_accvgpr_write_b32 a22, v58
    v_accvgpr_read_b32 v59, a23
    v_mul_f32 v59, v59, v34
    v_accvgpr_write_b32 a23, v59
    v_accvgpr_read_b32 v56, a24
    v_mul_f32 v56, v56, v33
    v_accvgpr_write_b32 a24, v56
    v_accvgpr_read_b32 v57, a25
    v_mul_f32 v57, v57, v33
    v_accvgpr_write_b32 a25, v57
    v_accvgpr_read_b32 v58, a26
    v_mul_f32 v58, v58, v33
    v_accvgpr_write_b32 a26, v58
    v_accvgpr_read_b32 v59, a27
    v_mul_f32 v59, v59, v33
    v_accvgpr_write_b32 a27, v59
    v_accvgpr_read_b32 v56, a28
    v_mul_f32 v56, v56, v34
    v_accvgpr_write_b32 a28, v56
    v_accvgpr_read_b32 v57, a29
    v_mul_f32 v57, v57, v34
    v_accvgpr_write_b32 a29, v57
    v_accvgpr_read_b32 v58, a30
    v_mul_f32 v58, v58, v34
    v_accvgpr_write_b32 a30, v58
    v_accvgpr_read_b32 v59, a31
    v_mul_f32 v59, v59, v34
    v_accvgpr_write_b32 a31, v59
    v_accvgpr_read_b32 v56, a32
    v_mul_f32 v56, v56, v33
    v_accvgpr_write_b32 a32, v56
    v_accvgpr_read_b32 v57, a33
    v_mul_f32 v57, v57, v33
    v_accvgpr_write_b32 a33, v57
    v_accvgpr_read_b32 v58, a34
    v_mul_f32 v58, v58, v33
    v_accvgpr_write_b32 a34, v58
    v_accvgpr_read_b32 v59, a35
    v_mul_f32 v59, v59, v33
    v_accvgpr_write_b32 a35, v59
    v_accvgpr_read_b32 v56, a36
    v_mul_f32 v56, v56, v34
    v_accvgpr_write_b32 a36, v56
    v_accvgpr_read_b32 v57, a37
    v_mul_f32 v57, v57, v34
    v_accvgpr_write_b32 a37, v57
    v_accvgpr_read_b32 v58, a38
    v_mul_f32 v58, v58, v34
    v_accvgpr_write_b32 a38, v58
    v_accvgpr_read_b32 v59, a39
    v_mul_f32 v59, v59, v34
    v_accvgpr_write_b32 a39, v59
    v_accvgpr_read_b32 v56, a40
    v_mul_f32 v56, v56, v33
    v_accvgpr_write_b32 a40, v56
    v_accvgpr_read_b32 v57, a41
    v_mul_f32 v57, v57, v33
    v_accvgpr_write_b32 a41, v57
    v_accvgpr_read_b32 v58, a42
    v_mul_f32 v58, v58, v33
    v_accvgpr_write_b32 a42, v58
    v_accvgpr_read_b32 v59, a43
    v_mul_f32 v59, v59, v33
    v_accvgpr_write_b32 a43, v59
    v_accvgpr_read_b32 v56, a44
    v_mul_f32 v56, v56, v34
    v_accvgpr_write_b32 a44, v56
    v_accvgpr_read_b32 v57, a45
    v_mul_f32 v57, v57, v34
    v_accvgpr_write_b32 a45, v57
    v_accvgpr_read_b32 v58, a46
    v_mul_f32 v58, v58, v34
    v_accvgpr_write_b32 a46, v58
    v_accvgpr_read_b32 v59, a47
    v_mul_f32 v59, v59, v34
    v_accvgpr_write_b32 a47, v59
    v_accvgpr_read_b32 v56, a48
    v_mul_f32 v56, v56, v33
    v_accvgpr_write_b32 a48, v56
    v_accvgpr_read_b32 v57, a49
    v_mul_f32 v57, v57, v33
    v_accvgpr_write_b32 a49, v57
    v_accvgpr_read_b32 v58, a50
    v_mul_f32 v58, v58, v33
    v_accvgpr_write_b32 a50, v58
    v_accvgpr_read_b32 v59, a51
    v_mul_f32 v59, v59, v33
    v_accvgpr_write_b32 a51, v59
    v_accvgpr_read_b32 v56, a52
    v_mul_f32 v56, v56, v34
    v_accvgpr_write_b32 a52, v56
    v_accvgpr_read_b32 v57, a53
    v_mul_f32 v57, v57, v34
    v_accvgpr_write_b32 a53, v57
    v_accvgpr_read_b32 v58, a54
    v_mul_f32 v58, v58, v34
    v_accvgpr_write_b32 a54, v58
    v_accvgpr_read_b32 v59, a55
    v_mul_f32 v59, v59, v34
    v_accvgpr_write_b32 a55, v59
    v_accvgpr_read_b32 v56, a56
    v_mul_f32 v56, v56, v33
    v_accvgpr_write_b32 a56, v56
    v_accvgpr_read_b32 v57, a57
    v_mul_f32 v57, v57, v33
    v_accvgpr_write_b32 a57, v57
    v_accvgpr_read_b32 v58, a58
    v_mul_f32 v58, v58, v33
    v_accvgpr_write_b32 a58, v58
    v_accvgpr_read_b32 v59, a59
    v_mul_f32 v59, v59, v33
    v_accvgpr_write_b32 a59, v59
    v_accvgpr_read_b32 v56, a60
    v_mul_f32 v56, v56, v34
    v_accvgpr_write_b32 a60, v56
    v_accvgpr_read_b32 v57, a61
    v_mul_f32 v57, v57, v34
    v_accvgpr_write_b32 a61, v57
    v_accvgpr_read_b32 v58, a62
    v_mul_f32 v58, v58, v34
    v_accvgpr_write_b32 a62, v58
    v_accvgpr_read_b32 v59, a63
    v_mul_f32 v59, v59, v34
    v_accvgpr_write_b32 a63, v59
    v_accvgpr_read_b32 v56, a64
    v_mul_f32 v56, v56, v33
    v_accvgpr_write_b32 a64, v56
    v_accvgpr_read_b32 v57, a65
    v_mul_f32 v57, v57, v33
    v_accvgpr_write_b32 a65, v57
    v_accvgpr_read_b32 v58, a66
    v_mul_f32 v58, v58, v33
    v_accvgpr_write_b32 a66, v58
    v_accvgpr_read_b32 v59, a67
    v_mul_f32 v59, v59, v33
    v_accvgpr_write_b32 a67, v59
    v_accvgpr_read_b32 v56, a68
    v_mul_f32 v56, v56, v34
    v_accvgpr_write_b32 a68, v56
    v_accvgpr_read_b32 v57, a69
    v_mul_f32 v57, v57, v34
    v_accvgpr_write_b32 a69, v57
    v_accvgpr_read_b32 v58, a70
    v_mul_f32 v58, v58, v34
    v_accvgpr_write_b32 a70, v58
    v_accvgpr_read_b32 v59, a71
    v_mul_f32 v59, v59, v34
    v_accvgpr_write_b32 a71, v59
    v_accvgpr_read_b32 v56, a72
    v_mul_f32 v56, v56, v33
    v_accvgpr_write_b32 a72, v56
    v_accvgpr_read_b32 v57, a73
    v_mul_f32 v57, v57, v33
    v_accvgpr_write_b32 a73, v57
    v_accvgpr_read_b32 v58, a74
    v_mul_f32 v58, v58, v33
    v_accvgpr_write_b32 a74, v58
    v_accvgpr_read_b32 v59, a75
    v_mul_f32 v59, v59, v33
    v_accvgpr_write_b32 a75, v59
    v_accvgpr_read_b32 v56, a76
    v_mul_f32 v56, v56, v34
    v_accvgpr_write_b32 a76, v56
    v_accvgpr_read_b32 v57, a77
    v_mul_f32 v57, v57, v34
    v_accvgpr_write_b32 a77, v57
    v_accvgpr_read_b32 v58, a78
    v_mul_f32 v58, v58, v34
    v_accvgpr_write_b32 a78, v58
    v_accvgpr_read_b32 v59, a79
    v_mul_f32 v59, v59, v34
    v_accvgpr_write_b32 a79, v59
    v_accvgpr_read_b32 v56, a80
    v_mul_f32 v56, v56, v33
    v_accvgpr_write_b32 a80, v56
    v_accvgpr_read_b32 v57, a81
    v_mul_f32 v57, v57, v33
    v_accvgpr_write_b32 a81, v57
    v_accvgpr_read_b32 v58, a82
    v_mul_f32 v58, v58, v33
    v_accvgpr_write_b32 a82, v58
    v_accvgpr_read_b32 v59, a83
    v_mul_f32 v59, v59, v33
    v_accvgpr_write_b32 a83, v59
    v_accvgpr_read_b32 v56, a84
    v_mul_f32 v56, v56, v34
    v_accvgpr_write_b32 a84, v56
    v_accvgpr_read_b32 v57, a85
    v_mul_f32 v57, v57, v34
    v_accvgpr_write_b32 a85, v57
    v_accvgpr_read_b32 v58, a86
    v_mul_f32 v58, v58, v34
    v_accvgpr_write_b32 a86, v58
    v_accvgpr_read_b32 v59, a87
    v_mul_f32 v59, v59, v34
    v_accvgpr_write_b32 a87, v59
    v_accvgpr_read_b32 v56, a88
    v_mul_f32 v56, v56, v33
    v_accvgpr_write_b32 a88, v56
    v_accvgpr_read_b32 v57, a89
    v_mul_f32 v57, v57, v33
    v_accvgpr_write_b32 a89, v57
    v_accvgpr_read_b32 v58, a90
    v_mul_f32 v58, v58, v33
    v_accvgpr_write_b32 a90, v58
    v_accvgpr_read_b32 v59, a91
    v_mul_f32 v59, v59, v33
    v_accvgpr_write_b32 a91, v59
    v_accvgpr_read_b32 v56, a92
    v_mul_f32 v56, v56, v34
    v_accvgpr_write_b32 a92, v56
    v_accvgpr_read_b32 v57, a93
    v_mul_f32 v57, v57, v34
    v_accvgpr_write_b32 a93, v57
    v_accvgpr_read_b32 v58, a94
    v_mul_f32 v58, v58, v34
    v_accvgpr_write_b32 a94, v58
    v_accvgpr_read_b32 v59, a95
    v_mul_f32 v59, v59, v34
    v_accvgpr_write_b32 a95, v59
    v_fma_f32 v80, v80, s35, v26
    v_fma_f32 v81, v81, s35, v26
    v_fma_f32 v82, v82, s35, v26
    v_fma_f32 v83, v83, s35, v26
    v_fma_f32 v84, v84, s35, v26
    v_fma_f32 v85, v85, s35, v26
    v_fma_f32 v86, v86, s35, v26
    v_fma_f32 v87, v87, s35, v26
    v_fma_f32 v88, v88, s35, v27
    v_fma_f32 v89, v89, s35, v27
    v_fma_f32 v90, v90, s35, v27
    v_fma_f32 v91, v91, s35, v27
    v_fma_f32 v92, v92, s35, v27
    v_fma_f32 v93, v93, s35, v27
    v_fma_f32 v94, v94, s35, v27
    v_fma_f32 v95, v95, s35, v27
    v_exp_f32 v80, v80
    v_exp_f32 v81, v81
    v_exp_f32 v82, v82
    v_exp_f32 v83, v83
    v_exp_f32 v84, v84
    v_exp_f32 v85, v85
    v_exp_f32 v86, v86
    v_exp_f32 v87, v87
    v_exp_f32 v88, v88
    v_exp_f32 v89, v89
    v_exp_f32 v90, v90
    v_exp_f32 v91, v91
    v_exp_f32 v92, v92
    v_exp_f32 v93, v93
    v_exp_f32 v94, v94
    v_exp_f32 v95, v95
    v_cvt_pk_bf16_f32 v56, v80, v81
    v_cvt_pk_bf16_f32 v57, v82, v83
    v_cvt_pk_bf16_f32 v58, v84, v85
    v_cvt_pk_bf16_f32 v59, v86, v87
    v_cvt_pk_bf16_f32 v60, v88, v89
    v_cvt_pk_bf16_f32 v61, v90, v91
    v_cvt_pk_bf16_f32 v62, v92, v93
    v_cvt_pk_bf16_f32 v63, v94, v95
    s_nop 1
    v_mfma_f32_16x16x32_bf16 v[28:31], a[248:251], v[56:59], 0
    v_mfma_f32_16x16x32_bf16 v[28:31], a[252:255], v[60:63], v[28:31]
    s_nop 15
    s_setpc_b64 s[40:41]
L_rare_B1:
    s_nop 15
    v_max3_f32 v33, v96, v97, v98
    v_max3_f32 v34, v104, v105, v106
    v_max3_f32 v33, v33, v99, v100
    v_max3_f32 v34, v34, v107, v108
    v_max3_f32 v33, v33, v101, v102
    v_max3_f32 v34, v34, v109, v110
    v_max_f32 v33, v33, v103
    v_max_f32 v34, v34, v111
    v_fma_f32 v33, v33, s35, v26
    v_fma_f32 v34, v34, s35, v27
    s_nop 1
    v_permlane32_swap_b32 v33, v34
    v_max_f32 v33, v33, v34
    v_mov_b32 v34, v33
    s_nop 1
    v_permlane16_swap_b32 v33, v34
    v_max_f32 v33, v33, v34
    v_max_f32 v33, 0, v33
    v_mov_b32 v34, v33
    s_nop 1
    v_permlane32_swap_b32 v33, v34
    v_sub_f32 v26, v26, v33
    v_sub_f32 v27, v27, v34
    v_exp_f32 v33, -v33
    v_exp_f32 v34, -v34
    s_nop 0
    v_mul_f32 v21, v21, v33
    v_mul_f32 v23, v23, v34
    v_accvgpr_read_b32 v56, a0
    v_mul_f32 v56, v56, v33
    v_accvgpr_write_b32 a0, v56
    v_accvgpr_read_b32 v57, a1
    v_mul_f32 v57, v57, v33
    v_accvgpr_write_b32 a1, v57
    v_accvgpr_read_b32 v58, a2
    v_mul_f32 v58, v58, v33
    v_accvgpr_write_b32 a2, v58
    v_accvgpr_read_b32 v59, a3
    v_mul_f32 v59, v59, v33
    v_accvgpr_write_b32 a3, v59
    v_accvgpr_read_b32 v56, a4
    v_mul_f32 v56, v56, v34
    v_accvgpr_write_b32 a4, v56
    v_accvgpr_read_b32 v57, a5
    v_mul_f32 v57, v57, v34
    v_accvgpr_write_b32 a5, v57
    v_accvgpr_read_b32 v58, a6
    v_mul_f32 v58, v58, v34
    v_accvgpr_write_b32 a6, v58
    v_accvgpr_read_b32 v59, a7
    v_mul_f32 v59, v59, v34
    v_accvgpr_write_b32 a7, v59
    v_accvgpr_read_b32 v56, a8
    v_mul_f32 v56, v56, v33
    v_accvgpr_write_b32 a8, v56
    v_accvgpr_read_b32 v57, a9
    v_mul_f32 v57, v57, v33
    v_accvgpr_write_b32 a9, v57
    v_accvgpr_read_b32 v58, a10
    v_mul_f32 v58, v58, v33
    v_accvgpr_write_b32 a10, v58
    v_accvgpr_read_b32 v59, a11
    v_mul_f32 v59, v59, v33
    v_accvgpr_write_b32 a11, v59
    v_accvgpr_read_b32 v56, a12
    v_mul_f32 v56, v56, v34
    v_accvgpr_write_b32 a12, v56
    v_accvgpr_read_b32 v57, a13
    v_mul_f32 v57, v57, v34
    v_accvgpr_write_b32 a13, v57
    v_accvgpr_read_b32 v58, a14
    v_mul_f32 v58, v58, v34
    v_accvgpr_write_b32 a14, v58
    v_accvgpr_read_b32 v59, a15
    v_mul_f32 v59, v59, v34
    v_accvgpr_write_b32 a15, v59
    v_accvgpr_read_b32 v56, a16
    v_mul_f32 v56, v56, v33
    v_accvgpr_write_b32 a16, v56
    v_accvgpr_read_b32 v57, a17
    v_mul_f32 v57, v57, v33
    v_accvgpr_write_b32 a17, v57
    v_accvgpr_read_b32 v58, a18
    v_mul_f32 v58, v58, v33
    v_accvgpr_write_b32 a18, v58
    v_accvgpr_read_b32 v59, a19
    v_mul_f32 v59, v59, v33
    v_accvgpr_write_b32 a19, v59
    v_accvgpr_read_b32 v56, a20
    v_mul_f32 v56, v56, v34
    v_accvgpr_write_b32 a20, v56
    v_accvgpr_read_b32 v57, a21
    v_mul_f32 v57, v57, v34
    v_accvgpr_write_b32 a21, v57
    v_accvgpr_read_b32 v58, a22
    v_mul_f32 v58, v58, v34
    v_accvgpr_write_b32 a22, v58
    v_accvgpr_read_b32 v59, a23
    v_mul_f32 v59, v59, v34
    v_accvgpr_write_b32 a23, v59
    v_accvgpr_read_b32 v56, a24
    v_mul_f32 v56, v56, v33
    v_accvgpr_write_b32 a24, v56
    v_accvgpr_read_b32 v57, a25
    v_mul_f32 v57, v57, v33
    v_accvgpr_write_b32 a25, v57
    v_accvgpr_read_b32 v58, a26
    v_mul_f32 v58, v58, v33
    v_accvgpr_write_b32 a26, v58
    v_accvgpr_read_b32 v59, a27
    v_mul_f32 v59, v59, v33
    v_accvgpr_write_b32 a27, v59
    v_accvgpr_read_b32 v56, a28
    v_mul_f32 v56, v56, v34
    v_accvgpr_write_b32 a28, v56
    v_accvgpr_read_b32 v57, a29
    v_mul_f32 v57, v57, v34
    v_accvgpr_write_b32 a29, v57
    v_accvgpr_read_b32 v58, a30
    v_mul_f32 v58, v58, v34
    v_accvgpr_write_b32 a30, v58
    v_accvgpr_read_b32 v59, a31
    v_mul_f32 v59, v59, v34
    v_accvgpr_write_b32 a31, v59
    v_accvgpr_read_b32 v56, a32
    v_mul_f32 v56, v56, v33
    v_accvgpr_write_b32 a32, v56
    v_accvgpr_read_b32 v57, a33
    v_mul_f32 v57, v57, v33
    v_accvgpr_write_b32 a33, v57
    v_accvgpr_read_b32 v58, a34
    v_mul_f32 v58, v58, v33
    v_accvgpr_write_b32 a34, v58
    v_accvgpr_read_b32 v59, a35
    v_mul_f32 v59, v59, v33
    v_accvgpr_write_b32 a35, v59
    v_accvgpr_read_b32 v56, a36
    v_mul_f32 v56, v56, v34
    v_accvgpr_write_b32 a36, v56
    v_accvgpr_read_b32 v57, a37
    v_mul_f32 v57, v57, v34
    v_accvgpr_write_b32 a37, v57
    v_accvgpr_read_b32 v58, a38
    v_mul_f32 v58, v58, v34
    v_accvgpr_write_b32 a38, v58
    v_accvgpr_read_b32 v59, a39
    v_mul_f32 v59, v59, v34
    v_accvgpr_write_b32 a39, v59
    v_accvgpr_read_b32 v56, a40
    v_mul_f32 v56, v56, v33
    v_accvgpr_write_b32 a40, v56
    v_accvgpr_read_b32 v57, a41
    v_mul_f32 v57, v57, v33
    v_accvgpr_write_b32 a41, v57
    v_accvgpr_read_b32 v58, a42
    v_mul_f32 v58, v58, v33
    v_accvgpr_write_b32 a42, v58
    v_accvgpr_read_b32 v59, a43
    v_mul_f32 v59, v59, v33
    v_accvgpr_write_b32 a43, v59
    v_accvgpr_read_b32 v56, a44
    v_mul_f32 v56, v56, v34
    v_accvgpr_write_b32 a44, v56
    v_accvgpr_read_b32 v57, a45
    v_mul_f32 v57, v57, v34
    v_accvgpr_write_b32 a45, v57
    v_accvgpr_read_b32 v58, a46
    v_mul_f32 v58, v58, v34
    v_accvgpr_write_b32 a46, v58
    v_accvgpr_read_b32 v59, a47
    v_mul_f32 v59, v59, v34
    v_accvgpr_write_b32 a47, v59
    v_accvgpr_read_b32 v56, a48
    v_mul_f32 v56, v56, v33
    v_accvgpr_write_b32 a48, v56
    v_accvgpr_read_b32 v57, a49
    v_mul_f32 v57, v57, v33
    v_accvgpr_write_b32 a49, v57
    v_accvgpr_read_b32 v58, a50
    v_mul_f32 v58, v58, v33
    v_accvgpr_write_b32 a50, v58
    v_accvgpr_read_b32 v59, a51
    v_mul_f32 v59, v59, v33
    v_accvgpr_write_b32 a51, v59
    v_accvgpr_read_b32 v56, a52
    v_mul_f32 v56, v56, v34
    v_accvgpr_write_b32 a52, v56
    v_accvgpr_read_b32 v57, a53
    v_mul_f32 v57, v57, v34
    v_accvgpr_write_b32 a53, v57
    v_accvgpr_read_b32 v58, a54
    v_mul_f32 v58, v58, v34
    v_accvgpr_write_b32 a54, v58
    v_accvgpr_read_b32 v59, a55
    v_mul_f32 v59, v59, v34
    v_accvgpr_write_b32 a55, v59
    v_accvgpr_read_b32 v56, a56
    v_mul_f32 v56, v56, v33
    v_accvgpr_write_b32 a56, v56
    v_accvgpr_read_b32 v57, a57
    v_mul_f32 v57, v57, v33
    v_accvgpr_write_b32 a57, v57
    v_accvgpr_read_b32 v58, a58
    v_mul_f32 v58, v58, v33
    v_accvgpr_write_b32 a58, v58
    v_accvgpr_read_b32 v59, a59
    v_mul_f32 v59, v59, v33
    v_accvgpr_write_b32 a59, v59
    v_accvgpr_read_b32 v56, a60
    v_mul_f32 v56, v56, v34
    v_accvgpr_write_b32 a60, v56
    v_accvgpr_read_b32 v57, a61
    v_mul_f32 v57, v57, v34
    v_accvgpr_write_b32 a61, v57
    v_accvgpr_read_b32 v58, a62
    v_mul_f32 v58, v58, v34
    v_accvgpr_write_b32 a62, v58
    v_accvgpr_read_b32 v59, a63
    v_mul_f32 v59, v59, v34
    v_accvgpr_write_b32 a63, v59
    v_accvgpr_read_b32 v56, a64
    v_mul_f32 v56, v56, v33
    v_accvgpr_write_b32 a64, v56
    v_accvgpr_read_b32 v57, a65
    v_mul_f32 v57, v57, v33
    v_accvgpr_write_b32 a65, v57
    v_accvgpr_read_b32 v58, a66
    v_mul_f32 v58, v58, v33
    v_accvgpr_write_b32 a66, v58
    v_accvgpr_read_b32 v59, a67
    v_mul_f32 v59, v59, v33
    v_accvgpr_write_b32 a67, v59
    v_accvgpr_read_b32 v56, a68
    v_mul_f32 v56, v56, v34
    v_accvgpr_write_b32 a68, v56
    v_accvgpr_read_b32 v57, a69
    v_mul_f32 v57, v57, v34
    v_accvgpr_write_b32 a69, v57
    v_accvgpr_read_b32 v58, a70
    v_mul_f32 v58, v58, v34
    v_accvgpr_write_b32 a70, v58
    v_accvgpr_read_b32 v59, a71
    v_mul_f32 v59, v59, v34
    v_accvgpr_write_b32 a71, v59
    v_accvgpr_read_b32 v56, a72
    v_mul_f32 v56, v56, v33
    v_accvgpr_write_b32 a72, v56
    v_accvgpr_read_b32 v57, a73
    v_mul_f32 v57, v57, v33
    v_accvgpr_write_b32 a73, v57
    v_accvgpr_read_b32 v58, a74
    v_mul_f32 v58, v58, v33
    v_accvgpr_write_b32 a74, v58
    v_accvgpr_read_b32 v59, a75
    v_mul_f32 v59, v59, v33
    v_accvgpr_write_b32 a75, v59
    v_accvgpr_read_b32 v56, a76
    v_mul_f32 v56, v56, v34
    v_accvgpr_write_b32 a76, v56
    v_accvgpr_read_b32 v57, a77
    v_mul_f32 v57, v57, v34
    v_accvgpr_write_b32 a77, v57
    v_accvgpr_read_b32 v58, a78
    v_mul_f32 v58, v58, v34
    v_accvgpr_write_b32 a78, v58
    v_accvgpr_read_b32 v59, a79
    v_mul_f32 v59, v59, v34
    v_accvgpr_write_b32 a79, v59
    v_accvgpr_read_b32 v56, a80
    v_mul_f32 v56, v56, v33
    v_accvgpr_write_b32 a80, v56
    v_accvgpr_read_b32 v57, a81
    v_mul_f32 v57, v57, v33
    v_accvgpr_write_b32 a81, v57
    v_accvgpr_read_b32 v58, a82
    v_mul_f32 v58, v58, v33
    v_accvgpr_write_b32 a82, v58
    v_accvgpr_read_b32 v59, a83
    v_mul_f32 v59, v59, v33
    v_accvgpr_write_b32 a83, v59
    v_accvgpr_read_b32 v56, a84
    v_mul_f32 v56, v56, v34
    v_accvgpr_write_b32 a84, v56
    v_accvgpr_read_b32 v57, a85
    v_mul_f32 v57, v57, v34
    v_accvgpr_write_b32 a85, v57
    v_accvgpr_read_b32 v58, a86
    v_mul_f32 v58, v58, v34
    v_accvgpr_write_b32 a86, v58
    v_accvgpr_read_b32 v59, a87
    v_mul_f32 v59, v59, v34
    v_accvgpr_write_b32 a87, v59
    v_accvgpr_read_b32 v56, a88
    v_mul_f32 v56, v56, v33
    v_accvgpr_write_b32 a88, v56
    v_accvgpr_read_b32 v57, a89
    v_mul_f32 v57, v57, v33
    v_accvgpr_write_b32 a89, v57
    v_accvgpr_read_b32 v58, a90
    v_mul_f32 v58, v58, v33
    v_accvgpr_write_b32 a90, v58
    v_accvgpr_read_b32 v59, a91
    v_mul_f32 v59, v59, v33
    v_accvgpr_write_b32 a91, v59
    v_accvgpr_read_b32 v56, a92
    v_mul_f32 v56, v56, v34
    v_accvgpr_write_b32 a92, v56
    v_accvgpr_read_b32 v57, a93
    v_mul_f32 v57, v57, v34
    v_accvgpr_write_b32 a93, v57
    v_accvgpr_read_b32 v58, a94
    v_mul_f32 v58, v58, v34
    v_accvgpr_write_b32 a94, v58
    v_accvgpr_read_b32 v59, a95
    v_mul_f32 v59, v59, v34
    v_accvgpr_write_b32 a95, v59
    v_fma_f32 v96, v96, s35, v26
    v_fma_f32 v97, v97, s35, v26
    v_fma_f32 v98, v98, s35, v26
    v_fma_f32 v99, v99, s35, v26
    v_fma_f32 v100, v100, s35, v26
    v_fma_f32 v101, v101, s35, v26
    v_fma_f32 v102, v102, s35, v26
    v_fma_f32 v103, v103, s35, v26
    v_fma_f32 v104, v104, s35, v27
    v_fma_f32 v105, v105, s35, v27
    v_fma_f32 v106, v106, s35, v27
    v_fma_f32 v107, v107, s35, v27
    v_fma_f32 v108, v108, s35, v27
    v_fma_f32 v109, v109, s35, v27
    v_fma_f32 v110, v110, s35, v27
    v_fma_f32 v111, v111, s35, v27
    v_exp_f32 v96, v96
    v_exp_f32 v97, v97
    v_exp_f32 v98, v98
    v_exp_f32 v99, v99
    v_exp_f32 v100, v100
    v_exp_f32 v101, v101
    v_exp_f32 v102, v102
    v_exp_f32 v103, v103
    v_exp_f32 v104, v104
    v_exp_f32 v105, v105
    v_exp_f32 v106, v106
    v_exp_f32 v107, v107
    v_exp_f32 v108, v108
    v_exp_f32 v109, v109
    v_exp_f32 v110, v110
    v_exp_f32 v111, v111
    v_cvt_pk_bf16_f32 v56, v96, v97
    v_cvt_pk_bf16_f32 v57, v98, v99
    v_cvt_pk_bf16_f32 v58, v100, v101
    v_cvt_pk_bf16_f32 v59, v102, v103
    v_cvt_pk_bf16_f32 v60, v104, v105
    v_cvt_pk_bf16_f32 v61, v106, v107
    v_cvt_pk_bf16_f32 v62, v108, v109
    v_cvt_pk_bf16_f32 v63, v110, v111
    s_nop 1
    v_mfma_f32_16x16x32_bf16 v[28:31], a[248:251], v[56:59], 0
    v_mfma_f32_16x16x32_bf16 v[28:31], a[252:255], v[60:63], v[28:31]
    s_nop 15
    s_setpc_b64 s[40:41]
L_rare_B3:
    s_nop 15
    v_max3_f32 v33, v96, v97, v98
    v_max3_f32 v34, v104, v105, v106
    v_max3_f32 v33, v33, v99, v100
    v_max3_f32 v34, v34, v107, v108
    v_max3_f32 v33, v33, v101, v102
    v_max3_f32 v34, v34, v109, v110
    v_max_f32 v33, v33, v103
    v_max_f32 v34, v34, v111
    v_fma_f32 v33, v33, s35, v26
    v_fma_f32 v34, v34, s35, v27
    s_nop 1
    v_permlane32_swap_b32 v33, v34
    v_max_f32 v33, v33, v34
    v_mov_b32 v34, v33
    s_nop 1
    v_permlane16_swap_b32 v33, v34
    v_max_f32 v33, v33, v34
    v_max_f32 v33, 0, v33
    v_mov_b32 v34, v33
    s_nop 1
    v_permlane32_swap_b32 v33, v34
    v_sub_f32 v26, v26, v33
    v_sub_f32 v27, v27, v34
    v_exp_f32 v33, -v33
    v_exp_f32 v34, -v34
    s_nop 0
    v_mul_f32 v21, v21, v33
    v_mul_f32 v23, v23, v34
    v_accvgpr_read_b32 v48, a0
    v_mul_f32 v48, v48, v33
    v_accvgpr_write_b32 a0, v48
    v_accvgpr_read_b32 v49, a1
    v_mul_f32 v49, v49, v33
    v_accvgpr_write_b32 a1, v49
    v_accvgpr_read_b32 v50, a2
    v_mul_f32 v50, v50, v33
    v_accvgpr_write_b32 a2, v50
    v_accvgpr_read_b32 v51, a3
    v_mul_f32 v51, v51, v33
    v_accvgpr_write_b32 a3, v51
    v_accvgpr_read_b32 v48, a4
    v_mul_f32 v48, v48, v34
    v_accvgpr_write_b32 a4, v48
    v_accvgpr_read_b32 v49, a5
    v_mul_f32 v49, v49, v34
    v_accvgpr_write_b32 a5, v49
    v_accvgpr_read_b32 v50, a6
    v_mul_f32 v50, v50, v34
    v_accvgpr_write_b32 a6, v50
    v_accvgpr_read_b32 v51, a7
    v_mul_f32 v51, v51, v34
    v_accvgpr_write_b32 a7, v51
    v_accvgpr_read_b32 v48, a8
    v_mul_f32 v48, v48, v33
    v_accvgpr_write_b32 a8, v48
    v_accvgpr_read_b32 v49, a9
    v_mul_f32 v49, v49, v33
    v_accvgpr_write_b32 a9, v49
    v_accvgpr_read_b32 v50, a10
    v_mul_f32 v50, v50, v33
    v_accvgpr_write_b32 a10, v50
    v_accvgpr_read_b32 v51, a11
    v_mul_f32 v51, v51, v33
    v_accvgpr_write_b32 a11, v51
    v_accvgpr_read_b32 v48, a12
    v_mul_f32 v48, v48, v34
    v_accvgpr_write_b32 a12, v48
    v_accvgpr_read_b32 v49, a13
    v_mul_f32 v49, v49, v34
    v_accvgpr_write_b32 a13, v49
    v_accvgpr_read_b32 v50, a14
    v_mul_f32 v50, v50, v34
    v_accvgpr_write_b32 a14, v50
    v_accvgpr_read_b32 v51, a15
    v_mul_f32 v51, v51, v34
    v_accvgpr_write_b32 a15, v51
    v_accvgpr_read_b32 v48, a16
    v_mul_f32 v48, v48, v33
    v_accvgpr_write_b32 a16, v48
    v_accvgpr_read_b32 v49, a17
    v_mul_f32 v49, v49, v33
    v_accvgpr_write_b32 a17, v49
    v_accvgpr_read_b32 v50, a18
    v_mul_f32 v50, v50, v33
    v_accvgpr_write_b32 a18, v50
    v_accvgpr_read_b32 v51, a19
    v_mul_f32 v51, v51, v33
    v_accvgpr_write_b32 a19, v51
    v_accvgpr_read_b32 v48, a20
    v_mul_f32 v48, v48, v34
    v_accvgpr_write_b32 a20, v48
    v_accvgpr_read_b32 v49, a21
    v_mul_f32 v49, v49, v34
    v_accvgpr_write_b32 a21, v49
    v_accvgpr_read_b32 v50, a22
    v_mul_f32 v50, v50, v34
    v_accvgpr_write_b32 a22, v50
    v_accvgpr_read_b32 v51, a23
    v_mul_f32 v51, v51, v34
    v_accvgpr_write_b32 a23, v51
    v_accvgpr_read_b32 v48, a24
    v_mul_f32 v48, v48, v33
    v_accvgpr_write_b32 a24, v48
    v_accvgpr_read_b32 v49, a25
    v_mul_f32 v49, v49, v33
    v_accvgpr_write_b32 a25, v49
    v_accvgpr_read_b32 v50, a26
    v_mul_f32 v50, v50, v33
    v_accvgpr_write_b32 a26, v50
    v_accvgpr_read_b32 v51, a27
    v_mul_f32 v51, v51, v33
    v_accvgpr_write_b32 a27, v51
    v_accvgpr_read_b32 v48, a28
    v_mul_f32 v48, v48, v34
    v_accvgpr_write_b32 a28, v48
    v_accvgpr_read_b32 v49, a29
    v_mul_f32 v49, v49, v34
    v_accvgpr_write_b32 a29, v49
    v_accvgpr_read_b32 v50, a30
    v_mul_f32 v50, v50, v34
    v_accvgpr_write_b32 a30, v50
    v_accvgpr_read_b32 v51, a31
    v_mul_f32 v51, v51, v34
    v_accvgpr_write_b32 a31, v51
    v_accvgpr_read_b32 v48, a32
    v_mul_f32 v48, v48, v33
    v_accvgpr_write_b32 a32, v48
    v_accvgpr_read_b32 v49, a33
    v_mul_f32 v49, v49, v33
    v_accvgpr_write_b32 a33, v49
    v_accvgpr_read_b32 v50, a34
    v_mul_f32 v50, v50, v33
    v_accvgpr_write_b32 a34, v50
    v_accvgpr_read_b32 v51, a35
    v_mul_f32 v51, v51, v33
    v_accvgpr_write_b32 a35, v51
    v_accvgpr_read_b32 v48, a36
    v_mul_f32 v48, v48, v34
    v_accvgpr_write_b32 a36, v48
    v_accvgpr_read_b32 v49, a37
    v_mul_f32 v49, v49, v34
    v_accvgpr_write_b32 a37, v49
    v_accvgpr_read_b32 v50, a38
    v_mul_f32 v50, v50, v34
    v_accvgpr_write_b32 a38, v50
    v_accvgpr_read_b32 v51, a39
    v_mul_f32 v51, v51, v34
    v_accvgpr_write_b32 a39, v51
    v_accvgpr_read_b32 v48, a40
    v_mul_f32 v48, v48, v33
    v_accvgpr_write_b32 a40, v48
    v_accvgpr_read_b32 v49, a41
    v_mul_f32 v49, v49, v33
    v_accvgpr_write_b32 a41, v49
    v_accvgpr_read_b32 v50, a42
    v_mul_f32 v50, v50, v33
    v_accvgpr_write_b32 a42, v50
    v_accvgpr_read_b32 v51, a43
    v_mul_f32 v51, v51, v33
    v_accvgpr_write_b32 a43, v51
    v_accvgpr_read_b32 v48, a44
    v_mul_f32 v48, v48, v34
    v_accvgpr_write_b32 a44, v48
    v_accvgpr_read_b32 v49, a45
    v_mul_f32 v49, v49, v34
    v_accvgpr_write_b32 a45, v49
    v_accvgpr_read_b32 v50, a46
    v_mul_f32 v50, v50, v34
    v_accvgpr_write_b32 a46, v50
    v_accvgpr_read_b32 v51, a47
    v_mul_f32 v51, v51, v34
    v_accvgpr_write_b32 a47, v51
    v_accvgpr_read_b32 v48, a48
    v_mul_f32 v48, v48, v33
    v_accvgpr_write_b32 a48, v48
    v_accvgpr_read_b32 v49, a49
    v_mul_f32 v49, v49, v33
    v_accvgpr_write_b32 a49, v49
    v_accvgpr_read_b32 v50, a50
    v_mul_f32 v50, v50, v33
    v_accvgpr_write_b32 a50, v50
    v_accvgpr_read_b32 v51, a51
    v_mul_f32 v51, v51, v33
    v_accvgpr_write_b32 a51, v51
    v_accvgpr_read_b32 v48, a52
    v_mul_f32 v48, v48, v34
    v_accvgpr_write_b32 a52, v48
    v_accvgpr_read_b32 v49, a53
    v_mul_f32 v49, v49, v34
    v_accvgpr_write_b32 a53, v49
    v_accvgpr_read_b32 v50, a54
    v_mul_f32 v50, v50, v34
    v_accvgpr_write_b32 a54, v50
    v_accvgpr_read_b32 v51, a55
    v_mul_f32 v51, v51, v34
    v_accvgpr_write_b32 a55, v51
    v_accvgpr_read_b32 v48, a56
    v_mul_f32 v48, v48, v33
    v_accvgpr_write_b32 a56, v48
    v_accvgpr_read_b32 v49, a57
    v_mul_f32 v49, v49, v33
    v_accvgpr_write_b32 a57, v49
    v_accvgpr_read_b32 v50, a58
    v_mul_f32 v50, v50, v33
    v_accvgpr_write_b32 a58, v50
    v_accvgpr_read_b32 v51, a59
    v_mul_f32 v51, v51, v33
    v_accvgpr_write_b32 a59, v51
    v_accvgpr_read_b32 v48, a60
    v_mul_f32 v48, v48, v34
    v_accvgpr_write_b32 a60, v48
    v_accvgpr_read_b32 v49, a61
    v_mul_f32 v49, v49, v34
    v_accvgpr_write_b32 a61, v49
    v_accvgpr_read_b32 v50, a62
    v_mul_f32 v50, v50, v34
    v_accvgpr_write_b32 a62, v50
    v_accvgpr_read_b32 v51, a63
    v_mul_f32 v51, v51, v34
    v_accvgpr_write_b32 a63, v51
    v_accvgpr_read_b32 v48, a64
    v_mul_f32 v48, v48, v33
    v_accvgpr_write_b32 a64, v48
    v_accvgpr_read_b32 v49, a65
    v_mul_f32 v49, v49, v33
    v_accvgpr_write_b32 a65, v49
    v_accvgpr_read_b32 v50, a66
    v_mul_f32 v50, v50, v33
    v_accvgpr_write_b32 a66, v50
    v_accvgpr_read_b32 v51, a67
    v_mul_f32 v51, v51, v33
    v_accvgpr_write_b32 a67, v51
    v_accvgpr_read_b32 v48, a68
    v_mul_f32 v48, v48, v34
    v_accvgpr_write_b32 a68, v48
    v_accvgpr_read_b32 v49, a69
    v_mul_f32 v49, v49, v34
    v_accvgpr_write_b32 a69, v49
    v_accvgpr_read_b32 v50, a70
    v_mul_f32 v50, v50, v34
    v_accvgpr_write_b32 a70, v50
    v_accvgpr_read_b32 v51, a71
    v_mul_f32 v51, v51, v34
    v_accvgpr_write_b32 a71, v51
    v_accvgpr_read_b32 v48, a72
    v_mul_f32 v48, v48, v33
    v_accvgpr_write_b32 a72, v48
    v_accvgpr_read_b32 v49, a73
    v_mul_f32 v49, v49, v33
    v_accvgpr_write_b32 a73, v49
    v_accvgpr_read_b32 v50, a74
    v_mul_f32 v50, v50, v33
    v_accvgpr_write_b32 a74, v50
    v_accvgpr_read_b32 v51, a75
    v_mul_f32 v51, v51, v33
    v_accvgpr_write_b32 a75, v51
    v_accvgpr_read_b32 v48, a76
    v_mul_f32 v48, v48, v34
    v_accvgpr_write_b32 a76, v48
    v_accvgpr_read_b32 v49, a77
    v_mul_f32 v49, v49, v34
    v_accvgpr_write_b32 a77, v49
    v_accvgpr_read_b32 v50, a78
    v_mul_f32 v50, v50, v34
    v_accvgpr_write_b32 a78, v50
    v_accvgpr_read_b32 v51, a79
    v_mul_f32 v51, v51, v34
    v_accvgpr_write_b32 a79, v51
    v_accvgpr_read_b32 v48, a80
    v_mul_f32 v48, v48, v33
    v_accvgpr_write_b32 a80, v48
    v_accvgpr_read_b32 v49, a81
    v_mul_f32 v49, v49, v33
    v_accvgpr_write_b32 a81, v49
    v_accvgpr_read_b32 v50, a82
    v_mul_f32 v50, v50, v33
    v_accvgpr_write_b32 a82, v50
    v_accvgpr_read_b32 v51, a83
    v_mul_f32 v51, v51, v33
    v_accvgpr_write_b32 a83, v51
    v_accvgpr_read_b32 v48, a84
    v_mul_f32 v48, v48, v34
    v_accvgpr_write_b32 a84, v48
    v_accvgpr_read_b32 v49, a85
    v_mul_f32 v49, v49, v34
    v_accvgpr_write_b32 a85, v49
    v_accvgpr_read_b32 v50, a86
    v_mul_f32 v50, v50, v34
    v_accvgpr_write_b32 a86, v50
    v_accvgpr_read_b32 v51, a87
    v_mul_f32 v51, v51, v34
    v_accvgpr_write_b32 a87, v51
    v_accvgpr_read_b32 v48, a88
    v_mul_f32 v48, v48, v33
    v_accvgpr_write_b32 a88, v48
    v_accvgpr_read_b32 v49, a89
    v_mul_f32 v49, v49, v33
    v_accvgpr_write_b32 a89, v49
    v_accvgpr_read_b32 v50, a90
    v_mul_f32 v50, v50, v33
    v_accvgpr_write_b32 a90, v50
    v_accvgpr_read_b32 v51, a91
    v_mul_f32 v51, v51, v33
    v_accvgpr_write_b32 a91, v51
    v_accvgpr_read_b32 v48, a92
    v_mul_f32 v48, v48, v34
    v_accvgpr_write_b32 a92, v48
    v_accvgpr_read_b32 v49, a93
    v_mul_f32 v49, v49, v34
    v_accvgpr_write_b32 a93, v49
    v_accvgpr_read_b32 v50, a94
    v_mul_f32 v50, v50, v34
    v_accvgpr_write_b32 a94, v50
    v_accvgpr_read_b32 v51, a95
    v_mul_f32 v51, v51, v34
    v_accvgpr_write_b32 a95, v51
    v_fma_f32 v96, v96, s35, v26
    v_fma_f32 v97, v97, s35, v26
    v_fma_f32 v98, v98, s35, v26
    v_fma_f32 v99, v99, s35, v26
    v_fma_f32 v100, v100, s35, v26
    v_fma_f32 v101, v101, s35, v26
    v_fma_f32 v102, v102, s35, v26
    v_fma_f32 v103, v103, s35, v26
    v_fma_f32 v104, v104, s35, v27
    v_fma_f32 v105, v105, s35, v27
    v_fma_f32 v106, v106, s35, v27
    v_fma_f32 v107, v107, s35, v27
    v_fma_f32 v108, v108, s35, v27
    v_fma_f32 v109, v109, s35, v27
    v_fma_f32 v110, v110, s35, v27
    v_fma_f32 v111, v111, s35, v27
    v_exp_f32 v96, v96
    v_exp_f32 v97, v97
    v_exp_f32 v98, v98
    v_exp_f32 v99, v99
    v_exp_f32 v100, v100
    v_exp_f32 v101, v101
    v_exp_f32 v102, v102
    v_exp_f32 v103, v103
    v_exp_f32 v104, v104
    v_exp_f32 v105, v105
    v_exp_f32 v106, v106
    v_exp_f32 v107, v107
    v_exp_f32 v108, v108
    v_exp_f32 v109, v109
    v_exp_f32 v110, v110
    v_exp_f32 v111, v111
    v_cvt_pk_bf16_f32 v48, v96, v97
    v_cvt_pk_bf16_f32 v49, v98, v99
    v_cvt_pk_bf16_f32 v50, v100, v101
    v_cvt_pk_bf16_f32 v51, v102, v103
    v_cvt_pk_bf16_f32 v52, v104, v105
    v_cvt_pk_bf16_f32 v53, v106, v107
    v_cvt_pk_bf16_f32 v54, v108, v109
    v_cvt_pk_bf16_f32 v55, v110, v111
    s_nop 1
    v_mfma_f32_16x16x32_bf16 v[28:31], a[248:251], v[48:51], 0
    v_mfma_f32_16x16x32_bf16 v[28:31], a[252:255], v[52:55], v[28:31]
    s_nop 15
    s_setpc_b64 s[40:41]
L_code_end:
    s_endpgm
.section .rodata,"a"
.p2align 6
.amdhsa_kernel standalone__gqa_softmax__near_ridge_kernel
  .amdhsa_next_free_vgpr 512
  .amdhsa_next_free_sgpr 102
  .amdhsa_accum_offset 256
  .amdhsa_group_segment_fixed_size 0
  .amdhsa_kernarg_size 48
  .amdhsa_user_sgpr_count 2
  .amdhsa_user_sgpr_kernarg_segment_ptr 1
  .amdhsa_system_sgpr_workgroup_id_x 1
  .amdhsa_float_denorm_mode_32 3
.end_amdhsa_kernel
```
